```python
import torch

def _softmax(x, axis=-1):
    return torch.softmax(x, dim=axis)
def _gelu(x):
    return torch.nn.functional.gelu(x, approximate="tanh")
def _silu(x):
    return torch.nn.functional.silu(x)
def _sigmoid(x):
    return torch.sigmoid(x)
def _layernorm(x, axis=-1, eps=1e-5):
    m = x.mean(dim=axis, keepdim=True)
    v = x.var(dim=axis, keepdim=True, unbiased=False)
    return (x - m) / torch.sqrt(v + eps)
def _scatter_add(tgt, idx, src, axis=0):
    return tgt.clone().index_add_(axis, idx, src)
def _segment_sum(src, seg, n):
    out = torch.zeros((n,) + src.shape[1:], dtype=src.dtype)
    return out.index_add_(0, seg, src)
def _pad(x, pw):
    flat = tuple(v for pair in reversed(pw) for v in pair)
    return torch.nn.functional.pad(x, flat)

kernel_name = 'concat_heads__gqa_block_cached__mha_block_cached__near_ridge'

def setup_inputs():

    _w = (lambda a: (lambda t: t.to(torch.bfloat16) if t.is_floating_point() else t)(torch.as_tensor(a)))
    def _A_setup():
        B, Sq, D = 8, 112, 448
        Hq, Hkv, Sk, Dh = 16, 8, 512, 256
        assert Hq % Hkv == 0, (Hq, Hkv)
        return {
            "x": _w((lambda *s: torch.randn(*s, dtype=torch.bfloat16) * 0.8)(B, Sq, D)),
            "k_cache": _w((lambda *s: torch.randn(*s, dtype=torch.bfloat16) * 0.8)(B, Hkv, Sk, Dh)),
            "v_cache": _w((lambda *s: torch.randn(*s, dtype=torch.bfloat16) * 0.05)(B, Hkv, Sk, Dh)),
            "wq": _w((lambda *s: torch.randn(*s, dtype=torch.bfloat16) * 0.8)(D, Hq * Dh) * (D ** -0.5)),
            "wo": _w((lambda *s: torch.randn(*s, dtype=torch.bfloat16) * 0.05)(Hq * Dh, D) * ((Hq * Dh) ** -0.5)),
        }
    _A_in = _A_setup()

    def _B_setup():
        B, Sq, D = 8, 112, 448
        H, Sk, Dh = 16, 512, 256
        return {
            "x": _w((lambda *s: torch.randn(*s, dtype=torch.bfloat16) * 0.8)(B, Sq, D)),
            "k_cache": _w((lambda *s: torch.randn(*s, dtype=torch.bfloat16) * 0.8)(B, H, Sk, Dh)),
            "v_cache": _w((lambda *s: torch.randn(*s, dtype=torch.bfloat16) * 0.05)(B, H, Sk, Dh)),
            "wq": _w((lambda *s: torch.randn(*s, dtype=torch.bfloat16) * 0.8)(D, H * Dh) * (D ** -0.5)),
            "wo": _w((lambda *s: torch.randn(*s, dtype=torch.bfloat16) * 0.05)(H * Dh, D) * ((H * Dh) ** -0.5)),
        }
    _B_in = _B_setup()

    return {
        "A_x": _A_in["x"],
        "A_k_cache": _A_in["k_cache"],
        "A_v_cache": _A_in["v_cache"],
        "A_wq": _A_in["wq"],
        "A_wo": _A_in["wo"],
        "B_x": _B_in["x"],
        "B_k_cache": _B_in["k_cache"],
        "B_v_cache": _B_in["v_cache"],
        "B_wq": _B_in["wq"],
        "B_wo": _B_in["wo"],
    }

def reference(A_x, A_k_cache, A_v_cache, A_wq, A_wo, B_x, B_k_cache, B_v_cache, B_wq, B_wo):
    def _A_ref(x, k_cache, v_cache, wq, wo):
        B, Sq, D = x.shape
        Hq, Dh = 16, 256
        Hkv = k_cache.shape[1]
        rep = Hq // Hkv
        q = (lambda x, *d: x.permute(*d))((x @ wq).reshape(B, Sq, Hq, Dh), 0, 2, 1, 3)
        k = (lambda x, n, axis: torch.repeat_interleave(x, n, dim=axis))(k_cache, rep, axis=1)
        v = (lambda x, n, axis: torch.repeat_interleave(x, n, dim=axis))(v_cache, rep, axis=1)
        scores = torch.einsum("bhqd,bhkd->bhqk", q, k) * (Dh ** -0.5)
        p = _softmax(scores, axis=-1)
        o = torch.einsum("bhqk,bhkd->bhqd", p, v)
        return (lambda x, *d: x.permute(*d))(o, 0, 2, 1, 3).reshape(B, Sq, Hq * Dh) @ wo

    def _B_ref(x, k_cache, v_cache, wq, wo):
        B, Sq, D = x.shape
        H, Dh = 16, 256
        q = (lambda x, *d: x.permute(*d))((x @ wq).reshape(B, Sq, H, Dh), 0, 2, 1, 3)
        scores = torch.einsum("bhqd,bhkd->bhqk", q, k_cache) * (Dh ** -0.5)
        p = _softmax(scores, axis=-1)
        o = torch.einsum("bhqk,bhkd->bhqd", p, v_cache)
        return (lambda x, *d: x.permute(*d))(o, 0, 2, 1, 3).reshape(B, Sq, H * Dh) @ wo

    a = _A_ref(A_x, A_k_cache, A_v_cache, A_wq, A_wo)
    b = _B_ref(B_x, B_k_cache, B_v_cache, B_wq, B_wo)
    return torch.concatenate([a, b], axis=-1)
```

```asm
; @launch grid=(256,1,1) block=(256,1,1) lds=163840
.amdgcn_target "amdgcn-amd-amdhsa--gfx950"
.text
.globl concat_heads__gqa_block_cached__mha_block_cached__near_ridge_kernel
.p2align 8
.type concat_heads__gqa_block_cached__mha_block_cached__near_ridge_kernel,@function
concat_heads__gqa_block_cached__mha_block_cached__near_ridge_kernel:
    s_cmp_lt_u32 s2, 256
    s_cbranch_scc1 L_go
    s_endpgm
L_go:
    s_lshr_b32 s3, s2, 3
    s_lshr_b32 s80, s3, 4
    s_mul_i32 s6, s80, 40
    s_add_u32 s4, s0, s6
    s_addc_u32 s5, s1, 0
    s_load_dwordx8 s[8:15], s[4:5], 0
    s_load_dwordx2 s[16:17], s[4:5], 32
    s_load_dwordx4 s[24:27], s[0:1], 80
    s_load_dwordx2 s[28:29], s[0:1], 96
    s_getpc_b64 s[68:69]
L_pc:
    s_mov_b32 s70, L_codeend-L_pc
    s_mov_b32 s71, 0x20000
    s_lshl_b32 s83, s3, 12
    v_lshlrev_b32 v1, 4, v0
    buffer_load_dword a255, v1, s[68:71], s83 offen
    v_lshrrev_b32 v1, 6, v0
    s_and_b32 s30, s2, 7
    s_and_b32 s31, s3, 1
    v_readfirstlane_b32 s72, v1
    s_bfe_u32 s81, s3, 0x30001
    s_lshl_b32 s79, s30, 1
    s_add_u32 s79, s79, s31
    s_mov_b32 s75, 0x3db8aa3b
    s_mov_b32 s76, 1.0
    s_mov_b32 s82, 1
    s_mov_b32 s85, 0x49800000
    s_lshl_b32 s73, s72, 10
    s_lshl_b32 s74, s72, 12
    s_lshl_b32 s18, s72, 18
    s_add_u32 s19, s18, 3145984
    s_cmp_eq_u32 s72, 2
    s_cselect_b32 s19, 384, s19
    s_lshl_b32 s87, s80, 3
    s_add_u32 s87, s87, s81
    s_cmp_eq_u32 s72, 3
    s_cbranch_scc1 L_H
    v_mov_b32 v48, 0
    v_mov_b32 v49, 0
    v_mov_b32 v50, 0
    v_mov_b32 v51, 0
    v_mov_b32 v52, 0
    v_mov_b32 v53, 0
    v_mov_b32 v54, 0
    v_mov_b32 v55, 0
L_restart_F:
    v_mbcnt_lo_u32_b32 v0, -1, 0
    v_mbcnt_hi_u32_b32 v0, -1, v0
    v_and_b32 v3, 63, v0
    v_lshrrev_b32 v4, 3, v3
    v_bfe_u32 v5, v3, 1, 2
    v_bfe_u32 v6, v3, 4, 1
    v_xor_b32 v6, v5, v6
    v_and_b32 v7, 1, v3
    v_lshlrev_b32 v7, 4, v7
    v_lshl_add_u32 v8, v6, 5, v7
    v_lshl_add_u32 v8, v4, 13, v8
    s_and_b32 s83, s72, 1
    s_lshl_b32 s83, s83, 6
    s_lshl_b32 s84, s72, 16
    v_xor_b32 v9, s83, v8
    v_add_u32 v40, s84, v9
    v_mov_b32 v196, v8
    v_xor_b32 v9, 64, v8
    v_add_u32 v204, 64512, v9
    v_add_u32 v212, 129024, v8
    v_add_u32 v220, 193536, v9
    v_and_b32 v9, 7, v3
    v_lshrrev_b32 v10, 4, v3
    v_xor_b32 v9, v9, v10
    v_lshlrev_b32 v9, 4, v9
    v_mul_u32_u24 v11, 896, v4
    s_mul_i32 s83, s72, 28672
    v_add3_u32 v197, v11, v9, s83
    v_xor_b32 v9, 64, v197
    v_add_u32 v205, 6144, v9
    v_add_u32 v213, 12288, v197
    v_add_u32 v221, 18432, v9
    v_and_b32 v9, 15, v3
    v_lshrrev_b32 v11, 1, v9
    v_xor_b32 v11, v11, v10
    v_lshlrev_b32 v11, 4, v11
    v_lshl_add_u32 v11, v9, 7, v11
    v_add_u32 v198, s74, v11
    v_xor_b32 v206, 64, v198
    v_add_u32 v214, 0x20000, v198
    v_add_u32 v222, 0x20000, v206
    s_mul_i32 s83, s81, 56
    v_min_u32 v2, 55, v3
    v_add_u32 v1, s83, v2
    s_lshl_b32 s84, s72, 7
    v_lshlrev_b32 v1, 13, v1
    v_add_u32 v1, s84, v1
    s_waitcnt lgkmcnt(0)
    s_lshl_b32 s84, s79, 9
    s_add_u32 s44, s14, s84
    s_addc_u32 s45, s15, 0
    s_sub_u32 s46, 3670016, s84
    s_mov_b32 s47, 0x20000
    s_add_u32 m0, s73, 65536
    s_mov_b32 s77, 0
    buffer_load_dwordx4 v40, s[44:47], s77 offen lds
    s_add_u32 m0, s73, 69632
    s_mov_b32 s77, 262144
    buffer_load_dwordx4 v40, s[44:47], s77 offen lds
    s_add_u32 m0, s73, 73728
    s_mov_b32 s77, 524288
    buffer_load_dwordx4 v40, s[44:47], s77 offen lds
    s_add_u32 m0, s73, 77824
    s_mov_b32 s77, 786432
    buffer_load_dwordx4 v40, s[44:47], s77 offen lds
    s_mul_i32 s84, s81, 100352
    s_add_u32 s32, s8, s84
    s_addc_u32 s33, s9, 0
    s_mov_b32 s34, 100352
    s_mov_b32 s35, 0x20000
    s_add_u32 m0, s74, 49152
    s_mov_b32 s77, 0
    buffer_load_dwordx4 v197, s[32:35], s77 offen offset:0 lds
    buffer_load_dwordx4 v205, s[32:35], s77 offen offset:1024 lds
    buffer_load_dwordx4 v213, s[32:35], s77 offen offset:2048 lds
    buffer_load_dwordx4 v221, s[32:35], s77 offen offset:3072 lds
    s_add_u32 m0, s74, 0
    s_mov_b32 s77, 128
    buffer_load_dwordx4 v197, s[32:35], s77 offen offset:0 lds
    buffer_load_dwordx4 v205, s[32:35], s77 offen offset:1024 lds
    buffer_load_dwordx4 v213, s[32:35], s77 offen offset:2048 lds
    buffer_load_dwordx4 v221, s[32:35], s77 offen offset:3072 lds
    s_add_u32 m0, s73, 81920
    s_mov_b32 s77, 1048576
    buffer_load_dwordx4 v40, s[44:47], s77 offen lds
    s_add_u32 m0, s73, 86016
    s_mov_b32 s77, 1310720
    buffer_load_dwordx4 v40, s[44:47], s77 offen lds
    s_add_u32 m0, s73, 90112
    s_mov_b32 s77, 1572864
    buffer_load_dwordx4 v40, s[44:47], s77 offen lds
    s_add_u32 m0, s73, 94208
    s_mov_b32 s77, 1835008
    buffer_load_dwordx4 v40, s[44:47], s77 offen lds
    s_add_u32 m0, s74, 16384
    s_mov_b32 s77, 256
    buffer_load_dwordx4 v197, s[32:35], s77 offen offset:0 lds
    buffer_load_dwordx4 v205, s[32:35], s77 offen offset:1024 lds
    buffer_load_dwordx4 v213, s[32:35], s77 offen offset:2048 lds
    buffer_load_dwordx4 v221, s[32:35], s77 offen offset:3072 lds
    s_add_u32 m0, s74, 131072
    s_mov_b32 s77, 384
    buffer_load_dwordx4 v197, s[32:35], s77 offen offset:0 lds
    buffer_load_dwordx4 v205, s[32:35], s77 offen offset:1024 lds
    buffer_load_dwordx4 v213, s[32:35], s77 offen offset:2048 lds
    buffer_load_dwordx4 v221, s[32:35], s77 offen offset:3072 lds
    v_and_b32 v44, 15, v3
    v_lshrrev_b32 v45, 4, v3
    v_bfe_u32 v46, v3, 2, 2
    v_and_b32 v47, 3, v3
    v_lshrrev_b32 v126, 5, v3
    v_and_b32 v127, 31, v3
    v_xor_b32 v127, v127, v126
    v_lshlrev_b32 v127, 4, v127
    v_lshl_add_u32 v127, v126, 9, v127
    s_and_b32 s83, s72, 1
    s_lshl_b32 s83, s83, 7
    v_xor_b32 v127, s83, v127
    v_add_u32 v127, s74, v127
    v_xor_b32 v36, 0, v127
    v_xor_b32 v37, 32, v127
    v_xor_b32 v38, 64, v127
    v_xor_b32 v39, 96, v127
    v_bfe_u32 v127, v3, 1, 4
    v_xor_b32 v127, v127, v126
    v_lshlrev_b32 v127, 5, v127
    v_lshl_add_u32 v127, v126, 9, v127
    v_and_b32 v125, 1, v3
    v_lshl_add_u32 v127, v125, 4, v127
    v_add_u32 v127, s74, v127
    v_xor_b32 v32, 0, v127
    v_xor_b32 v33, 64, v127
    v_xor_b32 v34, 128, v127
    v_xor_b32 v35, 192, v127
    v_bfe_u32 v127, v3, 1, 2
    v_xor_b32 v127, v127, v45
    v_lshlrev_b32 v127, 5, v127
    v_lshl_add_u32 v127, v125, 4, v127
    v_lshrrev_b32 v125, 3, v3
    v_mul_u32_u24 v125, 896, v125
    v_add_u32 v127, v127, v125
    s_mul_i32 s83, s72, 7168
    v_add_u32 v41, s83, v127
    v_and_b32 v127, 1, v45
    v_lshlrev_b32 v127, 1, v127
    v_lshrrev_b32 v125, 1, v45
    v_or_b32 v127, v127, v125
    v_xor_b32 v127, v127, v44
    v_lshlrev_b32 v127, 4, v127
    v_lshl_add_u32 v127, v44, 9, v127
    v_xor_b32 v4, 0, v127
    v_add_u32 v8, 0x10000, v4
    v_xor_b32 v5, 64, v127
    v_add_u32 v9, 0x10000, v5
    v_xor_b32 v6, 128, v127
    v_add_u32 v10, 0x10000, v6
    v_xor_b32 v7, 192, v127
    v_add_u32 v11, 0x10000, v7
    v_lshl_add_u32 v127, v45, 2, v46
    v_and_b32 v125, 7, v127
    v_lshlrev_b32 v125, 5, v125
    v_lshl_add_u32 v125, v127, 9, v125
    v_lshl_add_u32 v125, v47, 3, v125
    v_add_u32 v125, 0x10000, v125
    v_xor_b32 v12, 0, v125
    v_add_u32 v20, 32768, v12
    v_xor_b32 v13, 32, v125
    v_add_u32 v21, 32768, v13
    v_xor_b32 v14, 64, v125
    v_add_u32 v22, 32768, v14
    v_xor_b32 v15, 96, v125
    v_add_u32 v23, 32768, v15
    v_xor_b32 v16, 128, v125
    v_add_u32 v24, 32768, v16
    v_xor_b32 v17, 160, v125
    v_add_u32 v25, 32768, v17
    v_xor_b32 v18, 192, v125
    v_add_u32 v26, 32768, v18
    v_xor_b32 v19, 224, v125
    v_add_u32 v27, 32768, v19
    v_bfe_u32 v125, v127, 1, 2
    v_lshlrev_b32 v125, 5, v125
    v_lshl_add_u32 v125, v127, 7, v125
    v_lshl_add_u32 v125, v47, 3, v125
    v_xor_b32 v112, 0, v125
    v_add_u32 v116, 0x10000, v112
    v_add_u32 v120, 0x20000, v112
    v_xor_b32 v113, 32, v125
    v_add_u32 v117, 0x10000, v113
    v_add_u32 v121, 0x20000, v113
    v_xor_b32 v114, 64, v125
    v_add_u32 v118, 0x10000, v114
    v_add_u32 v122, 0x20000, v114
    v_xor_b32 v115, 96, v125
    v_add_u32 v119, 0x10000, v115
    v_add_u32 v123, 0x20000, v115
    v_lshl_add_u32 v127, v45, 3, v46
    v_lshrrev_b32 v125, 1, v46
    v_and_b32 v126, 1, v45
    v_lshl_or_b32 v125, v126, 1, v125
    v_lshlrev_b32 v125, 5, v125
    v_lshl_add_u32 v125, v127, 7, v125
    v_lshl_add_u32 v125, v47, 3, v125
    v_add_u32 v125, 0x10000, v125
    v_xor_b32 v28, 0, v125
    v_xor_b32 v29, 32, v125
    v_xor_b32 v30, 64, v125
    v_xor_b32 v31, 96, v125
    v_lshlrev_b32 v42, 4, v3
    s_lshl_b32 s83, s72, 11
    v_add_u32 v42, s83, v42
    s_lshl_b32 s83, s72, 2
    s_add_u32 s83, s83, 114688
    v_mov_b32 v124, s83
    v_mov_b32 v125, 114688
    v_mov_b32 v127, 0x3f803f80
    v_accvgpr_write_b32 a224, v127
    v_accvgpr_write_b32 a225, v127
    v_accvgpr_write_b32 a226, v127
    v_accvgpr_write_b32 a227, v127
    buffer_load_dword a255, v1, s[44:47], 0 offen
    s_add_u32 m0, s73, 98304
    s_mov_b32 s77, 2097152
    buffer_load_dwordx4 v40, s[44:47], s77 offen lds
    s_add_u32 m0, s73, 102400
    s_mov_b32 s77, 2359296
    buffer_load_dwordx4 v40, s[44:47], s77 offen lds
    s_add_u32 m0, s73, 106496
    s_mov_b32 s77, 2621440
    buffer_load_dwordx4 v40, s[44:47], s77 offen lds
    s_add_u32 m0, s73, 110592
    s_mov_b32 s77, 2883584
    buffer_load_dwordx4 v40, s[44:47], s77 offen lds
    s_add_u32 m0, s74, 32768
    s_mov_b32 s77, 512
    buffer_load_dwordx4 v197, s[32:35], s77 offen offset:0 lds
    buffer_load_dwordx4 v205, s[32:35], s77 offen offset:1024 lds
    buffer_load_dwordx4 v213, s[32:35], s77 offen offset:2048 lds
    buffer_load_dwordx4 v221, s[32:35], s77 offen offset:3072 lds
    s_add_u32 m0, s74, 147456
    s_mov_b32 s77, 640
    buffer_load_dwordx4 v197, s[32:35], s77 offen offset:0 lds
    buffer_load_dwordx4 v205, s[32:35], s77 offen offset:1024 lds
    buffer_load_dwordx4 v213, s[32:35], s77 offen offset:2048 lds
    buffer_load_dwordx4 v221, s[32:35], s77 offen offset:3072 lds
    s_add_u32 m0, s73, 114688
    s_mov_b32 s77, 3145728
    buffer_load_dwordx4 v40, s[44:47], s77 offen lds
    s_add_u32 m0, s73, 118784
    s_mov_b32 s77, 3407872
    buffer_load_dwordx4 v40, s[44:47], s77 offen lds
    s_add_u32 m0, s73, 122880
    s_mov_b32 s77, 128
    buffer_load_dwordx4 v40, s[44:47], s77 offen lds
    s_add_u32 m0, s73, 126976
    s_mov_b32 s77, 262272
    buffer_load_dwordx4 v40, s[44:47], s77 offen lds
    s_lshl_b32 s83, s81, 3
    s_add_u32 s83, s83, s30
    s_lshl_b32 s84, s81, 4
    s_add_u32 s84, s84, s79
    s_cmp_eq_u32 s80, 0
    s_cselect_b32 s83, s83, s84
    s_lshl_b32 s83, s83, 18
    s_add_u32 s36, s10, s83
    s_addc_u32 s37, s11, 0
    s_mov_b32 s38, 262144
    s_mov_b32 s39, 0x20000
    s_add_u32 s40, s12, s83
    s_addc_u32 s41, s13, 0
    s_mov_b32 s42, 262144
    s_mov_b32 s43, 0x20000
    s_mul_i32 s84, s79, 229376
    s_add_u32 s48, s16, s84
    s_addc_u32 s49, s17, 0
    s_mov_b32 s50, 229376
    s_mov_b32 s51, 0x20000
    s_lshl_b32 s83, s87, 4
    s_add_u32 s84, s83, s79
    s_mul_i32 s84, s84, 100352
    s_add_u32 s84, s84, 1048576
    s_add_u32 s52, s28, s84
    s_addc_u32 s53, s29, 0
    s_mov_b32 s54, 100352
    s_mov_b32 s55, 0x20000
    s_mul_i32 s83, s83, 100352
    s_mul_i32 s84, s79, 7168
    s_add_u32 s83, s83, s84
    s_add_u32 s83, s83, 1048576
    s_add_u32 s56, s28, s83
    s_addc_u32 s57, s29, 0
    s_sub_u32 s58, 1605632, s84
    s_mov_b32 s59, 0x20000
    s_mul_i32 s83, s80, 896
    s_lshl_b32 s84, s79, 6
    s_add_u32 s84, s83, s84
    s_mul_i32 s83, s81, 200704
    s_add_u32 s83, s83, s84
    s_add_u32 s60, s24, s83
    s_addc_u32 s61, s25, 0
    s_sub_u32 s62, 200704, s84
    s_mov_b32 s63, 0x20000
    s_mov_b32 s64, s26
    s_mov_b32 s65, s27
    s_mov_b32 s66, 256
    s_mov_b32 s67, 0x20000
    s_waitcnt vmcnt(37)
    s_barrier
    s_waitcnt vmcnt(33)
    ds_read_b128 a[0:3], v198 offset:49152
    ds_read_b128 a[4:7], v198 offset:51200
    ds_read_b64_tr_b16 a[176:177], v28 offset:0
    ds_read_b64_tr_b16 a[178:179], v28 offset:512
    ds_read_b64_tr_b16 a[180:181], v29 offset:0
    ds_read_b64_tr_b16 a[182:183], v29 offset:512
    ds_read_b64_tr_b16 a[184:185], v30 offset:0
    ds_read_b64_tr_b16 a[186:187], v30 offset:512
    ds_read_b64_tr_b16 a[188:189], v31 offset:0
    ds_read_b64_tr_b16 a[190:191], v31 offset:512
    ds_read_b128 a[8:11], v206 offset:49152
    ds_read_b128 a[12:15], v206 offset:51200
    ds_read_b64_tr_b16 a[192:193], v28 offset:4096
    ds_read_b64_tr_b16 a[194:195], v28 offset:4608
    ds_read_b64_tr_b16 a[196:197], v29 offset:4096
    ds_read_b64_tr_b16 a[198:199], v29 offset:4608
    ds_read_b64_tr_b16 a[200:201], v30 offset:4096
    ds_read_b64_tr_b16 a[202:203], v30 offset:4608
    ds_read_b64_tr_b16 a[204:205], v31 offset:4096
    ds_read_b64_tr_b16 a[206:207], v31 offset:4608
    s_waitcnt lgkmcnt(10)
    v_mfma_f32_16x16x32_bf16 v[128:131], a[176:179], a[0:3], 0
    ds_read_b64_tr_b16 a[208:209], v28 offset:8192
    v_mfma_f32_16x16x32_bf16 v[132:135], a[176:179], a[4:7], 0
    ds_read_b64_tr_b16 a[210:211], v28 offset:8704
    s_waitcnt vmcnt(29)
    ds_read_b128 a[16:19], v198 offset:0
    v_mfma_f32_16x16x32_bf16 v[136:139], a[180:183], a[0:3], 0
    ds_read_b64_tr_b16 a[212:213], v29 offset:8192
    v_mfma_f32_16x16x32_bf16 v[140:143], a[180:183], a[4:7], 0
    ds_read_b64_tr_b16 a[214:215], v29 offset:8704
    ds_read_b128 a[20:23], v198 offset:2048
    v_mfma_f32_16x16x32_bf16 v[144:147], a[184:187], a[0:3], 0
    ds_read_b64_tr_b16 a[216:217], v30 offset:8192
    v_mfma_f32_16x16x32_bf16 v[148:151], a[184:187], a[4:7], 0
    ds_read_b64_tr_b16 a[218:219], v30 offset:8704
    v_mfma_f32_16x16x32_bf16 v[152:155], a[188:191], a[0:3], 0
    ds_read_b64_tr_b16 a[220:221], v31 offset:8192
    v_mfma_f32_16x16x32_bf16 v[156:159], a[188:191], a[4:7], 0
    ds_read_b64_tr_b16 a[222:223], v31 offset:8704
    s_waitcnt lgkmcnt(10)
    v_mfma_f32_16x16x32_bf16 v[128:131], a[192:195], a[8:11], v[128:131]
    ds_read_b64_tr_b16 a[176:177], v28 offset:12288
    s_add_u32 m0, s74, 49152
    s_mov_b32 s77, 768
    buffer_load_dwordx4 v197, s[32:35], s77 offen offset:0 lds
    v_mfma_f32_16x16x32_bf16 v[132:135], a[192:195], a[12:15], v[132:135]
    ds_read_b64_tr_b16 a[178:179], v28 offset:12800
    ds_read_b128 a[24:27], v206 offset:0
    v_mfma_f32_16x16x32_bf16 v[136:139], a[196:199], a[8:11], v[136:139]
    ds_read_b64_tr_b16 a[180:181], v29 offset:12288
    buffer_load_dwordx4 v205, s[32:35], s77 offen offset:1024 lds
    v_mfma_f32_16x16x32_bf16 v[140:143], a[196:199], a[12:15], v[140:143]
    ds_read_b64_tr_b16 a[182:183], v29 offset:12800
    ds_read_b128 a[28:31], v206 offset:2048
    v_mfma_f32_16x16x32_bf16 v[144:147], a[200:203], a[8:11], v[144:147]
    ds_read_b64_tr_b16 a[184:185], v30 offset:12288
    buffer_load_dwordx4 v213, s[32:35], s77 offen offset:2048 lds
    v_mfma_f32_16x16x32_bf16 v[148:151], a[200:203], a[12:15], v[148:151]
    ds_read_b64_tr_b16 a[186:187], v30 offset:12800
    buffer_load_dwordx4 v221, s[32:35], s77 offen offset:3072 lds
    v_mfma_f32_16x16x32_bf16 v[152:155], a[204:207], a[8:11], v[152:155]
    ds_read_b64_tr_b16 a[188:189], v31 offset:12288
    v_mfma_f32_16x16x32_bf16 v[156:159], a[204:207], a[12:15], v[156:159]
    ds_read_b64_tr_b16 a[190:191], v31 offset:12800
    s_waitcnt lgkmcnt(10)
    v_mfma_f32_16x16x32_bf16 v[128:131], a[208:211], a[16:19], v[128:131]
    s_waitcnt vmcnt(29) lgkmcnt(4)
    s_barrier
    ds_read_b64_tr_b16 a[192:193], v28 offset:16384
    v_mfma_f32_16x16x32_bf16 v[132:135], a[208:211], a[20:23], v[132:135]
    ds_read_b64_tr_b16 a[194:195], v28 offset:16896
    s_waitcnt vmcnt(25)
    ds_read_b128 a[32:35], v198 offset:16384
    v_mfma_f32_16x16x32_bf16 v[136:139], a[212:215], a[16:19], v[136:139]
    ds_read_b64_tr_b16 a[196:197], v29 offset:16384
    v_mfma_f32_16x16x32_bf16 v[140:143], a[212:215], a[20:23], v[140:143]
    ds_read_b64_tr_b16 a[198:199], v29 offset:16896
    ds_read_b128 a[36:39], v198 offset:18432
    v_mfma_f32_16x16x32_bf16 v[144:147], a[216:219], a[16:19], v[144:147]
    ds_read_b64_tr_b16 a[200:201], v30 offset:16384
    v_mfma_f32_16x16x32_bf16 v[148:151], a[216:219], a[20:23], v[148:151]
    ds_read_b64_tr_b16 a[202:203], v30 offset:16896
    v_mfma_f32_16x16x32_bf16 v[152:155], a[220:223], a[16:19], v[152:155]
    ds_read_b64_tr_b16 a[204:205], v31 offset:16384
    v_mfma_f32_16x16x32_bf16 v[156:159], a[220:223], a[20:23], v[156:159]
    ds_read_b64_tr_b16 a[206:207], v31 offset:16896
    s_waitcnt lgkmcnt(10)
    v_mfma_f32_16x16x32_bf16 v[128:131], a[176:179], a[24:27], v[128:131]
    ds_read_b64_tr_b16 a[208:209], v28 offset:20480
    s_add_u32 s77, s18, 524416
    v_mfma_f32_16x16x32_bf16 v[132:135], a[176:179], a[28:31], v[132:135]
    ds_read_b64_tr_b16 a[210:211], v28 offset:20992
    ds_read_b128 a[40:43], v206 offset:16384
    v_mfma_f32_16x16x32_bf16 v[136:139], a[180:183], a[24:27], v[136:139]
    ds_read_b64_tr_b16 a[212:213], v29 offset:20480
    s_add_u32 m0, s74, 65536
    s_nop 0
    buffer_load_dwordx4 v196, s[44:47], s77 offen offset:0 lds
    v_mfma_f32_16x16x32_bf16 v[140:143], a[180:183], a[28:31], v[140:143]
    ds_read_b64_tr_b16 a[214:215], v29 offset:20992
    ds_read_b128 a[44:47], v206 offset:18432
    v_mfma_f32_16x16x32_bf16 v[144:147], a[184:187], a[24:27], v[144:147]
    ds_read_b64_tr_b16 a[216:217], v30 offset:20480
    buffer_load_dwordx4 v204, s[44:47], s77 offen offset:1024 lds
    v_mfma_f32_16x16x32_bf16 v[148:151], a[184:187], a[28:31], v[148:151]
    ds_read_b64_tr_b16 a[218:219], v30 offset:20992
    buffer_load_dwordx4 v212, s[44:47], s77 offen offset:2048 lds
    v_mfma_f32_16x16x32_bf16 v[152:155], a[188:191], a[24:27], v[152:155]
    ds_read_b64_tr_b16 a[220:221], v31 offset:20480
    buffer_load_dwordx4 v220, s[44:47], s77 offen offset:3072 lds
    v_mfma_f32_16x16x32_bf16 v[156:159], a[188:191], a[28:31], v[156:159]
    ds_read_b64_tr_b16 a[222:223], v31 offset:20992
    s_waitcnt lgkmcnt(10)
    v_mfma_f32_16x16x32_bf16 v[128:131], a[192:195], a[32:35], v[128:131]
    ds_read_b64_tr_b16 a[176:177], v28 offset:24576
    v_mfma_f32_16x16x32_bf16 v[132:135], a[192:195], a[36:39], v[132:135]
    ds_read_b64_tr_b16 a[178:179], v28 offset:25088
    s_waitcnt vmcnt(25)
    ds_read_b128 a[48:51], v214 offset:0
    v_mfma_f32_16x16x32_bf16 v[136:139], a[196:199], a[32:35], v[136:139]
    ds_read_b64_tr_b16 a[180:181], v29 offset:24576
    v_mfma_f32_16x16x32_bf16 v[140:143], a[196:199], a[36:39], v[140:143]
    ds_read_b64_tr_b16 a[182:183], v29 offset:25088
    ds_read_b128 a[52:55], v214 offset:2048
    v_mfma_f32_16x16x32_bf16 v[144:147], a[200:203], a[32:35], v[144:147]
    ds_read_b64_tr_b16 a[184:185], v30 offset:24576
    v_mfma_f32_16x16x32_bf16 v[148:151], a[200:203], a[36:39], v[148:151]
    ds_read_b64_tr_b16 a[186:187], v30 offset:25088
    s_mov_b32 s77, 1310848
    v_mfma_f32_16x16x32_bf16 v[152:155], a[204:207], a[32:35], v[152:155]
    ds_read_b64_tr_b16 a[188:189], v31 offset:24576
    v_mfma_f32_16x16x32_bf16 v[156:159], a[204:207], a[36:39], v[156:159]
    ds_read_b64_tr_b16 a[190:191], v31 offset:25088
    s_add_u32 m0, s73, 77824
    s_nop 0
    buffer_load_dwordx4 v40, s[44:47], s77 offen lds
    s_waitcnt lgkmcnt(10)
    v_mfma_f32_16x16x32_bf16 v[128:131], a[208:211], a[40:43], v[128:131]
    ds_read_b64_tr_b16 a[192:193], v28 offset:28672
    v_mfma_f32_16x16x32_bf16 v[132:135], a[208:211], a[44:47], v[132:135]
    ds_read_b64_tr_b16 a[194:195], v28 offset:29184
    ds_read_b128 a[56:59], v222 offset:0
    v_mfma_f32_16x16x32_bf16 v[136:139], a[212:215], a[40:43], v[136:139]
    ds_read_b64_tr_b16 a[196:197], v29 offset:28672
    v_mfma_f32_16x16x32_bf16 v[140:143], a[212:215], a[44:47], v[140:143]
    ds_read_b64_tr_b16 a[198:199], v29 offset:29184
    ds_read_b128 a[60:63], v222 offset:2048
    s_mov_b32 m0, 77824
    v_mfma_f32_16x16x32_bf16 v[144:147], a[216:219], a[40:43], v[144:147]
    ds_read_b64_tr_b16 a[200:201], v30 offset:28672
    buffer_load_dwordx4 v220, s[44:47], s77 offen offset:3072 lds
    v_mfma_f32_16x16x32_bf16 v[148:151], a[216:219], a[44:47], v[148:151]
    ds_read_b64_tr_b16 a[202:203], v30 offset:29184
    v_mfma_f32_16x16x32_bf16 v[152:155], a[220:223], a[40:43], v[152:155]
    ds_read_b64_tr_b16 a[204:205], v31 offset:28672
    v_mfma_f32_16x16x32_bf16 v[156:159], a[220:223], a[44:47], v[156:159]
    ds_read_b64_tr_b16 a[206:207], v31 offset:29184
    s_waitcnt lgkmcnt(10)
    v_mfma_f32_16x16x32_bf16 v[128:131], a[176:179], a[48:51], v[128:131]
    s_waitcnt vmcnt(22) lgkmcnt(4)
    s_barrier
    ds_read_b64_tr_b16 a[208:209], v28 offset:32768
    v_mfma_f32_16x16x32_bf16 v[132:135], a[176:179], a[52:55], v[132:135]
    ds_read_b64_tr_b16 a[210:211], v28 offset:33280
    s_waitcnt vmcnt(18)
    ds_read_b128 a[64:67], v198 offset:32768
    v_mfma_f32_16x16x32_bf16 v[136:139], a[180:183], a[48:51], v[136:139]
    ds_read_b64_tr_b16 a[212:213], v29 offset:32768
    v_mfma_f32_16x16x32_bf16 v[140:143], a[180:183], a[52:55], v[140:143]
    ds_read_b64_tr_b16 a[214:215], v29 offset:33280
    ds_read_b128 a[68:71], v198 offset:34816
    v_mfma_f32_16x16x32_bf16 v[144:147], a[184:187], a[48:51], v[144:147]
    ds_read_b64_tr_b16 a[216:217], v30 offset:32768
    v_mfma_f32_16x16x32_bf16 v[148:151], a[184:187], a[52:55], v[148:151]
    ds_read_b64_tr_b16 a[218:219], v30 offset:33280
    v_mfma_f32_16x16x32_bf16 v[152:155], a[188:191], a[48:51], v[152:155]
    ds_read_b64_tr_b16 a[220:221], v31 offset:32768
    v_mfma_f32_16x16x32_bf16 v[156:159], a[188:191], a[52:55], v[156:159]
    ds_read_b64_tr_b16 a[222:223], v31 offset:33280
    s_waitcnt lgkmcnt(10)
    v_mfma_f32_16x16x32_bf16 v[128:131], a[192:195], a[56:59], v[128:131]
    ds_read_b64_tr_b16 a[176:177], v28 offset:36864
    s_add_u32 s77, s18, 1572992
    v_mfma_f32_16x16x32_bf16 v[132:135], a[192:195], a[60:63], v[132:135]
    ds_read_b64_tr_b16 a[178:179], v28 offset:37376
    ds_read_b128 a[72:75], v206 offset:32768
    v_mfma_f32_16x16x32_bf16 v[136:139], a[196:199], a[56:59], v[136:139]
    ds_read_b64_tr_b16 a[180:181], v29 offset:36864
    s_add_u32 m0, s74, 81920
    s_nop 0
    buffer_load_dwordx4 v196, s[44:47], s77 offen offset:0 lds
    v_mfma_f32_16x16x32_bf16 v[140:143], a[196:199], a[60:63], v[140:143]
    ds_read_b64_tr_b16 a[182:183], v29 offset:37376
    ds_read_b128 a[76:79], v206 offset:34816
    v_mfma_f32_16x16x32_bf16 v[144:147], a[200:203], a[56:59], v[144:147]
    ds_read_b64_tr_b16 a[184:185], v30 offset:36864
    buffer_load_dwordx4 v204, s[44:47], s77 offen offset:1024 lds
    v_mfma_f32_16x16x32_bf16 v[148:151], a[200:203], a[60:63], v[148:151]
    ds_read_b64_tr_b16 a[186:187], v30 offset:37376
    buffer_load_dwordx4 v212, s[44:47], s77 offen offset:2048 lds
    v_mfma_f32_16x16x32_bf16 v[152:155], a[204:207], a[56:59], v[152:155]
    ds_read_b64_tr_b16 a[188:189], v31 offset:36864
    buffer_load_dwordx4 v220, s[44:47], s77 offen offset:3072 lds
    v_mfma_f32_16x16x32_bf16 v[156:159], a[204:207], a[60:63], v[156:159]
    ds_read_b64_tr_b16 a[190:191], v31 offset:37376
    s_waitcnt lgkmcnt(10)
    v_mfma_f32_16x16x32_bf16 v[128:131], a[208:211], a[64:67], v[128:131]
    ds_read_b64_tr_b16 a[192:193], v28 offset:40960
    v_mfma_f32_16x16x32_bf16 v[132:135], a[208:211], a[68:71], v[132:135]
    ds_read_b64_tr_b16 a[194:195], v28 offset:41472
    s_waitcnt vmcnt(18)
    ds_read_b128 a[80:83], v214 offset:16384
    v_mfma_f32_16x16x32_bf16 v[136:139], a[212:215], a[64:67], v[136:139]
    ds_read_b64_tr_b16 a[196:197], v29 offset:40960
    v_mfma_f32_16x16x32_bf16 v[140:143], a[212:215], a[68:71], v[140:143]
    ds_read_b64_tr_b16 a[198:199], v29 offset:41472
    ds_read_b128 a[84:87], v214 offset:18432
    v_mfma_f32_16x16x32_bf16 v[144:147], a[216:219], a[64:67], v[144:147]
    ds_read_b64_tr_b16 a[200:201], v30 offset:40960
    v_mfma_f32_16x16x32_bf16 v[148:151], a[216:219], a[68:71], v[148:151]
    ds_read_b64_tr_b16 a[202:203], v30 offset:41472
    s_mov_b32 s77, 2359424
    v_mfma_f32_16x16x32_bf16 v[152:155], a[220:223], a[64:67], v[152:155]
    ds_read_b64_tr_b16 a[204:205], v31 offset:40960
    v_mfma_f32_16x16x32_bf16 v[156:159], a[220:223], a[68:71], v[156:159]
    ds_read_b64_tr_b16 a[206:207], v31 offset:41472
    s_add_u32 m0, s73, 94208
    s_nop 0
    buffer_load_dwordx4 v40, s[44:47], s77 offen lds
    s_waitcnt lgkmcnt(10)
    v_mfma_f32_16x16x32_bf16 v[128:131], a[176:179], a[72:75], v[128:131]
    ds_read_b64_tr_b16 a[208:209], v28 offset:45056
    v_mfma_f32_16x16x32_bf16 v[132:135], a[176:179], a[76:79], v[132:135]
    ds_read_b64_tr_b16 a[210:211], v28 offset:45568
    ds_read_b128 a[88:91], v222 offset:16384
    v_mfma_f32_16x16x32_bf16 v[136:139], a[180:183], a[72:75], v[136:139]
    ds_read_b64_tr_b16 a[212:213], v29 offset:45056
    v_mfma_f32_16x16x32_bf16 v[140:143], a[180:183], a[76:79], v[140:143]
    ds_read_b64_tr_b16 a[214:215], v29 offset:45568
    ds_read_b128 a[92:95], v222 offset:18432
    s_mov_b32 m0, 94208
    v_mfma_f32_16x16x32_bf16 v[144:147], a[184:187], a[72:75], v[144:147]
    ds_read_b64_tr_b16 a[216:217], v30 offset:45056
    buffer_load_dwordx4 v220, s[44:47], s77 offen offset:3072 lds
    v_mfma_f32_16x16x32_bf16 v[148:151], a[184:187], a[76:79], v[148:151]
    ds_read_b64_tr_b16 a[218:219], v30 offset:45568
    v_mfma_f32_16x16x32_bf16 v[152:155], a[188:191], a[72:75], v[152:155]
    ds_read_b64_tr_b16 a[220:221], v31 offset:45056
    v_mfma_f32_16x16x32_bf16 v[156:159], a[188:191], a[76:79], v[156:159]
    ds_read_b64_tr_b16 a[222:223], v31 offset:45568
    s_waitcnt lgkmcnt(10)
    v_mfma_f32_16x16x32_bf16 v[128:131], a[192:195], a[80:83], v[128:131]
    s_waitcnt vmcnt(16) lgkmcnt(4)
    s_barrier
    ds_read_b64_tr_b16 a[176:177], v28 offset:49152
    v_mfma_f32_16x16x32_bf16 v[132:135], a[192:195], a[84:87], v[132:135]
    ds_read_b64_tr_b16 a[178:179], v28 offset:49664
    s_waitcnt vmcnt(12)
    ds_read_b128 a[96:99], v198 offset:49152
    v_mfma_f32_16x16x32_bf16 v[136:139], a[196:199], a[80:83], v[136:139]
    ds_read_b64_tr_b16 a[180:181], v29 offset:49152
    v_mfma_f32_16x16x32_bf16 v[140:143], a[196:199], a[84:87], v[140:143]
    ds_read_b64_tr_b16 a[182:183], v29 offset:49664
    ds_read_b128 a[100:103], v198 offset:51200
    v_mfma_f32_16x16x32_bf16 v[144:147], a[200:203], a[80:83], v[144:147]
    ds_read_b64_tr_b16 a[184:185], v30 offset:49152
    v_mfma_f32_16x16x32_bf16 v[148:151], a[200:203], a[84:87], v[148:151]
    ds_read_b64_tr_b16 a[186:187], v30 offset:49664
    v_mfma_f32_16x16x32_bf16 v[152:155], a[204:207], a[80:83], v[152:155]
    ds_read_b64_tr_b16 a[188:189], v31 offset:49152
    v_mfma_f32_16x16x32_bf16 v[156:159], a[204:207], a[84:87], v[156:159]
    ds_read_b64_tr_b16 a[190:191], v31 offset:49664
    s_waitcnt lgkmcnt(10)
    v_mfma_f32_16x16x32_bf16 v[128:131], a[208:211], a[88:91], v[128:131]
    ds_read_b64_tr_b16 a[192:193], v28 offset:53248
    s_add_u32 s77, s18, 2621568
    v_mfma_f32_16x16x32_bf16 v[132:135], a[208:211], a[92:95], v[132:135]
    ds_read_b64_tr_b16 a[194:195], v28 offset:53760
    ds_read_b128 a[104:107], v206 offset:49152
    v_mfma_f32_16x16x32_bf16 v[136:139], a[212:215], a[88:91], v[136:139]
    ds_read_b64_tr_b16 a[196:197], v29 offset:53248
    s_add_u32 m0, s74, 98304
    s_nop 0
    buffer_load_dwordx4 v196, s[44:47], s77 offen offset:0 lds
    v_mfma_f32_16x16x32_bf16 v[140:143], a[212:215], a[92:95], v[140:143]
    ds_read_b64_tr_b16 a[198:199], v29 offset:53760
    ds_read_b128 a[108:111], v206 offset:51200
    v_mfma_f32_16x16x32_bf16 v[144:147], a[216:219], a[88:91], v[144:147]
    ds_read_b64_tr_b16 a[200:201], v30 offset:53248
    buffer_load_dwordx4 v204, s[44:47], s77 offen offset:1024 lds
    v_mfma_f32_16x16x32_bf16 v[148:151], a[216:219], a[92:95], v[148:151]
    ds_read_b64_tr_b16 a[202:203], v30 offset:53760
    buffer_load_dwordx4 v212, s[44:47], s77 offen offset:2048 lds
    v_mfma_f32_16x16x32_bf16 v[152:155], a[220:223], a[88:91], v[152:155]
    ds_read_b64_tr_b16 a[204:205], v31 offset:53248
    buffer_load_dwordx4 v220, s[44:47], s77 offen offset:3072 lds
    v_mfma_f32_16x16x32_bf16 v[156:159], a[220:223], a[92:95], v[156:159]
    ds_read_b64_tr_b16 a[206:207], v31 offset:53760
    s_waitcnt lgkmcnt(10)
    v_mfma_f32_16x16x32_bf16 v[128:131], a[176:179], a[96:99], v[128:131]
    ds_read_b64_tr_b16 a[208:209], v28 offset:57344
    v_mfma_f32_16x16x32_bf16 v[132:135], a[176:179], a[100:103], v[132:135]
    ds_read_b64_tr_b16 a[210:211], v28 offset:57856
    v_mfma_f32_16x16x32_bf16 v[136:139], a[180:183], a[96:99], v[136:139]
    ds_read_b64_tr_b16 a[212:213], v29 offset:57344
    v_mfma_f32_16x16x32_bf16 v[140:143], a[180:183], a[100:103], v[140:143]
    ds_read_b64_tr_b16 a[214:215], v29 offset:57856
    v_mfma_f32_16x16x32_bf16 v[144:147], a[184:187], a[96:99], v[144:147]
    ds_read_b64_tr_b16 a[216:217], v30 offset:57344
    v_mfma_f32_16x16x32_bf16 v[148:151], a[184:187], a[100:103], v[148:151]
    ds_read_b64_tr_b16 a[218:219], v30 offset:57856
    s_mov_b32 s77, 3408000
    v_mfma_f32_16x16x32_bf16 v[152:155], a[188:191], a[96:99], v[152:155]
    ds_read_b64_tr_b16 a[220:221], v31 offset:57344
    v_mfma_f32_16x16x32_bf16 v[156:159], a[188:191], a[100:103], v[156:159]
    ds_read_b64_tr_b16 a[222:223], v31 offset:57856
    s_add_u32 m0, s73, 110592
    s_nop 0
    buffer_load_dwordx4 v40, s[44:47], s77 offen lds
    s_waitcnt lgkmcnt(8)
    v_mfma_f32_16x16x32_bf16 v[128:131], a[192:195], a[104:107], v[128:131]
    ds_read_b64_tr_b16 a[176:177], v28 offset:61440
    v_mfma_f32_16x16x32_bf16 v[132:135], a[192:195], a[108:111], v[132:135]
    ds_read_b64_tr_b16 a[178:179], v28 offset:61952
    v_mfma_f32_16x16x32_bf16 v[136:139], a[196:199], a[104:107], v[136:139]
    ds_read_b64_tr_b16 a[180:181], v29 offset:61440
    v_mfma_f32_16x16x32_bf16 v[140:143], a[196:199], a[108:111], v[140:143]
    ds_read_b64_tr_b16 a[182:183], v29 offset:61952
    s_mov_b32 m0, 110592
    s_nop 0
    buffer_load_dwordx4 v220, s[44:47], s77 offen offset:3072 lds
    v_mfma_f32_16x16x32_bf16 v[144:147], a[200:203], a[104:107], v[144:147]
    ds_read_b64_tr_b16 a[184:185], v30 offset:61440
    v_mfma_f32_16x16x32_bf16 v[148:151], a[200:203], a[108:111], v[148:151]
    ds_read_b64_tr_b16 a[186:187], v30 offset:61952
    v_mfma_f32_16x16x32_bf16 v[152:155], a[204:207], a[104:107], v[152:155]
    ds_read_b64_tr_b16 a[188:189], v31 offset:61440
    v_mfma_f32_16x16x32_bf16 v[156:159], a[204:207], a[108:111], v[156:159]
    ds_read_b64_tr_b16 a[190:191], v31 offset:61952
    s_waitcnt lgkmcnt(8)
    v_mfma_f32_16x16x32_bf16 v[160:163], a[208:211], a[0:3], 0
    s_waitcnt vmcnt(12)
    s_barrier
    ds_read_b64_tr_b16 a[192:193], v28 offset:0
    v_mfma_f32_16x16x32_bf16 v[164:167], a[208:211], a[4:7], 0
    ds_read_b64_tr_b16 a[194:195], v28 offset:512
    v_mfma_f32_16x16x32_bf16 v[168:171], a[212:215], a[0:3], 0
    ds_read_b64_tr_b16 a[196:197], v29 offset:0
    v_mul_f32 v128, s75, v128
    v_mfma_f32_16x16x32_bf16 v[172:175], a[212:215], a[4:7], 0
    ds_read_b64_tr_b16 a[198:199], v29 offset:512
    v_mul_f32 v129, s75, v129
    v_mfma_f32_16x16x32_bf16 v[176:179], a[216:219], a[0:3], 0
    ds_read_b64_tr_b16 a[200:201], v30 offset:0
    v_mul_f32 v130, s75, v130
    v_mfma_f32_16x16x32_bf16 v[180:183], a[216:219], a[4:7], 0
    ds_read_b64_tr_b16 a[202:203], v30 offset:512
    v_mul_f32 v131, s75, v131
    v_mfma_f32_16x16x32_bf16 v[184:187], a[220:223], a[0:3], 0
    ds_read_b64_tr_b16 a[204:205], v31 offset:0
    v_mul_f32 v136, s75, v136
    v_mfma_f32_16x16x32_bf16 v[188:191], a[220:223], a[4:7], 0
    ds_read_b64_tr_b16 a[206:207], v31 offset:512
    v_mul_f32 v137, s75, v137
    s_waitcnt lgkmcnt(8)
    v_mfma_f32_16x16x32_bf16 v[160:163], a[176:179], a[8:11], v[160:163]
    ds_read_b64_tr_b16 a[208:209], v28 offset:4096
    v_mul_f32 v138, s75, v138
    s_add_u32 s77, s18, 256
    v_mfma_f32_16x16x32_bf16 v[164:167], a[176:179], a[12:15], v[164:167]
    ds_read_b64_tr_b16 a[210:211], v28 offset:4608
    v_mul_f32 v139, s75, v139
    v_mfma_f32_16x16x32_bf16 v[168:171], a[180:183], a[8:11], v[168:171]
    ds_read_b64_tr_b16 a[212:213], v29 offset:4096
    v_cvt_pk_bf16_f32 v128, v128, v129
    s_add_u32 m0, s74, 114688
    v_mfma_f32_16x16x32_bf16 v[172:175], a[180:183], a[12:15], v[172:175]
    ds_read_b64_tr_b16 a[214:215], v29 offset:4608
    v_cvt_pk_bf16_f32 v136, v136, v137
    v_mfma_f32_16x16x32_bf16 v[176:179], a[184:187], a[8:11], v[176:179]
    ds_read_b64_tr_b16 a[216:217], v30 offset:4096
    v_cvt_pk_bf16_f32 v129, v130, v131
    v_mfma_f32_16x16x32_bf16 v[180:183], a[184:187], a[12:15], v[180:183]
    ds_read_b64_tr_b16 a[218:219], v30 offset:4608
    v_cvt_pk_bf16_f32 v137, v138, v139
    v_mfma_f32_16x16x32_bf16 v[184:187], a[188:191], a[8:11], v[184:187]
    ds_read_b64_tr_b16 a[220:221], v31 offset:4096
    buffer_load_dwordx4 v196, s[44:47], s77 offen offset:0 lds
    v_mfma_f32_16x16x32_bf16 v[188:191], a[188:191], a[12:15], v[188:191]
    ds_read_b64_tr_b16 a[222:223], v31 offset:4608
    v_permlane16_swap_b32 v128, v136
    s_waitcnt lgkmcnt(8)
    v_mfma_f32_16x16x32_bf16 v[160:163], a[192:195], a[16:19], v[160:163]
    ds_read_b64_tr_b16 a[176:177], v28 offset:8192
    v_permlane16_swap_b32 v129, v137
    v_mfma_f32_16x16x32_bf16 v[164:167], a[192:195], a[20:23], v[164:167]
    ds_read_b64_tr_b16 a[178:179], v28 offset:8704
    v_accvgpr_write_b32 a112, v128
    v_mfma_f32_16x16x32_bf16 v[168:171], a[196:199], a[16:19], v[168:171]
    ds_read_b64_tr_b16 a[180:181], v29 offset:8192
    v_accvgpr_write_b32 a114, v136
    v_mfma_f32_16x16x32_bf16 v[172:175], a[196:199], a[20:23], v[172:175]
    ds_read_b64_tr_b16 a[182:183], v29 offset:8704
    v_accvgpr_write_b32 a113, v129
    v_mfma_f32_16x16x32_bf16 v[176:179], a[200:203], a[16:19], v[176:179]
    ds_read_b64_tr_b16 a[184:185], v30 offset:8192
    v_accvgpr_write_b32 a115, v137
    v_mfma_f32_16x16x32_bf16 v[180:183], a[200:203], a[20:23], v[180:183]
    ds_read_b64_tr_b16 a[186:187], v30 offset:8704
    v_mul_f32 v132, s75, v132
    v_mfma_f32_16x16x32_bf16 v[184:187], a[204:207], a[16:19], v[184:187]
    ds_read_b64_tr_b16 a[188:189], v31 offset:8192
    v_mul_f32 v133, s75, v133
    v_mfma_f32_16x16x32_bf16 v[188:191], a[204:207], a[20:23], v[188:191]
    ds_read_b64_tr_b16 a[190:191], v31 offset:8704
    v_mul_f32 v134, s75, v134
    s_waitcnt lgkmcnt(8)
    v_mfma_f32_16x16x32_bf16 v[160:163], a[208:211], a[24:27], v[160:163]
    ds_read_b64_tr_b16 a[192:193], v28 offset:12288
    v_mul_f32 v135, s75, v135
    v_mfma_f32_16x16x32_bf16 v[164:167], a[208:211], a[28:31], v[164:167]
    ds_read_b64_tr_b16 a[194:195], v28 offset:12800
    v_mul_f32 v140, s75, v140
    v_mfma_f32_16x16x32_bf16 v[168:171], a[212:215], a[24:27], v[168:171]
    ds_read_b64_tr_b16 a[196:197], v29 offset:12288
    v_mul_f32 v141, s75, v141
    v_mfma_f32_16x16x32_bf16 v[172:175], a[212:215], a[28:31], v[172:175]
    ds_read_b64_tr_b16 a[198:199], v29 offset:12800
    buffer_load_dwordx4 v204, s[44:47], s77 offen offset:1024 lds
    v_mfma_f32_16x16x32_bf16 v[176:179], a[216:219], a[24:27], v[176:179]
    ds_read_b64_tr_b16 a[200:201], v30 offset:12288
    v_mul_f32 v142, s75, v142
    buffer_load_dwordx4 v212, s[44:47], s77 offen offset:2048 lds
    v_mfma_f32_16x16x32_bf16 v[180:183], a[216:219], a[28:31], v[180:183]
    ds_read_b64_tr_b16 a[202:203], v30 offset:12800
    v_mul_f32 v143, s75, v143
    buffer_load_dwordx4 v220, s[44:47], s77 offen offset:3072 lds
    s_mov_b32 s77, 786688
    s_add_u32 m0, s73, 126976
    v_mfma_f32_16x16x32_bf16 v[184:187], a[220:223], a[24:27], v[184:187]
    ds_read_b64_tr_b16 a[204:205], v31 offset:12288
    v_cvt_pk_bf16_f32 v132, v132, v133
    buffer_load_dwordx4 v40, s[44:47], s77 offen lds
    s_mov_b32 m0, 126976
    v_mfma_f32_16x16x32_bf16 v[188:191], a[220:223], a[28:31], v[188:191]
    ds_read_b64_tr_b16 a[206:207], v31 offset:12800
    v_cvt_pk_bf16_f32 v140, v140, v141
    buffer_load_dwordx4 v220, s[44:47], s77 offen offset:3072 lds
    s_waitcnt lgkmcnt(8)
    v_mfma_f32_16x16x32_bf16 v[160:163], a[176:179], a[32:35], v[160:163]
    s_waitcnt vmcnt(12)
    s_barrier
    ds_read_b64_tr_b16 a[208:209], v28 offset:16384
    v_cvt_pk_bf16_f32 v133, v134, v135
    v_mfma_f32_16x16x32_bf16 v[164:167], a[176:179], a[36:39], v[164:167]
    ds_read_b64_tr_b16 a[210:211], v28 offset:16896
    v_cvt_pk_bf16_f32 v141, v142, v143
    v_mfma_f32_16x16x32_bf16 v[168:171], a[180:183], a[32:35], v[168:171]
    ds_read_b64_tr_b16 a[212:213], v29 offset:16384
    v_permlane16_swap_b32 v132, v140
    v_mfma_f32_16x16x32_bf16 v[172:175], a[180:183], a[36:39], v[172:175]
    ds_read_b64_tr_b16 a[214:215], v29 offset:16896
    v_permlane16_swap_b32 v133, v141
    v_mfma_f32_16x16x32_bf16 v[176:179], a[184:187], a[32:35], v[176:179]
    ds_read_b64_tr_b16 a[216:217], v30 offset:16384
    v_accvgpr_write_b32 a116, v132
    v_mfma_f32_16x16x32_bf16 v[180:183], a[184:187], a[36:39], v[180:183]
    ds_read_b64_tr_b16 a[218:219], v30 offset:16896
    v_accvgpr_write_b32 a118, v140
    v_mfma_f32_16x16x32_bf16 v[184:187], a[188:191], a[32:35], v[184:187]
    ds_read_b64_tr_b16 a[220:221], v31 offset:16384
    v_accvgpr_write_b32 a117, v133
    v_mfma_f32_16x16x32_bf16 v[188:191], a[188:191], a[36:39], v[188:191]
    ds_read_b64_tr_b16 a[222:223], v31 offset:16896
    v_accvgpr_write_b32 a119, v141
    s_waitcnt lgkmcnt(8)
    v_mfma_f32_16x16x32_bf16 v[160:163], a[192:195], a[40:43], v[160:163]
    ds_read_b64_tr_b16 a[176:177], v28 offset:20480
    s_add_u32 s77, s18, 1048832
    v_mfma_f32_16x16x32_bf16 v[164:167], a[192:195], a[44:47], v[164:167]
    ds_read_b64_tr_b16 a[178:179], v28 offset:20992
    v_mul_f32 v144, s75, v144
    v_mfma_f32_16x16x32_bf16 v[168:171], a[196:199], a[40:43], v[168:171]
    ds_read_b64_tr_b16 a[180:181], v29 offset:20480
    v_mul_f32 v145, s75, v145
    s_add_u32 m0, s74, 65536
    v_mfma_f32_16x16x32_bf16 v[172:175], a[196:199], a[44:47], v[172:175]
    ds_read_b64_tr_b16 a[182:183], v29 offset:20992
    v_mul_f32 v146, s75, v146
    v_mfma_f32_16x16x32_bf16 v[176:179], a[200:203], a[40:43], v[176:179]
    ds_read_b64_tr_b16 a[184:185], v30 offset:20480
    v_mul_f32 v147, s75, v147
    v_mfma_f32_16x16x32_bf16 v[180:183], a[200:203], a[44:47], v[180:183]
    ds_read_b64_tr_b16 a[186:187], v30 offset:20992
    v_mul_f32 v152, s75, v152
    v_mfma_f32_16x16x32_bf16 v[184:187], a[204:207], a[40:43], v[184:187]
    ds_read_b64_tr_b16 a[188:189], v31 offset:20480
    v_mul_f32 v153, s75, v153
    v_mfma_f32_16x16x32_bf16 v[188:191], a[204:207], a[44:47], v[188:191]
    ds_read_b64_tr_b16 a[190:191], v31 offset:20992
    v_mul_f32 v154, s75, v154
    s_waitcnt lgkmcnt(8)
    v_mfma_f32_16x16x32_bf16 v[160:163], a[208:211], a[48:51], v[160:163]
    ds_read_b64_tr_b16 a[192:193], v28 offset:24576
    v_mul_f32 v155, s75, v155
    v_mfma_f32_16x16x32_bf16 v[164:167], a[208:211], a[52:55], v[164:167]
    ds_read_b64_tr_b16 a[194:195], v28 offset:25088
    v_cvt_pk_bf16_f32 v144, v144, v145
    v_mfma_f32_16x16x32_bf16 v[168:171], a[212:215], a[48:51], v[168:171]
    ds_read_b64_tr_b16 a[196:197], v29 offset:24576
    v_cvt_pk_bf16_f32 v152, v152, v153
    v_mfma_f32_16x16x32_bf16 v[172:175], a[212:215], a[52:55], v[172:175]
    ds_read_b64_tr_b16 a[198:199], v29 offset:25088
    v_cvt_pk_bf16_f32 v145, v146, v147
    v_mfma_f32_16x16x32_bf16 v[176:179], a[216:219], a[48:51], v[176:179]
    ds_read_b64_tr_b16 a[200:201], v30 offset:24576
    v_cvt_pk_bf16_f32 v153, v154, v155
    v_mfma_f32_16x16x32_bf16 v[180:183], a[216:219], a[52:55], v[180:183]
    ds_read_b64_tr_b16 a[202:203], v30 offset:25088
    buffer_load_dwordx4 v196, s[44:47], s77 offen offset:0 lds
    v_mfma_f32_16x16x32_bf16 v[184:187], a[220:223], a[48:51], v[184:187]
    ds_read_b64_tr_b16 a[204:205], v31 offset:24576
    v_permlane16_swap_b32 v144, v152
    buffer_load_dwordx4 v204, s[44:47], s77 offen offset:1024 lds
    v_mfma_f32_16x16x32_bf16 v[188:191], a[220:223], a[52:55], v[188:191]
    ds_read_b64_tr_b16 a[206:207], v31 offset:25088
    v_permlane16_swap_b32 v145, v153
    buffer_load_dwordx4 v212, s[44:47], s77 offen offset:2048 lds
    s_waitcnt lgkmcnt(8)
    v_mfma_f32_16x16x32_bf16 v[160:163], a[176:179], a[56:59], v[160:163]
    ds_read_b64_tr_b16 a[208:209], v28 offset:28672
    v_accvgpr_write_b32 a120, v144
    buffer_load_dwordx4 v220, s[44:47], s77 offen offset:3072 lds
    s_mov_b32 s77, 1835264
    s_add_u32 m0, s73, 77824
    v_mfma_f32_16x16x32_bf16 v[164:167], a[176:179], a[60:63], v[164:167]
    ds_read_b64_tr_b16 a[210:211], v28 offset:29184
    v_accvgpr_write_b32 a122, v152
    buffer_load_dwordx4 v40, s[44:47], s77 offen lds
    v_mfma_f32_16x16x32_bf16 v[168:171], a[180:183], a[56:59], v[168:171]
    ds_read_b64_tr_b16 a[212:213], v29 offset:28672
    v_accvgpr_write_b32 a121, v145
    v_mfma_f32_16x16x32_bf16 v[172:175], a[180:183], a[60:63], v[172:175]
    ds_read_b64_tr_b16 a[214:215], v29 offset:29184
    v_accvgpr_write_b32 a123, v153
    s_mov_b32 m0, 77824
    s_nop 0
    buffer_load_dwordx4 v220, s[44:47], s77 offen offset:3072 lds
    v_mfma_f32_16x16x32_bf16 v[176:179], a[184:187], a[56:59], v[176:179]
    ds_read_b64_tr_b16 a[216:217], v30 offset:28672
    v_mul_f32 v148, s75, v148
    v_mfma_f32_16x16x32_bf16 v[180:183], a[184:187], a[60:63], v[180:183]
    ds_read_b64_tr_b16 a[218:219], v30 offset:29184
    v_mul_f32 v149, s75, v149
    v_mfma_f32_16x16x32_bf16 v[184:187], a[188:191], a[56:59], v[184:187]
    ds_read_b64_tr_b16 a[220:221], v31 offset:28672
    v_mul_f32 v150, s75, v150
    v_mfma_f32_16x16x32_bf16 v[188:191], a[188:191], a[60:63], v[188:191]
    ds_read_b64_tr_b16 a[222:223], v31 offset:29184
    v_mul_f32 v151, s75, v151
    s_waitcnt lgkmcnt(8)
    v_mfma_f32_16x16x32_bf16 v[160:163], a[192:195], a[64:67], v[160:163]
    s_waitcnt vmcnt(12)
    s_barrier
    ds_read_b64_tr_b16 a[176:177], v28 offset:32768
    v_mul_f32 v156, s75, v156
    v_mfma_f32_16x16x32_bf16 v[164:167], a[192:195], a[68:71], v[164:167]
    ds_read_b64_tr_b16 a[178:179], v28 offset:33280
    v_mul_f32 v157, s75, v157
    v_mfma_f32_16x16x32_bf16 v[168:171], a[196:199], a[64:67], v[168:171]
    ds_read_b64_tr_b16 a[180:181], v29 offset:32768
    v_mfma_f32_16x16x32_bf16 v[172:175], a[196:199], a[68:71], v[172:175]
    ds_read_b64_tr_b16 a[182:183], v29 offset:33280
    v_mul_f32 v158, s75, v158
    v_mfma_f32_16x16x32_bf16 v[176:179], a[200:203], a[64:67], v[176:179]
    ds_read_b64_tr_b16 a[184:185], v30 offset:32768
    v_mul_f32 v159, s75, v159
    v_mfma_f32_16x16x32_bf16 v[180:183], a[200:203], a[68:71], v[180:183]
    ds_read_b64_tr_b16 a[186:187], v30 offset:33280
    v_cvt_pk_bf16_f32 v148, v148, v149
    v_mfma_f32_16x16x32_bf16 v[184:187], a[204:207], a[64:67], v[184:187]
    ds_read_b64_tr_b16 a[188:189], v31 offset:32768
    v_cvt_pk_bf16_f32 v156, v156, v157
    v_mfma_f32_16x16x32_bf16 v[188:191], a[204:207], a[68:71], v[188:191]
    ds_read_b64_tr_b16 a[190:191], v31 offset:33280
    v_cvt_pk_bf16_f32 v149, v150, v151
    s_waitcnt lgkmcnt(8)
    v_mfma_f32_16x16x32_bf16 v[160:163], a[208:211], a[72:75], v[160:163]
    ds_read_b64_tr_b16 a[192:193], v28 offset:36864
    v_cvt_pk_bf16_f32 v157, v158, v159
    s_add_u32 s77, s18, 2097408
    v_mfma_f32_16x16x32_bf16 v[164:167], a[208:211], a[76:79], v[164:167]
    ds_read_b64_tr_b16 a[194:195], v28 offset:37376
    v_permlane16_swap_b32 v148, v156
    v_mfma_f32_16x16x32_bf16 v[168:171], a[212:215], a[72:75], v[168:171]
    ds_read_b64_tr_b16 a[196:197], v29 offset:36864
    v_permlane16_swap_b32 v149, v157
    s_add_u32 m0, s74, 81920
    v_mfma_f32_16x16x32_bf16 v[172:175], a[212:215], a[76:79], v[172:175]
    ds_read_b64_tr_b16 a[198:199], v29 offset:37376
    v_accvgpr_write_b32 a124, v148
    v_mfma_f32_16x16x32_bf16 v[176:179], a[216:219], a[72:75], v[176:179]
    ds_read_b64_tr_b16 a[200:201], v30 offset:36864
    v_accvgpr_write_b32 a126, v156
    v_mfma_f32_16x16x32_bf16 v[180:183], a[216:219], a[76:79], v[180:183]
    ds_read_b64_tr_b16 a[202:203], v30 offset:37376
    v_accvgpr_write_b32 a125, v149
    v_mfma_f32_16x16x32_bf16 v[184:187], a[220:223], a[72:75], v[184:187]
    ds_read_b64_tr_b16 a[204:205], v31 offset:36864
    v_accvgpr_write_b32 a127, v157
    v_mfma_f32_16x16x32_bf16 v[188:191], a[220:223], a[76:79], v[188:191]
    ds_read_b64_tr_b16 a[206:207], v31 offset:37376
    buffer_load_dwordx4 v196, s[44:47], s77 offen offset:0 lds
    s_waitcnt lgkmcnt(8)
    v_mfma_f32_16x16x32_bf16 v[160:163], a[176:179], a[80:83], v[160:163]
    ds_read_b64_tr_b16 a[208:209], v28 offset:40960
    buffer_load_dwordx4 v204, s[44:47], s77 offen offset:1024 lds
    v_mfma_f32_16x16x32_bf16 v[164:167], a[176:179], a[84:87], v[164:167]
    ds_read_b64_tr_b16 a[210:211], v28 offset:41472
    buffer_load_dwordx4 v212, s[44:47], s77 offen offset:2048 lds
    v_mfma_f32_16x16x32_bf16 v[168:171], a[180:183], a[80:83], v[168:171]
    ds_read_b64_tr_b16 a[212:213], v29 offset:40960
    buffer_load_dwordx4 v220, s[44:47], s77 offen offset:3072 lds
    v_mfma_f32_16x16x32_bf16 v[172:175], a[180:183], a[84:87], v[172:175]
    ds_read_b64_tr_b16 a[214:215], v29 offset:41472
    v_mfma_f32_16x16x32_bf16 v[176:179], a[184:187], a[80:83], v[176:179]
    ds_read_b64_tr_b16 a[216:217], v30 offset:40960
    v_mfma_f32_16x16x32_bf16 v[180:183], a[184:187], a[84:87], v[180:183]
    ds_read_b64_tr_b16 a[218:219], v30 offset:41472
    s_mov_b32 s77, 2883840
    v_mfma_f32_16x16x32_bf16 v[184:187], a[188:191], a[80:83], v[184:187]
    ds_read_b64_tr_b16 a[220:221], v31 offset:40960
    v_mfma_f32_16x16x32_bf16 v[188:191], a[188:191], a[84:87], v[188:191]
    ds_read_b64_tr_b16 a[222:223], v31 offset:41472
    s_add_u32 m0, s73, 94208
    s_nop 0
    buffer_load_dwordx4 v40, s[44:47], s77 offen lds
    s_waitcnt lgkmcnt(8)
    v_mfma_f32_16x16x32_bf16 v[160:163], a[192:195], a[88:91], v[160:163]
    ds_read_b64_tr_b16 a[176:177], v28 offset:45056
    v_mfma_f32_16x16x32_bf16 v[164:167], a[192:195], a[92:95], v[164:167]
    ds_read_b64_tr_b16 a[178:179], v28 offset:45568
    v_mfma_f32_16x16x32_bf16 v[168:171], a[196:199], a[88:91], v[168:171]
    ds_read_b64_tr_b16 a[180:181], v29 offset:45056
    v_mfma_f32_16x16x32_bf16 v[172:175], a[196:199], a[92:95], v[172:175]
    ds_read_b64_tr_b16 a[182:183], v29 offset:45568
    s_mov_b32 m0, 94208
    s_nop 0
    buffer_load_dwordx4 v220, s[44:47], s77 offen offset:3072 lds
    v_mfma_f32_16x16x32_bf16 v[176:179], a[200:203], a[88:91], v[176:179]
    ds_read_b64_tr_b16 a[184:185], v30 offset:45056
    v_mfma_f32_16x16x32_bf16 v[180:183], a[200:203], a[92:95], v[180:183]
    ds_read_b64_tr_b16 a[186:187], v30 offset:45568
    v_mfma_f32_16x16x32_bf16 v[184:187], a[204:207], a[88:91], v[184:187]
    ds_read_b64_tr_b16 a[188:189], v31 offset:45056
    v_mfma_f32_16x16x32_bf16 v[188:191], a[204:207], a[92:95], v[188:191]
    ds_read_b64_tr_b16 a[190:191], v31 offset:45568
    s_waitcnt lgkmcnt(8)
    v_mfma_f32_16x16x32_bf16 v[160:163], a[208:211], a[96:99], v[160:163]
    s_waitcnt vmcnt(12)
    s_barrier
    ds_read_b64_tr_b16 a[192:193], v28 offset:49152
    v_mfma_f32_16x16x32_bf16 v[164:167], a[208:211], a[100:103], v[164:167]
    ds_read_b64_tr_b16 a[194:195], v28 offset:49664
    v_mfma_f32_16x16x32_bf16 v[168:171], a[212:215], a[96:99], v[168:171]
    ds_read_b64_tr_b16 a[196:197], v29 offset:49152
    v_mfma_f32_16x16x32_bf16 v[172:175], a[212:215], a[100:103], v[172:175]
    ds_read_b64_tr_b16 a[198:199], v29 offset:49664
    v_mfma_f32_16x16x32_bf16 v[176:179], a[216:219], a[96:99], v[176:179]
    ds_read_b64_tr_b16 a[200:201], v30 offset:49152
    v_mfma_f32_16x16x32_bf16 v[180:183], a[216:219], a[100:103], v[180:183]
    ds_read_b64_tr_b16 a[202:203], v30 offset:49664
    v_mfma_f32_16x16x32_bf16 v[184:187], a[220:223], a[96:99], v[184:187]
    ds_read_b64_tr_b16 a[204:205], v31 offset:49152
    v_mfma_f32_16x16x32_bf16 v[188:191], a[220:223], a[100:103], v[188:191]
    ds_read_b64_tr_b16 a[206:207], v31 offset:49664
    s_waitcnt lgkmcnt(8)
    v_mfma_f32_16x16x32_bf16 v[160:163], a[176:179], a[104:107], v[160:163]
    ds_read_b64_tr_b16 a[208:209], v28 offset:53248
    s_mov_b32 s77, s19
    v_mfma_f32_16x16x32_bf16 v[164:167], a[176:179], a[108:111], v[164:167]
    ds_read_b64_tr_b16 a[210:211], v28 offset:53760
    v_mfma_f32_16x16x32_bf16 v[168:171], a[180:183], a[104:107], v[168:171]
    ds_read_b64_tr_b16 a[212:213], v29 offset:53248
    s_add_u32 m0, s74, 98304
    s_nop 0
    buffer_load_dwordx4 v196, s[44:47], s77 offen offset:0 lds
    v_mfma_f32_16x16x32_bf16 v[172:175], a[180:183], a[108:111], v[172:175]
    ds_read_b64_tr_b16 a[214:215], v29 offset:53760
    buffer_load_dwordx4 v204, s[44:47], s77 offen offset:1024 lds
    v_mfma_f32_16x16x32_bf16 v[176:179], a[184:187], a[104:107], v[176:179]
    ds_read_b64_tr_b16 a[216:217], v30 offset:53248
    buffer_load_dwordx4 v212, s[44:47], s77 offen offset:2048 lds
    v_mfma_f32_16x16x32_bf16 v[180:183], a[184:187], a[108:111], v[180:183]
    ds_read_b64_tr_b16 a[218:219], v30 offset:53760
    buffer_load_dwordx4 v220, s[44:47], s77 offen offset:3072 lds
    v_mfma_f32_16x16x32_bf16 v[184:187], a[188:191], a[104:107], v[184:187]
    ds_read_b64_tr_b16 a[220:221], v31 offset:53248
    v_mfma_f32_16x16x32_bf16 v[188:191], a[188:191], a[108:111], v[188:191]
    ds_read_b64_tr_b16 a[222:223], v31 offset:53760
    s_waitcnt lgkmcnt(8)
    v_mfma_f32_16x16x32_bf16 v[128:131], a[192:195], a[0:3], 0
    ds_read_b64_tr_b16 a[176:177], v28 offset:57344
    v_mfma_f32_16x16x32_bf16 v[132:135], a[192:195], a[4:7], 0
    ds_read_b64_tr_b16 a[178:179], v28 offset:57856
    v_mfma_f32_16x16x32_bf16 v[136:139], a[196:199], a[0:3], 0
    ds_read_b64_tr_b16 a[180:181], v29 offset:57344
    v_mul_f32 v160, s75, v160
    v_mfma_f32_16x16x32_bf16 v[140:143], a[196:199], a[4:7], 0
    ds_read_b64_tr_b16 a[182:183], v29 offset:57856
    v_mul_f32 v161, s75, v161
    v_mfma_f32_16x16x32_bf16 v[144:147], a[200:203], a[0:3], 0
    ds_read_b64_tr_b16 a[184:185], v30 offset:57344
    v_mul_f32 v162, s75, v162
    v_mfma_f32_16x16x32_bf16 v[148:151], a[200:203], a[4:7], 0
    ds_read_b64_tr_b16 a[186:187], v30 offset:57856
    v_mul_f32 v163, s75, v163
    s_mov_b32 s77, 262528
    v_mfma_f32_16x16x32_bf16 v[152:155], a[204:207], a[0:3], 0
    ds_read_b64_tr_b16 a[188:189], v31 offset:57344
    v_mul_f32 v168, s75, v168
    v_mfma_f32_16x16x32_bf16 v[156:159], a[204:207], a[4:7], 0
    ds_read_b64_tr_b16 a[190:191], v31 offset:57856
    v_mul_f32 v169, s75, v169
    s_add_u32 m0, s73, 110592
    s_waitcnt lgkmcnt(8)
    v_mfma_f32_16x16x32_bf16 v[128:131], a[208:211], a[8:11], v[128:131]
    ds_read_b64_tr_b16 a[192:193], v28 offset:61440
    v_mul_f32 v170, s75, v170
    v_mfma_f32_16x16x32_bf16 v[132:135], a[208:211], a[12:15], v[132:135]
    ds_read_b64_tr_b16 a[194:195], v28 offset:61952
    v_mul_f32 v171, s75, v171
    v_mfma_f32_16x16x32_bf16 v[136:139], a[212:215], a[8:11], v[136:139]
    ds_read_b64_tr_b16 a[196:197], v29 offset:61440
    v_cvt_pk_bf16_f32 v160, v160, v161
    v_mfma_f32_16x16x32_bf16 v[140:143], a[212:215], a[12:15], v[140:143]
    ds_read_b64_tr_b16 a[198:199], v29 offset:61952
    v_cvt_pk_bf16_f32 v168, v168, v169
    v_mfma_f32_16x16x32_bf16 v[144:147], a[216:219], a[8:11], v[144:147]
    ds_read_b64_tr_b16 a[200:201], v30 offset:61440
    v_cvt_pk_bf16_f32 v161, v162, v163
    v_mfma_f32_16x16x32_bf16 v[148:151], a[216:219], a[12:15], v[148:151]
    ds_read_b64_tr_b16 a[202:203], v30 offset:61952
    v_cvt_pk_bf16_f32 v169, v170, v171
    v_mfma_f32_16x16x32_bf16 v[152:155], a[220:223], a[8:11], v[152:155]
    ds_read_b64_tr_b16 a[204:205], v31 offset:61440
    buffer_load_dwordx4 v40, s[44:47], s77 offen lds
    s_mov_b32 m0, 110592
    v_mfma_f32_16x16x32_bf16 v[156:159], a[220:223], a[12:15], v[156:159]
    ds_read_b64_tr_b16 a[206:207], v31 offset:61952
    v_permlane16_swap_b32 v160, v168
    buffer_load_dwordx4 v220, s[44:47], s77 offen offset:3072 lds
    s_waitcnt lgkmcnt(8)
    v_mfma_f32_16x16x32_bf16 v[128:131], a[176:179], a[16:19], v[128:131]
    s_waitcnt vmcnt(12)
    s_barrier
    ds_read_b64_tr_b16 a[208:209], v28 offset:0
    v_permlane16_swap_b32 v161, v169
    v_mfma_f32_16x16x32_bf16 v[132:135], a[176:179], a[20:23], v[132:135]
    ds_read_b64_tr_b16 a[210:211], v28 offset:512
    v_accvgpr_write_b32 a128, v160
    v_mfma_f32_16x16x32_bf16 v[136:139], a[180:183], a[16:19], v[136:139]
    ds_read_b64_tr_b16 a[212:213], v29 offset:0
    v_accvgpr_write_b32 a130, v168
    v_mfma_f32_16x16x32_bf16 v[140:143], a[180:183], a[20:23], v[140:143]
    ds_read_b64_tr_b16 a[214:215], v29 offset:512
    v_accvgpr_write_b32 a129, v161
    v_mfma_f32_16x16x32_bf16 v[144:147], a[184:187], a[16:19], v[144:147]
    ds_read_b64_tr_b16 a[216:217], v30 offset:0
    v_accvgpr_write_b32 a131, v169
    v_mfma_f32_16x16x32_bf16 v[148:151], a[184:187], a[20:23], v[148:151]
    ds_read_b64_tr_b16 a[218:219], v30 offset:512
    v_mul_f32 v164, s75, v164
    v_mfma_f32_16x16x32_bf16 v[152:155], a[188:191], a[16:19], v[152:155]
    ds_read_b64_tr_b16 a[220:221], v31 offset:0
    v_mul_f32 v165, s75, v165
    v_mfma_f32_16x16x32_bf16 v[156:159], a[188:191], a[20:23], v[156:159]
    ds_read_b64_tr_b16 a[222:223], v31 offset:512
    v_mul_f32 v166, s75, v166
    s_waitcnt lgkmcnt(8)
    v_mfma_f32_16x16x32_bf16 v[128:131], a[192:195], a[24:27], v[128:131]
    ds_read_b64_tr_b16 a[176:177], v28 offset:4096
    v_mul_f32 v167, s75, v167
    s_add_u32 s77, s18, 524672
    v_mfma_f32_16x16x32_bf16 v[132:135], a[192:195], a[28:31], v[132:135]
    ds_read_b64_tr_b16 a[178:179], v28 offset:4608
    v_mul_f32 v172, s75, v172
    v_mfma_f32_16x16x32_bf16 v[136:139], a[196:199], a[24:27], v[136:139]
    ds_read_b64_tr_b16 a[180:181], v29 offset:4096
    v_mul_f32 v173, s75, v173
    s_add_u32 m0, s74, 114688
    v_mfma_f32_16x16x32_bf16 v[140:143], a[196:199], a[28:31], v[140:143]
    ds_read_b64_tr_b16 a[182:183], v29 offset:4608
    buffer_load_dwordx4 v196, s[44:47], s77 offen offset:0 lds
    v_mfma_f32_16x16x32_bf16 v[144:147], a[200:203], a[24:27], v[144:147]
    ds_read_b64_tr_b16 a[184:185], v30 offset:4096
    v_mul_f32 v174, s75, v174
    v_mfma_f32_16x16x32_bf16 v[148:151], a[200:203], a[28:31], v[148:151]
    ds_read_b64_tr_b16 a[186:187], v30 offset:4608
    v_mul_f32 v175, s75, v175
    v_mfma_f32_16x16x32_bf16 v[152:155], a[204:207], a[24:27], v[152:155]
    ds_read_b64_tr_b16 a[188:189], v31 offset:4096
    v_cvt_pk_bf16_f32 v164, v164, v165
    v_mfma_f32_16x16x32_bf16 v[156:159], a[204:207], a[28:31], v[156:159]
    ds_read_b64_tr_b16 a[190:191], v31 offset:4608
    v_cvt_pk_bf16_f32 v172, v172, v173
    s_waitcnt lgkmcnt(8)
    v_mfma_f32_16x16x32_bf16 v[128:131], a[208:211], a[32:35], v[128:131]
    ds_read_b64_tr_b16 a[192:193], v28 offset:8192
    v_cvt_pk_bf16_f32 v165, v166, v167
    v_mfma_f32_16x16x32_bf16 v[132:135], a[208:211], a[36:39], v[132:135]
    ds_read_b64_tr_b16 a[194:195], v28 offset:8704
    v_cvt_pk_bf16_f32 v173, v174, v175
    v_mfma_f32_16x16x32_bf16 v[136:139], a[212:215], a[32:35], v[136:139]
    ds_read_b64_tr_b16 a[196:197], v29 offset:8192
    v_permlane16_swap_b32 v164, v172
    v_mfma_f32_16x16x32_bf16 v[140:143], a[212:215], a[36:39], v[140:143]
    ds_read_b64_tr_b16 a[198:199], v29 offset:8704
    v_permlane16_swap_b32 v165, v173
    v_mfma_f32_16x16x32_bf16 v[144:147], a[216:219], a[32:35], v[144:147]
    ds_read_b64_tr_b16 a[200:201], v30 offset:8192
    v_accvgpr_write_b32 a132, v164
    v_mfma_f32_16x16x32_bf16 v[148:151], a[216:219], a[36:39], v[148:151]
    ds_read_b64_tr_b16 a[202:203], v30 offset:8704
    v_accvgpr_write_b32 a134, v172
    v_mfma_f32_16x16x32_bf16 v[152:155], a[220:223], a[32:35], v[152:155]
    ds_read_b64_tr_b16 a[204:205], v31 offset:8192
    v_accvgpr_write_b32 a133, v165
    v_mfma_f32_16x16x32_bf16 v[156:159], a[220:223], a[36:39], v[156:159]
    ds_read_b64_tr_b16 a[206:207], v31 offset:8704
    v_accvgpr_write_b32 a135, v173
    s_waitcnt lgkmcnt(8)
    v_mfma_f32_16x16x32_bf16 v[128:131], a[176:179], a[40:43], v[128:131]
    ds_read_b64_tr_b16 a[208:209], v28 offset:12288
    buffer_load_dwordx4 v204, s[44:47], s77 offen offset:1024 lds
    v_mfma_f32_16x16x32_bf16 v[132:135], a[176:179], a[44:47], v[132:135]
    ds_read_b64_tr_b16 a[210:211], v28 offset:12800
    v_mul_f32 v176, s75, v176
    buffer_load_dwordx4 v212, s[44:47], s77 offen offset:2048 lds
    v_mfma_f32_16x16x32_bf16 v[136:139], a[180:183], a[40:43], v[136:139]
    ds_read_b64_tr_b16 a[212:213], v29 offset:12288
    v_mul_f32 v177, s75, v177
    buffer_load_dwordx4 v220, s[44:47], s77 offen offset:3072 lds
    s_mov_b32 s77, 1311104
    s_add_u32 m0, s73, 126976
    v_mfma_f32_16x16x32_bf16 v[140:143], a[180:183], a[44:47], v[140:143]
    ds_read_b64_tr_b16 a[214:215], v29 offset:12800
    v_mul_f32 v178, s75, v178
    buffer_load_dwordx4 v40, s[44:47], s77 offen lds
    s_mov_b32 m0, 126976
    v_mfma_f32_16x16x32_bf16 v[144:147], a[184:187], a[40:43], v[144:147]
    ds_read_b64_tr_b16 a[216:217], v30 offset:12288
    v_mul_f32 v179, s75, v179
    buffer_load_dwordx4 v220, s[44:47], s77 offen offset:3072 lds
    v_mfma_f32_16x16x32_bf16 v[148:151], a[184:187], a[44:47], v[148:151]
    ds_read_b64_tr_b16 a[218:219], v30 offset:12800
    v_mul_f32 v184, s75, v184
    v_mfma_f32_16x16x32_bf16 v[152:155], a[188:191], a[40:43], v[152:155]
    ds_read_b64_tr_b16 a[220:221], v31 offset:12288
    v_mul_f32 v185, s75, v185
    v_mfma_f32_16x16x32_bf16 v[156:159], a[188:191], a[44:47], v[156:159]
    ds_read_b64_tr_b16 a[222:223], v31 offset:12800
    v_mul_f32 v186, s75, v186
    s_waitcnt lgkmcnt(8)
    v_mfma_f32_16x16x32_bf16 v[128:131], a[192:195], a[48:51], v[128:131]
    s_waitcnt vmcnt(12)
    s_barrier
    ds_read_b64_tr_b16 a[176:177], v28 offset:16384
    v_mul_f32 v187, s75, v187
    v_mfma_f32_16x16x32_bf16 v[132:135], a[192:195], a[52:55], v[132:135]
    ds_read_b64_tr_b16 a[178:179], v28 offset:16896
    v_cvt_pk_bf16_f32 v176, v176, v177
    v_mfma_f32_16x16x32_bf16 v[136:139], a[196:199], a[48:51], v[136:139]
    ds_read_b64_tr_b16 a[180:181], v29 offset:16384
    v_cvt_pk_bf16_f32 v184, v184, v185
    v_mfma_f32_16x16x32_bf16 v[140:143], a[196:199], a[52:55], v[140:143]
    ds_read_b64_tr_b16 a[182:183], v29 offset:16896
    v_cvt_pk_bf16_f32 v177, v178, v179
    v_mfma_f32_16x16x32_bf16 v[144:147], a[200:203], a[48:51], v[144:147]
    ds_read_b64_tr_b16 a[184:185], v30 offset:16384
    v_cvt_pk_bf16_f32 v185, v186, v187
    v_mfma_f32_16x16x32_bf16 v[148:151], a[200:203], a[52:55], v[148:151]
    ds_read_b64_tr_b16 a[186:187], v30 offset:16896
    v_mfma_f32_16x16x32_bf16 v[152:155], a[204:207], a[48:51], v[152:155]
    ds_read_b64_tr_b16 a[188:189], v31 offset:16384
    v_permlane16_swap_b32 v176, v184
    v_mfma_f32_16x16x32_bf16 v[156:159], a[204:207], a[52:55], v[156:159]
    ds_read_b64_tr_b16 a[190:191], v31 offset:16896
    v_permlane16_swap_b32 v177, v185
    s_waitcnt lgkmcnt(8)
    v_mfma_f32_16x16x32_bf16 v[128:131], a[208:211], a[56:59], v[128:131]
    ds_read_b64_tr_b16 a[192:193], v28 offset:20480
    v_accvgpr_write_b32 a136, v176
    s_add_u32 s77, s18, 1573248
    v_mfma_f32_16x16x32_bf16 v[132:135], a[208:211], a[60:63], v[132:135]
    ds_read_b64_tr_b16 a[194:195], v28 offset:20992
    v_accvgpr_write_b32 a138, v184
    v_mfma_f32_16x16x32_bf16 v[136:139], a[212:215], a[56:59], v[136:139]
    ds_read_b64_tr_b16 a[196:197], v29 offset:20480
    v_accvgpr_write_b32 a137, v177
    s_add_u32 m0, s74, 65536
    v_mfma_f32_16x16x32_bf16 v[140:143], a[212:215], a[60:63], v[140:143]
    ds_read_b64_tr_b16 a[198:199], v29 offset:20992
    v_accvgpr_write_b32 a139, v185
    v_mfma_f32_16x16x32_bf16 v[144:147], a[216:219], a[56:59], v[144:147]
    ds_read_b64_tr_b16 a[200:201], v30 offset:20480
    v_mul_f32 v180, s75, v180
    v_mfma_f32_16x16x32_bf16 v[148:151], a[216:219], a[60:63], v[148:151]
    ds_read_b64_tr_b16 a[202:203], v30 offset:20992
    v_mul_f32 v181, s75, v181
    v_mfma_f32_16x16x32_bf16 v[152:155], a[220:223], a[56:59], v[152:155]
    ds_read_b64_tr_b16 a[204:205], v31 offset:20480
    v_mul_f32 v182, s75, v182
    v_mfma_f32_16x16x32_bf16 v[156:159], a[220:223], a[60:63], v[156:159]
    ds_read_b64_tr_b16 a[206:207], v31 offset:20992
    v_mul_f32 v183, s75, v183
    s_waitcnt lgkmcnt(8)
    v_mfma_f32_16x16x32_bf16 v[128:131], a[176:179], a[64:67], v[128:131]
    ds_read_b64_tr_b16 a[208:209], v28 offset:24576
    v_mul_f32 v188, s75, v188
    v_mfma_f32_16x16x32_bf16 v[132:135], a[176:179], a[68:71], v[132:135]
    ds_read_b64_tr_b16 a[210:211], v28 offset:25088
    v_mul_f32 v189, s75, v189
    v_mfma_f32_16x16x32_bf16 v[136:139], a[180:183], a[64:67], v[136:139]
    ds_read_b64_tr_b16 a[212:213], v29 offset:24576
    buffer_load_dwordx4 v196, s[44:47], s77 offen offset:0 lds
    v_mfma_f32_16x16x32_bf16 v[140:143], a[180:183], a[68:71], v[140:143]
    ds_read_b64_tr_b16 a[214:215], v29 offset:25088
    v_mul_f32 v190, s75, v190
    v_mfma_f32_16x16x32_bf16 v[144:147], a[184:187], a[64:67], v[144:147]
    ds_read_b64_tr_b16 a[216:217], v30 offset:24576
    v_mul_f32 v191, s75, v191
    v_mfma_f32_16x16x32_bf16 v[148:151], a[184:187], a[68:71], v[148:151]
    ds_read_b64_tr_b16 a[218:219], v30 offset:25088
    v_cvt_pk_bf16_f32 v180, v180, v181
    v_mfma_f32_16x16x32_bf16 v[152:155], a[188:191], a[64:67], v[152:155]
    ds_read_b64_tr_b16 a[220:221], v31 offset:24576
    v_cvt_pk_bf16_f32 v188, v188, v189
    v_mfma_f32_16x16x32_bf16 v[156:159], a[188:191], a[68:71], v[156:159]
    ds_read_b64_tr_b16 a[222:223], v31 offset:25088
    v_cvt_pk_bf16_f32 v181, v182, v183
    s_waitcnt lgkmcnt(8)
    v_mfma_f32_16x16x32_bf16 v[128:131], a[192:195], a[72:75], v[128:131]
    ds_read_b64_tr_b16 a[176:177], v28 offset:28672
    v_cvt_pk_bf16_f32 v189, v190, v191
    v_mfma_f32_16x16x32_bf16 v[132:135], a[192:195], a[76:79], v[132:135]
    ds_read_b64_tr_b16 a[178:179], v28 offset:29184
    v_permlane16_swap_b32 v180, v188
    v_mfma_f32_16x16x32_bf16 v[136:139], a[196:199], a[72:75], v[136:139]
    ds_read_b64_tr_b16 a[180:181], v29 offset:28672
    v_permlane16_swap_b32 v181, v189
    v_mfma_f32_16x16x32_bf16 v[140:143], a[196:199], a[76:79], v[140:143]
    ds_read_b64_tr_b16 a[182:183], v29 offset:29184
    v_accvgpr_write_b32 a140, v180
    v_mfma_f32_16x16x32_bf16 v[144:147], a[200:203], a[72:75], v[144:147]
    ds_read_b64_tr_b16 a[184:185], v30 offset:28672
    v_accvgpr_write_b32 a142, v188
    v_mfma_f32_16x16x32_bf16 v[148:151], a[200:203], a[76:79], v[148:151]
    ds_read_b64_tr_b16 a[186:187], v30 offset:29184
    v_accvgpr_write_b32 a141, v181
    v_mfma_f32_16x16x32_bf16 v[152:155], a[204:207], a[72:75], v[152:155]
    ds_read_b64_tr_b16 a[188:189], v31 offset:28672
    v_accvgpr_write_b32 a143, v189
    v_mfma_f32_16x16x32_bf16 v[156:159], a[204:207], a[76:79], v[156:159]
    ds_read_b64_tr_b16 a[190:191], v31 offset:29184
    buffer_load_dwordx4 v204, s[44:47], s77 offen offset:1024 lds
    buffer_load_dwordx4 v212, s[44:47], s77 offen offset:2048 lds
    buffer_load_dwordx4 v220, s[44:47], s77 offen offset:3072 lds
    s_mov_b32 s77, 2359680
    s_add_u32 m0, s73, 77824
    s_nop 0
    buffer_load_dwordx4 v40, s[44:47], s77 offen lds
    s_mov_b32 m0, 77824
    s_nop 0
    buffer_load_dwordx4 v220, s[44:47], s77 offen offset:3072 lds
    s_waitcnt lgkmcnt(8)
    v_mfma_f32_16x16x32_bf16 v[128:131], a[208:211], a[80:83], v[128:131]
    s_waitcnt vmcnt(12)
    s_barrier
    ds_read_b64_tr_b16 a[192:193], v28 offset:32768
    v_mfma_f32_16x16x32_bf16 v[132:135], a[208:211], a[84:87], v[132:135]
    ds_read_b64_tr_b16 a[194:195], v28 offset:33280
    v_mfma_f32_16x16x32_bf16 v[136:139], a[212:215], a[80:83], v[136:139]
    ds_read_b64_tr_b16 a[196:197], v29 offset:32768
    v_mfma_f32_16x16x32_bf16 v[140:143], a[212:215], a[84:87], v[140:143]
    ds_read_b64_tr_b16 a[198:199], v29 offset:33280
    v_mfma_f32_16x16x32_bf16 v[144:147], a[216:219], a[80:83], v[144:147]
    ds_read_b64_tr_b16 a[200:201], v30 offset:32768
    v_mfma_f32_16x16x32_bf16 v[148:151], a[216:219], a[84:87], v[148:151]
    ds_read_b64_tr_b16 a[202:203], v30 offset:33280
    v_mfma_f32_16x16x32_bf16 v[152:155], a[220:223], a[80:83], v[152:155]
    ds_read_b64_tr_b16 a[204:205], v31 offset:32768
    v_mfma_f32_16x16x32_bf16 v[156:159], a[220:223], a[84:87], v[156:159]
    ds_read_b64_tr_b16 a[206:207], v31 offset:33280
    s_waitcnt lgkmcnt(8)
    v_mfma_f32_16x16x32_bf16 v[128:131], a[176:179], a[88:91], v[128:131]
    ds_read_b64_tr_b16 a[208:209], v28 offset:36864
    s_add_u32 s77, s18, 2621824
    v_mfma_f32_16x16x32_bf16 v[132:135], a[176:179], a[92:95], v[132:135]
    ds_read_b64_tr_b16 a[210:211], v28 offset:37376
    v_mfma_f32_16x16x32_bf16 v[136:139], a[180:183], a[88:91], v[136:139]
    ds_read_b64_tr_b16 a[212:213], v29 offset:36864
    s_add_u32 m0, s74, 81920
    s_nop 0
    buffer_load_dwordx4 v196, s[44:47], s77 offen offset:0 lds
    v_mfma_f32_16x16x32_bf16 v[140:143], a[180:183], a[92:95], v[140:143]
    ds_read_b64_tr_b16 a[214:215], v29 offset:37376
    buffer_load_dwordx4 v204, s[44:47], s77 offen offset:1024 lds
    v_mfma_f32_16x16x32_bf16 v[144:147], a[184:187], a[88:91], v[144:147]
    ds_read_b64_tr_b16 a[216:217], v30 offset:36864
    buffer_load_dwordx4 v212, s[44:47], s77 offen offset:2048 lds
    v_mfma_f32_16x16x32_bf16 v[148:151], a[184:187], a[92:95], v[148:151]
    ds_read_b64_tr_b16 a[218:219], v30 offset:37376
    buffer_load_dwordx4 v220, s[44:47], s77 offen offset:3072 lds
    v_mfma_f32_16x16x32_bf16 v[152:155], a[188:191], a[88:91], v[152:155]
    ds_read_b64_tr_b16 a[220:221], v31 offset:36864
    v_mfma_f32_16x16x32_bf16 v[156:159], a[188:191], a[92:95], v[156:159]
    ds_read_b64_tr_b16 a[222:223], v31 offset:37376
    s_waitcnt lgkmcnt(8)
    v_mfma_f32_16x16x32_bf16 v[128:131], a[192:195], a[96:99], v[128:131]
    ds_read_b64_tr_b16 a[176:177], v28 offset:40960
    v_mfma_f32_16x16x32_bf16 v[132:135], a[192:195], a[100:103], v[132:135]
    ds_read_b64_tr_b16 a[178:179], v28 offset:41472
    v_mfma_f32_16x16x32_bf16 v[136:139], a[196:199], a[96:99], v[136:139]
    ds_read_b64_tr_b16 a[180:181], v29 offset:40960
    v_mfma_f32_16x16x32_bf16 v[140:143], a[196:199], a[100:103], v[140:143]
    ds_read_b64_tr_b16 a[182:183], v29 offset:41472
    v_mfma_f32_16x16x32_bf16 v[144:147], a[200:203], a[96:99], v[144:147]
    ds_read_b64_tr_b16 a[184:185], v30 offset:40960
    v_mfma_f32_16x16x32_bf16 v[148:151], a[200:203], a[100:103], v[148:151]
    ds_read_b64_tr_b16 a[186:187], v30 offset:41472
    s_mov_b32 s77, 3408256
    v_mfma_f32_16x16x32_bf16 v[152:155], a[204:207], a[96:99], v[152:155]
    ds_read_b64_tr_b16 a[188:189], v31 offset:40960
    v_mfma_f32_16x16x32_bf16 v[156:159], a[204:207], a[100:103], v[156:159]
    ds_read_b64_tr_b16 a[190:191], v31 offset:41472
    s_add_u32 m0, s73, 94208
    s_nop 0
    buffer_load_dwordx4 v40, s[44:47], s77 offen lds
    s_waitcnt lgkmcnt(8)
    v_mfma_f32_16x16x32_bf16 v[128:131], a[208:211], a[104:107], v[128:131]
    ds_read_b64_tr_b16 a[192:193], v28 offset:45056
    v_mfma_f32_16x16x32_bf16 v[132:135], a[208:211], a[108:111], v[132:135]
    ds_read_b64_tr_b16 a[194:195], v28 offset:45568
    v_mfma_f32_16x16x32_bf16 v[136:139], a[212:215], a[104:107], v[136:139]
    ds_read_b64_tr_b16 a[196:197], v29 offset:45056
    v_mfma_f32_16x16x32_bf16 v[140:143], a[212:215], a[108:111], v[140:143]
    ds_read_b64_tr_b16 a[198:199], v29 offset:45568
    s_mov_b32 m0, 94208
    s_nop 0
    buffer_load_dwordx4 v220, s[44:47], s77 offen offset:3072 lds
    v_mfma_f32_16x16x32_bf16 v[144:147], a[216:219], a[104:107], v[144:147]
    ds_read_b64_tr_b16 a[200:201], v30 offset:45056
    v_mfma_f32_16x16x32_bf16 v[148:151], a[216:219], a[108:111], v[148:151]
    ds_read_b64_tr_b16 a[202:203], v30 offset:45568
    v_mfma_f32_16x16x32_bf16 v[152:155], a[220:223], a[104:107], v[152:155]
    ds_read_b64_tr_b16 a[204:205], v31 offset:45056
    v_mfma_f32_16x16x32_bf16 v[156:159], a[220:223], a[108:111], v[156:159]
    ds_read_b64_tr_b16 a[206:207], v31 offset:45568
    s_waitcnt lgkmcnt(8)
    v_mfma_f32_16x16x32_bf16 v[160:163], a[176:179], a[0:3], 0
    s_waitcnt vmcnt(12)
    s_barrier
    ds_read_b64_tr_b16 a[208:209], v28 offset:49152
    v_mfma_f32_16x16x32_bf16 v[164:167], a[176:179], a[4:7], 0
    ds_read_b64_tr_b16 a[210:211], v28 offset:49664
    v_mfma_f32_16x16x32_bf16 v[168:171], a[180:183], a[0:3], 0
    ds_read_b64_tr_b16 a[212:213], v29 offset:49152
    v_mul_f32 v128, s75, v128
    v_mfma_f32_16x16x32_bf16 v[172:175], a[180:183], a[4:7], 0
    ds_read_b64_tr_b16 a[214:215], v29 offset:49664
    v_mul_f32 v129, s75, v129
    v_mfma_f32_16x16x32_bf16 v[176:179], a[184:187], a[0:3], 0
    ds_read_b64_tr_b16 a[216:217], v30 offset:49152
    v_mul_f32 v130, s75, v130
    v_mfma_f32_16x16x32_bf16 v[180:183], a[184:187], a[4:7], 0
    ds_read_b64_tr_b16 a[218:219], v30 offset:49664
    v_mul_f32 v131, s75, v131
    v_mfma_f32_16x16x32_bf16 v[184:187], a[188:191], a[0:3], 0
    ds_read_b64_tr_b16 a[220:221], v31 offset:49152
    v_mul_f32 v136, s75, v136
    v_mfma_f32_16x16x32_bf16 v[188:191], a[188:191], a[4:7], 0
    ds_read_b64_tr_b16 a[222:223], v31 offset:49664
    v_mul_f32 v137, s75, v137
    s_waitcnt lgkmcnt(8)
    v_mfma_f32_16x16x32_bf16 v[160:163], a[192:195], a[8:11], v[160:163]
    ds_read_b64_tr_b16 a[176:177], v28 offset:53248
    v_mul_f32 v138, s75, v138
    v_mfma_f32_16x16x32_bf16 v[164:167], a[192:195], a[12:15], v[164:167]
    ds_read_b64_tr_b16 a[178:179], v28 offset:53760
    v_mul_f32 v139, s75, v139
    v_mfma_f32_16x16x32_bf16 v[168:171], a[196:199], a[8:11], v[168:171]
    ds_read_b64_tr_b16 a[180:181], v29 offset:53248
    v_cvt_pk_bf16_f32 v128, v128, v129
    v_mfma_f32_16x16x32_bf16 v[172:175], a[196:199], a[12:15], v[172:175]
    ds_read_b64_tr_b16 a[182:183], v29 offset:53760
    v_cvt_pk_bf16_f32 v136, v136, v137
    v_mfma_f32_16x16x32_bf16 v[176:179], a[200:203], a[8:11], v[176:179]
    ds_read_b64_tr_b16 a[184:185], v30 offset:53248
    v_cvt_pk_bf16_f32 v129, v130, v131
    v_mfma_f32_16x16x32_bf16 v[180:183], a[200:203], a[12:15], v[180:183]
    ds_read_b64_tr_b16 a[186:187], v30 offset:53760
    v_cvt_pk_bf16_f32 v137, v138, v139
    v_mfma_f32_16x16x32_bf16 v[184:187], a[204:207], a[8:11], v[184:187]
    ds_read_b64_tr_b16 a[188:189], v31 offset:53248
    v_mfma_f32_16x16x32_bf16 v[188:191], a[204:207], a[12:15], v[188:191]
    ds_read_b64_tr_b16 a[190:191], v31 offset:53760
    v_permlane16_swap_b32 v128, v136
    s_waitcnt lgkmcnt(8)
    v_mfma_f32_16x16x32_bf16 v[160:163], a[208:211], a[16:19], v[160:163]
    ds_read_b64_tr_b16 a[192:193], v28 offset:57344
    v_permlane16_swap_b32 v129, v137
    v_mfma_f32_16x16x32_bf16 v[164:167], a[208:211], a[20:23], v[164:167]
    ds_read_b64_tr_b16 a[194:195], v28 offset:57856
    v_accvgpr_write_b32 a144, v128
    v_mfma_f32_16x16x32_bf16 v[168:171], a[212:215], a[16:19], v[168:171]
    ds_read_b64_tr_b16 a[196:197], v29 offset:57344
    v_accvgpr_write_b32 a146, v136
    v_mfma_f32_16x16x32_bf16 v[172:175], a[212:215], a[20:23], v[172:175]
    ds_read_b64_tr_b16 a[198:199], v29 offset:57856
    v_accvgpr_write_b32 a145, v129
    v_mfma_f32_16x16x32_bf16 v[176:179], a[216:219], a[16:19], v[176:179]
    ds_read_b64_tr_b16 a[200:201], v30 offset:57344
    v_accvgpr_write_b32 a147, v137
    v_mfma_f32_16x16x32_bf16 v[180:183], a[216:219], a[20:23], v[180:183]
    ds_read_b64_tr_b16 a[202:203], v30 offset:57856
    v_mul_f32 v132, s75, v132
    v_mfma_f32_16x16x32_bf16 v[184:187], a[220:223], a[16:19], v[184:187]
    ds_read_b64_tr_b16 a[204:205], v31 offset:57344
    v_mul_f32 v133, s75, v133
    v_mfma_f32_16x16x32_bf16 v[188:191], a[220:223], a[20:23], v[188:191]
    ds_read_b64_tr_b16 a[206:207], v31 offset:57856
    v_mul_f32 v134, s75, v134
    s_waitcnt lgkmcnt(8)
    v_mfma_f32_16x16x32_bf16 v[160:163], a[176:179], a[24:27], v[160:163]
    ds_read_b64_tr_b16 a[208:209], v28 offset:61440
    v_mul_f32 v135, s75, v135
    v_mfma_f32_16x16x32_bf16 v[164:167], a[176:179], a[28:31], v[164:167]
    ds_read_b64_tr_b16 a[210:211], v28 offset:61952
    v_mul_f32 v140, s75, v140
    v_mfma_f32_16x16x32_bf16 v[168:171], a[180:183], a[24:27], v[168:171]
    ds_read_b64_tr_b16 a[212:213], v29 offset:61440
    v_mul_f32 v141, s75, v141
    v_mfma_f32_16x16x32_bf16 v[172:175], a[180:183], a[28:31], v[172:175]
    ds_read_b64_tr_b16 a[214:215], v29 offset:61952
    v_mfma_f32_16x16x32_bf16 v[176:179], a[184:187], a[24:27], v[176:179]
    ds_read_b64_tr_b16 a[216:217], v30 offset:61440
    v_mul_f32 v142, s75, v142
    v_mfma_f32_16x16x32_bf16 v[180:183], a[184:187], a[28:31], v[180:183]
    ds_read_b64_tr_b16 a[218:219], v30 offset:61952
    v_mul_f32 v143, s75, v143
    v_mfma_f32_16x16x32_bf16 v[184:187], a[188:191], a[24:27], v[184:187]
    ds_read_b64_tr_b16 a[220:221], v31 offset:61440
    v_cvt_pk_bf16_f32 v132, v132, v133
    v_mfma_f32_16x16x32_bf16 v[188:191], a[188:191], a[28:31], v[188:191]
    ds_read_b64_tr_b16 a[222:223], v31 offset:61952
    v_cvt_pk_bf16_f32 v140, v140, v141
    s_waitcnt lgkmcnt(8)
    v_mfma_f32_16x16x32_bf16 v[160:163], a[192:195], a[32:35], v[160:163]
    s_waitcnt vmcnt(6)
    s_barrier
    ds_read_b64_tr_b16 a[176:177], v28 offset:0
    v_cvt_pk_bf16_f32 v133, v134, v135
    v_mfma_f32_16x16x32_bf16 v[164:167], a[192:195], a[36:39], v[164:167]
    ds_read_b64_tr_b16 a[178:179], v28 offset:512
    v_cvt_pk_bf16_f32 v141, v142, v143
    v_mfma_f32_16x16x32_bf16 v[168:171], a[196:199], a[32:35], v[168:171]
    ds_read_b64_tr_b16 a[180:181], v29 offset:0
    v_permlane16_swap_b32 v132, v140
    v_mfma_f32_16x16x32_bf16 v[172:175], a[196:199], a[36:39], v[172:175]
    ds_read_b64_tr_b16 a[182:183], v29 offset:512
    v_permlane16_swap_b32 v133, v141
    v_mfma_f32_16x16x32_bf16 v[176:179], a[200:203], a[32:35], v[176:179]
    ds_read_b64_tr_b16 a[184:185], v30 offset:0
    v_accvgpr_write_b32 a148, v132
    v_mfma_f32_16x16x32_bf16 v[180:183], a[200:203], a[36:39], v[180:183]
    ds_read_b64_tr_b16 a[186:187], v30 offset:512
    v_accvgpr_write_b32 a150, v140
    v_mfma_f32_16x16x32_bf16 v[184:187], a[204:207], a[32:35], v[184:187]
    ds_read_b64_tr_b16 a[188:189], v31 offset:0
    v_accvgpr_write_b32 a149, v133
    v_mfma_f32_16x16x32_bf16 v[188:191], a[204:207], a[36:39], v[188:191]
    ds_read_b64_tr_b16 a[190:191], v31 offset:512
    v_accvgpr_write_b32 a151, v141
    s_waitcnt lgkmcnt(8)
    v_mfma_f32_16x16x32_bf16 v[160:163], a[208:211], a[40:43], v[160:163]
    ds_read_b64_tr_b16 a[192:193], v28 offset:4096
    v_mfma_f32_16x16x32_bf16 v[164:167], a[208:211], a[44:47], v[164:167]
    ds_read_b64_tr_b16 a[194:195], v28 offset:4608
    v_mul_f32 v144, s75, v144
    v_mfma_f32_16x16x32_bf16 v[168:171], a[212:215], a[40:43], v[168:171]
    ds_read_b64_tr_b16 a[196:197], v29 offset:4096
    v_mul_f32 v145, s75, v145
    v_mfma_f32_16x16x32_bf16 v[172:175], a[212:215], a[44:47], v[172:175]
    ds_read_b64_tr_b16 a[198:199], v29 offset:4608
    v_mul_f32 v146, s75, v146
    v_mfma_f32_16x16x32_bf16 v[176:179], a[216:219], a[40:43], v[176:179]
    ds_read_b64_tr_b16 a[200:201], v30 offset:4096
    v_mul_f32 v147, s75, v147
    v_mfma_f32_16x16x32_bf16 v[180:183], a[216:219], a[44:47], v[180:183]
    ds_read_b64_tr_b16 a[202:203], v30 offset:4608
    v_mul_f32 v152, s75, v152
    v_mfma_f32_16x16x32_bf16 v[184:187], a[220:223], a[40:43], v[184:187]
    ds_read_b64_tr_b16 a[204:205], v31 offset:4096
    v_mul_f32 v153, s75, v153
    v_mfma_f32_16x16x32_bf16 v[188:191], a[220:223], a[44:47], v[188:191]
    ds_read_b64_tr_b16 a[206:207], v31 offset:4608
    v_mul_f32 v154, s75, v154
    s_waitcnt lgkmcnt(8)
    v_mfma_f32_16x16x32_bf16 v[160:163], a[176:179], a[48:51], v[160:163]
    ds_read_b64_tr_b16 a[208:209], v28 offset:8192
    v_mul_f32 v155, s75, v155
    v_mfma_f32_16x16x32_bf16 v[164:167], a[176:179], a[52:55], v[164:167]
    ds_read_b64_tr_b16 a[210:211], v28 offset:8704
    v_cvt_pk_bf16_f32 v144, v144, v145
    v_mfma_f32_16x16x32_bf16 v[168:171], a[180:183], a[48:51], v[168:171]
    ds_read_b64_tr_b16 a[212:213], v29 offset:8192
    v_cvt_pk_bf16_f32 v152, v152, v153
    v_mfma_f32_16x16x32_bf16 v[172:175], a[180:183], a[52:55], v[172:175]
    ds_read_b64_tr_b16 a[214:215], v29 offset:8704
    v_cvt_pk_bf16_f32 v145, v146, v147
    v_mfma_f32_16x16x32_bf16 v[176:179], a[184:187], a[48:51], v[176:179]
    ds_read_b64_tr_b16 a[216:217], v30 offset:8192
    v_cvt_pk_bf16_f32 v153, v154, v155
    v_mfma_f32_16x16x32_bf16 v[180:183], a[184:187], a[52:55], v[180:183]
    ds_read_b64_tr_b16 a[218:219], v30 offset:8704
    v_mfma_f32_16x16x32_bf16 v[184:187], a[188:191], a[48:51], v[184:187]
    ds_read_b64_tr_b16 a[220:221], v31 offset:8192
    v_permlane16_swap_b32 v144, v152
    v_mfma_f32_16x16x32_bf16 v[188:191], a[188:191], a[52:55], v[188:191]
    ds_read_b64_tr_b16 a[222:223], v31 offset:8704
    v_permlane16_swap_b32 v145, v153
    s_waitcnt lgkmcnt(8)
    v_mfma_f32_16x16x32_bf16 v[160:163], a[192:195], a[56:59], v[160:163]
    ds_read_b64_tr_b16 a[176:177], v28 offset:12288
    v_accvgpr_write_b32 a152, v144
    v_mfma_f32_16x16x32_bf16 v[164:167], a[192:195], a[60:63], v[164:167]
    ds_read_b64_tr_b16 a[178:179], v28 offset:12800
    v_accvgpr_write_b32 a154, v152
    v_mfma_f32_16x16x32_bf16 v[168:171], a[196:199], a[56:59], v[168:171]
    ds_read_b64_tr_b16 a[180:181], v29 offset:12288
    v_accvgpr_write_b32 a153, v145
    v_mfma_f32_16x16x32_bf16 v[172:175], a[196:199], a[60:63], v[172:175]
    ds_read_b64_tr_b16 a[182:183], v29 offset:12800
    v_accvgpr_write_b32 a155, v153
    v_mfma_f32_16x16x32_bf16 v[176:179], a[200:203], a[56:59], v[176:179]
    ds_read_b64_tr_b16 a[184:185], v30 offset:12288
    v_mul_f32 v148, s75, v148
    v_mfma_f32_16x16x32_bf16 v[180:183], a[200:203], a[60:63], v[180:183]
    ds_read_b64_tr_b16 a[186:187], v30 offset:12800
    v_mul_f32 v149, s75, v149
    v_mfma_f32_16x16x32_bf16 v[184:187], a[204:207], a[56:59], v[184:187]
    ds_read_b64_tr_b16 a[188:189], v31 offset:12288
    v_mul_f32 v150, s75, v150
    v_mfma_f32_16x16x32_bf16 v[188:191], a[204:207], a[60:63], v[188:191]
    ds_read_b64_tr_b16 a[190:191], v31 offset:12800
    v_mul_f32 v151, s75, v151
    s_waitcnt lgkmcnt(8)
    v_mfma_f32_16x16x32_bf16 v[160:163], a[208:211], a[64:67], v[160:163]
    s_waitcnt vmcnt(0)
    s_barrier
    ds_read_b64_tr_b16 a[192:193], v28 offset:16384
    v_mul_f32 v156, s75, v156
    v_mfma_f32_16x16x32_bf16 v[164:167], a[208:211], a[68:71], v[164:167]
    ds_read_b64_tr_b16 a[194:195], v28 offset:16896
    v_mul_f32 v157, s75, v157
    v_mfma_f32_16x16x32_bf16 v[168:171], a[212:215], a[64:67], v[168:171]
    ds_read_b64_tr_b16 a[196:197], v29 offset:16384
    v_mfma_f32_16x16x32_bf16 v[172:175], a[212:215], a[68:71], v[172:175]
    ds_read_b64_tr_b16 a[198:199], v29 offset:16896
    v_mul_f32 v158, s75, v158
    v_mfma_f32_16x16x32_bf16 v[176:179], a[216:219], a[64:67], v[176:179]
    ds_read_b64_tr_b16 a[200:201], v30 offset:16384
    v_mul_f32 v159, s75, v159
    v_mfma_f32_16x16x32_bf16 v[180:183], a[216:219], a[68:71], v[180:183]
    ds_read_b64_tr_b16 a[202:203], v30 offset:16896
    v_cvt_pk_bf16_f32 v148, v148, v149
    v_mfma_f32_16x16x32_bf16 v[184:187], a[220:223], a[64:67], v[184:187]
    ds_read_b64_tr_b16 a[204:205], v31 offset:16384
    v_cvt_pk_bf16_f32 v156, v156, v157
    v_mfma_f32_16x16x32_bf16 v[188:191], a[220:223], a[68:71], v[188:191]
    ds_read_b64_tr_b16 a[206:207], v31 offset:16896
    v_cvt_pk_bf16_f32 v149, v150, v151
    s_waitcnt lgkmcnt(8)
    v_mfma_f32_16x16x32_bf16 v[160:163], a[176:179], a[72:75], v[160:163]
    ds_read_b64_tr_b16 a[208:209], v28 offset:20480
    v_cvt_pk_bf16_f32 v157, v158, v159
    v_mfma_f32_16x16x32_bf16 v[164:167], a[176:179], a[76:79], v[164:167]
    ds_read_b64_tr_b16 a[210:211], v28 offset:20992
    v_permlane16_swap_b32 v148, v156
    v_mfma_f32_16x16x32_bf16 v[168:171], a[180:183], a[72:75], v[168:171]
    ds_read_b64_tr_b16 a[212:213], v29 offset:20480
    v_permlane16_swap_b32 v149, v157
    v_mfma_f32_16x16x32_bf16 v[172:175], a[180:183], a[76:79], v[172:175]
    ds_read_b64_tr_b16 a[214:215], v29 offset:20992
    v_accvgpr_write_b32 a156, v148
    v_mfma_f32_16x16x32_bf16 v[176:179], a[184:187], a[72:75], v[176:179]
    ds_read_b64_tr_b16 a[216:217], v30 offset:20480
    v_accvgpr_write_b32 a158, v156
    v_mfma_f32_16x16x32_bf16 v[180:183], a[184:187], a[76:79], v[180:183]
    ds_read_b64_tr_b16 a[218:219], v30 offset:20992
    v_accvgpr_write_b32 a157, v149
    v_mfma_f32_16x16x32_bf16 v[184:187], a[188:191], a[72:75], v[184:187]
    ds_read_b64_tr_b16 a[220:221], v31 offset:20480
    v_accvgpr_write_b32 a159, v157
    v_mfma_f32_16x16x32_bf16 v[188:191], a[188:191], a[76:79], v[188:191]
    ds_read_b64_tr_b16 a[222:223], v31 offset:20992
    s_waitcnt lgkmcnt(8)
    v_mfma_f32_16x16x32_bf16 v[160:163], a[192:195], a[80:83], v[160:163]
    ds_read_b64_tr_b16 a[176:177], v28 offset:24576
    v_mfma_f32_16x16x32_bf16 v[164:167], a[192:195], a[84:87], v[164:167]
    ds_read_b64_tr_b16 a[178:179], v28 offset:25088
    v_mfma_f32_16x16x32_bf16 v[168:171], a[196:199], a[80:83], v[168:171]
    ds_read_b64_tr_b16 a[180:181], v29 offset:24576
    v_mfma_f32_16x16x32_bf16 v[172:175], a[196:199], a[84:87], v[172:175]
    ds_read_b64_tr_b16 a[182:183], v29 offset:25088
    v_mfma_f32_16x16x32_bf16 v[176:179], a[200:203], a[80:83], v[176:179]
    ds_read_b64_tr_b16 a[184:185], v30 offset:24576
    v_mfma_f32_16x16x32_bf16 v[180:183], a[200:203], a[84:87], v[180:183]
    ds_read_b64_tr_b16 a[186:187], v30 offset:25088
    v_mfma_f32_16x16x32_bf16 v[184:187], a[204:207], a[80:83], v[184:187]
    ds_read_b64_tr_b16 a[188:189], v31 offset:24576
    v_mfma_f32_16x16x32_bf16 v[188:191], a[204:207], a[84:87], v[188:191]
    ds_read_b64_tr_b16 a[190:191], v31 offset:25088
    s_waitcnt lgkmcnt(8)
    v_mfma_f32_16x16x32_bf16 v[160:163], a[208:211], a[88:91], v[160:163]
    ds_read_b64_tr_b16 a[192:193], v28 offset:28672
    v_mfma_f32_16x16x32_bf16 v[164:167], a[208:211], a[92:95], v[164:167]
    ds_read_b64_tr_b16 a[194:195], v28 offset:29184
    v_mfma_f32_16x16x32_bf16 v[168:171], a[212:215], a[88:91], v[168:171]
    ds_read_b64_tr_b16 a[196:197], v29 offset:28672
    v_mfma_f32_16x16x32_bf16 v[172:175], a[212:215], a[92:95], v[172:175]
    ds_read_b64_tr_b16 a[198:199], v29 offset:29184
    v_mfma_f32_16x16x32_bf16 v[176:179], a[216:219], a[88:91], v[176:179]
    ds_read_b64_tr_b16 a[200:201], v30 offset:28672
    v_mfma_f32_16x16x32_bf16 v[180:183], a[216:219], a[92:95], v[180:183]
    ds_read_b64_tr_b16 a[202:203], v30 offset:29184
    v_mfma_f32_16x16x32_bf16 v[184:187], a[220:223], a[88:91], v[184:187]
    ds_read_b64_tr_b16 a[204:205], v31 offset:28672
    v_mfma_f32_16x16x32_bf16 v[188:191], a[220:223], a[92:95], v[188:191]
    ds_read_b64_tr_b16 a[206:207], v31 offset:29184
    s_waitcnt lgkmcnt(8)
    v_mfma_f32_16x16x32_bf16 v[160:163], a[176:179], a[96:99], v[160:163]
    s_barrier
    ds_read_b128 a[208:211], v4 offset:0
    v_mfma_f32_16x16x32_bf16 v[164:167], a[176:179], a[100:103], v[164:167]
    v_mfma_f32_16x16x32_bf16 v[168:171], a[180:183], a[96:99], v[168:171]
    ds_read_b128 a[212:215], v4 offset:8192
    v_mfma_f32_16x16x32_bf16 v[172:175], a[180:183], a[100:103], v[172:175]
    v_mfma_f32_16x16x32_bf16 v[176:179], a[184:187], a[96:99], v[176:179]
    ds_read_b128 a[216:219], v5 offset:0
    v_mfma_f32_16x16x32_bf16 v[180:183], a[184:187], a[100:103], v[180:183]
    v_mfma_f32_16x16x32_bf16 v[184:187], a[188:191], a[96:99], v[184:187]
    ds_read_b128 a[220:223], v5 offset:8192
    v_mfma_f32_16x16x32_bf16 v[188:191], a[188:191], a[100:103], v[188:191]
    s_waitcnt lgkmcnt(4)
    v_mfma_f32_16x16x32_bf16 v[160:163], a[192:195], a[104:107], v[160:163]
    ds_read_b128 a[176:179], v6 offset:0
    v_mfma_f32_16x16x32_bf16 v[164:167], a[192:195], a[108:111], v[164:167]
    v_mfma_f32_16x16x32_bf16 v[168:171], a[196:199], a[104:107], v[168:171]
    ds_read_b128 a[180:183], v6 offset:8192
    v_mfma_f32_16x16x32_bf16 v[172:175], a[196:199], a[108:111], v[172:175]
    v_mfma_f32_16x16x32_bf16 v[176:179], a[200:203], a[104:107], v[176:179]
    ds_read_b128 a[184:187], v7 offset:0
    v_mfma_f32_16x16x32_bf16 v[180:183], a[200:203], a[108:111], v[180:183]
    v_mfma_f32_16x16x32_bf16 v[184:187], a[204:207], a[104:107], v[184:187]
    ds_read_b128 a[188:191], v7 offset:8192
    v_mfma_f32_16x16x32_bf16 v[188:191], a[204:207], a[108:111], v[188:191]
    s_waitcnt lgkmcnt(4)
    v_mfma_f32_16x16x32_bf16 v[64:67], a[208:211], a[112:115], v[48:51]
    ds_read_b128 a[192:195], v4 offset:256
    v_mfma_f32_16x16x32_bf16 v[68:71], a[208:211], a[116:119], v[52:55]
    v_mfma_f32_16x16x32_bf16 v[72:75], a[212:215], a[112:115], v[48:51]
    ds_read_b128 a[196:199], v4 offset:8448
    v_mul_f32 v160, s75, v160
    v_mfma_f32_16x16x32_bf16 v[76:79], a[212:215], a[116:119], v[52:55]
    v_mul_f32 v161, s75, v161
    v_mul_f32 v162, s75, v162
    v_mfma_f32_16x16x32_bf16 v[64:67], a[216:219], a[120:123], v[64:67]
    ds_read_b128 a[200:203], v5 offset:256
    v_mul_f32 v163, s75, v163
    v_mfma_f32_16x16x32_bf16 v[68:71], a[216:219], a[124:127], v[68:71]
    v_mul_f32 v168, s75, v168
    v_mul_f32 v169, s75, v169
    v_mfma_f32_16x16x32_bf16 v[72:75], a[220:223], a[120:123], v[72:75]
    ds_read_b128 a[204:207], v5 offset:8448
    v_mul_f32 v170, s75, v170
    v_mfma_f32_16x16x32_bf16 v[76:79], a[220:223], a[124:127], v[76:79]
    v_mul_f32 v171, s75, v171
    v_cvt_pk_bf16_f32 v160, v160, v161
    s_waitcnt lgkmcnt(4)
    v_mfma_f32_16x16x32_bf16 v[64:67], a[176:179], a[128:131], v[64:67]
    ds_read_b128 a[208:211], v6 offset:256
    v_cvt_pk_bf16_f32 v168, v168, v169
    v_mfma_f32_16x16x32_bf16 v[68:71], a[176:179], a[132:135], v[68:71]
    v_cvt_pk_bf16_f32 v161, v162, v163
    v_cvt_pk_bf16_f32 v169, v170, v171
    v_mfma_f32_16x16x32_bf16 v[72:75], a[180:183], a[128:131], v[72:75]
    ds_read_b128 a[212:215], v6 offset:8448
    v_permlane16_swap_b32 v160, v168
    v_mfma_f32_16x16x32_bf16 v[76:79], a[180:183], a[132:135], v[76:79]
    v_permlane16_swap_b32 v161, v169
    v_accvgpr_write_b32 a160, v160
    v_mfma_f32_16x16x32_bf16 v[64:67], a[184:187], a[136:139], v[64:67]
    ds_read_b128 a[216:219], v7 offset:256
    v_accvgpr_write_b32 a162, v168
    v_mfma_f32_16x16x32_bf16 v[68:71], a[184:187], a[140:143], v[68:71]
    v_accvgpr_write_b32 a161, v161
    v_accvgpr_write_b32 a163, v169
    v_mfma_f32_16x16x32_bf16 v[72:75], a[188:191], a[136:139], v[72:75]
    ds_read_b128 a[220:223], v7 offset:8448
    v_mul_f32 v164, s75, v164
    v_mfma_f32_16x16x32_bf16 v[76:79], a[188:191], a[140:143], v[76:79]
    v_mul_f32 v165, s75, v165
    v_mul_f32 v166, s75, v166
    s_waitcnt lgkmcnt(4)
    v_mfma_f32_16x16x32_bf16 v[64:67], a[192:195], a[144:147], v[64:67]
    ds_read_b128 a[176:179], v4 offset:16384
    v_mul_f32 v167, s75, v167
    v_mfma_f32_16x16x32_bf16 v[68:71], a[192:195], a[148:151], v[68:71]
    v_mul_f32 v172, s75, v172
    v_mul_f32 v173, s75, v173
    v_mfma_f32_16x16x32_bf16 v[72:75], a[196:199], a[144:147], v[72:75]
    ds_read_b128 a[180:183], v4 offset:24576
    v_mul_f32 v174, s75, v174
    v_mfma_f32_16x16x32_bf16 v[76:79], a[196:199], a[148:151], v[76:79]
    v_mul_f32 v175, s75, v175
    v_cvt_pk_bf16_f32 v164, v164, v165
    v_mfma_f32_16x16x32_bf16 v[64:67], a[200:203], a[152:155], v[64:67]
    ds_read_b128 a[184:187], v5 offset:16384
    v_cvt_pk_bf16_f32 v172, v172, v173
    v_mfma_f32_16x16x32_bf16 v[68:71], a[200:203], a[156:159], v[68:71]
    v_cvt_pk_bf16_f32 v165, v166, v167
    v_cvt_pk_bf16_f32 v173, v174, v175
    v_mfma_f32_16x16x32_bf16 v[72:75], a[204:207], a[152:155], v[72:75]
    ds_read_b128 a[188:191], v5 offset:24576
    v_permlane16_swap_b32 v164, v172
    v_permlane16_swap_b32 v165, v173
    v_accvgpr_write_b32 a164, v164
    v_accvgpr_write_b32 a166, v172
    v_accvgpr_write_b32 a165, v165
    v_accvgpr_write_b32 a167, v173
    v_mul_f32 v176, s75, v176
    v_mul_f32 v177, s75, v177
    v_mul_f32 v178, s75, v178
    v_mul_f32 v179, s75, v179
    v_mul_f32 v184, s75, v184
    v_mul_f32 v185, s75, v185
    v_mul_f32 v186, s75, v186
    v_mul_f32 v187, s75, v187
    v_cvt_pk_bf16_f32 v176, v176, v177
    v_cvt_pk_bf16_f32 v184, v184, v185
    v_cvt_pk_bf16_f32 v177, v178, v179
    v_cvt_pk_bf16_f32 v185, v186, v187
    v_permlane16_swap_b32 v176, v184
    s_nop 0
    v_permlane16_swap_b32 v177, v185
    v_accvgpr_write_b32 a168, v176
    v_accvgpr_write_b32 a170, v184
    v_accvgpr_write_b32 a169, v177
    v_accvgpr_write_b32 a171, v185
    v_mul_f32 v180, s75, v180
    v_mul_f32 v181, s75, v181
    v_mul_f32 v182, s75, v182
    v_mul_f32 v183, s75, v183
    v_mul_f32 v188, s75, v188
    v_mul_f32 v189, s75, v189
    v_mul_f32 v190, s75, v190
    v_mul_f32 v191, s75, v191
    v_cvt_pk_bf16_f32 v180, v180, v181
    v_cvt_pk_bf16_f32 v188, v188, v189
    v_cvt_pk_bf16_f32 v181, v182, v183
    v_cvt_pk_bf16_f32 v189, v190, v191
    v_permlane16_swap_b32 v180, v188
    s_nop 0
    v_permlane16_swap_b32 v181, v189
    v_accvgpr_write_b32 a172, v180
    v_accvgpr_write_b32 a174, v188
    v_accvgpr_write_b32 a173, v181
    v_accvgpr_write_b32 a175, v189
    v_mfma_f32_16x16x32_bf16 v[76:79], a[204:207], a[156:159], v[76:79]
    s_waitcnt lgkmcnt(4)
    v_mfma_f32_16x16x32_bf16 v[64:67], a[208:211], a[160:163], v[64:67]
    ds_read_b128 a[192:195], v6 offset:16384
    v_mfma_f32_16x16x32_bf16 v[68:71], a[208:211], a[164:167], v[68:71]
    v_mfma_f32_16x16x32_bf16 v[72:75], a[212:215], a[160:163], v[72:75]
    ds_read_b128 a[196:199], v6 offset:24576
    v_mfma_f32_16x16x32_bf16 v[76:79], a[212:215], a[164:167], v[76:79]
    v_mfma_f32_16x16x32_bf16 v[64:67], a[216:219], a[168:171], v[64:67]
    ds_read_b128 a[200:203], v7 offset:16384
    v_mfma_f32_16x16x32_bf16 v[68:71], a[216:219], a[172:175], v[68:71]
    v_mfma_f32_16x16x32_bf16 v[72:75], a[220:223], a[168:171], v[72:75]
    ds_read_b128 a[204:207], v7 offset:24576
    v_mfma_f32_16x16x32_bf16 v[76:79], a[220:223], a[172:175], v[76:79]
    s_waitcnt lgkmcnt(4)
    v_mfma_f32_16x16x32_bf16 v[80:83], a[176:179], a[112:115], v[48:51]
    ds_read_b128 a[208:211], v4 offset:16640
    v_mfma_f32_16x16x32_bf16 v[84:87], a[176:179], a[116:119], v[52:55]
    v_mfma_f32_16x16x32_bf16 v[88:91], a[180:183], a[112:115], v[48:51]
    ds_read_b128 a[212:215], v4 offset:24832
    v_max3_f32 v46, v64, v65, v66
    v_mfma_f32_16x16x32_bf16 v[92:95], a[180:183], a[116:119], v[52:55]
    v_max3_f32 v47, v68, v69, v70
    v_max3_f32 v46, v46, v67, v72
    v_mfma_f32_16x16x32_bf16 v[80:83], a[184:187], a[120:123], v[80:83]
    ds_read_b128 a[216:219], v5 offset:16640
    v_max3_f32 v47, v47, v71, v76
    v_mfma_f32_16x16x32_bf16 v[84:87], a[184:187], a[124:127], v[84:87]
    v_max3_f32 v46, v46, v73, v74
    v_max3_f32 v47, v47, v77, v78
    v_mfma_f32_16x16x32_bf16 v[88:91], a[188:191], a[120:123], v[88:91]
    ds_read_b128 a[220:223], v5 offset:24832
    v_max_f32 v46, v46, v75
    v_mfma_f32_16x16x32_bf16 v[92:95], a[188:191], a[124:127], v[92:95]
    v_max_f32 v47, v47, v79
    v_mov_b32 v1, v46
    s_waitcnt lgkmcnt(4)
    v_mfma_f32_16x16x32_bf16 v[80:83], a[192:195], a[128:131], v[80:83]
    ds_read_b128 a[176:179], v6 offset:16640
    v_mov_b32 v2, v47
    v_mfma_f32_16x16x32_bf16 v[84:87], a[192:195], a[132:135], v[84:87]
    v_permlane32_swap_b32 v46, v1
    v_permlane32_swap_b32 v47, v2
    v_mfma_f32_16x16x32_bf16 v[88:91], a[196:199], a[128:131], v[88:91]
    ds_read_b128 a[180:183], v6 offset:24832
    v_max_f32 v46, v46, v1
    v_mfma_f32_16x16x32_bf16 v[92:95], a[196:199], a[132:135], v[92:95]
    v_max_f32 v47, v47, v2
    v_mov_b32 v1, v46
    v_mfma_f32_16x16x32_bf16 v[80:83], a[200:203], a[136:139], v[80:83]
    ds_read_b128 a[184:187], v7 offset:16640
    v_mov_b32 v2, v47
    v_mfma_f32_16x16x32_bf16 v[84:87], a[200:203], a[140:143], v[84:87]
    v_permlane16_swap_b32 v46, v1
    v_permlane16_swap_b32 v47, v2
    v_mfma_f32_16x16x32_bf16 v[88:91], a[204:207], a[136:139], v[88:91]
    ds_read_b128 a[188:191], v7 offset:24832
    v_max_f32 v46, v46, v1
    v_mfma_f32_16x16x32_bf16 v[92:95], a[204:207], a[140:143], v[92:95]
    v_max_f32 v47, v47, v2
    v_mul_f32 v46, s76, v46
    s_waitcnt lgkmcnt(4)
    v_mfma_f32_16x16x32_bf16 v[80:83], a[208:211], a[144:147], v[80:83]
    s_barrier
    ds_read_b64_tr_b16 a[192:193], v20 offset:32768
    v_mul_f32 v47, s76, v47
    v_mfma_f32_16x16x32_bf16 v[84:87], a[208:211], a[148:151], v[84:87]
    ds_read_b64_tr_b16 a[194:195], v20 offset:40960
    v_sub_f32 v64, v64, v46
    v_mfma_f32_16x16x32_bf16 v[88:91], a[212:215], a[144:147], v[88:91]
    ds_read_b64_tr_b16 a[196:197], v21 offset:32768
    v_sub_f32 v65, v65, v46
    v_mfma_f32_16x16x32_bf16 v[92:95], a[212:215], a[148:151], v[92:95]
    ds_read_b64_tr_b16 a[198:199], v21 offset:40960
    v_exp_f32 v64, v64
    v_mfma_f32_16x16x32_bf16 v[80:83], a[216:219], a[152:155], v[80:83]
    ds_read_b64_tr_b16 a[200:201], v22 offset:32768
    v_sub_f32 v66, v66, v46
    v_mfma_f32_16x16x32_bf16 v[84:87], a[216:219], a[156:159], v[84:87]
    ds_read_b64_tr_b16 a[202:203], v22 offset:40960
    v_exp_f32 v65, v65
    v_mfma_f32_16x16x32_bf16 v[88:91], a[220:223], a[152:155], v[88:91]
    ds_read_b64_tr_b16 a[204:205], v23 offset:32768
    v_sub_f32 v67, v67, v46
    v_mfma_f32_16x16x32_bf16 v[92:95], a[220:223], a[156:159], v[92:95]
    ds_read_b64_tr_b16 a[206:207], v23 offset:40960
    v_exp_f32 v66, v66
    s_waitcnt lgkmcnt(8)
    v_mfma_f32_16x16x32_bf16 v[80:83], a[176:179], a[160:163], v[80:83]
    ds_read_b64_tr_b16 a[208:209], v24 offset:32768
    v_cvt_pk_bf16_f32 v96, v64, v65
    s_add_u32 m0, s74, 0
    v_mfma_f32_16x16x32_bf16 v[84:87], a[176:179], a[164:167], v[84:87]
    ds_read_b64_tr_b16 a[210:211], v24 offset:40960
    v_sub_f32 v72, v72, v46
    v_mfma_f32_16x16x32_bf16 v[88:91], a[180:183], a[160:163], v[88:91]
    ds_read_b64_tr_b16 a[212:213], v25 offset:32768
    v_exp_f32 v67, v67
    v_mfma_f32_16x16x32_bf16 v[92:95], a[180:183], a[164:167], v[92:95]
    ds_read_b64_tr_b16 a[214:215], v25 offset:40960
    v_sub_f32 v73, v73, v46
    v_mfma_f32_16x16x32_bf16 v[80:83], a[184:187], a[168:171], v[80:83]
    ds_read_b64_tr_b16 a[216:217], v26 offset:32768
    v_exp_f32 v72, v72
    s_mov_b32 s77, 81920
    v_mfma_f32_16x16x32_bf16 v[84:87], a[184:187], a[172:175], v[84:87]
    ds_read_b64_tr_b16 a[218:219], v26 offset:40960
    v_cvt_pk_bf16_f32 v97, v66, v67
    v_mfma_f32_16x16x32_bf16 v[88:91], a[188:191], a[168:171], v[88:91]
    ds_read_b64_tr_b16 a[220:221], v27 offset:32768
    v_sub_f32 v74, v74, v46
    v_mfma_f32_16x16x32_bf16 v[92:95], a[188:191], a[172:175], v[92:95]
    ds_read_b64_tr_b16 a[222:223], v27 offset:40960
    v_exp_f32 v73, v73
    v_sub_f32 v75, v75, v46
    v_exp_f32 v74, v74
    v_cvt_pk_bf16_f32 v98, v72, v73
    v_sub_f32 v68, v68, v47
    v_exp_f32 v75, v75
    v_sub_f32 v69, v69, v47
    v_exp_f32 v68, v68
    v_cvt_pk_bf16_f32 v99, v74, v75
    v_sub_f32 v70, v70, v47
    v_exp_f32 v69, v69
    v_sub_f32 v71, v71, v47
    v_exp_f32 v70, v70
    v_cvt_pk_bf16_f32 v100, v68, v69
    v_sub_f32 v76, v76, v47
    v_exp_f32 v71, v71
    v_sub_f32 v77, v77, v47
    v_exp_f32 v76, v76
    v_cvt_pk_bf16_f32 v101, v70, v71
    v_sub_f32 v78, v78, v47
    v_exp_f32 v77, v77
    v_sub_f32 v79, v79, v47
    v_exp_f32 v78, v78
    v_cvt_pk_bf16_f32 v102, v76, v77
    v_exp_f32 v79, v79
    s_nop 0
    v_cvt_pk_bf16_f32 v103, v78, v79
    v_mfma_f32_16x16x32_bf16 v[56:59], a[224:227], v[96:99], 0
    ds_read_b64_tr_b16 a[176:177], v20 offset:33024
    v_sub_f32 v48, v48, v46
    v_mfma_f32_16x16x32_bf16 v[60:63], a[224:227], v[100:103], 0
    ds_read_b64_tr_b16 a[178:179], v20 offset:41216
    buffer_load_dwordx4 v36, s[36:39], s77 offen offset:0 nt lds
    s_waitcnt lgkmcnt(10)
    v_mfma_f32_16x16x32_bf16 v[128:131], a[192:195], v[96:99], 0
    ds_read_b64_tr_b16 a[180:181], v21 offset:33024
    v_sub_f32 v80, v80, v46
    v_mfma_f32_16x16x32_bf16 v[132:135], a[192:195], v[100:103], 0
    ds_read_b64_tr_b16 a[182:183], v21 offset:41216
    v_sub_f32 v81, v81, v46
    v_mfma_f32_16x16x32_bf16 v[136:139], a[196:199], v[96:99], 0
    ds_read_b64_tr_b16 a[184:185], v22 offset:33024
    v_sub_f32 v49, v49, v46
    v_mfma_f32_16x16x32_bf16 v[140:143], a[196:199], v[100:103], 0
    ds_read_b64_tr_b16 a[186:187], v22 offset:41216
    buffer_load_dwordx4 v37, s[36:39], s77 offen offset:1024 nt lds
    v_mfma_f32_16x16x32_bf16 v[144:147], a[200:203], v[96:99], 0
    ds_read_b64_tr_b16 a[188:189], v23 offset:33024
    buffer_load_dwordx4 v38, s[36:39], s77 offen offset:2048 nt lds
    v_mfma_f32_16x16x32_bf16 v[148:151], a[200:203], v[100:103], 0
    ds_read_b64_tr_b16 a[190:191], v23 offset:41216
    buffer_load_dwordx4 v39, s[36:39], s77 offen offset:3072 nt lds
    v_mfma_f32_16x16x32_bf16 v[152:155], a[204:207], v[96:99], 0
    v_sub_f32 v50, v50, v46
    v_mfma_f32_16x16x32_bf16 v[156:159], a[204:207], v[100:103], 0
    v_exp_f32 v80, v80
    s_waitcnt lgkmcnt(8)
    v_mfma_f32_16x16x32_bf16 v[160:163], a[208:211], v[96:99], 0
    ds_read_b64_tr_b16 a[192:193], v24 offset:33024
    v_sub_f32 v82, v82, v46
    v_mfma_f32_16x16x32_bf16 v[164:167], a[208:211], v[100:103], 0
    ds_read_b64_tr_b16 a[194:195], v24 offset:41216
    v_mfma_f32_16x16x32_bf16 v[168:171], a[212:215], v[96:99], 0
    ds_read_b64_tr_b16 a[196:197], v25 offset:33024
    v_sub_f32 v51, v51, v46
    v_mfma_f32_16x16x32_bf16 v[172:175], a[212:215], v[100:103], 0
    ds_read_b64_tr_b16 a[198:199], v25 offset:41216
    v_mfma_f32_16x16x32_bf16 v[176:179], a[216:219], v[96:99], 0
    ds_read_b64_tr_b16 a[200:201], v26 offset:33024
    v_mfma_f32_16x16x32_bf16 v[180:183], a[216:219], v[100:103], 0
    ds_read_b64_tr_b16 a[202:203], v26 offset:41216
    v_mfma_f32_16x16x32_bf16 v[184:187], a[220:223], v[96:99], 0
    ds_read_b64_tr_b16 a[204:205], v27 offset:33024
    v_sub_f32 v52, v52, v47
    v_mfma_f32_16x16x32_bf16 v[188:191], a[220:223], v[100:103], 0
    ds_read_b64_tr_b16 a[206:207], v27 offset:41216
    s_waitcnt lgkmcnt(8)
    v_mfma_f32_16x16x32_bf16 v[192:195], a[176:179], v[96:99], 0
    ds_read_b128 a[208:211], v4 offset:32768
    v_mfma_f32_16x16x32_bf16 v[196:199], a[176:179], v[100:103], 0
    v_exp_f32 v81, v81
    v_mfma_f32_16x16x32_bf16 v[200:203], a[180:183], v[96:99], 0
    ds_read_b128 a[212:215], v4 offset:40960
    v_sub_f32 v53, v53, v47
    v_mfma_f32_16x16x32_bf16 v[204:207], a[180:183], v[100:103], 0
    v_sub_f32 v83, v83, v46
    s_add_u32 m0, s74, 16384
    v_mfma_f32_16x16x32_bf16 v[208:211], a[184:187], v[96:99], 0
    ds_read_b128 a[216:219], v5 offset:32768
    v_mfma_f32_16x16x32_bf16 v[212:215], a[184:187], v[100:103], 0
    v_exp_f32 v82, v82
    v_mfma_f32_16x16x32_bf16 v[216:219], a[188:191], v[96:99], 0
    ds_read_b128 a[220:223], v5 offset:40960
    v_sub_f32 v54, v54, v47
    v_mfma_f32_16x16x32_bf16 v[220:223], a[188:191], v[100:103], 0
    v_cvt_pk_bf16_f32 v104, v80, v81
    v_sub_f32 v88, v88, v46
    s_mov_b32 s77, 98304
    s_waitcnt lgkmcnt(4)
    v_mfma_f32_16x16x32_bf16 v[224:227], a[192:195], v[96:99], 0
    ds_read_b128 a[176:179], v6 offset:32768
    buffer_load_dwordx4 v36, s[36:39], s77 offen offset:0 nt lds
    v_mfma_f32_16x16x32_bf16 v[228:231], a[192:195], v[100:103], 0
    v_exp_f32 v83, v83
    v_mfma_f32_16x16x32_bf16 v[232:235], a[196:199], v[96:99], 0
    ds_read_b128 a[180:183], v6 offset:40960
    v_sub_f32 v55, v55, v47
    v_mfma_f32_16x16x32_bf16 v[236:239], a[196:199], v[100:103], 0
    v_sub_f32 v89, v89, v46
    buffer_load_dwordx4 v37, s[36:39], s77 offen offset:1024 nt lds
    v_mfma_f32_16x16x32_bf16 v[240:243], a[200:203], v[96:99], 0
    ds_read_b128 a[184:187], v7 offset:32768
    buffer_load_dwordx4 v38, s[36:39], s77 offen offset:2048 nt lds
    v_mfma_f32_16x16x32_bf16 v[244:247], a[200:203], v[100:103], 0
    v_exp_f32 v88, v88
    v_mfma_f32_16x16x32_bf16 v[248:251], a[204:207], v[96:99], 0
    ds_read_b128 a[188:191], v7 offset:40960
    v_cvt_pk_bf16_f32 v105, v82, v83
    v_mfma_f32_16x16x32_bf16 v[252:255], a[204:207], v[100:103], 0
    v_sub_f32 v90, v90, v46
    buffer_load_dwordx4 v39, s[36:39], s77 offen offset:3072 nt lds
    s_waitcnt lgkmcnt(4)
    v_mfma_f32_16x16x32_bf16 v[64:67], a[208:211], a[112:115], v[48:51]
    ds_read_b128 a[192:195], v4 offset:33024
    v_mfma_f32_16x16x32_bf16 v[68:71], a[208:211], a[116:119], v[52:55]
    v_exp_f32 v89, v89
    v_mfma_f32_16x16x32_bf16 v[72:75], a[212:215], a[112:115], v[48:51]
    ds_read_b128 a[196:199], v4 offset:41216
    v_sub_f32 v91, v91, v46
    v_mfma_f32_16x16x32_bf16 v[76:79], a[212:215], a[116:119], v[52:55]
    v_exp_f32 v90, v90
    v_mfma_f32_16x16x32_bf16 v[64:67], a[216:219], a[120:123], v[64:67]
    ds_read_b128 a[200:203], v5 offset:33024
    v_cvt_pk_bf16_f32 v106, v88, v89
    v_mfma_f32_16x16x32_bf16 v[68:71], a[216:219], a[124:127], v[68:71]
    v_sub_f32 v84, v84, v47
    v_mfma_f32_16x16x32_bf16 v[72:75], a[220:223], a[120:123], v[72:75]
    ds_read_b128 a[204:207], v5 offset:41216
    v_mfma_f32_16x16x32_bf16 v[76:79], a[220:223], a[124:127], v[76:79]
    v_exp_f32 v91, v91
    s_waitcnt lgkmcnt(4)
    v_mfma_f32_16x16x32_bf16 v[64:67], a[176:179], a[128:131], v[64:67]
    ds_read_b128 a[208:211], v6 offset:33024
    v_sub_f32 v85, v85, v47
    v_mfma_f32_16x16x32_bf16 v[68:71], a[176:179], a[132:135], v[68:71]
    v_exp_f32 v84, v84
    v_mfma_f32_16x16x32_bf16 v[72:75], a[180:183], a[128:131], v[72:75]
    ds_read_b128 a[212:215], v6 offset:41216
    v_cvt_pk_bf16_f32 v107, v90, v91
    v_mfma_f32_16x16x32_bf16 v[76:79], a[180:183], a[132:135], v[76:79]
    v_sub_f32 v86, v86, v47
    v_mfma_f32_16x16x32_bf16 v[64:67], a[184:187], a[136:139], v[64:67]
    ds_read_b128 a[216:219], v7 offset:33024
    v_mfma_f32_16x16x32_bf16 v[68:71], a[184:187], a[140:143], v[68:71]
    v_exp_f32 v85, v85
    v_mfma_f32_16x16x32_bf16 v[72:75], a[188:191], a[136:139], v[72:75]
    ds_read_b128 a[220:223], v7 offset:41216
    v_sub_f32 v87, v87, v47
    v_mfma_f32_16x16x32_bf16 v[76:79], a[188:191], a[140:143], v[76:79]
    v_exp_f32 v86, v86
    s_waitcnt lgkmcnt(4)
    v_mfma_f32_16x16x32_bf16 v[64:67], a[192:195], a[144:147], v[64:67]
    s_barrier
    ds_read_b64_tr_b16 a[176:177], v20 offset:49152
    v_cvt_pk_bf16_f32 v108, v84, v85
    v_mfma_f32_16x16x32_bf16 v[68:71], a[192:195], a[148:151], v[68:71]
    ds_read_b64_tr_b16 a[178:179], v20 offset:57344
    v_sub_f32 v92, v92, v47
    v_mfma_f32_16x16x32_bf16 v[72:75], a[196:199], a[144:147], v[72:75]
    ds_read_b64_tr_b16 a[180:181], v21 offset:49152
    v_exp_f32 v87, v87
    v_mfma_f32_16x16x32_bf16 v[76:79], a[196:199], a[148:151], v[76:79]
    ds_read_b64_tr_b16 a[182:183], v21 offset:57344
    v_sub_f32 v93, v93, v47
    v_mfma_f32_16x16x32_bf16 v[64:67], a[200:203], a[152:155], v[64:67]
    ds_read_b64_tr_b16 a[184:185], v22 offset:49152
    v_exp_f32 v92, v92
    v_mfma_f32_16x16x32_bf16 v[68:71], a[200:203], a[156:159], v[68:71]
    ds_read_b64_tr_b16 a[186:187], v22 offset:57344
    v_cvt_pk_bf16_f32 v109, v86, v87
    v_mfma_f32_16x16x32_bf16 v[72:75], a[204:207], a[152:155], v[72:75]
    ds_read_b64_tr_b16 a[188:189], v23 offset:49152
    v_sub_f32 v94, v94, v47
    v_mfma_f32_16x16x32_bf16 v[76:79], a[204:207], a[156:159], v[76:79]
    ds_read_b64_tr_b16 a[190:191], v23 offset:57344
    v_exp_f32 v93, v93
    s_waitcnt lgkmcnt(8)
    v_mfma_f32_16x16x32_bf16 v[64:67], a[208:211], a[160:163], v[64:67]
    ds_read_b64_tr_b16 a[192:193], v24 offset:49152
    v_sub_f32 v95, v95, v47
    s_add_u32 m0, s74, 131072
    v_mfma_f32_16x16x32_bf16 v[68:71], a[208:211], a[164:167], v[68:71]
    ds_read_b64_tr_b16 a[194:195], v24 offset:57344
    v_exp_f32 v94, v94
    v_mfma_f32_16x16x32_bf16 v[72:75], a[212:215], a[160:163], v[72:75]
    ds_read_b64_tr_b16 a[196:197], v25 offset:49152
    v_mfma_f32_16x16x32_bf16 v[76:79], a[212:215], a[164:167], v[76:79]
    ds_read_b64_tr_b16 a[198:199], v25 offset:57344
    v_cvt_pk_bf16_f32 v110, v92, v93
    v_mfma_f32_16x16x32_bf16 v[64:67], a[216:219], a[168:171], v[64:67]
    ds_read_b64_tr_b16 a[200:201], v26 offset:49152
    v_exp_f32 v95, v95
    v_mfma_f32_16x16x32_bf16 v[68:71], a[216:219], a[172:175], v[68:71]
    ds_read_b64_tr_b16 a[202:203], v26 offset:57344
    v_mfma_f32_16x16x32_bf16 v[72:75], a[220:223], a[168:171], v[72:75]
    ds_read_b64_tr_b16 a[204:205], v27 offset:49152
    v_cvt_pk_bf16_f32 v111, v94, v95
    v_mfma_f32_16x16x32_bf16 v[76:79], a[220:223], a[172:175], v[76:79]
    ds_read_b64_tr_b16 a[206:207], v27 offset:57344
    v_mfma_f32_16x16x32_bf16 v[56:59], a[224:227], v[104:107], v[56:59]
    ds_read_b64_tr_b16 a[208:209], v20 offset:49408
    v_mfma_f32_16x16x32_bf16 v[60:63], a[224:227], v[108:111], v[60:63]
    ds_read_b64_tr_b16 a[210:211], v20 offset:57600
    s_mov_b32 s77, 81920
    s_waitcnt lgkmcnt(10)
    v_mfma_f32_16x16x32_bf16 v[128:131], a[176:179], v[104:107], v[128:131]
    ds_read_b64_tr_b16 a[212:213], v21 offset:49408
    v_mfma_f32_16x16x32_bf16 v[132:135], a[176:179], v[108:111], v[132:135]
    ds_read_b64_tr_b16 a[214:215], v21 offset:57600
    v_mfma_f32_16x16x32_bf16 v[136:139], a[180:183], v[104:107], v[136:139]
    ds_read_b64_tr_b16 a[216:217], v22 offset:49408
    v_mfma_f32_16x16x32_bf16 v[140:143], a[180:183], v[108:111], v[140:143]
    ds_read_b64_tr_b16 a[218:219], v22 offset:57600
    v_mfma_f32_16x16x32_bf16 v[144:147], a[184:187], v[104:107], v[144:147]
    ds_read_b64_tr_b16 a[220:221], v23 offset:49408
    v_mfma_f32_16x16x32_bf16 v[148:151], a[184:187], v[108:111], v[148:151]
    ds_read_b64_tr_b16 a[222:223], v23 offset:57600
    v_mfma_f32_16x16x32_bf16 v[152:155], a[188:191], v[104:107], v[152:155]
    v_exp_f32 v64, v64
    v_mfma_f32_16x16x32_bf16 v[156:159], a[188:191], v[108:111], v[156:159]
    v_exp_f32 v65, v65
    s_waitcnt lgkmcnt(8)
    v_mfma_f32_16x16x32_bf16 v[160:163], a[192:195], v[104:107], v[160:163]
    ds_read_b64_tr_b16 a[176:177], v24 offset:49408
    v_mfma_f32_16x16x32_bf16 v[164:167], a[192:195], v[108:111], v[164:167]
    ds_read_b64_tr_b16 a[178:179], v24 offset:57600
    v_mfma_f32_16x16x32_bf16 v[168:171], a[196:199], v[104:107], v[168:171]
    ds_read_b64_tr_b16 a[180:181], v25 offset:49408
    v_mfma_f32_16x16x32_bf16 v[172:175], a[196:199], v[108:111], v[172:175]
    ds_read_b64_tr_b16 a[182:183], v25 offset:57600
    v_mfma_f32_16x16x32_bf16 v[176:179], a[200:203], v[104:107], v[176:179]
    ds_read_b64_tr_b16 a[184:185], v26 offset:49408
    v_mfma_f32_16x16x32_bf16 v[180:183], a[200:203], v[108:111], v[180:183]
    ds_read_b64_tr_b16 a[186:187], v26 offset:57600
    v_mfma_f32_16x16x32_bf16 v[184:187], a[204:207], v[104:107], v[184:187]
    ds_read_b64_tr_b16 a[188:189], v27 offset:49408
    v_mfma_f32_16x16x32_bf16 v[188:191], a[204:207], v[108:111], v[188:191]
    ds_read_b64_tr_b16 a[190:191], v27 offset:57600
    s_waitcnt lgkmcnt(8)
    v_mfma_f32_16x16x32_bf16 v[192:195], a[208:211], v[104:107], v[192:195]
    ds_read_b128 a[192:195], v4 offset:49152
    v_mfma_f32_16x16x32_bf16 v[196:199], a[208:211], v[108:111], v[196:199]
    v_exp_f32 v66, v66
    v_mfma_f32_16x16x32_bf16 v[200:203], a[212:215], v[104:107], v[200:203]
    ds_read_b128 a[196:199], v4 offset:57344
    v_cvt_pk_bf16_f32 v96, v64, v65
    v_mfma_f32_16x16x32_bf16 v[204:207], a[212:215], v[108:111], v[204:207]
    v_exp_f32 v67, v67
    v_mfma_f32_16x16x32_bf16 v[208:211], a[216:219], v[104:107], v[208:211]
    ds_read_b128 a[200:203], v5 offset:49152
    v_mfma_f32_16x16x32_bf16 v[212:215], a[216:219], v[108:111], v[212:215]
    v_exp_f32 v72, v72
    v_mfma_f32_16x16x32_bf16 v[216:219], a[220:223], v[104:107], v[216:219]
    ds_read_b128 a[204:207], v5 offset:57344
    v_cvt_pk_bf16_f32 v97, v66, v67
    v_mfma_f32_16x16x32_bf16 v[220:223], a[220:223], v[108:111], v[220:223]
    v_exp_f32 v73, v73
    s_waitcnt lgkmcnt(4)
    v_mfma_f32_16x16x32_bf16 v[224:227], a[176:179], v[104:107], v[224:227]
    ds_read_b128 a[208:211], v6 offset:49152
    v_mfma_f32_16x16x32_bf16 v[228:231], a[176:179], v[108:111], v[228:231]
    v_exp_f32 v74, v74
    v_mfma_f32_16x16x32_bf16 v[232:235], a[180:183], v[104:107], v[232:235]
    ds_read_b128 a[212:215], v6 offset:57344
    v_cvt_pk_bf16_f32 v98, v72, v73
    v_mfma_f32_16x16x32_bf16 v[236:239], a[180:183], v[108:111], v[236:239]
    v_exp_f32 v75, v75
    v_mfma_f32_16x16x32_bf16 v[240:243], a[184:187], v[104:107], v[240:243]
    ds_read_b128 a[216:219], v7 offset:49152
    v_mfma_f32_16x16x32_bf16 v[244:247], a[184:187], v[108:111], v[244:247]
    v_exp_f32 v68, v68
    v_mfma_f32_16x16x32_bf16 v[248:251], a[188:191], v[104:107], v[248:251]
    ds_read_b128 a[220:223], v7 offset:57344
    v_mfma_f32_16x16x32_bf16 v[252:255], a[188:191], v[108:111], v[252:255]
    buffer_load_dwordx4 v32, s[40:43], s77 offen offset:0 nt lds
    s_waitcnt lgkmcnt(4)
    v_mfma_f32_16x16x32_bf16 v[80:83], a[192:195], a[112:115], v[48:51]
    ds_read_b128 a[176:179], v4 offset:49408
    v_cvt_pk_bf16_f32 v99, v74, v75
    v_mfma_f32_16x16x32_bf16 v[84:87], a[192:195], a[116:119], v[52:55]
    buffer_load_dwordx4 v33, s[40:43], s77 offen offset:1024 nt lds
    v_mfma_f32_16x16x32_bf16 v[88:91], a[196:199], a[112:115], v[48:51]
    ds_read_b128 a[180:183], v4 offset:57600
    v_mfma_f32_16x16x32_bf16 v[92:95], a[196:199], a[116:119], v[52:55]
    v_exp_f32 v69, v69
    v_mfma_f32_16x16x32_bf16 v[80:83], a[200:203], a[120:123], v[80:83]
    ds_read_b128 a[184:187], v5 offset:49408
    v_mfma_f32_16x16x32_bf16 v[84:87], a[200:203], a[124:127], v[84:87]
    v_exp_f32 v70, v70
    v_mfma_f32_16x16x32_bf16 v[88:91], a[204:207], a[120:123], v[88:91]
    ds_read_b128 a[188:191], v5 offset:57600
    v_mfma_f32_16x16x32_bf16 v[92:95], a[204:207], a[124:127], v[92:95]
    buffer_load_dwordx4 v34, s[40:43], s77 offen offset:2048 nt lds
    s_waitcnt lgkmcnt(4)
    v_mfma_f32_16x16x32_bf16 v[80:83], a[208:211], a[128:131], v[80:83]
    ds_read_b128 a[192:195], v6 offset:49408
    v_cvt_pk_bf16_f32 v100, v68, v69
    v_mfma_f32_16x16x32_bf16 v[84:87], a[208:211], a[132:135], v[84:87]
    buffer_load_dwordx4 v35, s[40:43], s77 offen offset:3072 nt lds
    v_mfma_f32_16x16x32_bf16 v[88:91], a[212:215], a[128:131], v[88:91]
    ds_read_b128 a[196:199], v6 offset:57600
    v_mfma_f32_16x16x32_bf16 v[92:95], a[212:215], a[132:135], v[92:95]
    v_exp_f32 v71, v71
    v_mfma_f32_16x16x32_bf16 v[80:83], a[216:219], a[136:139], v[80:83]
    ds_read_b128 a[200:203], v7 offset:49408
    v_mfma_f32_16x16x32_bf16 v[84:87], a[216:219], a[140:143], v[84:87]
    v_exp_f32 v76, v76
    v_mfma_f32_16x16x32_bf16 v[88:91], a[220:223], a[136:139], v[88:91]
    ds_read_b128 a[204:207], v7 offset:57600
    v_mfma_f32_16x16x32_bf16 v[92:95], a[220:223], a[140:143], v[92:95]
    s_waitcnt lgkmcnt(4)
    v_mfma_f32_16x16x32_bf16 v[80:83], a[176:179], a[144:147], v[80:83]
    s_barrier
    ds_read_b64_tr_b16 a[208:209], v12 offset:32768
    v_cvt_pk_bf16_f32 v101, v70, v71
    v_mfma_f32_16x16x32_bf16 v[84:87], a[176:179], a[148:151], v[84:87]
    ds_read_b64_tr_b16 a[210:211], v12 offset:40960
    v_exp_f32 v77, v77
    v_mfma_f32_16x16x32_bf16 v[88:91], a[180:183], a[144:147], v[88:91]
    ds_read_b64_tr_b16 a[212:213], v13 offset:32768
    v_exp_f32 v78, v78
    v_mfma_f32_16x16x32_bf16 v[92:95], a[180:183], a[148:151], v[92:95]
    ds_read_b64_tr_b16 a[214:215], v13 offset:40960
    v_mfma_f32_16x16x32_bf16 v[80:83], a[184:187], a[152:155], v[80:83]
    ds_read_b64_tr_b16 a[216:217], v14 offset:32768
    v_mfma_f32_16x16x32_bf16 v[84:87], a[184:187], a[156:159], v[84:87]
    ds_read_b64_tr_b16 a[218:219], v14 offset:40960
    v_mfma_f32_16x16x32_bf16 v[88:91], a[188:191], a[152:155], v[88:91]
    ds_read_b64_tr_b16 a[220:221], v15 offset:32768
    v_mfma_f32_16x16x32_bf16 v[92:95], a[188:191], a[156:159], v[92:95]
    ds_read_b64_tr_b16 a[222:223], v15 offset:40960
    s_waitcnt lgkmcnt(8)
    v_mfma_f32_16x16x32_bf16 v[80:83], a[192:195], a[160:163], v[80:83]
    ds_read_b64_tr_b16 a[176:177], v16 offset:32768
    v_cvt_pk_bf16_f32 v102, v76, v77
    s_add_u32 m0, s74, 147456
    v_mfma_f32_16x16x32_bf16 v[84:87], a[192:195], a[164:167], v[84:87]
    ds_read_b64_tr_b16 a[178:179], v16 offset:40960
    v_exp_f32 v79, v79
    v_mfma_f32_16x16x32_bf16 v[88:91], a[196:199], a[160:163], v[88:91]
    ds_read_b64_tr_b16 a[180:181], v17 offset:32768
    v_mfma_f32_16x16x32_bf16 v[92:95], a[196:199], a[164:167], v[92:95]
    ds_read_b64_tr_b16 a[182:183], v17 offset:40960
    v_mfma_f32_16x16x32_bf16 v[80:83], a[200:203], a[168:171], v[80:83]
    ds_read_b64_tr_b16 a[184:185], v18 offset:32768
    v_mfma_f32_16x16x32_bf16 v[84:87], a[200:203], a[172:175], v[84:87]
    ds_read_b64_tr_b16 a[186:187], v18 offset:40960
    v_cvt_pk_bf16_f32 v103, v78, v79
    v_mfma_f32_16x16x32_bf16 v[88:91], a[204:207], a[168:171], v[88:91]
    ds_read_b64_tr_b16 a[188:189], v19 offset:32768
    v_mfma_f32_16x16x32_bf16 v[92:95], a[204:207], a[172:175], v[92:95]
    ds_read_b64_tr_b16 a[190:191], v19 offset:40960
    v_mfma_f32_16x16x32_bf16 v[56:59], a[224:227], v[96:99], v[56:59]
    ds_read_b64_tr_b16 a[192:193], v12 offset:33024
    v_mfma_f32_16x16x32_bf16 v[60:63], a[224:227], v[100:103], v[60:63]
    ds_read_b64_tr_b16 a[194:195], v12 offset:41216
    s_mov_b32 s77, 98304
    s_waitcnt lgkmcnt(10)
    v_mfma_f32_16x16x32_bf16 v[128:131], a[208:211], v[96:99], v[128:131]
    ds_read_b64_tr_b16 a[196:197], v13 offset:33024
    v_mfma_f32_16x16x32_bf16 v[132:135], a[208:211], v[100:103], v[132:135]
    ds_read_b64_tr_b16 a[198:199], v13 offset:41216
    v_mfma_f32_16x16x32_bf16 v[136:139], a[212:215], v[96:99], v[136:139]
    ds_read_b64_tr_b16 a[200:201], v14 offset:33024
    v_mfma_f32_16x16x32_bf16 v[140:143], a[212:215], v[100:103], v[140:143]
    ds_read_b64_tr_b16 a[202:203], v14 offset:41216
    v_mfma_f32_16x16x32_bf16 v[144:147], a[216:219], v[96:99], v[144:147]
    ds_read_b64_tr_b16 a[204:205], v15 offset:33024
    v_mfma_f32_16x16x32_bf16 v[148:151], a[216:219], v[100:103], v[148:151]
    ds_read_b64_tr_b16 a[206:207], v15 offset:41216
    v_mfma_f32_16x16x32_bf16 v[152:155], a[220:223], v[96:99], v[152:155]
    v_exp_f32 v80, v80
    v_mfma_f32_16x16x32_bf16 v[156:159], a[220:223], v[100:103], v[156:159]
    v_exp_f32 v81, v81
    s_waitcnt lgkmcnt(8)
    v_mfma_f32_16x16x32_bf16 v[160:163], a[176:179], v[96:99], v[160:163]
    ds_read_b64_tr_b16 a[208:209], v16 offset:33024
    v_mfma_f32_16x16x32_bf16 v[164:167], a[176:179], v[100:103], v[164:167]
    ds_read_b64_tr_b16 a[210:211], v16 offset:41216
    v_mfma_f32_16x16x32_bf16 v[168:171], a[180:183], v[96:99], v[168:171]
    ds_read_b64_tr_b16 a[212:213], v17 offset:33024
    v_mfma_f32_16x16x32_bf16 v[172:175], a[180:183], v[100:103], v[172:175]
    ds_read_b64_tr_b16 a[214:215], v17 offset:41216
    v_mfma_f32_16x16x32_bf16 v[176:179], a[184:187], v[96:99], v[176:179]
    ds_read_b64_tr_b16 a[216:217], v18 offset:33024
    v_mfma_f32_16x16x32_bf16 v[180:183], a[184:187], v[100:103], v[180:183]
    ds_read_b64_tr_b16 a[218:219], v18 offset:41216
    v_mfma_f32_16x16x32_bf16 v[184:187], a[188:191], v[96:99], v[184:187]
    ds_read_b64_tr_b16 a[220:221], v19 offset:33024
    v_mfma_f32_16x16x32_bf16 v[188:191], a[188:191], v[100:103], v[188:191]
    ds_read_b64_tr_b16 a[222:223], v19 offset:41216
    s_waitcnt lgkmcnt(8)
    v_mfma_f32_16x16x32_bf16 v[192:195], a[192:195], v[96:99], v[192:195]
    ds_read_b128 a[176:179], v8 offset:49152
    v_mfma_f32_16x16x32_bf16 v[196:199], a[192:195], v[100:103], v[196:199]
    v_exp_f32 v82, v82
    v_mfma_f32_16x16x32_bf16 v[200:203], a[196:199], v[96:99], v[200:203]
    ds_read_b128 a[180:183], v8 offset:57344
    v_cvt_pk_bf16_f32 v104, v80, v81
    v_mfma_f32_16x16x32_bf16 v[204:207], a[196:199], v[100:103], v[204:207]
    v_exp_f32 v83, v83
    v_mfma_f32_16x16x32_bf16 v[208:211], a[200:203], v[96:99], v[208:211]
    ds_read_b128 a[184:187], v9 offset:49152
    v_mfma_f32_16x16x32_bf16 v[212:215], a[200:203], v[100:103], v[212:215]
    v_exp_f32 v88, v88
    v_mfma_f32_16x16x32_bf16 v[216:219], a[204:207], v[96:99], v[216:219]
    ds_read_b128 a[188:191], v9 offset:57344
    v_cvt_pk_bf16_f32 v105, v82, v83
    v_mfma_f32_16x16x32_bf16 v[220:223], a[204:207], v[100:103], v[220:223]
    v_exp_f32 v89, v89
    s_waitcnt lgkmcnt(4)
    v_mfma_f32_16x16x32_bf16 v[224:227], a[208:211], v[96:99], v[224:227]
    ds_read_b128 a[192:195], v10 offset:49152
    v_mfma_f32_16x16x32_bf16 v[228:231], a[208:211], v[100:103], v[228:231]
    v_exp_f32 v90, v90
    v_mfma_f32_16x16x32_bf16 v[232:235], a[212:215], v[96:99], v[232:235]
    ds_read_b128 a[196:199], v10 offset:57344
    v_cvt_pk_bf16_f32 v106, v88, v89
    v_mfma_f32_16x16x32_bf16 v[236:239], a[212:215], v[100:103], v[236:239]
    v_exp_f32 v91, v91
    v_mfma_f32_16x16x32_bf16 v[240:243], a[216:219], v[96:99], v[240:243]
    ds_read_b128 a[200:203], v11 offset:49152
    v_mfma_f32_16x16x32_bf16 v[244:247], a[216:219], v[100:103], v[244:247]
    v_exp_f32 v84, v84
    v_mfma_f32_16x16x32_bf16 v[248:251], a[220:223], v[96:99], v[248:251]
    ds_read_b128 a[204:207], v11 offset:57344
    v_mfma_f32_16x16x32_bf16 v[252:255], a[220:223], v[100:103], v[252:255]
    buffer_load_dwordx4 v32, s[40:43], s77 offen offset:0 nt lds
    s_waitcnt lgkmcnt(4)
    v_mfma_f32_16x16x32_bf16 v[64:67], a[176:179], a[112:115], v[48:51]
    ds_read_b128 a[208:211], v8 offset:49408
    v_cvt_pk_bf16_f32 v107, v90, v91
    v_mfma_f32_16x16x32_bf16 v[68:71], a[176:179], a[116:119], v[52:55]
    buffer_load_dwordx4 v33, s[40:43], s77 offen offset:1024 nt lds
    v_mfma_f32_16x16x32_bf16 v[72:75], a[180:183], a[112:115], v[48:51]
    ds_read_b128 a[212:215], v8 offset:57600
    v_mfma_f32_16x16x32_bf16 v[76:79], a[180:183], a[116:119], v[52:55]
    v_exp_f32 v85, v85
    v_mfma_f32_16x16x32_bf16 v[64:67], a[184:187], a[120:123], v[64:67]
    ds_read_b128 a[216:219], v9 offset:49408
    v_mfma_f32_16x16x32_bf16 v[68:71], a[184:187], a[124:127], v[68:71]
    v_exp_f32 v86, v86
    v_mfma_f32_16x16x32_bf16 v[72:75], a[188:191], a[120:123], v[72:75]
    ds_read_b128 a[220:223], v9 offset:57600
    v_mfma_f32_16x16x32_bf16 v[76:79], a[188:191], a[124:127], v[76:79]
    buffer_load_dwordx4 v34, s[40:43], s77 offen offset:2048 nt lds
    s_waitcnt lgkmcnt(4)
    v_mfma_f32_16x16x32_bf16 v[64:67], a[192:195], a[128:131], v[64:67]
    ds_read_b128 a[176:179], v10 offset:49408
    v_cvt_pk_bf16_f32 v108, v84, v85
    v_mfma_f32_16x16x32_bf16 v[68:71], a[192:195], a[132:135], v[68:71]
    buffer_load_dwordx4 v35, s[40:43], s77 offen offset:3072 nt lds
    v_mfma_f32_16x16x32_bf16 v[72:75], a[196:199], a[128:131], v[72:75]
    ds_read_b128 a[180:183], v10 offset:57600
    v_mfma_f32_16x16x32_bf16 v[76:79], a[196:199], a[132:135], v[76:79]
    v_exp_f32 v87, v87
    v_mfma_f32_16x16x32_bf16 v[64:67], a[200:203], a[136:139], v[64:67]
    ds_read_b128 a[184:187], v11 offset:49408
    v_mfma_f32_16x16x32_bf16 v[68:71], a[200:203], a[140:143], v[68:71]
    v_exp_f32 v92, v92
    v_mfma_f32_16x16x32_bf16 v[72:75], a[204:207], a[136:139], v[72:75]
    ds_read_b128 a[188:191], v11 offset:57600
    v_mfma_f32_16x16x32_bf16 v[76:79], a[204:207], a[140:143], v[76:79]
    s_waitcnt lgkmcnt(4)
    v_mfma_f32_16x16x32_bf16 v[64:67], a[208:211], a[144:147], v[64:67]
    s_waitcnt vmcnt(12)
    s_barrier
    ds_read_b64_tr_b16 a[192:193], v12 offset:0
    v_cvt_pk_bf16_f32 v109, v86, v87
    v_mfma_f32_16x16x32_bf16 v[68:71], a[208:211], a[148:151], v[68:71]
    ds_read_b64_tr_b16 a[194:195], v12 offset:8192
    v_exp_f32 v93, v93
    v_mfma_f32_16x16x32_bf16 v[72:75], a[212:215], a[144:147], v[72:75]
    ds_read_b64_tr_b16 a[196:197], v13 offset:0
    v_exp_f32 v94, v94
    v_mfma_f32_16x16x32_bf16 v[76:79], a[212:215], a[148:151], v[76:79]
    ds_read_b64_tr_b16 a[198:199], v13 offset:8192
    v_mfma_f32_16x16x32_bf16 v[64:67], a[216:219], a[152:155], v[64:67]
    ds_read_b64_tr_b16 a[200:201], v14 offset:0
    v_mfma_f32_16x16x32_bf16 v[68:71], a[216:219], a[156:159], v[68:71]
    ds_read_b64_tr_b16 a[202:203], v14 offset:8192
    v_mfma_f32_16x16x32_bf16 v[72:75], a[220:223], a[152:155], v[72:75]
    ds_read_b64_tr_b16 a[204:205], v15 offset:0
    v_mfma_f32_16x16x32_bf16 v[76:79], a[220:223], a[156:159], v[76:79]
    ds_read_b64_tr_b16 a[206:207], v15 offset:8192
    s_waitcnt lgkmcnt(8)
    v_mfma_f32_16x16x32_bf16 v[64:67], a[176:179], a[160:163], v[64:67]
    ds_read_b64_tr_b16 a[208:209], v16 offset:0
    v_cvt_pk_bf16_f32 v110, v92, v93
    s_add_u32 m0, s74, 98304
    v_mfma_f32_16x16x32_bf16 v[68:71], a[176:179], a[164:167], v[68:71]
    ds_read_b64_tr_b16 a[210:211], v16 offset:8192
    v_exp_f32 v95, v95
    v_mfma_f32_16x16x32_bf16 v[72:75], a[180:183], a[160:163], v[72:75]
    ds_read_b64_tr_b16 a[212:213], v17 offset:0
    v_mfma_f32_16x16x32_bf16 v[76:79], a[180:183], a[164:167], v[76:79]
    ds_read_b64_tr_b16 a[214:215], v17 offset:8192
    v_mfma_f32_16x16x32_bf16 v[64:67], a[184:187], a[168:171], v[64:67]
    ds_read_b64_tr_b16 a[216:217], v18 offset:0
    v_mfma_f32_16x16x32_bf16 v[68:71], a[184:187], a[172:175], v[68:71]
    ds_read_b64_tr_b16 a[218:219], v18 offset:8192
    v_cvt_pk_bf16_f32 v111, v94, v95
    v_mfma_f32_16x16x32_bf16 v[72:75], a[188:191], a[168:171], v[72:75]
    ds_read_b64_tr_b16 a[220:221], v19 offset:0
    v_mfma_f32_16x16x32_bf16 v[76:79], a[188:191], a[172:175], v[76:79]
    ds_read_b64_tr_b16 a[222:223], v19 offset:8192
    v_mfma_f32_16x16x32_bf16 v[56:59], a[224:227], v[104:107], v[56:59]
    ds_read_b64_tr_b16 a[176:177], v12 offset:256
    v_mfma_f32_16x16x32_bf16 v[60:63], a[224:227], v[108:111], v[60:63]
    ds_read_b64_tr_b16 a[178:179], v12 offset:8448
    s_mov_b32 s77, 114688
    s_waitcnt lgkmcnt(10)
    v_mfma_f32_16x16x32_bf16 v[128:131], a[192:195], v[104:107], v[128:131]
    ds_read_b64_tr_b16 a[180:181], v13 offset:256
    v_mfma_f32_16x16x32_bf16 v[132:135], a[192:195], v[108:111], v[132:135]
    ds_read_b64_tr_b16 a[182:183], v13 offset:8448
    v_mfma_f32_16x16x32_bf16 v[136:139], a[196:199], v[104:107], v[136:139]
    ds_read_b64_tr_b16 a[184:185], v14 offset:256
    v_mfma_f32_16x16x32_bf16 v[140:143], a[196:199], v[108:111], v[140:143]
    ds_read_b64_tr_b16 a[186:187], v14 offset:8448
    v_mfma_f32_16x16x32_bf16 v[144:147], a[200:203], v[104:107], v[144:147]
    ds_read_b64_tr_b16 a[188:189], v15 offset:256
    v_mfma_f32_16x16x32_bf16 v[148:151], a[200:203], v[108:111], v[148:151]
    ds_read_b64_tr_b16 a[190:191], v15 offset:8448
    v_mfma_f32_16x16x32_bf16 v[152:155], a[204:207], v[104:107], v[152:155]
    v_exp_f32 v64, v64
    v_mfma_f32_16x16x32_bf16 v[156:159], a[204:207], v[108:111], v[156:159]
    v_exp_f32 v65, v65
    s_waitcnt lgkmcnt(8)
    v_mfma_f32_16x16x32_bf16 v[160:163], a[208:211], v[104:107], v[160:163]
    ds_read_b64_tr_b16 a[192:193], v16 offset:256
    v_mfma_f32_16x16x32_bf16 v[164:167], a[208:211], v[108:111], v[164:167]
    ds_read_b64_tr_b16 a[194:195], v16 offset:8448
    v_mfma_f32_16x16x32_bf16 v[168:171], a[212:215], v[104:107], v[168:171]
    ds_read_b64_tr_b16 a[196:197], v17 offset:256
    v_mfma_f32_16x16x32_bf16 v[172:175], a[212:215], v[108:111], v[172:175]
    ds_read_b64_tr_b16 a[198:199], v17 offset:8448
    v_mfma_f32_16x16x32_bf16 v[176:179], a[216:219], v[104:107], v[176:179]
    ds_read_b64_tr_b16 a[200:201], v18 offset:256
    v_mfma_f32_16x16x32_bf16 v[180:183], a[216:219], v[108:111], v[180:183]
    ds_read_b64_tr_b16 a[202:203], v18 offset:8448
    v_mfma_f32_16x16x32_bf16 v[184:187], a[220:223], v[104:107], v[184:187]
    ds_read_b64_tr_b16 a[204:205], v19 offset:256
    v_mfma_f32_16x16x32_bf16 v[188:191], a[220:223], v[108:111], v[188:191]
    ds_read_b64_tr_b16 a[206:207], v19 offset:8448
    s_waitcnt lgkmcnt(8)
    v_mfma_f32_16x16x32_bf16 v[192:195], a[176:179], v[104:107], v[192:195]
    ds_read_b128 a[208:211], v4 offset:0
    v_mfma_f32_16x16x32_bf16 v[196:199], a[176:179], v[108:111], v[196:199]
    v_exp_f32 v66, v66
    v_mfma_f32_16x16x32_bf16 v[200:203], a[180:183], v[104:107], v[200:203]
    ds_read_b128 a[212:215], v4 offset:8192
    v_cvt_pk_bf16_f32 v96, v64, v65
    v_mfma_f32_16x16x32_bf16 v[204:207], a[180:183], v[108:111], v[204:207]
    v_exp_f32 v67, v67
    v_mfma_f32_16x16x32_bf16 v[208:211], a[184:187], v[104:107], v[208:211]
    ds_read_b128 a[216:219], v5 offset:0
    v_mfma_f32_16x16x32_bf16 v[212:215], a[184:187], v[108:111], v[212:215]
    v_exp_f32 v72, v72
    v_mfma_f32_16x16x32_bf16 v[216:219], a[188:191], v[104:107], v[216:219]
    ds_read_b128 a[220:223], v5 offset:8192
    v_cvt_pk_bf16_f32 v97, v66, v67
    v_mfma_f32_16x16x32_bf16 v[220:223], a[188:191], v[108:111], v[220:223]
    v_exp_f32 v73, v73
    s_waitcnt lgkmcnt(4)
    v_mfma_f32_16x16x32_bf16 v[224:227], a[192:195], v[104:107], v[224:227]
    ds_read_b128 a[176:179], v6 offset:0
    v_mfma_f32_16x16x32_bf16 v[228:231], a[192:195], v[108:111], v[228:231]
    v_exp_f32 v74, v74
    v_mfma_f32_16x16x32_bf16 v[232:235], a[196:199], v[104:107], v[232:235]
    ds_read_b128 a[180:183], v6 offset:8192
    v_cvt_pk_bf16_f32 v98, v72, v73
    v_mfma_f32_16x16x32_bf16 v[236:239], a[196:199], v[108:111], v[236:239]
    v_exp_f32 v75, v75
    v_mfma_f32_16x16x32_bf16 v[240:243], a[200:203], v[104:107], v[240:243]
    ds_read_b128 a[184:187], v7 offset:0
    v_mfma_f32_16x16x32_bf16 v[244:247], a[200:203], v[108:111], v[244:247]
    v_exp_f32 v68, v68
    v_mfma_f32_16x16x32_bf16 v[248:251], a[204:207], v[104:107], v[248:251]
    ds_read_b128 a[188:191], v7 offset:8192
    v_mfma_f32_16x16x32_bf16 v[252:255], a[204:207], v[108:111], v[252:255]
    buffer_load_dwordx4 v32, s[40:43], s77 offen offset:0 nt lds
    s_waitcnt lgkmcnt(4)
    v_mfma_f32_16x16x32_bf16 v[80:83], a[208:211], a[112:115], v[48:51]
    ds_read_b128 a[192:195], v4 offset:256
    v_cvt_pk_bf16_f32 v99, v74, v75
    v_mfma_f32_16x16x32_bf16 v[84:87], a[208:211], a[116:119], v[52:55]
    buffer_load_dwordx4 v33, s[40:43], s77 offen offset:1024 nt lds
    v_mfma_f32_16x16x32_bf16 v[88:91], a[212:215], a[112:115], v[48:51]
    ds_read_b128 a[196:199], v4 offset:8448
    v_mfma_f32_16x16x32_bf16 v[92:95], a[212:215], a[116:119], v[52:55]
    v_exp_f32 v69, v69
    v_mfma_f32_16x16x32_bf16 v[80:83], a[216:219], a[120:123], v[80:83]
    ds_read_b128 a[200:203], v5 offset:256
    v_mfma_f32_16x16x32_bf16 v[84:87], a[216:219], a[124:127], v[84:87]
    v_exp_f32 v70, v70
    v_mfma_f32_16x16x32_bf16 v[88:91], a[220:223], a[120:123], v[88:91]
    ds_read_b128 a[204:207], v5 offset:8448
    v_mfma_f32_16x16x32_bf16 v[92:95], a[220:223], a[124:127], v[92:95]
    buffer_load_dwordx4 v34, s[40:43], s77 offen offset:2048 nt lds
    s_waitcnt lgkmcnt(4)
    v_mfma_f32_16x16x32_bf16 v[80:83], a[176:179], a[128:131], v[80:83]
    ds_read_b128 a[208:211], v6 offset:256
    v_cvt_pk_bf16_f32 v100, v68, v69
    v_mfma_f32_16x16x32_bf16 v[84:87], a[176:179], a[132:135], v[84:87]
    buffer_load_dwordx4 v35, s[40:43], s77 offen offset:3072 nt lds
    v_mfma_f32_16x16x32_bf16 v[88:91], a[180:183], a[128:131], v[88:91]
    ds_read_b128 a[212:215], v6 offset:8448
    v_mfma_f32_16x16x32_bf16 v[92:95], a[180:183], a[132:135], v[92:95]
    v_exp_f32 v71, v71
    v_mfma_f32_16x16x32_bf16 v[80:83], a[184:187], a[136:139], v[80:83]
    ds_read_b128 a[216:219], v7 offset:256
    v_mfma_f32_16x16x32_bf16 v[84:87], a[184:187], a[140:143], v[84:87]
    v_exp_f32 v76, v76
    v_mfma_f32_16x16x32_bf16 v[88:91], a[188:191], a[136:139], v[88:91]
    ds_read_b128 a[220:223], v7 offset:8448
    v_mfma_f32_16x16x32_bf16 v[92:95], a[188:191], a[140:143], v[92:95]
    s_waitcnt lgkmcnt(4)
    v_mfma_f32_16x16x32_bf16 v[80:83], a[192:195], a[144:147], v[80:83]
    s_waitcnt vmcnt(12)
    s_barrier
    ds_read_b64_tr_b16 a[176:177], v12 offset:16384
    v_cvt_pk_bf16_f32 v101, v70, v71
    v_mfma_f32_16x16x32_bf16 v[84:87], a[192:195], a[148:151], v[84:87]
    ds_read_b64_tr_b16 a[178:179], v12 offset:24576
    v_exp_f32 v77, v77
    v_mfma_f32_16x16x32_bf16 v[88:91], a[196:199], a[144:147], v[88:91]
    ds_read_b64_tr_b16 a[180:181], v13 offset:16384
    v_exp_f32 v78, v78
    v_mfma_f32_16x16x32_bf16 v[92:95], a[196:199], a[148:151], v[92:95]
    ds_read_b64_tr_b16 a[182:183], v13 offset:24576
    v_mfma_f32_16x16x32_bf16 v[80:83], a[200:203], a[152:155], v[80:83]
    ds_read_b64_tr_b16 a[184:185], v14 offset:16384
    v_mfma_f32_16x16x32_bf16 v[84:87], a[200:203], a[156:159], v[84:87]
    ds_read_b64_tr_b16 a[186:187], v14 offset:24576
    v_mfma_f32_16x16x32_bf16 v[88:91], a[204:207], a[152:155], v[88:91]
    ds_read_b64_tr_b16 a[188:189], v15 offset:16384
    v_mfma_f32_16x16x32_bf16 v[92:95], a[204:207], a[156:159], v[92:95]
    ds_read_b64_tr_b16 a[190:191], v15 offset:24576
    s_waitcnt lgkmcnt(8)
    v_mfma_f32_16x16x32_bf16 v[80:83], a[208:211], a[160:163], v[80:83]
    ds_read_b64_tr_b16 a[192:193], v16 offset:16384
    v_cvt_pk_bf16_f32 v102, v76, v77
    s_add_u32 m0, s74, 65536
    v_mfma_f32_16x16x32_bf16 v[84:87], a[208:211], a[164:167], v[84:87]
    ds_read_b64_tr_b16 a[194:195], v16 offset:24576
    v_exp_f32 v79, v79
    v_mfma_f32_16x16x32_bf16 v[88:91], a[212:215], a[160:163], v[88:91]
    ds_read_b64_tr_b16 a[196:197], v17 offset:16384
    v_mfma_f32_16x16x32_bf16 v[92:95], a[212:215], a[164:167], v[92:95]
    ds_read_b64_tr_b16 a[198:199], v17 offset:24576
    v_mfma_f32_16x16x32_bf16 v[80:83], a[216:219], a[168:171], v[80:83]
    ds_read_b64_tr_b16 a[200:201], v18 offset:16384
    v_mfma_f32_16x16x32_bf16 v[84:87], a[216:219], a[172:175], v[84:87]
    ds_read_b64_tr_b16 a[202:203], v18 offset:24576
    v_cvt_pk_bf16_f32 v103, v78, v79
    v_mfma_f32_16x16x32_bf16 v[88:91], a[220:223], a[168:171], v[88:91]
    ds_read_b64_tr_b16 a[204:205], v19 offset:16384
    v_mfma_f32_16x16x32_bf16 v[92:95], a[220:223], a[172:175], v[92:95]
    ds_read_b64_tr_b16 a[206:207], v19 offset:24576
    v_mfma_f32_16x16x32_bf16 v[56:59], a[224:227], v[96:99], v[56:59]
    ds_read_b64_tr_b16 a[208:209], v12 offset:16640
    v_mfma_f32_16x16x32_bf16 v[60:63], a[224:227], v[100:103], v[60:63]
    ds_read_b64_tr_b16 a[210:211], v12 offset:24832
    s_mov_b32 s77, 131072
    s_waitcnt lgkmcnt(10)
    v_mfma_f32_16x16x32_bf16 v[128:131], a[176:179], v[96:99], v[128:131]
    ds_read_b64_tr_b16 a[212:213], v13 offset:16640
    v_mfma_f32_16x16x32_bf16 v[132:135], a[176:179], v[100:103], v[132:135]
    ds_read_b64_tr_b16 a[214:215], v13 offset:24832
    v_mfma_f32_16x16x32_bf16 v[136:139], a[180:183], v[96:99], v[136:139]
    ds_read_b64_tr_b16 a[216:217], v14 offset:16640
    v_mfma_f32_16x16x32_bf16 v[140:143], a[180:183], v[100:103], v[140:143]
    ds_read_b64_tr_b16 a[218:219], v14 offset:24832
    v_mfma_f32_16x16x32_bf16 v[144:147], a[184:187], v[96:99], v[144:147]
    ds_read_b64_tr_b16 a[220:221], v15 offset:16640
    v_mfma_f32_16x16x32_bf16 v[148:151], a[184:187], v[100:103], v[148:151]
    ds_read_b64_tr_b16 a[222:223], v15 offset:24832
    v_mfma_f32_16x16x32_bf16 v[152:155], a[188:191], v[96:99], v[152:155]
    v_exp_f32 v80, v80
    v_mfma_f32_16x16x32_bf16 v[156:159], a[188:191], v[100:103], v[156:159]
    v_exp_f32 v81, v81
    s_waitcnt lgkmcnt(8)
    v_mfma_f32_16x16x32_bf16 v[160:163], a[192:195], v[96:99], v[160:163]
    ds_read_b64_tr_b16 a[176:177], v16 offset:16640
    v_mfma_f32_16x16x32_bf16 v[164:167], a[192:195], v[100:103], v[164:167]
    ds_read_b64_tr_b16 a[178:179], v16 offset:24832
    v_mfma_f32_16x16x32_bf16 v[168:171], a[196:199], v[96:99], v[168:171]
    ds_read_b64_tr_b16 a[180:181], v17 offset:16640
    v_mfma_f32_16x16x32_bf16 v[172:175], a[196:199], v[100:103], v[172:175]
    ds_read_b64_tr_b16 a[182:183], v17 offset:24832
    v_mfma_f32_16x16x32_bf16 v[176:179], a[200:203], v[96:99], v[176:179]
    ds_read_b64_tr_b16 a[184:185], v18 offset:16640
    v_mfma_f32_16x16x32_bf16 v[180:183], a[200:203], v[100:103], v[180:183]
    ds_read_b64_tr_b16 a[186:187], v18 offset:24832
    v_mfma_f32_16x16x32_bf16 v[184:187], a[204:207], v[96:99], v[184:187]
    ds_read_b64_tr_b16 a[188:189], v19 offset:16640
    v_mfma_f32_16x16x32_bf16 v[188:191], a[204:207], v[100:103], v[188:191]
    ds_read_b64_tr_b16 a[190:191], v19 offset:24832
    s_waitcnt lgkmcnt(8)
    v_mfma_f32_16x16x32_bf16 v[192:195], a[208:211], v[96:99], v[192:195]
    ds_read_b128 a[192:195], v4 offset:16384
    v_mfma_f32_16x16x32_bf16 v[196:199], a[208:211], v[100:103], v[196:199]
    v_exp_f32 v82, v82
    v_mfma_f32_16x16x32_bf16 v[200:203], a[212:215], v[96:99], v[200:203]
    ds_read_b128 a[196:199], v4 offset:24576
    v_cvt_pk_bf16_f32 v104, v80, v81
    v_mfma_f32_16x16x32_bf16 v[204:207], a[212:215], v[100:103], v[204:207]
    v_exp_f32 v83, v83
    v_mfma_f32_16x16x32_bf16 v[208:211], a[216:219], v[96:99], v[208:211]
    ds_read_b128 a[200:203], v5 offset:16384
    v_mfma_f32_16x16x32_bf16 v[212:215], a[216:219], v[100:103], v[212:215]
    v_exp_f32 v88, v88
    v_mfma_f32_16x16x32_bf16 v[216:219], a[220:223], v[96:99], v[216:219]
    ds_read_b128 a[204:207], v5 offset:24576
    v_cvt_pk_bf16_f32 v105, v82, v83
    v_mfma_f32_16x16x32_bf16 v[220:223], a[220:223], v[100:103], v[220:223]
    v_exp_f32 v89, v89
    s_waitcnt lgkmcnt(4)
    v_mfma_f32_16x16x32_bf16 v[224:227], a[176:179], v[96:99], v[224:227]
    ds_read_b128 a[208:211], v6 offset:16384
    v_mfma_f32_16x16x32_bf16 v[228:231], a[176:179], v[100:103], v[228:231]
    v_exp_f32 v90, v90
    v_mfma_f32_16x16x32_bf16 v[232:235], a[180:183], v[96:99], v[232:235]
    ds_read_b128 a[212:215], v6 offset:24576
    v_cvt_pk_bf16_f32 v106, v88, v89
    v_mfma_f32_16x16x32_bf16 v[236:239], a[180:183], v[100:103], v[236:239]
    v_exp_f32 v91, v91
    v_mfma_f32_16x16x32_bf16 v[240:243], a[184:187], v[96:99], v[240:243]
    ds_read_b128 a[216:219], v7 offset:16384
    v_mfma_f32_16x16x32_bf16 v[244:247], a[184:187], v[100:103], v[244:247]
    v_exp_f32 v84, v84
    v_mfma_f32_16x16x32_bf16 v[248:251], a[188:191], v[96:99], v[248:251]
    ds_read_b128 a[220:223], v7 offset:24576
    v_mfma_f32_16x16x32_bf16 v[252:255], a[188:191], v[100:103], v[252:255]
    buffer_load_dwordx4 v32, s[40:43], s77 offen offset:0 nt lds
    s_waitcnt lgkmcnt(4)
    v_mfma_f32_16x16x32_bf16 v[64:67], a[192:195], a[112:115], v[48:51]
    ds_read_b128 a[176:179], v4 offset:16640
    v_cvt_pk_bf16_f32 v107, v90, v91
    v_mfma_f32_16x16x32_bf16 v[68:71], a[192:195], a[116:119], v[52:55]
    buffer_load_dwordx4 v33, s[40:43], s77 offen offset:1024 nt lds
    v_mfma_f32_16x16x32_bf16 v[72:75], a[196:199], a[112:115], v[48:51]
    ds_read_b128 a[180:183], v4 offset:24832
    v_mfma_f32_16x16x32_bf16 v[76:79], a[196:199], a[116:119], v[52:55]
    v_exp_f32 v85, v85
    v_mfma_f32_16x16x32_bf16 v[64:67], a[200:203], a[120:123], v[64:67]
    ds_read_b128 a[184:187], v5 offset:16640
    v_mfma_f32_16x16x32_bf16 v[68:71], a[200:203], a[124:127], v[68:71]
    v_exp_f32 v86, v86
    v_mfma_f32_16x16x32_bf16 v[72:75], a[204:207], a[120:123], v[72:75]
    ds_read_b128 a[188:191], v5 offset:24832
    v_mfma_f32_16x16x32_bf16 v[76:79], a[204:207], a[124:127], v[76:79]
    buffer_load_dwordx4 v34, s[40:43], s77 offen offset:2048 nt lds
    s_waitcnt lgkmcnt(4)
    v_mfma_f32_16x16x32_bf16 v[64:67], a[208:211], a[128:131], v[64:67]
    ds_read_b128 a[192:195], v6 offset:16640
    v_cvt_pk_bf16_f32 v108, v84, v85
    v_mfma_f32_16x16x32_bf16 v[68:71], a[208:211], a[132:135], v[68:71]
    buffer_load_dwordx4 v35, s[40:43], s77 offen offset:3072 nt lds
    v_mfma_f32_16x16x32_bf16 v[72:75], a[212:215], a[128:131], v[72:75]
    ds_read_b128 a[196:199], v6 offset:24832
    v_mfma_f32_16x16x32_bf16 v[76:79], a[212:215], a[132:135], v[76:79]
    v_exp_f32 v87, v87
    v_mfma_f32_16x16x32_bf16 v[64:67], a[216:219], a[136:139], v[64:67]
    ds_read_b128 a[200:203], v7 offset:16640
    v_mfma_f32_16x16x32_bf16 v[68:71], a[216:219], a[140:143], v[68:71]
    v_exp_f32 v92, v92
    v_mfma_f32_16x16x32_bf16 v[72:75], a[220:223], a[136:139], v[72:75]
    ds_read_b128 a[204:207], v7 offset:24832
    v_mfma_f32_16x16x32_bf16 v[76:79], a[220:223], a[140:143], v[76:79]
    s_waitcnt lgkmcnt(4)
    v_mfma_f32_16x16x32_bf16 v[64:67], a[176:179], a[144:147], v[64:67]
    s_waitcnt vmcnt(12)
    s_barrier
    ds_read_b64_tr_b16 a[208:209], v20 offset:32768
    v_cvt_pk_bf16_f32 v109, v86, v87
    v_mfma_f32_16x16x32_bf16 v[68:71], a[176:179], a[148:151], v[68:71]
    ds_read_b64_tr_b16 a[210:211], v20 offset:40960
    v_exp_f32 v93, v93
    v_mfma_f32_16x16x32_bf16 v[72:75], a[180:183], a[144:147], v[72:75]
    ds_read_b64_tr_b16 a[212:213], v21 offset:32768
    v_exp_f32 v94, v94
    v_mfma_f32_16x16x32_bf16 v[76:79], a[180:183], a[148:151], v[76:79]
    ds_read_b64_tr_b16 a[214:215], v21 offset:40960
    v_mfma_f32_16x16x32_bf16 v[64:67], a[184:187], a[152:155], v[64:67]
    ds_read_b64_tr_b16 a[216:217], v22 offset:32768
    v_mfma_f32_16x16x32_bf16 v[68:71], a[184:187], a[156:159], v[68:71]
    ds_read_b64_tr_b16 a[218:219], v22 offset:40960
    v_mfma_f32_16x16x32_bf16 v[72:75], a[188:191], a[152:155], v[72:75]
    ds_read_b64_tr_b16 a[220:221], v23 offset:32768
    v_mfma_f32_16x16x32_bf16 v[76:79], a[188:191], a[156:159], v[76:79]
    ds_read_b64_tr_b16 a[222:223], v23 offset:40960
    s_waitcnt lgkmcnt(8)
    v_mfma_f32_16x16x32_bf16 v[64:67], a[192:195], a[160:163], v[64:67]
    ds_read_b64_tr_b16 a[176:177], v24 offset:32768
    v_cvt_pk_bf16_f32 v110, v92, v93
    s_add_u32 m0, s74, 81920
    v_mfma_f32_16x16x32_bf16 v[68:71], a[192:195], a[164:167], v[68:71]
    ds_read_b64_tr_b16 a[178:179], v24 offset:40960
    v_exp_f32 v95, v95
    v_mfma_f32_16x16x32_bf16 v[72:75], a[196:199], a[160:163], v[72:75]
    ds_read_b64_tr_b16 a[180:181], v25 offset:32768
    v_mfma_f32_16x16x32_bf16 v[76:79], a[196:199], a[164:167], v[76:79]
    ds_read_b64_tr_b16 a[182:183], v25 offset:40960
    v_mfma_f32_16x16x32_bf16 v[64:67], a[200:203], a[168:171], v[64:67]
    ds_read_b64_tr_b16 a[184:185], v26 offset:32768
    v_mfma_f32_16x16x32_bf16 v[68:71], a[200:203], a[172:175], v[68:71]
    ds_read_b64_tr_b16 a[186:187], v26 offset:40960
    v_cvt_pk_bf16_f32 v111, v94, v95
    v_mfma_f32_16x16x32_bf16 v[72:75], a[204:207], a[168:171], v[72:75]
    ds_read_b64_tr_b16 a[188:189], v27 offset:32768
    v_mfma_f32_16x16x32_bf16 v[76:79], a[204:207], a[172:175], v[76:79]
    ds_read_b64_tr_b16 a[190:191], v27 offset:40960
    v_mfma_f32_16x16x32_bf16 v[56:59], a[224:227], v[104:107], v[56:59]
    ds_read_b64_tr_b16 a[192:193], v20 offset:33024
    v_mfma_f32_16x16x32_bf16 v[60:63], a[224:227], v[108:111], v[60:63]
    ds_read_b64_tr_b16 a[194:195], v20 offset:41216
    s_mov_b32 s77, 147456
    s_waitcnt lgkmcnt(10)
    v_mfma_f32_16x16x32_bf16 v[128:131], a[208:211], v[104:107], v[128:131]
    ds_read_b64_tr_b16 a[196:197], v21 offset:33024
    v_mfma_f32_16x16x32_bf16 v[132:135], a[208:211], v[108:111], v[132:135]
    ds_read_b64_tr_b16 a[198:199], v21 offset:41216
    v_mfma_f32_16x16x32_bf16 v[136:139], a[212:215], v[104:107], v[136:139]
    ds_read_b64_tr_b16 a[200:201], v22 offset:33024
    v_mfma_f32_16x16x32_bf16 v[140:143], a[212:215], v[108:111], v[140:143]
    ds_read_b64_tr_b16 a[202:203], v22 offset:41216
    v_mfma_f32_16x16x32_bf16 v[144:147], a[216:219], v[104:107], v[144:147]
    ds_read_b64_tr_b16 a[204:205], v23 offset:33024
    v_mfma_f32_16x16x32_bf16 v[148:151], a[216:219], v[108:111], v[148:151]
    ds_read_b64_tr_b16 a[206:207], v23 offset:41216
    v_mfma_f32_16x16x32_bf16 v[152:155], a[220:223], v[104:107], v[152:155]
    v_exp_f32 v64, v64
    v_mfma_f32_16x16x32_bf16 v[156:159], a[220:223], v[108:111], v[156:159]
    v_exp_f32 v65, v65
    s_waitcnt lgkmcnt(8)
    v_mfma_f32_16x16x32_bf16 v[160:163], a[176:179], v[104:107], v[160:163]
    ds_read_b64_tr_b16 a[208:209], v24 offset:33024
    v_mfma_f32_16x16x32_bf16 v[164:167], a[176:179], v[108:111], v[164:167]
    ds_read_b64_tr_b16 a[210:211], v24 offset:41216
    v_mfma_f32_16x16x32_bf16 v[168:171], a[180:183], v[104:107], v[168:171]
    ds_read_b64_tr_b16 a[212:213], v25 offset:33024
    v_mfma_f32_16x16x32_bf16 v[172:175], a[180:183], v[108:111], v[172:175]
    ds_read_b64_tr_b16 a[214:215], v25 offset:41216
    v_mfma_f32_16x16x32_bf16 v[176:179], a[184:187], v[104:107], v[176:179]
    ds_read_b64_tr_b16 a[216:217], v26 offset:33024
    v_mfma_f32_16x16x32_bf16 v[180:183], a[184:187], v[108:111], v[180:183]
    ds_read_b64_tr_b16 a[218:219], v26 offset:41216
    v_mfma_f32_16x16x32_bf16 v[184:187], a[188:191], v[104:107], v[184:187]
    ds_read_b64_tr_b16 a[220:221], v27 offset:33024
    v_mfma_f32_16x16x32_bf16 v[188:191], a[188:191], v[108:111], v[188:191]
    ds_read_b64_tr_b16 a[222:223], v27 offset:41216
    s_waitcnt lgkmcnt(8)
    v_mfma_f32_16x16x32_bf16 v[192:195], a[192:195], v[104:107], v[192:195]
    ds_read_b128 a[176:179], v4 offset:32768
    v_mfma_f32_16x16x32_bf16 v[196:199], a[192:195], v[108:111], v[196:199]
    v_exp_f32 v66, v66
    v_mfma_f32_16x16x32_bf16 v[200:203], a[196:199], v[104:107], v[200:203]
    ds_read_b128 a[180:183], v4 offset:40960
    v_cvt_pk_bf16_f32 v96, v64, v65
    v_mfma_f32_16x16x32_bf16 v[204:207], a[196:199], v[108:111], v[204:207]
    v_exp_f32 v67, v67
    v_mfma_f32_16x16x32_bf16 v[208:211], a[200:203], v[104:107], v[208:211]
    ds_read_b128 a[184:187], v5 offset:32768
    v_mfma_f32_16x16x32_bf16 v[212:215], a[200:203], v[108:111], v[212:215]
    v_exp_f32 v72, v72
    v_mfma_f32_16x16x32_bf16 v[216:219], a[204:207], v[104:107], v[216:219]
    ds_read_b128 a[188:191], v5 offset:40960
    v_cvt_pk_bf16_f32 v97, v66, v67
    v_mfma_f32_16x16x32_bf16 v[220:223], a[204:207], v[108:111], v[220:223]
    v_exp_f32 v73, v73
    s_waitcnt lgkmcnt(4)
    v_mfma_f32_16x16x32_bf16 v[224:227], a[208:211], v[104:107], v[224:227]
    ds_read_b128 a[192:195], v6 offset:32768
    v_mfma_f32_16x16x32_bf16 v[228:231], a[208:211], v[108:111], v[228:231]
    v_exp_f32 v74, v74
    v_mfma_f32_16x16x32_bf16 v[232:235], a[212:215], v[104:107], v[232:235]
    ds_read_b128 a[196:199], v6 offset:40960
    v_cvt_pk_bf16_f32 v98, v72, v73
    v_mfma_f32_16x16x32_bf16 v[236:239], a[212:215], v[108:111], v[236:239]
    v_exp_f32 v75, v75
    v_mfma_f32_16x16x32_bf16 v[240:243], a[216:219], v[104:107], v[240:243]
    ds_read_b128 a[200:203], v7 offset:32768
    v_mfma_f32_16x16x32_bf16 v[244:247], a[216:219], v[108:111], v[244:247]
    v_exp_f32 v68, v68
    v_mfma_f32_16x16x32_bf16 v[248:251], a[220:223], v[104:107], v[248:251]
    ds_read_b128 a[204:207], v7 offset:40960
    v_mfma_f32_16x16x32_bf16 v[252:255], a[220:223], v[108:111], v[252:255]
    buffer_load_dwordx4 v32, s[40:43], s77 offen offset:0 nt lds
    s_waitcnt lgkmcnt(4)
    v_mfma_f32_16x16x32_bf16 v[80:83], a[176:179], a[112:115], v[48:51]
    ds_read_b128 a[208:211], v4 offset:33024
    v_cvt_pk_bf16_f32 v99, v74, v75
    v_mfma_f32_16x16x32_bf16 v[84:87], a[176:179], a[116:119], v[52:55]
    buffer_load_dwordx4 v33, s[40:43], s77 offen offset:1024 nt lds
    v_mfma_f32_16x16x32_bf16 v[88:91], a[180:183], a[112:115], v[48:51]
    ds_read_b128 a[212:215], v4 offset:41216
    v_mfma_f32_16x16x32_bf16 v[92:95], a[180:183], a[116:119], v[52:55]
    v_exp_f32 v69, v69
    v_mfma_f32_16x16x32_bf16 v[80:83], a[184:187], a[120:123], v[80:83]
    ds_read_b128 a[216:219], v5 offset:33024
    v_mfma_f32_16x16x32_bf16 v[84:87], a[184:187], a[124:127], v[84:87]
    v_exp_f32 v70, v70
    v_mfma_f32_16x16x32_bf16 v[88:91], a[188:191], a[120:123], v[88:91]
    ds_read_b128 a[220:223], v5 offset:41216
    v_mfma_f32_16x16x32_bf16 v[92:95], a[188:191], a[124:127], v[92:95]
    buffer_load_dwordx4 v34, s[40:43], s77 offen offset:2048 nt lds
    s_waitcnt lgkmcnt(4)
    v_mfma_f32_16x16x32_bf16 v[80:83], a[192:195], a[128:131], v[80:83]
    ds_read_b128 a[176:179], v6 offset:33024
    v_cvt_pk_bf16_f32 v100, v68, v69
    v_mfma_f32_16x16x32_bf16 v[84:87], a[192:195], a[132:135], v[84:87]
    buffer_load_dwordx4 v35, s[40:43], s77 offen offset:3072 nt lds
    v_mfma_f32_16x16x32_bf16 v[88:91], a[196:199], a[128:131], v[88:91]
    ds_read_b128 a[180:183], v6 offset:41216
    v_mfma_f32_16x16x32_bf16 v[92:95], a[196:199], a[132:135], v[92:95]
    v_exp_f32 v71, v71
    v_mfma_f32_16x16x32_bf16 v[80:83], a[200:203], a[136:139], v[80:83]
    ds_read_b128 a[184:187], v7 offset:33024
    v_mfma_f32_16x16x32_bf16 v[84:87], a[200:203], a[140:143], v[84:87]
    v_exp_f32 v76, v76
    v_mfma_f32_16x16x32_bf16 v[88:91], a[204:207], a[136:139], v[88:91]
    ds_read_b128 a[188:191], v7 offset:41216
    v_mfma_f32_16x16x32_bf16 v[92:95], a[204:207], a[140:143], v[92:95]
    s_waitcnt lgkmcnt(4)
    v_mfma_f32_16x16x32_bf16 v[80:83], a[208:211], a[144:147], v[80:83]
    s_waitcnt vmcnt(12)
    s_barrier
    ds_read_b64_tr_b16 a[192:193], v20 offset:49152
    v_cvt_pk_bf16_f32 v101, v70, v71
    v_mfma_f32_16x16x32_bf16 v[84:87], a[208:211], a[148:151], v[84:87]
    ds_read_b64_tr_b16 a[194:195], v20 offset:57344
    v_exp_f32 v77, v77
    v_mfma_f32_16x16x32_bf16 v[88:91], a[212:215], a[144:147], v[88:91]
    ds_read_b64_tr_b16 a[196:197], v21 offset:49152
    v_exp_f32 v78, v78
    v_mfma_f32_16x16x32_bf16 v[92:95], a[212:215], a[148:151], v[92:95]
    ds_read_b64_tr_b16 a[198:199], v21 offset:57344
    v_mfma_f32_16x16x32_bf16 v[80:83], a[216:219], a[152:155], v[80:83]
    ds_read_b64_tr_b16 a[200:201], v22 offset:49152
    v_mfma_f32_16x16x32_bf16 v[84:87], a[216:219], a[156:159], v[84:87]
    ds_read_b64_tr_b16 a[202:203], v22 offset:57344
    v_mfma_f32_16x16x32_bf16 v[88:91], a[220:223], a[152:155], v[88:91]
    ds_read_b64_tr_b16 a[204:205], v23 offset:49152
    v_mfma_f32_16x16x32_bf16 v[92:95], a[220:223], a[156:159], v[92:95]
    ds_read_b64_tr_b16 a[206:207], v23 offset:57344
    s_waitcnt lgkmcnt(8)
    v_mfma_f32_16x16x32_bf16 v[80:83], a[176:179], a[160:163], v[80:83]
    ds_read_b64_tr_b16 a[208:209], v24 offset:49152
    v_cvt_pk_bf16_f32 v102, v76, v77
    s_add_u32 m0, s74, 131072
    v_mfma_f32_16x16x32_bf16 v[84:87], a[176:179], a[164:167], v[84:87]
    ds_read_b64_tr_b16 a[210:211], v24 offset:57344
    v_exp_f32 v79, v79
    v_mfma_f32_16x16x32_bf16 v[88:91], a[180:183], a[160:163], v[88:91]
    ds_read_b64_tr_b16 a[212:213], v25 offset:49152
    v_mfma_f32_16x16x32_bf16 v[92:95], a[180:183], a[164:167], v[92:95]
    ds_read_b64_tr_b16 a[214:215], v25 offset:57344
    v_mfma_f32_16x16x32_bf16 v[80:83], a[184:187], a[168:171], v[80:83]
    ds_read_b64_tr_b16 a[216:217], v26 offset:49152
    v_mfma_f32_16x16x32_bf16 v[84:87], a[184:187], a[172:175], v[84:87]
    ds_read_b64_tr_b16 a[218:219], v26 offset:57344
    v_cvt_pk_bf16_f32 v103, v78, v79
    v_mfma_f32_16x16x32_bf16 v[88:91], a[188:191], a[168:171], v[88:91]
    ds_read_b64_tr_b16 a[220:221], v27 offset:49152
    v_mfma_f32_16x16x32_bf16 v[92:95], a[188:191], a[172:175], v[92:95]
    ds_read_b64_tr_b16 a[222:223], v27 offset:57344
    v_mfma_f32_16x16x32_bf16 v[56:59], a[224:227], v[96:99], v[56:59]
    ds_read_b64_tr_b16 a[176:177], v20 offset:49408
    v_mfma_f32_16x16x32_bf16 v[60:63], a[224:227], v[100:103], v[60:63]
    ds_read_b64_tr_b16 a[178:179], v20 offset:57600
    s_mov_b32 s77, 163840
    s_waitcnt lgkmcnt(10)
    v_mfma_f32_16x16x32_bf16 v[128:131], a[192:195], v[96:99], v[128:131]
    ds_read_b64_tr_b16 a[180:181], v21 offset:49408
    v_mfma_f32_16x16x32_bf16 v[132:135], a[192:195], v[100:103], v[132:135]
    ds_read_b64_tr_b16 a[182:183], v21 offset:57600
    v_mfma_f32_16x16x32_bf16 v[136:139], a[196:199], v[96:99], v[136:139]
    ds_read_b64_tr_b16 a[184:185], v22 offset:49408
    v_mfma_f32_16x16x32_bf16 v[140:143], a[196:199], v[100:103], v[140:143]
    ds_read_b64_tr_b16 a[186:187], v22 offset:57600
    v_mfma_f32_16x16x32_bf16 v[144:147], a[200:203], v[96:99], v[144:147]
    ds_read_b64_tr_b16 a[188:189], v23 offset:49408
    v_mfma_f32_16x16x32_bf16 v[148:151], a[200:203], v[100:103], v[148:151]
    ds_read_b64_tr_b16 a[190:191], v23 offset:57600
    v_mfma_f32_16x16x32_bf16 v[152:155], a[204:207], v[96:99], v[152:155]
    v_exp_f32 v80, v80
    v_mfma_f32_16x16x32_bf16 v[156:159], a[204:207], v[100:103], v[156:159]
    v_exp_f32 v81, v81
    s_waitcnt lgkmcnt(8)
    v_mfma_f32_16x16x32_bf16 v[160:163], a[208:211], v[96:99], v[160:163]
    ds_read_b64_tr_b16 a[192:193], v24 offset:49408
    v_mfma_f32_16x16x32_bf16 v[164:167], a[208:211], v[100:103], v[164:167]
    ds_read_b64_tr_b16 a[194:195], v24 offset:57600
    v_mfma_f32_16x16x32_bf16 v[168:171], a[212:215], v[96:99], v[168:171]
    ds_read_b64_tr_b16 a[196:197], v25 offset:49408
    v_mfma_f32_16x16x32_bf16 v[172:175], a[212:215], v[100:103], v[172:175]
    ds_read_b64_tr_b16 a[198:199], v25 offset:57600
    v_mfma_f32_16x16x32_bf16 v[176:179], a[216:219], v[96:99], v[176:179]
    ds_read_b64_tr_b16 a[200:201], v26 offset:49408
    v_mfma_f32_16x16x32_bf16 v[180:183], a[216:219], v[100:103], v[180:183]
    ds_read_b64_tr_b16 a[202:203], v26 offset:57600
    v_mfma_f32_16x16x32_bf16 v[184:187], a[220:223], v[96:99], v[184:187]
    ds_read_b64_tr_b16 a[204:205], v27 offset:49408
    v_mfma_f32_16x16x32_bf16 v[188:191], a[220:223], v[100:103], v[188:191]
    ds_read_b64_tr_b16 a[206:207], v27 offset:57600
    s_waitcnt lgkmcnt(8)
    v_mfma_f32_16x16x32_bf16 v[192:195], a[176:179], v[96:99], v[192:195]
    ds_read_b128 a[208:211], v4 offset:49152
    v_mfma_f32_16x16x32_bf16 v[196:199], a[176:179], v[100:103], v[196:199]
    v_exp_f32 v82, v82
    v_mfma_f32_16x16x32_bf16 v[200:203], a[180:183], v[96:99], v[200:203]
    ds_read_b128 a[212:215], v4 offset:57344
    v_cvt_pk_bf16_f32 v104, v80, v81
    v_mfma_f32_16x16x32_bf16 v[204:207], a[180:183], v[100:103], v[204:207]
    v_exp_f32 v83, v83
    v_mfma_f32_16x16x32_bf16 v[208:211], a[184:187], v[96:99], v[208:211]
    ds_read_b128 a[216:219], v5 offset:49152
    v_mfma_f32_16x16x32_bf16 v[212:215], a[184:187], v[100:103], v[212:215]
    v_exp_f32 v88, v88
    v_mfma_f32_16x16x32_bf16 v[216:219], a[188:191], v[96:99], v[216:219]
    ds_read_b128 a[220:223], v5 offset:57344
    v_cvt_pk_bf16_f32 v105, v82, v83
    v_mfma_f32_16x16x32_bf16 v[220:223], a[188:191], v[100:103], v[220:223]
    v_exp_f32 v89, v89
    s_waitcnt lgkmcnt(4)
    v_mfma_f32_16x16x32_bf16 v[224:227], a[192:195], v[96:99], v[224:227]
    ds_read_b128 a[176:179], v6 offset:49152
    v_mfma_f32_16x16x32_bf16 v[228:231], a[192:195], v[100:103], v[228:231]
    v_exp_f32 v90, v90
    v_mfma_f32_16x16x32_bf16 v[232:235], a[196:199], v[96:99], v[232:235]
    ds_read_b128 a[180:183], v6 offset:57344
    v_cvt_pk_bf16_f32 v106, v88, v89
    v_mfma_f32_16x16x32_bf16 v[236:239], a[196:199], v[100:103], v[236:239]
    v_exp_f32 v91, v91
    v_mfma_f32_16x16x32_bf16 v[240:243], a[200:203], v[96:99], v[240:243]
    ds_read_b128 a[184:187], v7 offset:49152
    v_mfma_f32_16x16x32_bf16 v[244:247], a[200:203], v[100:103], v[244:247]
    v_exp_f32 v84, v84
    v_mfma_f32_16x16x32_bf16 v[248:251], a[204:207], v[96:99], v[248:251]
    ds_read_b128 a[188:191], v7 offset:57344
    v_mfma_f32_16x16x32_bf16 v[252:255], a[204:207], v[100:103], v[252:255]
    buffer_load_dwordx4 v32, s[40:43], s77 offen offset:0 nt lds
    s_waitcnt lgkmcnt(4)
    v_mfma_f32_16x16x32_bf16 v[64:67], a[208:211], a[112:115], v[48:51]
    ds_read_b128 a[192:195], v4 offset:49408
    v_cvt_pk_bf16_f32 v107, v90, v91
    v_mfma_f32_16x16x32_bf16 v[68:71], a[208:211], a[116:119], v[52:55]
    buffer_load_dwordx4 v33, s[40:43], s77 offen offset:1024 nt lds
    v_mfma_f32_16x16x32_bf16 v[72:75], a[212:215], a[112:115], v[48:51]
    ds_read_b128 a[196:199], v4 offset:57600
    v_mfma_f32_16x16x32_bf16 v[76:79], a[212:215], a[116:119], v[52:55]
    v_exp_f32 v85, v85
    v_mfma_f32_16x16x32_bf16 v[64:67], a[216:219], a[120:123], v[64:67]
    ds_read_b128 a[200:203], v5 offset:49408
    v_mfma_f32_16x16x32_bf16 v[68:71], a[216:219], a[124:127], v[68:71]
    v_exp_f32 v86, v86
    v_mfma_f32_16x16x32_bf16 v[72:75], a[220:223], a[120:123], v[72:75]
    ds_read_b128 a[204:207], v5 offset:57600
    v_mfma_f32_16x16x32_bf16 v[76:79], a[220:223], a[124:127], v[76:79]
    buffer_load_dwordx4 v34, s[40:43], s77 offen offset:2048 nt lds
    s_waitcnt lgkmcnt(4)
    v_mfma_f32_16x16x32_bf16 v[64:67], a[176:179], a[128:131], v[64:67]
    ds_read_b128 a[208:211], v6 offset:49408
    v_cvt_pk_bf16_f32 v108, v84, v85
    v_mfma_f32_16x16x32_bf16 v[68:71], a[176:179], a[132:135], v[68:71]
    buffer_load_dwordx4 v35, s[40:43], s77 offen offset:3072 nt lds
    v_mfma_f32_16x16x32_bf16 v[72:75], a[180:183], a[128:131], v[72:75]
    ds_read_b128 a[212:215], v6 offset:57600
    v_mfma_f32_16x16x32_bf16 v[76:79], a[180:183], a[132:135], v[76:79]
    v_exp_f32 v87, v87
    v_mfma_f32_16x16x32_bf16 v[64:67], a[184:187], a[136:139], v[64:67]
    ds_read_b128 a[216:219], v7 offset:49408
    v_mfma_f32_16x16x32_bf16 v[68:71], a[184:187], a[140:143], v[68:71]
    v_exp_f32 v92, v92
    v_mfma_f32_16x16x32_bf16 v[72:75], a[188:191], a[136:139], v[72:75]
    ds_read_b128 a[220:223], v7 offset:57600
    v_mfma_f32_16x16x32_bf16 v[76:79], a[188:191], a[140:143], v[76:79]
    s_waitcnt lgkmcnt(4)
    v_mfma_f32_16x16x32_bf16 v[64:67], a[192:195], a[144:147], v[64:67]
    s_waitcnt vmcnt(12)
    s_barrier
    ds_read_b64_tr_b16 a[176:177], v12 offset:32768
    v_cvt_pk_bf16_f32 v109, v86, v87
    v_mfma_f32_16x16x32_bf16 v[68:71], a[192:195], a[148:151], v[68:71]
    ds_read_b64_tr_b16 a[178:179], v12 offset:40960
    v_exp_f32 v93, v93
    v_mfma_f32_16x16x32_bf16 v[72:75], a[196:199], a[144:147], v[72:75]
    ds_read_b64_tr_b16 a[180:181], v13 offset:32768
    v_exp_f32 v94, v94
    v_mfma_f32_16x16x32_bf16 v[76:79], a[196:199], a[148:151], v[76:79]
    ds_read_b64_tr_b16 a[182:183], v13 offset:40960
    v_mfma_f32_16x16x32_bf16 v[64:67], a[200:203], a[152:155], v[64:67]
    ds_read_b64_tr_b16 a[184:185], v14 offset:32768
    v_mfma_f32_16x16x32_bf16 v[68:71], a[200:203], a[156:159], v[68:71]
    ds_read_b64_tr_b16 a[186:187], v14 offset:40960
    v_mfma_f32_16x16x32_bf16 v[72:75], a[204:207], a[152:155], v[72:75]
    ds_read_b64_tr_b16 a[188:189], v15 offset:32768
    v_mfma_f32_16x16x32_bf16 v[76:79], a[204:207], a[156:159], v[76:79]
    ds_read_b64_tr_b16 a[190:191], v15 offset:40960
    s_waitcnt lgkmcnt(8)
    v_mfma_f32_16x16x32_bf16 v[64:67], a[208:211], a[160:163], v[64:67]
    ds_read_b64_tr_b16 a[192:193], v16 offset:32768
    v_cvt_pk_bf16_f32 v110, v92, v93
    s_add_u32 m0, s74, 147456
    v_mfma_f32_16x16x32_bf16 v[68:71], a[208:211], a[164:167], v[68:71]
    ds_read_b64_tr_b16 a[194:195], v16 offset:40960
    v_exp_f32 v95, v95
    v_mfma_f32_16x16x32_bf16 v[72:75], a[212:215], a[160:163], v[72:75]
    ds_read_b64_tr_b16 a[196:197], v17 offset:32768
    v_mfma_f32_16x16x32_bf16 v[76:79], a[212:215], a[164:167], v[76:79]
    ds_read_b64_tr_b16 a[198:199], v17 offset:40960
    v_mfma_f32_16x16x32_bf16 v[64:67], a[216:219], a[168:171], v[64:67]
    ds_read_b64_tr_b16 a[200:201], v18 offset:32768
    v_mfma_f32_16x16x32_bf16 v[68:71], a[216:219], a[172:175], v[68:71]
    ds_read_b64_tr_b16 a[202:203], v18 offset:40960
    v_cvt_pk_bf16_f32 v111, v94, v95
    v_mfma_f32_16x16x32_bf16 v[72:75], a[220:223], a[168:171], v[72:75]
    ds_read_b64_tr_b16 a[204:205], v19 offset:32768
    v_mfma_f32_16x16x32_bf16 v[76:79], a[220:223], a[172:175], v[76:79]
    ds_read_b64_tr_b16 a[206:207], v19 offset:40960
    v_mfma_f32_16x16x32_bf16 v[56:59], a[224:227], v[104:107], v[56:59]
    ds_read_b64_tr_b16 a[208:209], v12 offset:33024
    v_mfma_f32_16x16x32_bf16 v[60:63], a[224:227], v[108:111], v[60:63]
    ds_read_b64_tr_b16 a[210:211], v12 offset:41216
    s_mov_b32 s77, 180224
    s_waitcnt lgkmcnt(10)
    v_mfma_f32_16x16x32_bf16 v[128:131], a[176:179], v[104:107], v[128:131]
    ds_read_b64_tr_b16 a[212:213], v13 offset:33024
    v_mfma_f32_16x16x32_bf16 v[132:135], a[176:179], v[108:111], v[132:135]
    ds_read_b64_tr_b16 a[214:215], v13 offset:41216
    v_mfma_f32_16x16x32_bf16 v[136:139], a[180:183], v[104:107], v[136:139]
    ds_read_b64_tr_b16 a[216:217], v14 offset:33024
    v_mfma_f32_16x16x32_bf16 v[140:143], a[180:183], v[108:111], v[140:143]
    ds_read_b64_tr_b16 a[218:219], v14 offset:41216
    v_mfma_f32_16x16x32_bf16 v[144:147], a[184:187], v[104:107], v[144:147]
    ds_read_b64_tr_b16 a[220:221], v15 offset:33024
    v_mfma_f32_16x16x32_bf16 v[148:151], a[184:187], v[108:111], v[148:151]
    ds_read_b64_tr_b16 a[222:223], v15 offset:41216
    v_mfma_f32_16x16x32_bf16 v[152:155], a[188:191], v[104:107], v[152:155]
    v_exp_f32 v64, v64
    v_mfma_f32_16x16x32_bf16 v[156:159], a[188:191], v[108:111], v[156:159]
    v_exp_f32 v65, v65
    s_waitcnt lgkmcnt(8)
    v_mfma_f32_16x16x32_bf16 v[160:163], a[192:195], v[104:107], v[160:163]
    ds_read_b64_tr_b16 a[176:177], v16 offset:33024
    v_mfma_f32_16x16x32_bf16 v[164:167], a[192:195], v[108:111], v[164:167]
    ds_read_b64_tr_b16 a[178:179], v16 offset:41216
    v_mfma_f32_16x16x32_bf16 v[168:171], a[196:199], v[104:107], v[168:171]
    ds_read_b64_tr_b16 a[180:181], v17 offset:33024
    v_mfma_f32_16x16x32_bf16 v[172:175], a[196:199], v[108:111], v[172:175]
    ds_read_b64_tr_b16 a[182:183], v17 offset:41216
    v_mfma_f32_16x16x32_bf16 v[176:179], a[200:203], v[104:107], v[176:179]
    ds_read_b64_tr_b16 a[184:185], v18 offset:33024
    v_mfma_f32_16x16x32_bf16 v[180:183], a[200:203], v[108:111], v[180:183]
    ds_read_b64_tr_b16 a[186:187], v18 offset:41216
    v_mfma_f32_16x16x32_bf16 v[184:187], a[204:207], v[104:107], v[184:187]
    ds_read_b64_tr_b16 a[188:189], v19 offset:33024
    v_mfma_f32_16x16x32_bf16 v[188:191], a[204:207], v[108:111], v[188:191]
    ds_read_b64_tr_b16 a[190:191], v19 offset:41216
    s_waitcnt lgkmcnt(8)
    v_mfma_f32_16x16x32_bf16 v[192:195], a[208:211], v[104:107], v[192:195]
    ds_read_b128 a[192:195], v8 offset:49152
    v_mfma_f32_16x16x32_bf16 v[196:199], a[208:211], v[108:111], v[196:199]
    v_exp_f32 v66, v66
    v_mfma_f32_16x16x32_bf16 v[200:203], a[212:215], v[104:107], v[200:203]
    ds_read_b128 a[196:199], v8 offset:57344
    v_cvt_pk_bf16_f32 v96, v64, v65
    v_mfma_f32_16x16x32_bf16 v[204:207], a[212:215], v[108:111], v[204:207]
    v_exp_f32 v67, v67
    v_mfma_f32_16x16x32_bf16 v[208:211], a[216:219], v[104:107], v[208:211]
    ds_read_b128 a[200:203], v9 offset:49152
    v_mfma_f32_16x16x32_bf16 v[212:215], a[216:219], v[108:111], v[212:215]
    v_exp_f32 v72, v72
    v_mfma_f32_16x16x32_bf16 v[216:219], a[220:223], v[104:107], v[216:219]
    ds_read_b128 a[204:207], v9 offset:57344
    v_cvt_pk_bf16_f32 v97, v66, v67
    v_mfma_f32_16x16x32_bf16 v[220:223], a[220:223], v[108:111], v[220:223]
    v_exp_f32 v73, v73
    s_waitcnt lgkmcnt(4)
    v_mfma_f32_16x16x32_bf16 v[224:227], a[176:179], v[104:107], v[224:227]
    ds_read_b128 a[208:211], v10 offset:49152
    v_mfma_f32_16x16x32_bf16 v[228:231], a[176:179], v[108:111], v[228:231]
    v_exp_f32 v74, v74
    v_mfma_f32_16x16x32_bf16 v[232:235], a[180:183], v[104:107], v[232:235]
    ds_read_b128 a[212:215], v10 offset:57344
    v_cvt_pk_bf16_f32 v98, v72, v73
    v_mfma_f32_16x16x32_bf16 v[236:239], a[180:183], v[108:111], v[236:239]
    v_exp_f32 v75, v75
    v_mfma_f32_16x16x32_bf16 v[240:243], a[184:187], v[104:107], v[240:243]
    ds_read_b128 a[216:219], v11 offset:49152
    v_mfma_f32_16x16x32_bf16 v[244:247], a[184:187], v[108:111], v[244:247]
    v_exp_f32 v68, v68
    v_mfma_f32_16x16x32_bf16 v[248:251], a[188:191], v[104:107], v[248:251]
    ds_read_b128 a[220:223], v11 offset:57344
    v_mfma_f32_16x16x32_bf16 v[252:255], a[188:191], v[108:111], v[252:255]
    buffer_load_dwordx4 v32, s[40:43], s77 offen offset:0 nt lds
    s_waitcnt lgkmcnt(4)
    v_mfma_f32_16x16x32_bf16 v[80:83], a[192:195], a[112:115], v[48:51]
    ds_read_b128 a[176:179], v8 offset:49408
    v_cvt_pk_bf16_f32 v99, v74, v75
    v_mfma_f32_16x16x32_bf16 v[84:87], a[192:195], a[116:119], v[52:55]
    buffer_load_dwordx4 v33, s[40:43], s77 offen offset:1024 nt lds
    v_mfma_f32_16x16x32_bf16 v[88:91], a[196:199], a[112:115], v[48:51]
    ds_read_b128 a[180:183], v8 offset:57600
    v_mfma_f32_16x16x32_bf16 v[92:95], a[196:199], a[116:119], v[52:55]
    v_exp_f32 v69, v69
    v_mfma_f32_16x16x32_bf16 v[80:83], a[200:203], a[120:123], v[80:83]
    ds_read_b128 a[184:187], v9 offset:49408
    v_mfma_f32_16x16x32_bf16 v[84:87], a[200:203], a[124:127], v[84:87]
    v_exp_f32 v70, v70
    v_mfma_f32_16x16x32_bf16 v[88:91], a[204:207], a[120:123], v[88:91]
    ds_read_b128 a[188:191], v9 offset:57600
    v_mfma_f32_16x16x32_bf16 v[92:95], a[204:207], a[124:127], v[92:95]
    buffer_load_dwordx4 v34, s[40:43], s77 offen offset:2048 nt lds
    s_waitcnt lgkmcnt(4)
    v_mfma_f32_16x16x32_bf16 v[80:83], a[208:211], a[128:131], v[80:83]
    ds_read_b128 a[192:195], v10 offset:49408
    v_cvt_pk_bf16_f32 v100, v68, v69
    v_mfma_f32_16x16x32_bf16 v[84:87], a[208:211], a[132:135], v[84:87]
    buffer_load_dwordx4 v35, s[40:43], s77 offen offset:3072 nt lds
    v_mfma_f32_16x16x32_bf16 v[88:91], a[212:215], a[128:131], v[88:91]
    ds_read_b128 a[196:199], v10 offset:57600
    v_mfma_f32_16x16x32_bf16 v[92:95], a[212:215], a[132:135], v[92:95]
    v_exp_f32 v71, v71
    v_mfma_f32_16x16x32_bf16 v[80:83], a[216:219], a[136:139], v[80:83]
    ds_read_b128 a[200:203], v11 offset:49408
    v_mfma_f32_16x16x32_bf16 v[84:87], a[216:219], a[140:143], v[84:87]
    v_exp_f32 v76, v76
    v_mfma_f32_16x16x32_bf16 v[88:91], a[220:223], a[136:139], v[88:91]
    ds_read_b128 a[204:207], v11 offset:57600
    v_mfma_f32_16x16x32_bf16 v[92:95], a[220:223], a[140:143], v[92:95]
    s_waitcnt lgkmcnt(4)
    v_mfma_f32_16x16x32_bf16 v[80:83], a[176:179], a[144:147], v[80:83]
    s_waitcnt vmcnt(12)
    s_barrier
    ds_read_b64_tr_b16 a[208:209], v12 offset:0
    v_cvt_pk_bf16_f32 v101, v70, v71
    v_mfma_f32_16x16x32_bf16 v[84:87], a[176:179], a[148:151], v[84:87]
    ds_read_b64_tr_b16 a[210:211], v12 offset:8192
    v_exp_f32 v77, v77
    v_mfma_f32_16x16x32_bf16 v[88:91], a[180:183], a[144:147], v[88:91]
    ds_read_b64_tr_b16 a[212:213], v13 offset:0
    v_exp_f32 v78, v78
    v_mfma_f32_16x16x32_bf16 v[92:95], a[180:183], a[148:151], v[92:95]
    ds_read_b64_tr_b16 a[214:215], v13 offset:8192
    v_mfma_f32_16x16x32_bf16 v[80:83], a[184:187], a[152:155], v[80:83]
    ds_read_b64_tr_b16 a[216:217], v14 offset:0
    v_mfma_f32_16x16x32_bf16 v[84:87], a[184:187], a[156:159], v[84:87]
    ds_read_b64_tr_b16 a[218:219], v14 offset:8192
    v_mfma_f32_16x16x32_bf16 v[88:91], a[188:191], a[152:155], v[88:91]
    ds_read_b64_tr_b16 a[220:221], v15 offset:0
    v_mfma_f32_16x16x32_bf16 v[92:95], a[188:191], a[156:159], v[92:95]
    ds_read_b64_tr_b16 a[222:223], v15 offset:8192
    s_waitcnt lgkmcnt(8)
    v_mfma_f32_16x16x32_bf16 v[80:83], a[192:195], a[160:163], v[80:83]
    ds_read_b64_tr_b16 a[176:177], v16 offset:0
    v_cvt_pk_bf16_f32 v102, v76, v77
    s_add_u32 m0, s74, 98304
    v_mfma_f32_16x16x32_bf16 v[84:87], a[192:195], a[164:167], v[84:87]
    ds_read_b64_tr_b16 a[178:179], v16 offset:8192
    v_exp_f32 v79, v79
    v_mfma_f32_16x16x32_bf16 v[88:91], a[196:199], a[160:163], v[88:91]
    ds_read_b64_tr_b16 a[180:181], v17 offset:0
    v_mfma_f32_16x16x32_bf16 v[92:95], a[196:199], a[164:167], v[92:95]
    ds_read_b64_tr_b16 a[182:183], v17 offset:8192
    v_mfma_f32_16x16x32_bf16 v[80:83], a[200:203], a[168:171], v[80:83]
    ds_read_b64_tr_b16 a[184:185], v18 offset:0
    v_mfma_f32_16x16x32_bf16 v[84:87], a[200:203], a[172:175], v[84:87]
    ds_read_b64_tr_b16 a[186:187], v18 offset:8192
    v_cvt_pk_bf16_f32 v103, v78, v79
    v_mfma_f32_16x16x32_bf16 v[88:91], a[204:207], a[168:171], v[88:91]
    ds_read_b64_tr_b16 a[188:189], v19 offset:0
    v_mfma_f32_16x16x32_bf16 v[92:95], a[204:207], a[172:175], v[92:95]
    ds_read_b64_tr_b16 a[190:191], v19 offset:8192
    v_mfma_f32_16x16x32_bf16 v[56:59], a[224:227], v[96:99], v[56:59]
    ds_read_b64_tr_b16 a[192:193], v12 offset:256
    v_mfma_f32_16x16x32_bf16 v[60:63], a[224:227], v[100:103], v[60:63]
    ds_read_b64_tr_b16 a[194:195], v12 offset:8448
    s_mov_b32 s77, 196608
    s_waitcnt lgkmcnt(10)
    v_mfma_f32_16x16x32_bf16 v[128:131], a[208:211], v[96:99], v[128:131]
    ds_read_b64_tr_b16 a[196:197], v13 offset:256
    v_mfma_f32_16x16x32_bf16 v[132:135], a[208:211], v[100:103], v[132:135]
    ds_read_b64_tr_b16 a[198:199], v13 offset:8448
    v_mfma_f32_16x16x32_bf16 v[136:139], a[212:215], v[96:99], v[136:139]
    ds_read_b64_tr_b16 a[200:201], v14 offset:256
    v_mfma_f32_16x16x32_bf16 v[140:143], a[212:215], v[100:103], v[140:143]
    ds_read_b64_tr_b16 a[202:203], v14 offset:8448
    v_mfma_f32_16x16x32_bf16 v[144:147], a[216:219], v[96:99], v[144:147]
    ds_read_b64_tr_b16 a[204:205], v15 offset:256
    v_mfma_f32_16x16x32_bf16 v[148:151], a[216:219], v[100:103], v[148:151]
    ds_read_b64_tr_b16 a[206:207], v15 offset:8448
    v_mfma_f32_16x16x32_bf16 v[152:155], a[220:223], v[96:99], v[152:155]
    v_exp_f32 v80, v80
    v_mfma_f32_16x16x32_bf16 v[156:159], a[220:223], v[100:103], v[156:159]
    v_exp_f32 v81, v81
    s_waitcnt lgkmcnt(8)
    v_mfma_f32_16x16x32_bf16 v[160:163], a[176:179], v[96:99], v[160:163]
    ds_read_b64_tr_b16 a[208:209], v16 offset:256
    v_mfma_f32_16x16x32_bf16 v[164:167], a[176:179], v[100:103], v[164:167]
    ds_read_b64_tr_b16 a[210:211], v16 offset:8448
    v_mfma_f32_16x16x32_bf16 v[168:171], a[180:183], v[96:99], v[168:171]
    ds_read_b64_tr_b16 a[212:213], v17 offset:256
    v_mfma_f32_16x16x32_bf16 v[172:175], a[180:183], v[100:103], v[172:175]
    ds_read_b64_tr_b16 a[214:215], v17 offset:8448
    v_mfma_f32_16x16x32_bf16 v[176:179], a[184:187], v[96:99], v[176:179]
    ds_read_b64_tr_b16 a[216:217], v18 offset:256
    v_mfma_f32_16x16x32_bf16 v[180:183], a[184:187], v[100:103], v[180:183]
    ds_read_b64_tr_b16 a[218:219], v18 offset:8448
    v_mfma_f32_16x16x32_bf16 v[184:187], a[188:191], v[96:99], v[184:187]
    ds_read_b64_tr_b16 a[220:221], v19 offset:256
    v_mfma_f32_16x16x32_bf16 v[188:191], a[188:191], v[100:103], v[188:191]
    ds_read_b64_tr_b16 a[222:223], v19 offset:8448
    s_waitcnt lgkmcnt(8)
    v_mfma_f32_16x16x32_bf16 v[192:195], a[192:195], v[96:99], v[192:195]
    ds_read_b128 a[176:179], v4 offset:0
    v_mfma_f32_16x16x32_bf16 v[196:199], a[192:195], v[100:103], v[196:199]
    v_exp_f32 v82, v82
    v_mfma_f32_16x16x32_bf16 v[200:203], a[196:199], v[96:99], v[200:203]
    ds_read_b128 a[180:183], v4 offset:8192
    v_cvt_pk_bf16_f32 v104, v80, v81
    v_mfma_f32_16x16x32_bf16 v[204:207], a[196:199], v[100:103], v[204:207]
    v_exp_f32 v83, v83
    v_mfma_f32_16x16x32_bf16 v[208:211], a[200:203], v[96:99], v[208:211]
    ds_read_b128 a[184:187], v5 offset:0
    v_mfma_f32_16x16x32_bf16 v[212:215], a[200:203], v[100:103], v[212:215]
    v_exp_f32 v88, v88
    v_mfma_f32_16x16x32_bf16 v[216:219], a[204:207], v[96:99], v[216:219]
    ds_read_b128 a[188:191], v5 offset:8192
    v_cvt_pk_bf16_f32 v105, v82, v83
    v_mfma_f32_16x16x32_bf16 v[220:223], a[204:207], v[100:103], v[220:223]
    v_exp_f32 v89, v89
    s_waitcnt lgkmcnt(4)
    v_mfma_f32_16x16x32_bf16 v[224:227], a[208:211], v[96:99], v[224:227]
    ds_read_b128 a[192:195], v6 offset:0
    v_mfma_f32_16x16x32_bf16 v[228:231], a[208:211], v[100:103], v[228:231]
    v_exp_f32 v90, v90
    v_mfma_f32_16x16x32_bf16 v[232:235], a[212:215], v[96:99], v[232:235]
    ds_read_b128 a[196:199], v6 offset:8192
    v_cvt_pk_bf16_f32 v106, v88, v89
    v_mfma_f32_16x16x32_bf16 v[236:239], a[212:215], v[100:103], v[236:239]
    v_exp_f32 v91, v91
    v_mfma_f32_16x16x32_bf16 v[240:243], a[216:219], v[96:99], v[240:243]
    ds_read_b128 a[200:203], v7 offset:0
    v_mfma_f32_16x16x32_bf16 v[244:247], a[216:219], v[100:103], v[244:247]
    v_exp_f32 v84, v84
    v_mfma_f32_16x16x32_bf16 v[248:251], a[220:223], v[96:99], v[248:251]
    ds_read_b128 a[204:207], v7 offset:8192
    v_mfma_f32_16x16x32_bf16 v[252:255], a[220:223], v[100:103], v[252:255]
    buffer_load_dwordx4 v32, s[40:43], s77 offen offset:0 nt lds
    s_waitcnt lgkmcnt(4)
    v_mfma_f32_16x16x32_bf16 v[64:67], a[176:179], a[112:115], v[48:51]
    ds_read_b128 a[208:211], v4 offset:256
    v_cvt_pk_bf16_f32 v107, v90, v91
    v_mfma_f32_16x16x32_bf16 v[68:71], a[176:179], a[116:119], v[52:55]
    buffer_load_dwordx4 v33, s[40:43], s77 offen offset:1024 nt lds
    v_mfma_f32_16x16x32_bf16 v[72:75], a[180:183], a[112:115], v[48:51]
    ds_read_b128 a[212:215], v4 offset:8448
    v_mfma_f32_16x16x32_bf16 v[76:79], a[180:183], a[116:119], v[52:55]
    v_exp_f32 v85, v85
    v_mfma_f32_16x16x32_bf16 v[64:67], a[184:187], a[120:123], v[64:67]
    ds_read_b128 a[216:219], v5 offset:256
    v_mfma_f32_16x16x32_bf16 v[68:71], a[184:187], a[124:127], v[68:71]
    v_exp_f32 v86, v86
    v_mfma_f32_16x16x32_bf16 v[72:75], a[188:191], a[120:123], v[72:75]
    ds_read_b128 a[220:223], v5 offset:8448
    v_mfma_f32_16x16x32_bf16 v[76:79], a[188:191], a[124:127], v[76:79]
    buffer_load_dwordx4 v34, s[40:43], s77 offen offset:2048 nt lds
    s_waitcnt lgkmcnt(4)
    v_mfma_f32_16x16x32_bf16 v[64:67], a[192:195], a[128:131], v[64:67]
    ds_read_b128 a[176:179], v6 offset:256
    v_cvt_pk_bf16_f32 v108, v84, v85
    v_mfma_f32_16x16x32_bf16 v[68:71], a[192:195], a[132:135], v[68:71]
    buffer_load_dwordx4 v35, s[40:43], s77 offen offset:3072 nt lds
    v_mfma_f32_16x16x32_bf16 v[72:75], a[196:199], a[128:131], v[72:75]
    ds_read_b128 a[180:183], v6 offset:8448
    v_mfma_f32_16x16x32_bf16 v[76:79], a[196:199], a[132:135], v[76:79]
    v_exp_f32 v87, v87
    v_mfma_f32_16x16x32_bf16 v[64:67], a[200:203], a[136:139], v[64:67]
    ds_read_b128 a[184:187], v7 offset:256
    v_mfma_f32_16x16x32_bf16 v[68:71], a[200:203], a[140:143], v[68:71]
    v_exp_f32 v92, v92
    v_mfma_f32_16x16x32_bf16 v[72:75], a[204:207], a[136:139], v[72:75]
    ds_read_b128 a[188:191], v7 offset:8448
    v_mfma_f32_16x16x32_bf16 v[76:79], a[204:207], a[140:143], v[76:79]
    s_waitcnt lgkmcnt(4)
    v_mfma_f32_16x16x32_bf16 v[64:67], a[208:211], a[144:147], v[64:67]
    s_waitcnt vmcnt(12)
    s_barrier
    ds_read_b64_tr_b16 a[192:193], v12 offset:16384
    v_cvt_pk_bf16_f32 v109, v86, v87
    v_mfma_f32_16x16x32_bf16 v[68:71], a[208:211], a[148:151], v[68:71]
    ds_read_b64_tr_b16 a[194:195], v12 offset:24576
    v_exp_f32 v93, v93
    v_mfma_f32_16x16x32_bf16 v[72:75], a[212:215], a[144:147], v[72:75]
    ds_read_b64_tr_b16 a[196:197], v13 offset:16384
    v_exp_f32 v94, v94
    v_mfma_f32_16x16x32_bf16 v[76:79], a[212:215], a[148:151], v[76:79]
    ds_read_b64_tr_b16 a[198:199], v13 offset:24576
    v_mfma_f32_16x16x32_bf16 v[64:67], a[216:219], a[152:155], v[64:67]
    ds_read_b64_tr_b16 a[200:201], v14 offset:16384
    v_mfma_f32_16x16x32_bf16 v[68:71], a[216:219], a[156:159], v[68:71]
    ds_read_b64_tr_b16 a[202:203], v14 offset:24576
    v_mfma_f32_16x16x32_bf16 v[72:75], a[220:223], a[152:155], v[72:75]
    ds_read_b64_tr_b16 a[204:205], v15 offset:16384
    v_mfma_f32_16x16x32_bf16 v[76:79], a[220:223], a[156:159], v[76:79]
    ds_read_b64_tr_b16 a[206:207], v15 offset:24576
    s_waitcnt lgkmcnt(8)
    v_mfma_f32_16x16x32_bf16 v[64:67], a[176:179], a[160:163], v[64:67]
    ds_read_b64_tr_b16 a[208:209], v16 offset:16384
    v_cvt_pk_bf16_f32 v110, v92, v93
    s_add_u32 m0, s74, 65536
    v_mfma_f32_16x16x32_bf16 v[68:71], a[176:179], a[164:167], v[68:71]
    ds_read_b64_tr_b16 a[210:211], v16 offset:24576
    v_exp_f32 v95, v95
    v_mfma_f32_16x16x32_bf16 v[72:75], a[180:183], a[160:163], v[72:75]
    ds_read_b64_tr_b16 a[212:213], v17 offset:16384
    v_mfma_f32_16x16x32_bf16 v[76:79], a[180:183], a[164:167], v[76:79]
    ds_read_b64_tr_b16 a[214:215], v17 offset:24576
    v_mfma_f32_16x16x32_bf16 v[64:67], a[184:187], a[168:171], v[64:67]
    ds_read_b64_tr_b16 a[216:217], v18 offset:16384
    v_mfma_f32_16x16x32_bf16 v[68:71], a[184:187], a[172:175], v[68:71]
    ds_read_b64_tr_b16 a[218:219], v18 offset:24576
    v_cvt_pk_bf16_f32 v111, v94, v95
    v_mfma_f32_16x16x32_bf16 v[72:75], a[188:191], a[168:171], v[72:75]
    ds_read_b64_tr_b16 a[220:221], v19 offset:16384
    v_mfma_f32_16x16x32_bf16 v[76:79], a[188:191], a[172:175], v[76:79]
    ds_read_b64_tr_b16 a[222:223], v19 offset:24576
    v_mfma_f32_16x16x32_bf16 v[56:59], a[224:227], v[104:107], v[56:59]
    ds_read_b64_tr_b16 a[176:177], v12 offset:16640
    v_mfma_f32_16x16x32_bf16 v[60:63], a[224:227], v[108:111], v[60:63]
    ds_read_b64_tr_b16 a[178:179], v12 offset:24832
    s_mov_b32 s77, 212992
    s_waitcnt lgkmcnt(10)
    v_mfma_f32_16x16x32_bf16 v[128:131], a[192:195], v[104:107], v[128:131]
    ds_read_b64_tr_b16 a[180:181], v13 offset:16640
    v_mfma_f32_16x16x32_bf16 v[132:135], a[192:195], v[108:111], v[132:135]
    ds_read_b64_tr_b16 a[182:183], v13 offset:24832
    v_mfma_f32_16x16x32_bf16 v[136:139], a[196:199], v[104:107], v[136:139]
    ds_read_b64_tr_b16 a[184:185], v14 offset:16640
    v_mfma_f32_16x16x32_bf16 v[140:143], a[196:199], v[108:111], v[140:143]
    ds_read_b64_tr_b16 a[186:187], v14 offset:24832
    v_mfma_f32_16x16x32_bf16 v[144:147], a[200:203], v[104:107], v[144:147]
    ds_read_b64_tr_b16 a[188:189], v15 offset:16640
    v_mfma_f32_16x16x32_bf16 v[148:151], a[200:203], v[108:111], v[148:151]
    ds_read_b64_tr_b16 a[190:191], v15 offset:24832
    v_mfma_f32_16x16x32_bf16 v[152:155], a[204:207], v[104:107], v[152:155]
    v_exp_f32 v64, v64
    v_mfma_f32_16x16x32_bf16 v[156:159], a[204:207], v[108:111], v[156:159]
    v_exp_f32 v65, v65
    s_waitcnt lgkmcnt(8)
    v_mfma_f32_16x16x32_bf16 v[160:163], a[208:211], v[104:107], v[160:163]
    ds_read_b64_tr_b16 a[192:193], v16 offset:16640
    v_mfma_f32_16x16x32_bf16 v[164:167], a[208:211], v[108:111], v[164:167]
    ds_read_b64_tr_b16 a[194:195], v16 offset:24832
    v_mfma_f32_16x16x32_bf16 v[168:171], a[212:215], v[104:107], v[168:171]
    ds_read_b64_tr_b16 a[196:197], v17 offset:16640
    v_mfma_f32_16x16x32_bf16 v[172:175], a[212:215], v[108:111], v[172:175]
    ds_read_b64_tr_b16 a[198:199], v17 offset:24832
    v_mfma_f32_16x16x32_bf16 v[176:179], a[216:219], v[104:107], v[176:179]
    ds_read_b64_tr_b16 a[200:201], v18 offset:16640
    v_mfma_f32_16x16x32_bf16 v[180:183], a[216:219], v[108:111], v[180:183]
    ds_read_b64_tr_b16 a[202:203], v18 offset:24832
    v_mfma_f32_16x16x32_bf16 v[184:187], a[220:223], v[104:107], v[184:187]
    ds_read_b64_tr_b16 a[204:205], v19 offset:16640
    v_mfma_f32_16x16x32_bf16 v[188:191], a[220:223], v[108:111], v[188:191]
    ds_read_b64_tr_b16 a[206:207], v19 offset:24832
    s_waitcnt lgkmcnt(8)
    v_mfma_f32_16x16x32_bf16 v[192:195], a[176:179], v[104:107], v[192:195]
    ds_read_b128 a[208:211], v4 offset:16384
    v_mfma_f32_16x16x32_bf16 v[196:199], a[176:179], v[108:111], v[196:199]
    v_exp_f32 v66, v66
    v_mfma_f32_16x16x32_bf16 v[200:203], a[180:183], v[104:107], v[200:203]
    ds_read_b128 a[212:215], v4 offset:24576
    v_cvt_pk_bf16_f32 v96, v64, v65
    v_mfma_f32_16x16x32_bf16 v[204:207], a[180:183], v[108:111], v[204:207]
    v_exp_f32 v67, v67
    v_mfma_f32_16x16x32_bf16 v[208:211], a[184:187], v[104:107], v[208:211]
    ds_read_b128 a[216:219], v5 offset:16384
    v_mfma_f32_16x16x32_bf16 v[212:215], a[184:187], v[108:111], v[212:215]
    v_exp_f32 v72, v72
    v_mfma_f32_16x16x32_bf16 v[216:219], a[188:191], v[104:107], v[216:219]
    ds_read_b128 a[220:223], v5 offset:24576
    v_cvt_pk_bf16_f32 v97, v66, v67
    v_mfma_f32_16x16x32_bf16 v[220:223], a[188:191], v[108:111], v[220:223]
    v_exp_f32 v73, v73
    s_waitcnt lgkmcnt(4)
    v_mfma_f32_16x16x32_bf16 v[224:227], a[192:195], v[104:107], v[224:227]
    ds_read_b128 a[176:179], v6 offset:16384
    v_mfma_f32_16x16x32_bf16 v[228:231], a[192:195], v[108:111], v[228:231]
    v_exp_f32 v74, v74
    v_mfma_f32_16x16x32_bf16 v[232:235], a[196:199], v[104:107], v[232:235]
    ds_read_b128 a[180:183], v6 offset:24576
    v_cvt_pk_bf16_f32 v98, v72, v73
    v_mfma_f32_16x16x32_bf16 v[236:239], a[196:199], v[108:111], v[236:239]
    v_exp_f32 v75, v75
    v_mfma_f32_16x16x32_bf16 v[240:243], a[200:203], v[104:107], v[240:243]
    ds_read_b128 a[184:187], v7 offset:16384
    v_mfma_f32_16x16x32_bf16 v[244:247], a[200:203], v[108:111], v[244:247]
    v_exp_f32 v68, v68
    v_mfma_f32_16x16x32_bf16 v[248:251], a[204:207], v[104:107], v[248:251]
    ds_read_b128 a[188:191], v7 offset:24576
    v_mfma_f32_16x16x32_bf16 v[252:255], a[204:207], v[108:111], v[252:255]
    buffer_load_dwordx4 v32, s[40:43], s77 offen offset:0 nt lds
    s_waitcnt lgkmcnt(4)
    v_mfma_f32_16x16x32_bf16 v[80:83], a[208:211], a[112:115], v[48:51]
    ds_read_b128 a[192:195], v4 offset:16640
    v_cvt_pk_bf16_f32 v99, v74, v75
    v_mfma_f32_16x16x32_bf16 v[84:87], a[208:211], a[116:119], v[52:55]
    buffer_load_dwordx4 v33, s[40:43], s77 offen offset:1024 nt lds
    v_mfma_f32_16x16x32_bf16 v[88:91], a[212:215], a[112:115], v[48:51]
    ds_read_b128 a[196:199], v4 offset:24832
    v_mfma_f32_16x16x32_bf16 v[92:95], a[212:215], a[116:119], v[52:55]
    v_exp_f32 v69, v69
    v_mfma_f32_16x16x32_bf16 v[80:83], a[216:219], a[120:123], v[80:83]
    ds_read_b128 a[200:203], v5 offset:16640
    v_mfma_f32_16x16x32_bf16 v[84:87], a[216:219], a[124:127], v[84:87]
    v_exp_f32 v70, v70
    v_mfma_f32_16x16x32_bf16 v[88:91], a[220:223], a[120:123], v[88:91]
    ds_read_b128 a[204:207], v5 offset:24832
    v_mfma_f32_16x16x32_bf16 v[92:95], a[220:223], a[124:127], v[92:95]
    buffer_load_dwordx4 v34, s[40:43], s77 offen offset:2048 nt lds
    s_waitcnt lgkmcnt(4)
    v_mfma_f32_16x16x32_bf16 v[80:83], a[176:179], a[128:131], v[80:83]
    ds_read_b128 a[208:211], v6 offset:16640
    v_cvt_pk_bf16_f32 v100, v68, v69
    v_mfma_f32_16x16x32_bf16 v[84:87], a[176:179], a[132:135], v[84:87]
    buffer_load_dwordx4 v35, s[40:43], s77 offen offset:3072 nt lds
    v_mfma_f32_16x16x32_bf16 v[88:91], a[180:183], a[128:131], v[88:91]
    ds_read_b128 a[212:215], v6 offset:24832
    v_mfma_f32_16x16x32_bf16 v[92:95], a[180:183], a[132:135], v[92:95]
    v_exp_f32 v71, v71
    v_mfma_f32_16x16x32_bf16 v[80:83], a[184:187], a[136:139], v[80:83]
    ds_read_b128 a[216:219], v7 offset:16640
    v_mfma_f32_16x16x32_bf16 v[84:87], a[184:187], a[140:143], v[84:87]
    v_exp_f32 v76, v76
    v_mfma_f32_16x16x32_bf16 v[88:91], a[188:191], a[136:139], v[88:91]
    ds_read_b128 a[220:223], v7 offset:24832
    v_mfma_f32_16x16x32_bf16 v[92:95], a[188:191], a[140:143], v[92:95]
    s_waitcnt lgkmcnt(4)
    v_mfma_f32_16x16x32_bf16 v[80:83], a[192:195], a[144:147], v[80:83]
    s_waitcnt vmcnt(12)
    s_barrier
    ds_read_b64_tr_b16 a[176:177], v20 offset:32768
    v_cvt_pk_bf16_f32 v101, v70, v71
    v_mfma_f32_16x16x32_bf16 v[84:87], a[192:195], a[148:151], v[84:87]
    ds_read_b64_tr_b16 a[178:179], v20 offset:40960
    v_exp_f32 v77, v77
    v_mfma_f32_16x16x32_bf16 v[88:91], a[196:199], a[144:147], v[88:91]
    ds_read_b64_tr_b16 a[180:181], v21 offset:32768
    v_exp_f32 v78, v78
    v_mfma_f32_16x16x32_bf16 v[92:95], a[196:199], a[148:151], v[92:95]
    ds_read_b64_tr_b16 a[182:183], v21 offset:40960
    v_mfma_f32_16x16x32_bf16 v[80:83], a[200:203], a[152:155], v[80:83]
    ds_read_b64_tr_b16 a[184:185], v22 offset:32768
    v_mfma_f32_16x16x32_bf16 v[84:87], a[200:203], a[156:159], v[84:87]
    ds_read_b64_tr_b16 a[186:187], v22 offset:40960
    v_mfma_f32_16x16x32_bf16 v[88:91], a[204:207], a[152:155], v[88:91]
    ds_read_b64_tr_b16 a[188:189], v23 offset:32768
    v_mfma_f32_16x16x32_bf16 v[92:95], a[204:207], a[156:159], v[92:95]
    ds_read_b64_tr_b16 a[190:191], v23 offset:40960
    s_waitcnt lgkmcnt(8)
    v_mfma_f32_16x16x32_bf16 v[80:83], a[208:211], a[160:163], v[80:83]
    ds_read_b64_tr_b16 a[192:193], v24 offset:32768
    v_cvt_pk_bf16_f32 v102, v76, v77
    s_add_u32 m0, s74, 81920
    v_mfma_f32_16x16x32_bf16 v[84:87], a[208:211], a[164:167], v[84:87]
    ds_read_b64_tr_b16 a[194:195], v24 offset:40960
    v_exp_f32 v79, v79
    v_mfma_f32_16x16x32_bf16 v[88:91], a[212:215], a[160:163], v[88:91]
    ds_read_b64_tr_b16 a[196:197], v25 offset:32768
    v_mfma_f32_16x16x32_bf16 v[92:95], a[212:215], a[164:167], v[92:95]
    ds_read_b64_tr_b16 a[198:199], v25 offset:40960
    v_mfma_f32_16x16x32_bf16 v[80:83], a[216:219], a[168:171], v[80:83]
    ds_read_b64_tr_b16 a[200:201], v26 offset:32768
    s_mov_b32 s77, 229376
    v_mfma_f32_16x16x32_bf16 v[84:87], a[216:219], a[172:175], v[84:87]
    ds_read_b64_tr_b16 a[202:203], v26 offset:40960
    v_cvt_pk_bf16_f32 v103, v78, v79
    v_mfma_f32_16x16x32_bf16 v[88:91], a[220:223], a[168:171], v[88:91]
    ds_read_b64_tr_b16 a[204:205], v27 offset:32768
    v_mfma_f32_16x16x32_bf16 v[92:95], a[220:223], a[172:175], v[92:95]
    ds_read_b64_tr_b16 a[206:207], v27 offset:40960
    v_mfma_f32_16x16x32_bf16 v[56:59], a[224:227], v[96:99], v[56:59]
    ds_read_b64_tr_b16 a[208:209], v20 offset:33024
    v_mfma_f32_16x16x32_bf16 v[60:63], a[224:227], v[100:103], v[60:63]
    ds_read_b64_tr_b16 a[210:211], v20 offset:41216
    s_waitcnt lgkmcnt(10)
    v_mfma_f32_16x16x32_bf16 v[128:131], a[176:179], v[96:99], v[128:131]
    ds_read_b64_tr_b16 a[212:213], v21 offset:33024
    v_mfma_f32_16x16x32_bf16 v[132:135], a[176:179], v[100:103], v[132:135]
    ds_read_b64_tr_b16 a[214:215], v21 offset:41216
    v_mfma_f32_16x16x32_bf16 v[136:139], a[180:183], v[96:99], v[136:139]
    ds_read_b64_tr_b16 a[216:217], v22 offset:33024
    v_mfma_f32_16x16x32_bf16 v[140:143], a[180:183], v[100:103], v[140:143]
    ds_read_b64_tr_b16 a[218:219], v22 offset:41216
    v_mfma_f32_16x16x32_bf16 v[144:147], a[184:187], v[96:99], v[144:147]
    ds_read_b64_tr_b16 a[220:221], v23 offset:33024
    v_mfma_f32_16x16x32_bf16 v[148:151], a[184:187], v[100:103], v[148:151]
    ds_read_b64_tr_b16 a[222:223], v23 offset:41216
    v_mfma_f32_16x16x32_bf16 v[152:155], a[188:191], v[96:99], v[152:155]
    v_exp_f32 v80, v80
    v_mfma_f32_16x16x32_bf16 v[156:159], a[188:191], v[100:103], v[156:159]
    v_exp_f32 v81, v81
    s_waitcnt lgkmcnt(8)
    v_mfma_f32_16x16x32_bf16 v[160:163], a[192:195], v[96:99], v[160:163]
    ds_read_b64_tr_b16 a[176:177], v24 offset:33024
    v_mfma_f32_16x16x32_bf16 v[164:167], a[192:195], v[100:103], v[164:167]
    ds_read_b64_tr_b16 a[178:179], v24 offset:41216
    v_mfma_f32_16x16x32_bf16 v[168:171], a[196:199], v[96:99], v[168:171]
    ds_read_b64_tr_b16 a[180:181], v25 offset:33024
    v_mfma_f32_16x16x32_bf16 v[172:175], a[196:199], v[100:103], v[172:175]
    ds_read_b64_tr_b16 a[182:183], v25 offset:41216
    v_mfma_f32_16x16x32_bf16 v[176:179], a[200:203], v[96:99], v[176:179]
    ds_read_b64_tr_b16 a[184:185], v26 offset:33024
    v_mfma_f32_16x16x32_bf16 v[180:183], a[200:203], v[100:103], v[180:183]
    ds_read_b64_tr_b16 a[186:187], v26 offset:41216
    v_mfma_f32_16x16x32_bf16 v[184:187], a[204:207], v[96:99], v[184:187]
    ds_read_b64_tr_b16 a[188:189], v27 offset:33024
    v_mfma_f32_16x16x32_bf16 v[188:191], a[204:207], v[100:103], v[188:191]
    ds_read_b64_tr_b16 a[190:191], v27 offset:41216
    s_waitcnt lgkmcnt(8)
    v_mfma_f32_16x16x32_bf16 v[192:195], a[208:211], v[96:99], v[192:195]
    ds_read_b128 a[192:195], v4 offset:32768
    v_mfma_f32_16x16x32_bf16 v[196:199], a[208:211], v[100:103], v[196:199]
    v_exp_f32 v82, v82
    v_mfma_f32_16x16x32_bf16 v[200:203], a[212:215], v[96:99], v[200:203]
    ds_read_b128 a[196:199], v4 offset:40960
    v_cvt_pk_bf16_f32 v104, v80, v81
    v_mfma_f32_16x16x32_bf16 v[204:207], a[212:215], v[100:103], v[204:207]
    v_exp_f32 v83, v83
    v_mfma_f32_16x16x32_bf16 v[208:211], a[216:219], v[96:99], v[208:211]
    ds_read_b128 a[200:203], v5 offset:32768
    v_mfma_f32_16x16x32_bf16 v[212:215], a[216:219], v[100:103], v[212:215]
    v_exp_f32 v88, v88
    v_mfma_f32_16x16x32_bf16 v[216:219], a[220:223], v[96:99], v[216:219]
    ds_read_b128 a[204:207], v5 offset:40960
    v_cvt_pk_bf16_f32 v105, v82, v83
    v_mfma_f32_16x16x32_bf16 v[220:223], a[220:223], v[100:103], v[220:223]
    v_exp_f32 v89, v89
    s_waitcnt lgkmcnt(4)
    v_mfma_f32_16x16x32_bf16 v[224:227], a[176:179], v[96:99], v[224:227]
    ds_read_b128 a[208:211], v6 offset:32768
    v_mfma_f32_16x16x32_bf16 v[228:231], a[176:179], v[100:103], v[228:231]
    v_exp_f32 v90, v90
    v_mfma_f32_16x16x32_bf16 v[232:235], a[180:183], v[96:99], v[232:235]
    ds_read_b128 a[212:215], v6 offset:40960
    v_cvt_pk_bf16_f32 v106, v88, v89
    v_mfma_f32_16x16x32_bf16 v[236:239], a[180:183], v[100:103], v[236:239]
    v_exp_f32 v91, v91
    v_mfma_f32_16x16x32_bf16 v[240:243], a[184:187], v[96:99], v[240:243]
    ds_read_b128 a[216:219], v7 offset:32768
    v_mfma_f32_16x16x32_bf16 v[244:247], a[184:187], v[100:103], v[244:247]
    v_exp_f32 v84, v84
    v_mfma_f32_16x16x32_bf16 v[248:251], a[188:191], v[96:99], v[248:251]
    ds_read_b128 a[220:223], v7 offset:40960
    v_mfma_f32_16x16x32_bf16 v[252:255], a[188:191], v[100:103], v[252:255]
    buffer_load_dwordx4 v32, s[40:43], s77 offen offset:0 nt lds
    s_waitcnt lgkmcnt(4)
    v_mfma_f32_16x16x32_bf16 v[64:67], a[192:195], a[112:115], v[48:51]
    ds_read_b128 a[176:179], v4 offset:33024
    v_cvt_pk_bf16_f32 v107, v90, v91
    v_mfma_f32_16x16x32_bf16 v[68:71], a[192:195], a[116:119], v[52:55]
    buffer_load_dwordx4 v33, s[40:43], s77 offen offset:1024 nt lds
    v_mfma_f32_16x16x32_bf16 v[72:75], a[196:199], a[112:115], v[48:51]
    ds_read_b128 a[180:183], v4 offset:41216
    v_mfma_f32_16x16x32_bf16 v[76:79], a[196:199], a[116:119], v[52:55]
    v_exp_f32 v85, v85
    v_mfma_f32_16x16x32_bf16 v[64:67], a[200:203], a[120:123], v[64:67]
    ds_read_b128 a[184:187], v5 offset:33024
    v_mfma_f32_16x16x32_bf16 v[68:71], a[200:203], a[124:127], v[68:71]
    v_exp_f32 v86, v86
    v_mfma_f32_16x16x32_bf16 v[72:75], a[204:207], a[120:123], v[72:75]
    ds_read_b128 a[188:191], v5 offset:41216
    v_mfma_f32_16x16x32_bf16 v[76:79], a[204:207], a[124:127], v[76:79]
    buffer_load_dwordx4 v34, s[40:43], s77 offen offset:2048 nt lds
    s_waitcnt lgkmcnt(4)
    v_mfma_f32_16x16x32_bf16 v[64:67], a[208:211], a[128:131], v[64:67]
    ds_read_b128 a[192:195], v6 offset:33024
    v_cvt_pk_bf16_f32 v108, v84, v85
    v_mfma_f32_16x16x32_bf16 v[68:71], a[208:211], a[132:135], v[68:71]
    buffer_load_dwordx4 v35, s[40:43], s77 offen offset:3072 nt lds
    s_add_u32 m0, s73, 16384
    s_mov_b32 s77, 0
    v_mfma_f32_16x16x32_bf16 v[72:75], a[212:215], a[128:131], v[72:75]
    ds_read_b128 a[196:199], v6 offset:41216
    v_mfma_f32_16x16x32_bf16 v[76:79], a[212:215], a[132:135], v[76:79]
    v_exp_f32 v87, v87
    v_mfma_f32_16x16x32_bf16 v[64:67], a[216:219], a[136:139], v[64:67]
    ds_read_b128 a[200:203], v7 offset:33024
    v_mfma_f32_16x16x32_bf16 v[68:71], a[216:219], a[140:143], v[68:71]
    v_exp_f32 v92, v92
    v_mfma_f32_16x16x32_bf16 v[72:75], a[220:223], a[136:139], v[72:75]
    ds_read_b128 a[204:207], v7 offset:41216
    v_mfma_f32_16x16x32_bf16 v[76:79], a[220:223], a[140:143], v[76:79]
    buffer_load_dwordx4 v41, s[48:51], s77 offen lds
    s_add_u32 m0, s73, 20480
    s_mov_b32 s77, 28672
    buffer_load_dwordx4 v41, s[48:51], s77 offen lds
    s_waitcnt lgkmcnt(4)
    v_mfma_f32_16x16x32_bf16 v[64:67], a[176:179], a[144:147], v[64:67]
    s_waitcnt vmcnt(14)
    s_barrier
    ds_read_b64_tr_b16 a[208:209], v20 offset:49152
    v_cvt_pk_bf16_f32 v109, v86, v87
    v_mfma_f32_16x16x32_bf16 v[68:71], a[176:179], a[148:151], v[68:71]
    ds_read_b64_tr_b16 a[210:211], v20 offset:57344
    v_exp_f32 v93, v93
    v_mfma_f32_16x16x32_bf16 v[72:75], a[180:183], a[144:147], v[72:75]
    ds_read_b64_tr_b16 a[212:213], v21 offset:49152
    v_exp_f32 v94, v94
    v_mfma_f32_16x16x32_bf16 v[76:79], a[180:183], a[148:151], v[76:79]
    ds_read_b64_tr_b16 a[214:215], v21 offset:57344
    v_mfma_f32_16x16x32_bf16 v[64:67], a[184:187], a[152:155], v[64:67]
    ds_read_b64_tr_b16 a[216:217], v22 offset:49152
    v_mfma_f32_16x16x32_bf16 v[68:71], a[184:187], a[156:159], v[68:71]
    ds_read_b64_tr_b16 a[218:219], v22 offset:57344
    v_mfma_f32_16x16x32_bf16 v[72:75], a[188:191], a[152:155], v[72:75]
    ds_read_b64_tr_b16 a[220:221], v23 offset:49152
    v_mfma_f32_16x16x32_bf16 v[76:79], a[188:191], a[156:159], v[76:79]
    ds_read_b64_tr_b16 a[222:223], v23 offset:57344
    s_waitcnt lgkmcnt(8)
    v_mfma_f32_16x16x32_bf16 v[64:67], a[192:195], a[160:163], v[64:67]
    ds_read_b64_tr_b16 a[176:177], v24 offset:49152
    v_cvt_pk_bf16_f32 v110, v92, v93
    s_add_u32 m0, s74, 131072
    v_mfma_f32_16x16x32_bf16 v[68:71], a[192:195], a[164:167], v[68:71]
    ds_read_b64_tr_b16 a[178:179], v24 offset:57344
    v_exp_f32 v95, v95
    v_mfma_f32_16x16x32_bf16 v[72:75], a[196:199], a[160:163], v[72:75]
    ds_read_b64_tr_b16 a[180:181], v25 offset:49152
    v_mfma_f32_16x16x32_bf16 v[76:79], a[196:199], a[164:167], v[76:79]
    ds_read_b64_tr_b16 a[182:183], v25 offset:57344
    v_mfma_f32_16x16x32_bf16 v[64:67], a[200:203], a[168:171], v[64:67]
    ds_read_b64_tr_b16 a[184:185], v26 offset:49152
    s_mov_b32 s77, 245760
    v_mfma_f32_16x16x32_bf16 v[68:71], a[200:203], a[172:175], v[68:71]
    ds_read_b64_tr_b16 a[186:187], v26 offset:57344
    v_cvt_pk_bf16_f32 v111, v94, v95
    v_mfma_f32_16x16x32_bf16 v[72:75], a[204:207], a[168:171], v[72:75]
    ds_read_b64_tr_b16 a[188:189], v27 offset:49152
    v_mfma_f32_16x16x32_bf16 v[76:79], a[204:207], a[172:175], v[76:79]
    ds_read_b64_tr_b16 a[190:191], v27 offset:57344
    v_mfma_f32_16x16x32_bf16 v[56:59], a[224:227], v[104:107], v[56:59]
    ds_read_b64_tr_b16 a[192:193], v20 offset:49408
    v_mfma_f32_16x16x32_bf16 v[60:63], a[224:227], v[108:111], v[60:63]
    ds_read_b64_tr_b16 a[194:195], v20 offset:57600
    s_waitcnt lgkmcnt(10)
    v_mfma_f32_16x16x32_bf16 v[128:131], a[208:211], v[104:107], v[128:131]
    ds_read_b64_tr_b16 a[196:197], v21 offset:49408
    v_mfma_f32_16x16x32_bf16 v[132:135], a[208:211], v[108:111], v[132:135]
    ds_read_b64_tr_b16 a[198:199], v21 offset:57600
    v_mfma_f32_16x16x32_bf16 v[136:139], a[212:215], v[104:107], v[136:139]
    ds_read_b64_tr_b16 a[200:201], v22 offset:49408
    v_mfma_f32_16x16x32_bf16 v[140:143], a[212:215], v[108:111], v[140:143]
    ds_read_b64_tr_b16 a[202:203], v22 offset:57600
    v_mfma_f32_16x16x32_bf16 v[144:147], a[216:219], v[104:107], v[144:147]
    ds_read_b64_tr_b16 a[204:205], v23 offset:49408
    v_mfma_f32_16x16x32_bf16 v[148:151], a[216:219], v[108:111], v[148:151]
    ds_read_b64_tr_b16 a[206:207], v23 offset:57600
    v_mfma_f32_16x16x32_bf16 v[152:155], a[220:223], v[104:107], v[152:155]
    v_exp_f32 v64, v64
    v_mfma_f32_16x16x32_bf16 v[156:159], a[220:223], v[108:111], v[156:159]
    v_exp_f32 v65, v65
    s_waitcnt lgkmcnt(8)
    v_mfma_f32_16x16x32_bf16 v[160:163], a[176:179], v[104:107], v[160:163]
    ds_read_b64_tr_b16 a[208:209], v24 offset:49408
    v_mfma_f32_16x16x32_bf16 v[164:167], a[176:179], v[108:111], v[164:167]
    ds_read_b64_tr_b16 a[210:211], v24 offset:57600
    v_mfma_f32_16x16x32_bf16 v[168:171], a[180:183], v[104:107], v[168:171]
    ds_read_b64_tr_b16 a[212:213], v25 offset:49408
    v_mfma_f32_16x16x32_bf16 v[172:175], a[180:183], v[108:111], v[172:175]
    ds_read_b64_tr_b16 a[214:215], v25 offset:57600
    v_mfma_f32_16x16x32_bf16 v[176:179], a[184:187], v[104:107], v[176:179]
    ds_read_b64_tr_b16 a[216:217], v26 offset:49408
    v_mfma_f32_16x16x32_bf16 v[180:183], a[184:187], v[108:111], v[180:183]
    ds_read_b64_tr_b16 a[218:219], v26 offset:57600
    v_mfma_f32_16x16x32_bf16 v[184:187], a[188:191], v[104:107], v[184:187]
    ds_read_b64_tr_b16 a[220:221], v27 offset:49408
    v_mfma_f32_16x16x32_bf16 v[188:191], a[188:191], v[108:111], v[188:191]
    ds_read_b64_tr_b16 a[222:223], v27 offset:57600
    s_waitcnt lgkmcnt(8)
    v_mfma_f32_16x16x32_bf16 v[192:195], a[192:195], v[104:107], v[192:195]
    ds_read_b128 a[176:179], v4 offset:49152
    v_mfma_f32_16x16x32_bf16 v[196:199], a[192:195], v[108:111], v[196:199]
    v_exp_f32 v66, v66
    v_mfma_f32_16x16x32_bf16 v[200:203], a[196:199], v[104:107], v[200:203]
    ds_read_b128 a[180:183], v4 offset:57344
    v_cvt_pk_bf16_f32 v96, v64, v65
    v_mfma_f32_16x16x32_bf16 v[204:207], a[196:199], v[108:111], v[204:207]
    v_exp_f32 v67, v67
    v_mfma_f32_16x16x32_bf16 v[208:211], a[200:203], v[104:107], v[208:211]
    ds_read_b128 a[184:187], v5 offset:49152
    v_mfma_f32_16x16x32_bf16 v[212:215], a[200:203], v[108:111], v[212:215]
    v_exp_f32 v72, v72
    v_mfma_f32_16x16x32_bf16 v[216:219], a[204:207], v[104:107], v[216:219]
    ds_read_b128 a[188:191], v5 offset:57344
    v_cvt_pk_bf16_f32 v97, v66, v67
    v_mfma_f32_16x16x32_bf16 v[220:223], a[204:207], v[108:111], v[220:223]
    v_exp_f32 v73, v73
    s_waitcnt lgkmcnt(4)
    v_mfma_f32_16x16x32_bf16 v[224:227], a[208:211], v[104:107], v[224:227]
    ds_read_b128 a[192:195], v6 offset:49152
    v_mfma_f32_16x16x32_bf16 v[228:231], a[208:211], v[108:111], v[228:231]
    v_exp_f32 v74, v74
    v_mfma_f32_16x16x32_bf16 v[232:235], a[212:215], v[104:107], v[232:235]
    ds_read_b128 a[196:199], v6 offset:57344
    v_cvt_pk_bf16_f32 v98, v72, v73
    v_mfma_f32_16x16x32_bf16 v[236:239], a[212:215], v[108:111], v[236:239]
    v_exp_f32 v75, v75
    v_mfma_f32_16x16x32_bf16 v[240:243], a[216:219], v[104:107], v[240:243]
    ds_read_b128 a[200:203], v7 offset:49152
    v_mfma_f32_16x16x32_bf16 v[244:247], a[216:219], v[108:111], v[244:247]
    v_exp_f32 v68, v68
    v_mfma_f32_16x16x32_bf16 v[248:251], a[220:223], v[104:107], v[248:251]
    ds_read_b128 a[204:207], v7 offset:57344
    v_mfma_f32_16x16x32_bf16 v[252:255], a[220:223], v[108:111], v[252:255]
    buffer_load_dwordx4 v32, s[40:43], s77 offen offset:0 nt lds
    s_waitcnt lgkmcnt(4)
    v_mfma_f32_16x16x32_bf16 v[80:83], a[176:179], a[112:115], v[48:51]
    ds_read_b128 a[208:211], v4 offset:49408
    v_cvt_pk_bf16_f32 v99, v74, v75
    v_mfma_f32_16x16x32_bf16 v[84:87], a[176:179], a[116:119], v[52:55]
    buffer_load_dwordx4 v33, s[40:43], s77 offen offset:1024 nt lds
    v_mfma_f32_16x16x32_bf16 v[88:91], a[180:183], a[112:115], v[48:51]
    ds_read_b128 a[212:215], v4 offset:57600
    v_mfma_f32_16x16x32_bf16 v[92:95], a[180:183], a[116:119], v[52:55]
    v_exp_f32 v69, v69
    v_mfma_f32_16x16x32_bf16 v[80:83], a[184:187], a[120:123], v[80:83]
    ds_read_b128 a[216:219], v5 offset:49408
    v_mfma_f32_16x16x32_bf16 v[84:87], a[184:187], a[124:127], v[84:87]
    v_exp_f32 v70, v70
    v_mfma_f32_16x16x32_bf16 v[88:91], a[188:191], a[120:123], v[88:91]
    ds_read_b128 a[220:223], v5 offset:57600
    v_mfma_f32_16x16x32_bf16 v[92:95], a[188:191], a[124:127], v[92:95]
    buffer_load_dwordx4 v34, s[40:43], s77 offen offset:2048 nt lds
    s_waitcnt lgkmcnt(4)
    v_mfma_f32_16x16x32_bf16 v[80:83], a[192:195], a[128:131], v[80:83]
    ds_read_b128 a[176:179], v6 offset:49408
    v_cvt_pk_bf16_f32 v100, v68, v69
    v_mfma_f32_16x16x32_bf16 v[84:87], a[192:195], a[132:135], v[84:87]
    buffer_load_dwordx4 v35, s[40:43], s77 offen offset:3072 nt lds
    s_add_u32 m0, s73, 32768
    s_mov_b32 s77, 114688
    v_mfma_f32_16x16x32_bf16 v[88:91], a[196:199], a[128:131], v[88:91]
    ds_read_b128 a[180:183], v6 offset:57600
    v_mfma_f32_16x16x32_bf16 v[92:95], a[196:199], a[132:135], v[92:95]
    v_exp_f32 v71, v71
    v_mfma_f32_16x16x32_bf16 v[80:83], a[200:203], a[136:139], v[80:83]
    ds_read_b128 a[184:187], v7 offset:49408
    v_mfma_f32_16x16x32_bf16 v[84:87], a[200:203], a[140:143], v[84:87]
    v_exp_f32 v76, v76
    v_mfma_f32_16x16x32_bf16 v[88:91], a[204:207], a[136:139], v[88:91]
    ds_read_b128 a[188:191], v7 offset:57600
    v_mfma_f32_16x16x32_bf16 v[92:95], a[204:207], a[140:143], v[92:95]
    buffer_load_dwordx4 v41, s[48:51], s77 offen lds
    s_add_u32 m0, s73, 36864
    s_mov_b32 s77, 143360
    buffer_load_dwordx4 v41, s[48:51], s77 offen lds
    s_waitcnt lgkmcnt(4)
    v_mfma_f32_16x16x32_bf16 v[80:83], a[208:211], a[144:147], v[80:83]
    s_waitcnt vmcnt(16)
    s_barrier
    ds_read_b64_tr_b16 a[192:193], v12 offset:32768
    v_cvt_pk_bf16_f32 v101, v70, v71
    v_mfma_f32_16x16x32_bf16 v[84:87], a[208:211], a[148:151], v[84:87]
    ds_read_b64_tr_b16 a[194:195], v12 offset:40960
    v_exp_f32 v77, v77
    v_mfma_f32_16x16x32_bf16 v[88:91], a[212:215], a[144:147], v[88:91]
    ds_read_b64_tr_b16 a[196:197], v13 offset:32768
    v_exp_f32 v78, v78
    v_mfma_f32_16x16x32_bf16 v[92:95], a[212:215], a[148:151], v[92:95]
    ds_read_b64_tr_b16 a[198:199], v13 offset:40960
    v_mfma_f32_16x16x32_bf16 v[80:83], a[216:219], a[152:155], v[80:83]
    ds_read_b64_tr_b16 a[200:201], v14 offset:32768
    v_mfma_f32_16x16x32_bf16 v[84:87], a[216:219], a[156:159], v[84:87]
    ds_read_b64_tr_b16 a[202:203], v14 offset:40960
    v_mfma_f32_16x16x32_bf16 v[88:91], a[220:223], a[152:155], v[88:91]
    ds_read_b64_tr_b16 a[204:205], v15 offset:32768
    v_mfma_f32_16x16x32_bf16 v[92:95], a[220:223], a[156:159], v[92:95]
    ds_read_b64_tr_b16 a[206:207], v15 offset:40960
    s_waitcnt lgkmcnt(8)
    v_mfma_f32_16x16x32_bf16 v[80:83], a[176:179], a[160:163], v[80:83]
    ds_read_b64_tr_b16 a[208:209], v16 offset:32768
    v_cvt_pk_bf16_f32 v102, v76, v77
    s_add_u32 m0, s73, 49152
    v_mfma_f32_16x16x32_bf16 v[84:87], a[176:179], a[164:167], v[84:87]
    ds_read_b64_tr_b16 a[210:211], v16 offset:40960
    v_exp_f32 v79, v79
    v_mfma_f32_16x16x32_bf16 v[88:91], a[180:183], a[160:163], v[88:91]
    ds_read_b64_tr_b16 a[212:213], v17 offset:32768
    v_mfma_f32_16x16x32_bf16 v[92:95], a[180:183], a[164:167], v[92:95]
    ds_read_b64_tr_b16 a[214:215], v17 offset:40960
    v_mfma_f32_16x16x32_bf16 v[80:83], a[184:187], a[168:171], v[80:83]
    ds_read_b64_tr_b16 a[216:217], v18 offset:32768
    s_mov_b32 s77, 128
    v_mfma_f32_16x16x32_bf16 v[84:87], a[184:187], a[172:175], v[84:87]
    ds_read_b64_tr_b16 a[218:219], v18 offset:40960
    v_cvt_pk_bf16_f32 v103, v78, v79
    v_mfma_f32_16x16x32_bf16 v[88:91], a[188:191], a[168:171], v[88:91]
    ds_read_b64_tr_b16 a[220:221], v19 offset:32768
    v_mfma_f32_16x16x32_bf16 v[92:95], a[188:191], a[172:175], v[92:95]
    ds_read_b64_tr_b16 a[222:223], v19 offset:40960
    v_mfma_f32_16x16x32_bf16 v[56:59], a[224:227], v[96:99], v[56:59]
    ds_read_b64_tr_b16 a[176:177], v12 offset:33024
    v_mfma_f32_16x16x32_bf16 v[60:63], a[224:227], v[100:103], v[60:63]
    ds_read_b64_tr_b16 a[178:179], v12 offset:41216
    s_waitcnt lgkmcnt(10)
    v_mfma_f32_16x16x32_bf16 v[128:131], a[192:195], v[96:99], v[128:131]
    ds_read_b64_tr_b16 a[180:181], v13 offset:33024
    v_mfma_f32_16x16x32_bf16 v[132:135], a[192:195], v[100:103], v[132:135]
    ds_read_b64_tr_b16 a[182:183], v13 offset:41216
    v_mfma_f32_16x16x32_bf16 v[136:139], a[196:199], v[96:99], v[136:139]
    ds_read_b64_tr_b16 a[184:185], v14 offset:33024
    v_mfma_f32_16x16x32_bf16 v[140:143], a[196:199], v[100:103], v[140:143]
    ds_read_b64_tr_b16 a[186:187], v14 offset:41216
    v_mfma_f32_16x16x32_bf16 v[144:147], a[200:203], v[96:99], v[144:147]
    ds_read_b64_tr_b16 a[188:189], v15 offset:33024
    v_mfma_f32_16x16x32_bf16 v[148:151], a[200:203], v[100:103], v[148:151]
    ds_read_b64_tr_b16 a[190:191], v15 offset:41216
    v_mfma_f32_16x16x32_bf16 v[152:155], a[204:207], v[96:99], v[152:155]
    v_exp_f32 v80, v80
    v_mfma_f32_16x16x32_bf16 v[156:159], a[204:207], v[100:103], v[156:159]
    v_exp_f32 v81, v81
    s_waitcnt lgkmcnt(8)
    v_mfma_f32_16x16x32_bf16 v[160:163], a[208:211], v[96:99], v[160:163]
    ds_read_b64_tr_b16 a[192:193], v16 offset:33024
    v_mfma_f32_16x16x32_bf16 v[164:167], a[208:211], v[100:103], v[164:167]
    ds_read_b64_tr_b16 a[194:195], v16 offset:41216
    v_mfma_f32_16x16x32_bf16 v[168:171], a[212:215], v[96:99], v[168:171]
    ds_read_b64_tr_b16 a[196:197], v17 offset:33024
    v_mfma_f32_16x16x32_bf16 v[172:175], a[212:215], v[100:103], v[172:175]
    ds_read_b64_tr_b16 a[198:199], v17 offset:41216
    v_mfma_f32_16x16x32_bf16 v[176:179], a[216:219], v[96:99], v[176:179]
    ds_read_b64_tr_b16 a[200:201], v18 offset:33024
    v_mfma_f32_16x16x32_bf16 v[180:183], a[216:219], v[100:103], v[180:183]
    ds_read_b64_tr_b16 a[202:203], v18 offset:41216
    v_mfma_f32_16x16x32_bf16 v[184:187], a[220:223], v[96:99], v[184:187]
    ds_read_b64_tr_b16 a[204:205], v19 offset:33024
    v_mfma_f32_16x16x32_bf16 v[188:191], a[220:223], v[100:103], v[188:191]
    ds_read_b64_tr_b16 a[206:207], v19 offset:41216
    s_waitcnt lgkmcnt(8)
    v_mfma_f32_16x16x32_bf16 v[192:195], a[176:179], v[96:99], v[192:195]
    ds_read_b128 a[208:211], v8 offset:49152
    v_mfma_f32_16x16x32_bf16 v[196:199], a[176:179], v[100:103], v[196:199]
    v_exp_f32 v82, v82
    v_mfma_f32_16x16x32_bf16 v[200:203], a[180:183], v[96:99], v[200:203]
    ds_read_b128 a[212:215], v8 offset:57344
    v_cvt_pk_bf16_f32 v104, v80, v81
    v_mfma_f32_16x16x32_bf16 v[204:207], a[180:183], v[100:103], v[204:207]
    v_exp_f32 v83, v83
    v_mfma_f32_16x16x32_bf16 v[208:211], a[184:187], v[96:99], v[208:211]
    ds_read_b128 a[216:219], v9 offset:49152
    v_mfma_f32_16x16x32_bf16 v[212:215], a[184:187], v[100:103], v[212:215]
    v_exp_f32 v88, v88
    v_mfma_f32_16x16x32_bf16 v[216:219], a[188:191], v[96:99], v[216:219]
    ds_read_b128 a[220:223], v9 offset:57344
    v_cvt_pk_bf16_f32 v105, v82, v83
    v_mfma_f32_16x16x32_bf16 v[220:223], a[188:191], v[100:103], v[220:223]
    v_exp_f32 v89, v89
    s_waitcnt lgkmcnt(4)
    v_mfma_f32_16x16x32_bf16 v[224:227], a[192:195], v[96:99], v[224:227]
    ds_read_b128 a[176:179], v10 offset:49152
    v_mfma_f32_16x16x32_bf16 v[228:231], a[192:195], v[100:103], v[228:231]
    v_exp_f32 v90, v90
    v_mfma_f32_16x16x32_bf16 v[232:235], a[196:199], v[96:99], v[232:235]
    ds_read_b128 a[180:183], v10 offset:57344
    v_cvt_pk_bf16_f32 v106, v88, v89
    v_mfma_f32_16x16x32_bf16 v[236:239], a[196:199], v[100:103], v[236:239]
    v_exp_f32 v91, v91
    v_mfma_f32_16x16x32_bf16 v[240:243], a[200:203], v[96:99], v[240:243]
    ds_read_b128 a[184:187], v11 offset:49152
    v_mfma_f32_16x16x32_bf16 v[244:247], a[200:203], v[100:103], v[244:247]
    v_exp_f32 v84, v84
    v_mfma_f32_16x16x32_bf16 v[248:251], a[204:207], v[96:99], v[248:251]
    ds_read_b128 a[188:191], v11 offset:57344
    v_mfma_f32_16x16x32_bf16 v[252:255], a[204:207], v[100:103], v[252:255]
    buffer_load_dwordx4 v41, s[48:51], s77 offen lds
    s_add_u32 m0, s73, 53248
    s_mov_b32 s77, 28800
    s_waitcnt lgkmcnt(4)
    v_mfma_f32_16x16x32_bf16 v[64:67], a[208:211], a[112:115], v[48:51]
    ds_read_b128 a[192:195], v8 offset:49408
    v_cvt_pk_bf16_f32 v107, v90, v91
    v_mfma_f32_16x16x32_bf16 v[68:71], a[208:211], a[116:119], v[52:55]
    buffer_load_dwordx4 v41, s[48:51], s77 offen lds
    s_add_u32 m0, s73, 147456
    s_mov_b32 s77, 114816
    v_mfma_f32_16x16x32_bf16 v[72:75], a[212:215], a[112:115], v[48:51]
    ds_read_b128 a[196:199], v8 offset:57600
    v_mfma_f32_16x16x32_bf16 v[76:79], a[212:215], a[116:119], v[52:55]
    v_exp_f32 v85, v85
    v_mfma_f32_16x16x32_bf16 v[64:67], a[216:219], a[120:123], v[64:67]
    ds_read_b128 a[200:203], v9 offset:49408
    v_mfma_f32_16x16x32_bf16 v[68:71], a[216:219], a[124:127], v[68:71]
    v_exp_f32 v86, v86
    v_mfma_f32_16x16x32_bf16 v[72:75], a[220:223], a[120:123], v[72:75]
    ds_read_b128 a[204:207], v9 offset:57600
    v_mfma_f32_16x16x32_bf16 v[76:79], a[220:223], a[124:127], v[76:79]
    buffer_load_dwordx4 v41, s[48:51], s77 offen lds
    s_add_u32 m0, s73, 151552
    s_mov_b32 s77, 143488
    s_waitcnt lgkmcnt(4)
    v_mfma_f32_16x16x32_bf16 v[64:67], a[176:179], a[128:131], v[64:67]
    ds_read_b128 a[208:211], v10 offset:49408
    v_cvt_pk_bf16_f32 v108, v84, v85
    v_mfma_f32_16x16x32_bf16 v[68:71], a[176:179], a[132:135], v[68:71]
    v_mfma_f32_16x16x32_bf16 v[72:75], a[180:183], a[128:131], v[72:75]
    ds_read_b128 a[212:215], v10 offset:57600
    v_mfma_f32_16x16x32_bf16 v[76:79], a[180:183], a[132:135], v[76:79]
    v_exp_f32 v87, v87
    v_mfma_f32_16x16x32_bf16 v[64:67], a[184:187], a[136:139], v[64:67]
    ds_read_b128 a[216:219], v11 offset:49408
    v_mfma_f32_16x16x32_bf16 v[68:71], a[184:187], a[140:143], v[68:71]
    v_exp_f32 v92, v92
    v_mfma_f32_16x16x32_bf16 v[72:75], a[188:191], a[136:139], v[72:75]
    ds_read_b128 a[220:223], v11 offset:57600
    v_mfma_f32_16x16x32_bf16 v[76:79], a[188:191], a[140:143], v[76:79]
    buffer_load_dwordx4 v41, s[48:51], s77 offen lds
    s_waitcnt lgkmcnt(4)
    v_mfma_f32_16x16x32_bf16 v[64:67], a[192:195], a[144:147], v[64:67]
    s_waitcnt vmcnt(16)
    s_barrier
    ds_read_b64_tr_b16 a[176:177], v12 offset:0
    v_cvt_pk_bf16_f32 v109, v86, v87
    v_mfma_f32_16x16x32_bf16 v[68:71], a[192:195], a[148:151], v[68:71]
    ds_read_b64_tr_b16 a[178:179], v12 offset:8192
    v_exp_f32 v93, v93
    v_mfma_f32_16x16x32_bf16 v[72:75], a[196:199], a[144:147], v[72:75]
    ds_read_b64_tr_b16 a[180:181], v13 offset:0
    v_exp_f32 v94, v94
    v_mfma_f32_16x16x32_bf16 v[76:79], a[196:199], a[148:151], v[76:79]
    ds_read_b64_tr_b16 a[182:183], v13 offset:8192
    v_mfma_f32_16x16x32_bf16 v[64:67], a[200:203], a[152:155], v[64:67]
    ds_read_b64_tr_b16 a[184:185], v14 offset:0
    v_mfma_f32_16x16x32_bf16 v[68:71], a[200:203], a[156:159], v[68:71]
    ds_read_b64_tr_b16 a[186:187], v14 offset:8192
    v_mfma_f32_16x16x32_bf16 v[72:75], a[204:207], a[152:155], v[72:75]
    ds_read_b64_tr_b16 a[188:189], v15 offset:0
    v_mfma_f32_16x16x32_bf16 v[76:79], a[204:207], a[156:159], v[76:79]
    ds_read_b64_tr_b16 a[190:191], v15 offset:8192
    s_waitcnt lgkmcnt(8)
    v_mfma_f32_16x16x32_bf16 v[64:67], a[208:211], a[160:163], v[64:67]
    ds_read_b64_tr_b16 a[192:193], v16 offset:0
    v_cvt_pk_bf16_f32 v110, v92, v93
    s_add_u32 m0, s73, 98304
    v_mfma_f32_16x16x32_bf16 v[68:71], a[208:211], a[164:167], v[68:71]
    ds_read_b64_tr_b16 a[194:195], v16 offset:8192
    v_exp_f32 v95, v95
    v_mfma_f32_16x16x32_bf16 v[72:75], a[212:215], a[160:163], v[72:75]
    ds_read_b64_tr_b16 a[196:197], v17 offset:0
    v_mfma_f32_16x16x32_bf16 v[76:79], a[212:215], a[164:167], v[76:79]
    ds_read_b64_tr_b16 a[198:199], v17 offset:8192
    v_mfma_f32_16x16x32_bf16 v[64:67], a[216:219], a[168:171], v[64:67]
    ds_read_b64_tr_b16 a[200:201], v18 offset:0
    v_mfma_f32_16x16x32_bf16 v[68:71], a[216:219], a[172:175], v[68:71]
    ds_read_b64_tr_b16 a[202:203], v18 offset:8192
    v_cvt_pk_bf16_f32 v111, v94, v95
    v_mfma_f32_16x16x32_bf16 v[72:75], a[220:223], a[168:171], v[72:75]
    ds_read_b64_tr_b16 a[204:205], v19 offset:0
    v_mfma_f32_16x16x32_bf16 v[76:79], a[220:223], a[172:175], v[76:79]
    ds_read_b64_tr_b16 a[206:207], v19 offset:8192
    v_mfma_f32_16x16x32_bf16 v[56:59], a[224:227], v[104:107], v[56:59]
    ds_read_b64_tr_b16 a[208:209], v12 offset:256
    v_mfma_f32_16x16x32_bf16 v[60:63], a[224:227], v[108:111], v[60:63]
    ds_read_b64_tr_b16 a[210:211], v12 offset:8448
    s_mov_b32 s77, 256
    s_waitcnt lgkmcnt(10)
    v_mfma_f32_16x16x32_bf16 v[128:131], a[176:179], v[104:107], v[128:131]
    ds_read_b64_tr_b16 a[212:213], v13 offset:256
    v_mfma_f32_16x16x32_bf16 v[132:135], a[176:179], v[108:111], v[132:135]
    ds_read_b64_tr_b16 a[214:215], v13 offset:8448
    v_mfma_f32_16x16x32_bf16 v[136:139], a[180:183], v[104:107], v[136:139]
    ds_read_b64_tr_b16 a[216:217], v14 offset:256
    v_mfma_f32_16x16x32_bf16 v[140:143], a[180:183], v[108:111], v[140:143]
    ds_read_b64_tr_b16 a[218:219], v14 offset:8448
    v_mfma_f32_16x16x32_bf16 v[144:147], a[184:187], v[104:107], v[144:147]
    ds_read_b64_tr_b16 a[220:221], v15 offset:256
    v_mfma_f32_16x16x32_bf16 v[148:151], a[184:187], v[108:111], v[148:151]
    ds_read_b64_tr_b16 a[222:223], v15 offset:8448
    v_mfma_f32_16x16x32_bf16 v[152:155], a[188:191], v[104:107], v[152:155]
    v_exp_f32 v64, v64
    v_mfma_f32_16x16x32_bf16 v[156:159], a[188:191], v[108:111], v[156:159]
    v_exp_f32 v65, v65
    s_waitcnt lgkmcnt(8)
    v_mfma_f32_16x16x32_bf16 v[160:163], a[192:195], v[104:107], v[160:163]
    ds_read_b64_tr_b16 a[176:177], v16 offset:256
    v_mfma_f32_16x16x32_bf16 v[164:167], a[192:195], v[108:111], v[164:167]
    ds_read_b64_tr_b16 a[178:179], v16 offset:8448
    v_mfma_f32_16x16x32_bf16 v[168:171], a[196:199], v[104:107], v[168:171]
    ds_read_b64_tr_b16 a[180:181], v17 offset:256
    v_mfma_f32_16x16x32_bf16 v[172:175], a[196:199], v[108:111], v[172:175]
    ds_read_b64_tr_b16 a[182:183], v17 offset:8448
    v_mfma_f32_16x16x32_bf16 v[176:179], a[200:203], v[104:107], v[176:179]
    ds_read_b64_tr_b16 a[184:185], v18 offset:256
    v_mfma_f32_16x16x32_bf16 v[180:183], a[200:203], v[108:111], v[180:183]
    ds_read_b64_tr_b16 a[186:187], v18 offset:8448
    v_mfma_f32_16x16x32_bf16 v[184:187], a[204:207], v[104:107], v[184:187]
    ds_read_b64_tr_b16 a[188:189], v19 offset:256
    v_mfma_f32_16x16x32_bf16 v[188:191], a[204:207], v[108:111], v[188:191]
    ds_read_b64_tr_b16 a[190:191], v19 offset:8448
    s_waitcnt lgkmcnt(8)
    v_mfma_f32_16x16x32_bf16 v[192:195], a[208:211], v[104:107], v[192:195]
    ds_read_b128 a[192:195], v4 offset:0
    v_mfma_f32_16x16x32_bf16 v[196:199], a[208:211], v[108:111], v[196:199]
    v_exp_f32 v66, v66
    v_mfma_f32_16x16x32_bf16 v[200:203], a[212:215], v[104:107], v[200:203]
    ds_read_b128 a[196:199], v4 offset:8192
    v_cvt_pk_bf16_f32 v96, v64, v65
    v_mfma_f32_16x16x32_bf16 v[204:207], a[212:215], v[108:111], v[204:207]
    v_exp_f32 v67, v67
    v_mfma_f32_16x16x32_bf16 v[208:211], a[216:219], v[104:107], v[208:211]
    ds_read_b128 a[200:203], v5 offset:0
    v_mfma_f32_16x16x32_bf16 v[212:215], a[216:219], v[108:111], v[212:215]
    v_exp_f32 v72, v72
    v_mfma_f32_16x16x32_bf16 v[216:219], a[220:223], v[104:107], v[216:219]
    ds_read_b128 a[204:207], v5 offset:8192
    v_cvt_pk_bf16_f32 v97, v66, v67
    v_mfma_f32_16x16x32_bf16 v[220:223], a[220:223], v[108:111], v[220:223]
    v_exp_f32 v73, v73
    s_waitcnt lgkmcnt(4)
    v_mfma_f32_16x16x32_bf16 v[224:227], a[176:179], v[104:107], v[224:227]
    ds_read_b128 a[208:211], v6 offset:0
    v_mfma_f32_16x16x32_bf16 v[228:231], a[176:179], v[108:111], v[228:231]
    v_exp_f32 v74, v74
    v_mfma_f32_16x16x32_bf16 v[232:235], a[180:183], v[104:107], v[232:235]
    ds_read_b128 a[212:215], v6 offset:8192
    v_cvt_pk_bf16_f32 v98, v72, v73
    v_mfma_f32_16x16x32_bf16 v[236:239], a[180:183], v[108:111], v[236:239]
    v_exp_f32 v75, v75
    v_mfma_f32_16x16x32_bf16 v[240:243], a[184:187], v[104:107], v[240:243]
    ds_read_b128 a[216:219], v7 offset:0
    v_mfma_f32_16x16x32_bf16 v[244:247], a[184:187], v[108:111], v[244:247]
    v_exp_f32 v68, v68
    v_mfma_f32_16x16x32_bf16 v[248:251], a[188:191], v[104:107], v[248:251]
    ds_read_b128 a[220:223], v7 offset:8192
    v_mfma_f32_16x16x32_bf16 v[252:255], a[188:191], v[108:111], v[252:255]
    buffer_load_dwordx4 v41, s[48:51], s77 offen lds
    s_add_u32 m0, s73, 102400
    s_mov_b32 s77, 28928
    s_waitcnt lgkmcnt(4)
    v_mfma_f32_16x16x32_bf16 v[80:83], a[192:195], a[112:115], v[48:51]
    ds_read_b128 a[176:179], v4 offset:256
    v_cvt_pk_bf16_f32 v99, v74, v75
    v_mfma_f32_16x16x32_bf16 v[84:87], a[192:195], a[116:119], v[52:55]
    v_mfma_f32_16x16x32_bf16 v[88:91], a[196:199], a[112:115], v[48:51]
    ds_read_b128 a[180:183], v4 offset:8448
    v_mfma_f32_16x16x32_bf16 v[92:95], a[196:199], a[116:119], v[52:55]
    v_exp_f32 v69, v69
    v_mfma_f32_16x16x32_bf16 v[80:83], a[200:203], a[120:123], v[80:83]
    ds_read_b128 a[184:187], v5 offset:256
    v_mfma_f32_16x16x32_bf16 v[84:87], a[200:203], a[124:127], v[84:87]
    v_exp_f32 v70, v70
    v_mfma_f32_16x16x32_bf16 v[88:91], a[204:207], a[120:123], v[88:91]
    ds_read_b128 a[188:191], v5 offset:8448
    v_mfma_f32_16x16x32_bf16 v[92:95], a[204:207], a[124:127], v[92:95]
    buffer_load_dwordx4 v41, s[48:51], s77 offen lds
    s_waitcnt lgkmcnt(4)
    v_mfma_f32_16x16x32_bf16 v[80:83], a[208:211], a[128:131], v[80:83]
    ds_read_b128 a[192:195], v6 offset:256
    v_cvt_pk_bf16_f32 v100, v68, v69
    v_mfma_f32_16x16x32_bf16 v[84:87], a[208:211], a[132:135], v[84:87]
    v_mfma_f32_16x16x32_bf16 v[88:91], a[212:215], a[128:131], v[88:91]
    ds_read_b128 a[196:199], v6 offset:8448
    v_mfma_f32_16x16x32_bf16 v[92:95], a[212:215], a[132:135], v[92:95]
    v_exp_f32 v71, v71
    v_mfma_f32_16x16x32_bf16 v[80:83], a[216:219], a[136:139], v[80:83]
    ds_read_b128 a[200:203], v7 offset:256
    v_mfma_f32_16x16x32_bf16 v[84:87], a[216:219], a[140:143], v[84:87]
    v_exp_f32 v76, v76
    v_mfma_f32_16x16x32_bf16 v[88:91], a[220:223], a[136:139], v[88:91]
    ds_read_b128 a[204:207], v7 offset:8448
    v_mfma_f32_16x16x32_bf16 v[92:95], a[220:223], a[140:143], v[92:95]
    s_waitcnt lgkmcnt(4)
    v_mfma_f32_16x16x32_bf16 v[80:83], a[176:179], a[144:147], v[80:83]
    s_waitcnt vmcnt(8)
    s_barrier
    ds_read_b64_tr_b16 a[208:209], v12 offset:16384
    v_cvt_pk_bf16_f32 v101, v70, v71
    v_mfma_f32_16x16x32_bf16 v[84:87], a[176:179], a[148:151], v[84:87]
    ds_read_b64_tr_b16 a[210:211], v12 offset:24576
    v_exp_f32 v77, v77
    v_mfma_f32_16x16x32_bf16 v[88:91], a[180:183], a[144:147], v[88:91]
    ds_read_b64_tr_b16 a[212:213], v13 offset:16384
    v_exp_f32 v78, v78
    v_mfma_f32_16x16x32_bf16 v[92:95], a[180:183], a[148:151], v[92:95]
    ds_read_b64_tr_b16 a[214:215], v13 offset:24576
    v_mfma_f32_16x16x32_bf16 v[80:83], a[184:187], a[152:155], v[80:83]
    ds_read_b64_tr_b16 a[216:217], v14 offset:16384
    v_mfma_f32_16x16x32_bf16 v[84:87], a[184:187], a[156:159], v[84:87]
    ds_read_b64_tr_b16 a[218:219], v14 offset:24576
    v_mfma_f32_16x16x32_bf16 v[88:91], a[188:191], a[152:155], v[88:91]
    ds_read_b64_tr_b16 a[220:221], v15 offset:16384
    v_mfma_f32_16x16x32_bf16 v[92:95], a[188:191], a[156:159], v[92:95]
    ds_read_b64_tr_b16 a[222:223], v15 offset:24576
    s_waitcnt lgkmcnt(8)
    v_mfma_f32_16x16x32_bf16 v[80:83], a[192:195], a[160:163], v[80:83]
    ds_read_b64_tr_b16 a[176:177], v16 offset:16384
    v_cvt_pk_bf16_f32 v102, v76, v77
    s_add_u32 m0, s73, 0
    v_mfma_f32_16x16x32_bf16 v[84:87], a[192:195], a[164:167], v[84:87]
    ds_read_b64_tr_b16 a[178:179], v16 offset:24576
    v_exp_f32 v79, v79
    v_mfma_f32_16x16x32_bf16 v[88:91], a[196:199], a[160:163], v[88:91]
    ds_read_b64_tr_b16 a[180:181], v17 offset:16384
    v_mfma_f32_16x16x32_bf16 v[92:95], a[196:199], a[164:167], v[92:95]
    ds_read_b64_tr_b16 a[182:183], v17 offset:24576
    v_mfma_f32_16x16x32_bf16 v[80:83], a[200:203], a[168:171], v[80:83]
    ds_read_b64_tr_b16 a[184:185], v18 offset:16384
    v_mfma_f32_16x16x32_bf16 v[84:87], a[200:203], a[172:175], v[84:87]
    ds_read_b64_tr_b16 a[186:187], v18 offset:24576
    v_cvt_pk_bf16_f32 v103, v78, v79
    s_mov_b32 s77, 114944
    v_mfma_f32_16x16x32_bf16 v[88:91], a[204:207], a[168:171], v[88:91]
    ds_read_b64_tr_b16 a[188:189], v19 offset:16384
    v_mfma_f32_16x16x32_bf16 v[92:95], a[204:207], a[172:175], v[92:95]
    ds_read_b64_tr_b16 a[190:191], v19 offset:24576
    v_mfma_f32_16x16x32_bf16 v[56:59], a[224:227], v[96:99], v[56:59]
    ds_read_b64_tr_b16 a[192:193], v12 offset:16640
    v_mfma_f32_16x16x32_bf16 v[60:63], a[224:227], v[100:103], v[60:63]
    ds_read_b64_tr_b16 a[194:195], v12 offset:24832
    s_waitcnt lgkmcnt(10)
    v_mfma_f32_16x16x32_bf16 v[128:131], a[208:211], v[96:99], v[128:131]
    ds_read_b64_tr_b16 a[196:197], v13 offset:16640
    v_mfma_f32_16x16x32_bf16 v[132:135], a[208:211], v[100:103], v[132:135]
    ds_read_b64_tr_b16 a[198:199], v13 offset:24832
    v_mfma_f32_16x16x32_bf16 v[136:139], a[212:215], v[96:99], v[136:139]
    ds_read_b64_tr_b16 a[200:201], v14 offset:16640
    v_mfma_f32_16x16x32_bf16 v[140:143], a[212:215], v[100:103], v[140:143]
    ds_read_b64_tr_b16 a[202:203], v14 offset:24832
    v_mfma_f32_16x16x32_bf16 v[144:147], a[216:219], v[96:99], v[144:147]
    ds_read_b64_tr_b16 a[204:205], v15 offset:16640
    v_mfma_f32_16x16x32_bf16 v[148:151], a[216:219], v[100:103], v[148:151]
    ds_read_b64_tr_b16 a[206:207], v15 offset:24832
    v_mfma_f32_16x16x32_bf16 v[152:155], a[220:223], v[96:99], v[152:155]
    v_exp_f32 v80, v80
    v_mfma_f32_16x16x32_bf16 v[156:159], a[220:223], v[100:103], v[156:159]
    v_exp_f32 v81, v81
    s_waitcnt lgkmcnt(8)
    v_mfma_f32_16x16x32_bf16 v[160:163], a[176:179], v[96:99], v[160:163]
    ds_read_b64_tr_b16 a[208:209], v16 offset:16640
    v_exp_f32 v82, v82
    v_mfma_f32_16x16x32_bf16 v[164:167], a[176:179], v[100:103], v[164:167]
    ds_read_b64_tr_b16 a[210:211], v16 offset:24832
    v_cvt_pk_bf16_f32 v104, v80, v81
    v_mfma_f32_16x16x32_bf16 v[168:171], a[180:183], v[96:99], v[168:171]
    ds_read_b64_tr_b16 a[212:213], v17 offset:16640
    v_exp_f32 v83, v83
    v_mfma_f32_16x16x32_bf16 v[172:175], a[180:183], v[100:103], v[172:175]
    ds_read_b64_tr_b16 a[214:215], v17 offset:24832
    v_exp_f32 v88, v88
    v_mfma_f32_16x16x32_bf16 v[176:179], a[184:187], v[96:99], v[176:179]
    ds_read_b64_tr_b16 a[216:217], v18 offset:16640
    v_cvt_pk_bf16_f32 v105, v82, v83
    v_mfma_f32_16x16x32_bf16 v[180:183], a[184:187], v[100:103], v[180:183]
    ds_read_b64_tr_b16 a[218:219], v18 offset:24832
    v_exp_f32 v89, v89
    v_mfma_f32_16x16x32_bf16 v[184:187], a[188:191], v[96:99], v[184:187]
    ds_read_b64_tr_b16 a[220:221], v19 offset:16640
    v_exp_f32 v90, v90
    v_mfma_f32_16x16x32_bf16 v[188:191], a[188:191], v[100:103], v[188:191]
    ds_read_b64_tr_b16 a[222:223], v19 offset:24832
    v_cvt_pk_bf16_f32 v106, v88, v89
    s_waitcnt lgkmcnt(8)
    v_mfma_f32_16x16x32_bf16 v[192:195], a[192:195], v[96:99], v[192:195]
    ds_read_b64_tr_b16 a[176:177], v20 offset:32768
    v_exp_f32 v91, v91
    v_mfma_f32_16x16x32_bf16 v[196:199], a[192:195], v[100:103], v[196:199]
    ds_read_b64_tr_b16 a[178:179], v20 offset:40960
    v_exp_f32 v84, v84
    v_mfma_f32_16x16x32_bf16 v[200:203], a[196:199], v[96:99], v[200:203]
    ds_read_b64_tr_b16 a[180:181], v21 offset:32768
    v_cvt_pk_bf16_f32 v107, v90, v91
    v_mfma_f32_16x16x32_bf16 v[204:207], a[196:199], v[100:103], v[204:207]
    ds_read_b64_tr_b16 a[182:183], v21 offset:40960
    v_exp_f32 v85, v85
    v_mfma_f32_16x16x32_bf16 v[208:211], a[200:203], v[96:99], v[208:211]
    ds_read_b64_tr_b16 a[184:185], v22 offset:32768
    v_exp_f32 v86, v86
    v_mfma_f32_16x16x32_bf16 v[212:215], a[200:203], v[100:103], v[212:215]
    ds_read_b64_tr_b16 a[186:187], v22 offset:40960
    v_cvt_pk_bf16_f32 v108, v84, v85
    v_mfma_f32_16x16x32_bf16 v[216:219], a[204:207], v[96:99], v[216:219]
    ds_read_b64_tr_b16 a[188:189], v23 offset:32768
    v_exp_f32 v87, v87
    v_mfma_f32_16x16x32_bf16 v[220:223], a[204:207], v[100:103], v[220:223]
    ds_read_b64_tr_b16 a[190:191], v23 offset:40960
    v_exp_f32 v92, v92
    s_waitcnt lgkmcnt(8)
    v_mfma_f32_16x16x32_bf16 v[224:227], a[208:211], v[96:99], v[224:227]
    ds_read_b64_tr_b16 a[192:193], v24 offset:32768
    v_cvt_pk_bf16_f32 v109, v86, v87
    v_mfma_f32_16x16x32_bf16 v[228:231], a[208:211], v[100:103], v[228:231]
    ds_read_b64_tr_b16 a[194:195], v24 offset:40960
    v_exp_f32 v93, v93
    v_mfma_f32_16x16x32_bf16 v[232:235], a[212:215], v[96:99], v[232:235]
    ds_read_b64_tr_b16 a[196:197], v25 offset:32768
    v_exp_f32 v94, v94
    v_mfma_f32_16x16x32_bf16 v[236:239], a[212:215], v[100:103], v[236:239]
    ds_read_b64_tr_b16 a[198:199], v25 offset:40960
    v_mfma_f32_16x16x32_bf16 v[240:243], a[216:219], v[96:99], v[240:243]
    ds_read_b64_tr_b16 a[200:201], v26 offset:32768
    v_cvt_pk_bf16_f32 v110, v92, v93
    v_mfma_f32_16x16x32_bf16 v[244:247], a[216:219], v[100:103], v[244:247]
    ds_read_b64_tr_b16 a[202:203], v26 offset:40960
    v_exp_f32 v95, v95
    v_mfma_f32_16x16x32_bf16 v[248:251], a[220:223], v[96:99], v[248:251]
    ds_read_b64_tr_b16 a[204:205], v27 offset:32768
    v_cvt_pk_bf16_f32 v111, v94, v95
    v_mfma_f32_16x16x32_bf16 v[252:255], a[220:223], v[100:103], v[252:255]
    ds_read_b64_tr_b16 a[206:207], v27 offset:40960
    v_mfma_f32_16x16x32_bf16 v[56:59], a[224:227], v[104:107], v[56:59]
    ds_read_b64_tr_b16 a[208:209], v20 offset:33024
    v_mfma_f32_16x16x32_bf16 v[60:63], a[224:227], v[108:111], v[60:63]
    ds_read_b64_tr_b16 a[210:211], v20 offset:41216
    s_waitcnt lgkmcnt(10)
    v_mfma_f32_16x16x32_bf16 v[128:131], a[176:179], v[104:107], v[128:131]
    ds_read_b64_tr_b16 a[212:213], v21 offset:33024
    v_mfma_f32_16x16x32_bf16 v[132:135], a[176:179], v[108:111], v[132:135]
    ds_read_b64_tr_b16 a[214:215], v21 offset:41216
    v_mfma_f32_16x16x32_bf16 v[136:139], a[180:183], v[104:107], v[136:139]
    ds_read_b64_tr_b16 a[216:217], v22 offset:33024
    v_mfma_f32_16x16x32_bf16 v[140:143], a[180:183], v[108:111], v[140:143]
    ds_read_b64_tr_b16 a[218:219], v22 offset:41216
    v_cmp_ngt_f32 vcc, s85, v56
    v_mfma_f32_16x16x32_bf16 v[144:147], a[184:187], v[104:107], v[144:147]
    ds_read_b64_tr_b16 a[220:221], v23 offset:33024
    v_cmp_ngt_f32_e64 s[88:89], s85, v60
    s_nop 1
    s_or_b64 vcc, vcc, s[88:89]
    s_cmp_lg_u64 vcc, 0
    s_cselect_b32 s83, 1, 0
    v_mfma_f32_16x16x32_bf16 v[148:151], a[184:187], v[108:111], v[148:151]
    ds_read_b64_tr_b16 a[222:223], v23 offset:41216
    v_mov_b32 v1, s83
    ds_write_b32 v124, v1
    v_mfma_f32_16x16x32_bf16 v[152:155], a[188:191], v[104:107], v[152:155]
    buffer_load_dwordx4 v41, s[48:51], s77 offen lds
    s_add_u32 m0, s73, 4096
    s_mov_b32 s77, 143616
    v_rcp_f32 v44, v56
    v_mfma_f32_16x16x32_bf16 v[156:159], a[188:191], v[108:111], v[156:159]
    buffer_load_dwordx4 v41, s[48:51], s77 offen lds
    s_add_u32 m0, s73, 65536
    s_mov_b32 s77, 384
    v_rcp_f32 v45, v60
    s_waitcnt lgkmcnt(9)
    v_mfma_f32_16x16x32_bf16 v[160:163], a[192:195], v[104:107], v[160:163]
    ds_read_b64_tr_b16 a[176:177], v24 offset:33024
    buffer_load_dwordx4 v41, s[48:51], s77 offen lds
    s_add_u32 m0, s73, 69632
    s_mov_b32 s77, 29056
    v_mfma_f32_16x16x32_bf16 v[164:167], a[192:195], v[108:111], v[164:167]
    ds_read_b64_tr_b16 a[178:179], v24 offset:41216
    buffer_load_dwordx4 v41, s[48:51], s77 offen lds
    v_mfma_f32_16x16x32_bf16 v[168:171], a[196:199], v[104:107], v[168:171]
    ds_read_b64_tr_b16 a[180:181], v25 offset:33024
    v_cvt_pk_bf16_f32 v128, v128, v129
    v_mfma_f32_16x16x32_bf16 v[172:175], a[196:199], v[108:111], v[172:175]
    ds_read_b64_tr_b16 a[182:183], v25 offset:41216
    v_cvt_pk_bf16_f32 v129, v130, v131
    v_mfma_f32_16x16x32_bf16 v[176:179], a[200:203], v[104:107], v[176:179]
    ds_read_b64_tr_b16 a[184:185], v26 offset:33024
    v_cvt_pk_bf16_f32 v130, v136, v137
    v_mfma_f32_16x16x32_bf16 v[180:183], a[200:203], v[108:111], v[180:183]
    ds_read_b64_tr_b16 a[186:187], v26 offset:41216
    v_cvt_pk_bf16_f32 v131, v138, v139
    v_mfma_f32_16x16x32_bf16 v[184:187], a[204:207], v[104:107], v[184:187]
    ds_read_b64_tr_b16 a[188:189], v27 offset:33024
    v_cvt_pk_bf16_f32 v132, v132, v133
    v_mfma_f32_16x16x32_bf16 v[188:191], a[204:207], v[108:111], v[188:191]
    ds_read_b64_tr_b16 a[190:191], v27 offset:41216
    v_cvt_pk_bf16_f32 v133, v134, v135
    s_waitcnt lgkmcnt(9)
    v_mfma_f32_16x16x32_bf16 v[192:195], a[208:211], v[104:107], v[192:195]
    s_waitcnt vmcnt(10) lgkmcnt(8)
    s_barrier
    ds_read_b64_tr_b16 a[192:193], v112 offset:16384
    v_cvt_pk_bf16_f32 v134, v140, v141
    v_mfma_f32_16x16x32_bf16 v[196:199], a[208:211], v[108:111], v[196:199]
    ds_read_b64_tr_b16 a[194:195], v112 offset:18432
    v_cvt_pk_bf16_f32 v135, v142, v143
    ds_read_b128 v[0:3], v125
    v_mfma_f32_16x16x32_bf16 v[200:203], a[212:215], v[104:107], v[200:203]
    ds_read_b64_tr_b16 a[196:197], v113 offset:16384
    v_cvt_pk_bf16_f32 v144, v144, v145
    s_waitcnt lgkmcnt(1)
    v_or3_b32 v0, v0, v1, v2
    v_mfma_f32_16x16x32_bf16 v[204:207], a[212:215], v[108:111], v[204:207]
    ds_read_b64_tr_b16 a[198:199], v113 offset:18432
    v_cvt_pk_bf16_f32 v145, v146, v147
    v_or_b32 v0, v0, v3
    v_mfma_f32_16x16x32_bf16 v[208:211], a[216:219], v[104:107], v[208:211]
    ds_read_b64_tr_b16 a[200:201], v114 offset:16384
    v_cvt_pk_bf16_f32 v146, v152, v153
    v_readfirstlane_b32 s83, v0
    v_mfma_f32_16x16x32_bf16 v[212:215], a[216:219], v[108:111], v[212:215]
    ds_read_b64_tr_b16 a[202:203], v114 offset:18432
    v_cvt_pk_bf16_f32 v147, v154, v155
    v_mfma_f32_16x16x32_bf16 v[216:219], a[220:223], v[104:107], v[216:219]
    ds_read_b64_tr_b16 a[204:205], v115 offset:16384
    v_cvt_pk_bf16_f32 v148, v148, v149
    v_mfma_f32_16x16x32_bf16 v[220:223], a[220:223], v[108:111], v[220:223]
    ds_read_b64_tr_b16 a[206:207], v115 offset:18432
    v_cvt_pk_bf16_f32 v149, v150, v151
    v_mfma_f32_16x16x32_bf16 v[224:227], a[176:179], v[104:107], v[224:227]
    ds_read_b64_tr_b16 a[208:209], v112 offset:20480
    s_add_u32 m0, s73, 81920
    v_cvt_pk_bf16_f32 v150, v156, v157
    v_mfma_f32_16x16x32_bf16 v[228:231], a[176:179], v[108:111], v[228:231]
    ds_read_b64_tr_b16 a[210:211], v112 offset:22528
    v_cvt_pk_bf16_f32 v151, v158, v159
    v_mfma_f32_16x16x32_bf16 v[232:235], a[180:183], v[104:107], v[232:235]
    ds_read_b64_tr_b16 a[212:213], v113 offset:20480
    v_cvt_pk_bf16_f32 v160, v160, v161
    v_mfma_f32_16x16x32_bf16 v[236:239], a[180:183], v[108:111], v[236:239]
    ds_read_b64_tr_b16 a[214:215], v113 offset:22528
    v_cvt_pk_bf16_f32 v161, v162, v163
    v_mfma_f32_16x16x32_bf16 v[240:243], a[184:187], v[104:107], v[240:243]
    ds_read_b64_tr_b16 a[216:217], v114 offset:20480
    s_mov_b32 s77, 115072
    buffer_load_dwordx4 v41, s[48:51], s77 offen lds
    v_mfma_f32_16x16x32_bf16 v[244:247], a[184:187], v[108:111], v[244:247]
    ds_read_b64_tr_b16 a[218:219], v114 offset:22528
    v_cvt_pk_bf16_f32 v162, v168, v169
    s_and_b32 s83, s83, s82
    s_cbranch_scc1 L_fb_F
    v_mfma_f32_16x16x32_bf16 v[248:251], a[188:191], v[104:107], v[248:251]
    ds_read_b64_tr_b16 a[220:221], v115 offset:20480
    v_cvt_pk_bf16_f32 v163, v170, v171
    v_mfma_f32_16x16x32_bf16 v[252:255], a[188:191], v[108:111], v[252:255]
    ds_read_b64_tr_b16 a[222:223], v115 offset:22528
    v_cvt_pk_bf16_f32 v164, v164, v165
    s_waitcnt lgkmcnt(8)
    v_mfma_f32_16x16x32_bf16 v[64:67], a[192:195], v[128:131], 0
    ds_read_b64_tr_b16 a[176:177], v112 offset:24576
    v_cvt_pk_bf16_f32 v165, v166, v167
    v_mfma_f32_16x16x32_bf16 v[68:71], a[192:195], v[132:135], 0
    ds_read_b64_tr_b16 a[178:179], v112 offset:26624
    v_cvt_pk_bf16_f32 v166, v172, v173
    v_mfma_f32_16x16x32_bf16 v[72:75], a[196:199], v[128:131], 0
    ds_read_b64_tr_b16 a[180:181], v113 offset:24576
    v_cvt_pk_bf16_f32 v167, v174, v175
    v_mfma_f32_16x16x32_bf16 v[76:79], a[196:199], v[132:135], 0
    ds_read_b64_tr_b16 a[182:183], v113 offset:26624
    v_cvt_pk_bf16_f32 v176, v176, v177
    v_mfma_f32_16x16x32_bf16 v[80:83], a[200:203], v[128:131], 0
    ds_read_b64_tr_b16 a[184:185], v114 offset:24576
    v_cvt_pk_bf16_f32 v177, v178, v179
    v_mfma_f32_16x16x32_bf16 v[84:87], a[200:203], v[132:135], 0
    ds_read_b64_tr_b16 a[186:187], v114 offset:26624
    v_cvt_pk_bf16_f32 v178, v184, v185
    v_mfma_f32_16x16x32_bf16 v[88:91], a[204:207], v[128:131], 0
    ds_read_b64_tr_b16 a[188:189], v115 offset:24576
    s_add_u32 m0, s73, 86016
    v_cvt_pk_bf16_f32 v179, v186, v187
    v_mfma_f32_16x16x32_bf16 v[92:95], a[204:207], v[132:135], 0
    ds_read_b64_tr_b16 a[190:191], v115 offset:26624
    v_cvt_pk_bf16_f32 v180, v180, v181
    s_waitcnt lgkmcnt(8)
    v_mfma_f32_16x16x32_bf16 v[64:67], a[208:211], v[144:147], v[64:67]
    ds_read_b64_tr_b16 a[192:193], v112 offset:28672
    v_cvt_pk_bf16_f32 v181, v182, v183
    v_mfma_f32_16x16x32_bf16 v[68:71], a[208:211], v[148:151], v[68:71]
    ds_read_b64_tr_b16 a[194:195], v112 offset:30720
    v_cvt_pk_bf16_f32 v182, v188, v189
    v_mfma_f32_16x16x32_bf16 v[72:75], a[212:215], v[144:147], v[72:75]
    ds_read_b64_tr_b16 a[196:197], v113 offset:28672
    s_mov_b32 s77, 143744
    buffer_load_dwordx4 v41, s[48:51], s77 offen lds
    v_mfma_f32_16x16x32_bf16 v[76:79], a[212:215], v[148:151], v[76:79]
    ds_read_b64_tr_b16 a[198:199], v113 offset:30720
    v_cvt_pk_bf16_f32 v183, v190, v191
    v_mfma_f32_16x16x32_bf16 v[80:83], a[216:219], v[144:147], v[80:83]
    ds_read_b64_tr_b16 a[200:201], v114 offset:28672
    v_cvt_pk_bf16_f32 v192, v192, v193
    v_mfma_f32_16x16x32_bf16 v[84:87], a[216:219], v[148:151], v[84:87]
    ds_read_b64_tr_b16 a[202:203], v114 offset:30720
    v_cvt_pk_bf16_f32 v193, v194, v195
    v_mfma_f32_16x16x32_bf16 v[88:91], a[220:223], v[144:147], v[88:91]
    ds_read_b64_tr_b16 a[204:205], v115 offset:28672
    v_cvt_pk_bf16_f32 v194, v200, v201
    v_mfma_f32_16x16x32_bf16 v[92:95], a[220:223], v[148:151], v[92:95]
    ds_read_b64_tr_b16 a[206:207], v115 offset:30720
    v_cvt_pk_bf16_f32 v195, v202, v203
    s_waitcnt lgkmcnt(8)
    v_mfma_f32_16x16x32_bf16 v[64:67], a[176:179], v[160:163], v[64:67]
    ds_read_b64_tr_b16 a[208:209], v112 offset:32768
    v_cvt_pk_bf16_f32 v196, v196, v197
    v_mfma_f32_16x16x32_bf16 v[68:71], a[176:179], v[164:167], v[68:71]
    ds_read_b64_tr_b16 a[210:211], v112 offset:34816
    v_cvt_pk_bf16_f32 v197, v198, v199
    v_mfma_f32_16x16x32_bf16 v[72:75], a[180:183], v[160:163], v[72:75]
    ds_read_b64_tr_b16 a[212:213], v113 offset:32768
    v_cvt_pk_bf16_f32 v198, v204, v205
    v_mfma_f32_16x16x32_bf16 v[76:79], a[180:183], v[164:167], v[76:79]
    ds_read_b64_tr_b16 a[214:215], v113 offset:34816
    v_cvt_pk_bf16_f32 v199, v206, v207
    v_mfma_f32_16x16x32_bf16 v[80:83], a[184:187], v[160:163], v[80:83]
    ds_read_b64_tr_b16 a[216:217], v114 offset:32768
    s_add_u32 m0, s73, 131072
    v_cvt_pk_bf16_f32 v208, v208, v209
    v_mfma_f32_16x16x32_bf16 v[84:87], a[184:187], v[164:167], v[84:87]
    ds_read_b64_tr_b16 a[218:219], v114 offset:34816
    v_cvt_pk_bf16_f32 v209, v210, v211
    v_mfma_f32_16x16x32_bf16 v[88:91], a[188:191], v[160:163], v[88:91]
    ds_read_b64_tr_b16 a[220:221], v115 offset:32768
    v_cvt_pk_bf16_f32 v210, v216, v217
    v_mfma_f32_16x16x32_bf16 v[92:95], a[188:191], v[164:167], v[92:95]
    ds_read_b64_tr_b16 a[222:223], v115 offset:34816
    v_cvt_pk_bf16_f32 v211, v218, v219
    s_waitcnt lgkmcnt(8)
    v_mfma_f32_16x16x32_bf16 v[64:67], a[192:195], v[176:179], v[64:67]
    ds_read_b64_tr_b16 a[176:177], v112 offset:36864
    s_mov_b32 s77, 512
    buffer_load_dwordx4 v41, s[48:51], s77 offen lds
    v_mfma_f32_16x16x32_bf16 v[68:71], a[192:195], v[180:183], v[68:71]
    ds_read_b64_tr_b16 a[178:179], v112 offset:38912
    v_cvt_pk_bf16_f32 v212, v212, v213
    v_mfma_f32_16x16x32_bf16 v[72:75], a[196:199], v[176:179], v[72:75]
    ds_read_b64_tr_b16 a[180:181], v113 offset:36864
    v_cvt_pk_bf16_f32 v213, v214, v215
    v_mfma_f32_16x16x32_bf16 v[76:79], a[196:199], v[180:183], v[76:79]
    ds_read_b64_tr_b16 a[182:183], v113 offset:38912
    v_cvt_pk_bf16_f32 v214, v220, v221
    v_mfma_f32_16x16x32_bf16 v[80:83], a[200:203], v[176:179], v[80:83]
    ds_read_b64_tr_b16 a[184:185], v114 offset:36864
    v_cvt_pk_bf16_f32 v215, v222, v223
    v_mfma_f32_16x16x32_bf16 v[84:87], a[200:203], v[180:183], v[84:87]
    ds_read_b64_tr_b16 a[186:187], v114 offset:38912
    v_cvt_pk_bf16_f32 v224, v224, v225
    v_mfma_f32_16x16x32_bf16 v[88:91], a[204:207], v[176:179], v[88:91]
    ds_read_b64_tr_b16 a[188:189], v115 offset:36864
    v_cvt_pk_bf16_f32 v225, v226, v227
    v_mfma_f32_16x16x32_bf16 v[92:95], a[204:207], v[180:183], v[92:95]
    ds_read_b64_tr_b16 a[190:191], v115 offset:38912
    v_cvt_pk_bf16_f32 v226, v232, v233
    s_waitcnt lgkmcnt(8)
    v_mfma_f32_16x16x32_bf16 v[64:67], a[208:211], v[192:195], v[64:67]
    ds_read_b64_tr_b16 a[192:193], v112 offset:40960
    v_cvt_pk_bf16_f32 v227, v234, v235
    v_mfma_f32_16x16x32_bf16 v[68:71], a[208:211], v[196:199], v[68:71]
    ds_read_b64_tr_b16 a[194:195], v112 offset:43008
    v_cvt_pk_bf16_f32 v228, v228, v229
    v_mfma_f32_16x16x32_bf16 v[72:75], a[212:215], v[192:195], v[72:75]
    ds_read_b64_tr_b16 a[196:197], v113 offset:40960
    s_add_u32 m0, s73, 135168
    v_cvt_pk_bf16_f32 v229, v230, v231
    v_mfma_f32_16x16x32_bf16 v[76:79], a[212:215], v[196:199], v[76:79]
    ds_read_b64_tr_b16 a[198:199], v113 offset:43008
    v_cvt_pk_bf16_f32 v230, v236, v237
    v_mfma_f32_16x16x32_bf16 v[80:83], a[216:219], v[192:195], v[80:83]
    ds_read_b64_tr_b16 a[200:201], v114 offset:40960
    v_cvt_pk_bf16_f32 v231, v238, v239
    v_mfma_f32_16x16x32_bf16 v[84:87], a[216:219], v[196:199], v[84:87]
    ds_read_b64_tr_b16 a[202:203], v114 offset:43008
    v_cvt_pk_bf16_f32 v240, v240, v241
    v_mfma_f32_16x16x32_bf16 v[88:91], a[220:223], v[192:195], v[88:91]
    ds_read_b64_tr_b16 a[204:205], v115 offset:40960
    s_mov_b32 s77, 29184
    buffer_load_dwordx4 v41, s[48:51], s77 offen lds
    v_mfma_f32_16x16x32_bf16 v[92:95], a[220:223], v[196:199], v[92:95]
    ds_read_b64_tr_b16 a[206:207], v115 offset:43008
    v_cvt_pk_bf16_f32 v241, v242, v243
    s_waitcnt lgkmcnt(8)
    v_mfma_f32_16x16x32_bf16 v[64:67], a[176:179], v[208:211], v[64:67]
    ds_read_b64_tr_b16 a[208:209], v112 offset:45056
    v_cvt_pk_bf16_f32 v242, v248, v249
    v_mfma_f32_16x16x32_bf16 v[68:71], a[176:179], v[212:215], v[68:71]
    ds_read_b64_tr_b16 a[210:211], v112 offset:47104
    v_cvt_pk_bf16_f32 v243, v250, v251
    v_mfma_f32_16x16x32_bf16 v[72:75], a[180:183], v[208:211], v[72:75]
    ds_read_b64_tr_b16 a[212:213], v113 offset:45056
    v_cvt_pk_bf16_f32 v244, v244, v245
    v_mfma_f32_16x16x32_bf16 v[76:79], a[180:183], v[212:215], v[76:79]
    ds_read_b64_tr_b16 a[214:215], v113 offset:47104
    v_cvt_pk_bf16_f32 v245, v246, v247
    v_mfma_f32_16x16x32_bf16 v[80:83], a[184:187], v[208:211], v[80:83]
    ds_read_b64_tr_b16 a[216:217], v114 offset:45056
    v_cvt_pk_bf16_f32 v246, v252, v253
    v_mfma_f32_16x16x32_bf16 v[84:87], a[184:187], v[212:215], v[84:87]
    ds_read_b64_tr_b16 a[218:219], v114 offset:47104
    v_cvt_pk_bf16_f32 v247, v254, v255
    v_mfma_f32_16x16x32_bf16 v[88:91], a[188:191], v[208:211], v[88:91]
    ds_read_b64_tr_b16 a[220:221], v115 offset:45056
    v_mfma_f32_16x16x32_bf16 v[92:95], a[188:191], v[212:215], v[92:95]
    ds_read_b64_tr_b16 a[222:223], v115 offset:47104
    s_waitcnt lgkmcnt(8)
    v_mfma_f32_16x16x32_bf16 v[64:67], a[192:195], v[224:227], v[64:67]
    s_waitcnt vmcnt(10)
    s_barrier
    ds_read_b64_tr_b16 a[176:177], v112 offset:49152
    v_mfma_f32_16x16x32_bf16 v[68:71], a[192:195], v[228:231], v[68:71]
    ds_read_b64_tr_b16 a[178:179], v112 offset:51200
    v_mfma_f32_16x16x32_bf16 v[72:75], a[196:199], v[224:227], v[72:75]
    ds_read_b64_tr_b16 a[180:181], v113 offset:49152
    v_mfma_f32_16x16x32_bf16 v[76:79], a[196:199], v[228:231], v[76:79]
    ds_read_b64_tr_b16 a[182:183], v113 offset:51200
    v_mfma_f32_16x16x32_bf16 v[80:83], a[200:203], v[224:227], v[80:83]
    ds_read_b64_tr_b16 a[184:185], v114 offset:49152
    v_mfma_f32_16x16x32_bf16 v[84:87], a[200:203], v[228:231], v[84:87]
    ds_read_b64_tr_b16 a[186:187], v114 offset:51200
    v_mfma_f32_16x16x32_bf16 v[88:91], a[204:207], v[224:227], v[88:91]
    ds_read_b64_tr_b16 a[188:189], v115 offset:49152
    v_mfma_f32_16x16x32_bf16 v[92:95], a[204:207], v[228:231], v[92:95]
    ds_read_b64_tr_b16 a[190:191], v115 offset:51200
    s_waitcnt lgkmcnt(8)
    v_mfma_f32_16x16x32_bf16 v[64:67], a[208:211], v[240:243], v[64:67]
    ds_read_b64_tr_b16 a[192:193], v112 offset:53248
    s_add_u32 m0, s73, 16384
    v_mfma_f32_16x16x32_bf16 v[68:71], a[208:211], v[244:247], v[68:71]
    ds_read_b64_tr_b16 a[194:195], v112 offset:55296
    v_mfma_f32_16x16x32_bf16 v[72:75], a[212:215], v[240:243], v[72:75]
    ds_read_b64_tr_b16 a[196:197], v113 offset:53248
    v_mfma_f32_16x16x32_bf16 v[76:79], a[212:215], v[244:247], v[76:79]
    ds_read_b64_tr_b16 a[198:199], v113 offset:55296
    v_mfma_f32_16x16x32_bf16 v[80:83], a[216:219], v[240:243], v[80:83]
    ds_read_b64_tr_b16 a[200:201], v114 offset:53248
    s_mov_b32 s77, 640
    buffer_load_dwordx4 v41, s[48:51], s77 offen lds
    v_mfma_f32_16x16x32_bf16 v[84:87], a[216:219], v[244:247], v[84:87]
    ds_read_b64_tr_b16 a[202:203], v114 offset:55296
    v_mfma_f32_16x16x32_bf16 v[88:91], a[220:223], v[240:243], v[88:91]
    ds_read_b64_tr_b16 a[204:205], v115 offset:53248
    v_mfma_f32_16x16x32_bf16 v[92:95], a[220:223], v[244:247], v[92:95]
    ds_read_b64_tr_b16 a[206:207], v115 offset:55296
    s_waitcnt lgkmcnt(8)
    v_mfma_f32_16x16x32_bf16 v[136:139], a[176:179], v[128:131], 0
    ds_read_b64_tr_b16 a[208:209], v112 offset:57344
    v_mfma_f32_16x16x32_bf16 v[140:143], a[176:179], v[132:135], 0
    ds_read_b64_tr_b16 a[210:211], v112 offset:59392
    v_mfma_f32_16x16x32_bf16 v[152:155], a[180:183], v[128:131], 0
    ds_read_b64_tr_b16 a[212:213], v113 offset:57344
    v_mul_f32 v64, v64, v44
    v_mfma_f32_16x16x32_bf16 v[156:159], a[180:183], v[132:135], 0
    ds_read_b64_tr_b16 a[214:215], v113 offset:59392
    v_mul_f32 v65, v65, v44
    v_mfma_f32_16x16x32_bf16 v[168:171], a[184:187], v[128:131], 0
    ds_read_b64_tr_b16 a[216:217], v114 offset:57344
    v_mul_f32 v66, v66, v44
    v_mfma_f32_16x16x32_bf16 v[172:175], a[184:187], v[132:135], 0
    ds_read_b64_tr_b16 a[218:219], v114 offset:59392
    v_mul_f32 v67, v67, v44
    v_mfma_f32_16x16x32_bf16 v[184:187], a[188:191], v[128:131], 0
    ds_read_b64_tr_b16 a[220:221], v115 offset:57344
    s_add_u32 m0, s73, 20480
    v_mul_f32 v72, v72, v44
    v_mfma_f32_16x16x32_bf16 v[188:191], a[188:191], v[132:135], 0
    ds_read_b64_tr_b16 a[222:223], v115 offset:59392
    v_mul_f32 v73, v73, v44
    s_waitcnt lgkmcnt(8)
    v_mfma_f32_16x16x32_bf16 v[136:139], a[192:195], v[144:147], v[136:139]
    ds_read_b64_tr_b16 a[176:177], v112 offset:61440
    v_mul_f32 v74, v74, v44
    v_mfma_f32_16x16x32_bf16 v[140:143], a[192:195], v[148:151], v[140:143]
    ds_read_b64_tr_b16 a[178:179], v112 offset:63488
    v_mul_f32 v75, v75, v44
    v_mfma_f32_16x16x32_bf16 v[152:155], a[196:199], v[144:147], v[152:155]
    ds_read_b64_tr_b16 a[180:181], v113 offset:61440
    s_mov_b32 s77, 29312
    buffer_load_dwordx4 v41, s[48:51], s77 offen lds
    v_mfma_f32_16x16x32_bf16 v[156:159], a[196:199], v[148:151], v[156:159]
    ds_read_b64_tr_b16 a[182:183], v113 offset:63488
    v_cvt_pk_bf16_f32 v64, v64, v65
    v_mfma_f32_16x16x32_bf16 v[168:171], a[200:203], v[144:147], v[168:171]
    ds_read_b64_tr_b16 a[184:185], v114 offset:61440
    v_cvt_pk_bf16_f32 v65, v66, v67
    v_mfma_f32_16x16x32_bf16 v[172:175], a[200:203], v[148:151], v[172:175]
    ds_read_b64_tr_b16 a[186:187], v114 offset:63488
    v_cvt_pk_bf16_f32 v66, v72, v73
    v_mfma_f32_16x16x32_bf16 v[184:187], a[204:207], v[144:147], v[184:187]
    ds_read_b64_tr_b16 a[188:189], v115 offset:61440
    v_cvt_pk_bf16_f32 v67, v74, v75
    s_mov_b32 s78, 0
    v_mfma_f32_16x16x32_bf16 v[188:191], a[204:207], v[148:151], v[188:191]
    ds_read_b64_tr_b16 a[190:191], v115 offset:63488
    buffer_store_dwordx4 v[64:67], v42, s[52:55], s78 offen offset:0 sc1
    s_waitcnt lgkmcnt(8)
    v_mfma_f32_16x16x32_bf16 v[136:139], a[208:211], v[160:163], v[136:139]
    ds_read_b64_tr_b16 a[192:193], v120 offset:16384
    v_mul_f32 v80, v80, v44
    v_mfma_f32_16x16x32_bf16 v[140:143], a[208:211], v[164:167], v[140:143]
    ds_read_b64_tr_b16 a[194:195], v120 offset:18432
    v_mul_f32 v81, v81, v44
    v_mfma_f32_16x16x32_bf16 v[152:155], a[212:215], v[160:163], v[152:155]
    ds_read_b64_tr_b16 a[196:197], v121 offset:16384
    v_mul_f32 v82, v82, v44
    v_mfma_f32_16x16x32_bf16 v[156:159], a[212:215], v[164:167], v[156:159]
    ds_read_b64_tr_b16 a[198:199], v121 offset:18432
    v_mul_f32 v83, v83, v44
    v_mfma_f32_16x16x32_bf16 v[168:171], a[216:219], v[160:163], v[168:171]
    ds_read_b64_tr_b16 a[200:201], v122 offset:16384
    s_add_u32 m0, s73, 32768
    v_mul_f32 v88, v88, v44
    v_mfma_f32_16x16x32_bf16 v[172:175], a[216:219], v[164:167], v[172:175]
    ds_read_b64_tr_b16 a[202:203], v122 offset:18432
    v_mul_f32 v89, v89, v44
    v_mfma_f32_16x16x32_bf16 v[184:187], a[220:223], v[160:163], v[184:187]
    ds_read_b64_tr_b16 a[204:205], v123 offset:16384
    v_mul_f32 v90, v90, v44
    v_mfma_f32_16x16x32_bf16 v[188:191], a[220:223], v[164:167], v[188:191]
    ds_read_b64_tr_b16 a[206:207], v123 offset:18432
    v_mul_f32 v91, v91, v44
    s_waitcnt lgkmcnt(8)
    v_mfma_f32_16x16x32_bf16 v[136:139], a[176:179], v[176:179], v[136:139]
    ds_read_b64_tr_b16 a[208:209], v120 offset:20480
    s_mov_b32 s77, 115328
    buffer_load_dwordx4 v41, s[48:51], s77 offen lds
    v_mfma_f32_16x16x32_bf16 v[140:143], a[176:179], v[180:183], v[140:143]
    ds_read_b64_tr_b16 a[210:211], v120 offset:22528
    v_cvt_pk_bf16_f32 v80, v80, v81
    v_mfma_f32_16x16x32_bf16 v[152:155], a[180:183], v[176:179], v[152:155]
    ds_read_b64_tr_b16 a[212:213], v121 offset:20480
    v_cvt_pk_bf16_f32 v81, v82, v83
    v_mfma_f32_16x16x32_bf16 v[156:159], a[180:183], v[180:183], v[156:159]
    ds_read_b64_tr_b16 a[214:215], v121 offset:22528
    v_cvt_pk_bf16_f32 v82, v88, v89
    v_mfma_f32_16x16x32_bf16 v[168:171], a[184:187], v[176:179], v[168:171]
    ds_read_b64_tr_b16 a[216:217], v122 offset:20480
    v_cvt_pk_bf16_f32 v83, v90, v91
    s_mov_b32 s78, 7168
    v_mfma_f32_16x16x32_bf16 v[172:175], a[184:187], v[180:183], v[172:175]
    ds_read_b64_tr_b16 a[218:219], v122 offset:22528
    buffer_store_dwordx4 v[80:83], v42, s[52:55], s78 offen offset:0 sc1
    v_mfma_f32_16x16x32_bf16 v[184:187], a[188:191], v[176:179], v[184:187]
    ds_read_b64_tr_b16 a[220:221], v123 offset:20480
    v_mul_f32 v68, v68, v45
    v_mfma_f32_16x16x32_bf16 v[188:191], a[188:191], v[180:183], v[188:191]
    ds_read_b64_tr_b16 a[222:223], v123 offset:22528
    v_mul_f32 v69, v69, v45
    s_waitcnt lgkmcnt(8)
    v_mfma_f32_16x16x32_bf16 v[136:139], a[192:195], v[192:195], v[136:139]
    ds_read_b64_tr_b16 a[176:177], v120 offset:24576
    v_mul_f32 v70, v70, v45
    v_mfma_f32_16x16x32_bf16 v[140:143], a[192:195], v[196:199], v[140:143]
    ds_read_b64_tr_b16 a[178:179], v120 offset:26624
    v_mul_f32 v71, v71, v45
    v_mfma_f32_16x16x32_bf16 v[152:155], a[196:199], v[192:195], v[152:155]
    ds_read_b64_tr_b16 a[180:181], v121 offset:24576
    s_add_u32 m0, s73, 36864
    v_mul_f32 v76, v76, v45
    v_mfma_f32_16x16x32_bf16 v[156:159], a[196:199], v[196:199], v[156:159]
    ds_read_b64_tr_b16 a[182:183], v121 offset:26624
    v_mul_f32 v77, v77, v45
    v_mfma_f32_16x16x32_bf16 v[168:171], a[200:203], v[192:195], v[168:171]
    ds_read_b64_tr_b16 a[184:185], v122 offset:24576
    v_mul_f32 v78, v78, v45
    v_mfma_f32_16x16x32_bf16 v[172:175], a[200:203], v[196:199], v[172:175]
    ds_read_b64_tr_b16 a[186:187], v122 offset:26624
    v_mul_f32 v79, v79, v45
    v_mfma_f32_16x16x32_bf16 v[184:187], a[204:207], v[192:195], v[184:187]
    ds_read_b64_tr_b16 a[188:189], v123 offset:24576
    s_mov_b32 s77, 144000
    buffer_load_dwordx4 v41, s[48:51], s77 offen lds
    v_mfma_f32_16x16x32_bf16 v[188:191], a[204:207], v[196:199], v[188:191]
    ds_read_b64_tr_b16 a[190:191], v123 offset:26624
    v_cvt_pk_bf16_f32 v68, v68, v69
    s_waitcnt lgkmcnt(8)
    v_mfma_f32_16x16x32_bf16 v[136:139], a[208:211], v[208:211], v[136:139]
    ds_read_b64_tr_b16 a[192:193], v120 offset:28672
    v_cvt_pk_bf16_f32 v69, v70, v71
    v_mfma_f32_16x16x32_bf16 v[140:143], a[208:211], v[212:215], v[140:143]
    ds_read_b64_tr_b16 a[194:195], v120 offset:30720
    v_cvt_pk_bf16_f32 v70, v76, v77
    v_mfma_f32_16x16x32_bf16 v[152:155], a[212:215], v[208:211], v[152:155]
    ds_read_b64_tr_b16 a[196:197], v121 offset:28672
    v_cvt_pk_bf16_f32 v71, v78, v79
    s_mov_b32 s78, 0
    v_mfma_f32_16x16x32_bf16 v[156:159], a[212:215], v[212:215], v[156:159]
    ds_read_b64_tr_b16 a[198:199], v121 offset:30720
    buffer_store_dwordx4 v[68:71], v42, s[52:55], s78 offen offset:1024 sc1
    v_mfma_f32_16x16x32_bf16 v[168:171], a[216:219], v[208:211], v[168:171]
    ds_read_b64_tr_b16 a[200:201], v122 offset:28672
    v_mul_f32 v84, v84, v45
    v_mfma_f32_16x16x32_bf16 v[172:175], a[216:219], v[212:215], v[172:175]
    ds_read_b64_tr_b16 a[202:203], v122 offset:30720
    v_mul_f32 v85, v85, v45
    v_mfma_f32_16x16x32_bf16 v[184:187], a[220:223], v[208:211], v[184:187]
    ds_read_b64_tr_b16 a[204:205], v123 offset:28672
    v_mul_f32 v86, v86, v45
    v_mul_f32 v87, v87, v45
    v_mul_f32 v92, v92, v45
    v_mul_f32 v93, v93, v45
    v_mul_f32 v94, v94, v45
    v_mul_f32 v95, v95, v45
    v_cvt_pk_bf16_f32 v84, v84, v85
    v_cvt_pk_bf16_f32 v85, v86, v87
    v_cvt_pk_bf16_f32 v86, v92, v93
    v_cvt_pk_bf16_f32 v87, v94, v95
    s_mov_b32 s78, 7168
    buffer_store_dwordx4 v[84:87], v42, s[52:55], s78 offen offset:1024 sc1
    v_mfma_f32_16x16x32_bf16 v[188:191], a[220:223], v[212:215], v[188:191]
    ds_read_b64_tr_b16 a[206:207], v123 offset:30720
    s_waitcnt lgkmcnt(8)
    v_mfma_f32_16x16x32_bf16 v[136:139], a[176:179], v[224:227], v[136:139]
    s_waitcnt vmcnt(14)
    s_barrier
    ds_read_b64_tr_b16 a[208:209], v116 offset:32768
    v_mfma_f32_16x16x32_bf16 v[140:143], a[176:179], v[228:231], v[140:143]
    ds_read_b64_tr_b16 a[210:211], v116 offset:34816
    v_mfma_f32_16x16x32_bf16 v[152:155], a[180:183], v[224:227], v[152:155]
    ds_read_b64_tr_b16 a[212:213], v117 offset:32768
    v_mfma_f32_16x16x32_bf16 v[156:159], a[180:183], v[228:231], v[156:159]
    ds_read_b64_tr_b16 a[214:215], v117 offset:34816
    v_mfma_f32_16x16x32_bf16 v[168:171], a[184:187], v[224:227], v[168:171]
    ds_read_b64_tr_b16 a[216:217], v118 offset:32768
    v_mfma_f32_16x16x32_bf16 v[172:175], a[184:187], v[228:231], v[172:175]
    ds_read_b64_tr_b16 a[218:219], v118 offset:34816
    v_mfma_f32_16x16x32_bf16 v[184:187], a[188:191], v[224:227], v[184:187]
    ds_read_b64_tr_b16 a[220:221], v119 offset:32768
    v_mfma_f32_16x16x32_bf16 v[188:191], a[188:191], v[228:231], v[188:191]
    ds_read_b64_tr_b16 a[222:223], v119 offset:34816
    s_waitcnt lgkmcnt(8)
    v_mfma_f32_16x16x32_bf16 v[136:139], a[192:195], v[240:243], v[136:139]
    ds_read_b64_tr_b16 a[176:177], v116 offset:36864
    s_add_u32 m0, s73, 114688
    v_mfma_f32_16x16x32_bf16 v[140:143], a[192:195], v[244:247], v[140:143]
    ds_read_b64_tr_b16 a[178:179], v116 offset:38912
    v_mfma_f32_16x16x32_bf16 v[152:155], a[196:199], v[240:243], v[152:155]
    ds_read_b64_tr_b16 a[180:181], v117 offset:36864
    v_mfma_f32_16x16x32_bf16 v[156:159], a[196:199], v[244:247], v[156:159]
    ds_read_b64_tr_b16 a[182:183], v117 offset:38912
    s_mov_b32 s77, 115200
    buffer_load_dwordx4 v41, s[48:51], s77 offen lds
    v_mfma_f32_16x16x32_bf16 v[168:171], a[200:203], v[240:243], v[168:171]
    ds_read_b64_tr_b16 a[184:185], v118 offset:36864
    v_mfma_f32_16x16x32_bf16 v[172:175], a[200:203], v[244:247], v[172:175]
    ds_read_b64_tr_b16 a[186:187], v118 offset:38912
    v_mfma_f32_16x16x32_bf16 v[184:187], a[204:207], v[240:243], v[184:187]
    ds_read_b64_tr_b16 a[188:189], v119 offset:36864
    v_mfma_f32_16x16x32_bf16 v[188:191], a[204:207], v[244:247], v[188:191]
    ds_read_b64_tr_b16 a[190:191], v119 offset:38912
    s_waitcnt lgkmcnt(8)
    v_mfma_f32_16x16x32_bf16 v[64:67], a[208:211], v[128:131], 0
    ds_read_b64_tr_b16 a[192:193], v116 offset:40960
    v_mfma_f32_16x16x32_bf16 v[68:71], a[208:211], v[132:135], 0
    ds_read_b64_tr_b16 a[194:195], v116 offset:43008
    s_add_u32 m0, s73, 118784
    v_mfma_f32_16x16x32_bf16 v[72:75], a[212:215], v[128:131], 0
    ds_read_b64_tr_b16 a[196:197], v117 offset:40960
    v_mul_f32 v136, v136, v44
    v_mfma_f32_16x16x32_bf16 v[76:79], a[212:215], v[132:135], 0
    ds_read_b64_tr_b16 a[198:199], v117 offset:43008
    v_mul_f32 v137, v137, v44
    v_mfma_f32_16x16x32_bf16 v[80:83], a[216:219], v[128:131], 0
    ds_read_b64_tr_b16 a[200:201], v118 offset:40960
    s_mov_b32 s77, 143872
    buffer_load_dwordx4 v41, s[48:51], s77 offen lds
    v_mfma_f32_16x16x32_bf16 v[84:87], a[216:219], v[132:135], 0
    ds_read_b64_tr_b16 a[202:203], v118 offset:43008
    v_mul_f32 v138, v138, v44
    v_mfma_f32_16x16x32_bf16 v[88:91], a[220:223], v[128:131], 0
    ds_read_b64_tr_b16 a[204:205], v119 offset:40960
    v_mul_f32 v139, v139, v44
    v_mfma_f32_16x16x32_bf16 v[92:95], a[220:223], v[132:135], 0
    ds_read_b64_tr_b16 a[206:207], v119 offset:43008
    v_mul_f32 v152, v152, v44
    s_waitcnt lgkmcnt(8)
    v_mfma_f32_16x16x32_bf16 v[64:67], a[176:179], v[144:147], v[64:67]
    ds_read_b64_tr_b16 a[208:209], v116 offset:45056
    v_mul_f32 v153, v153, v44
    v_mfma_f32_16x16x32_bf16 v[68:71], a[176:179], v[148:151], v[68:71]
    ds_read_b64_tr_b16 a[210:211], v116 offset:47104
    v_mul_f32 v154, v154, v44
    v_mfma_f32_16x16x32_bf16 v[72:75], a[180:183], v[144:147], v[72:75]
    ds_read_b64_tr_b16 a[212:213], v117 offset:45056
    s_add_u32 m0, s73, 49152
    v_mul_f32 v155, v155, v44
    v_mfma_f32_16x16x32_bf16 v[76:79], a[180:183], v[148:151], v[76:79]
    ds_read_b64_tr_b16 a[214:215], v117 offset:47104
    v_cvt_pk_bf16_f32 v136, v136, v137
    v_mfma_f32_16x16x32_bf16 v[80:83], a[184:187], v[144:147], v[80:83]
    ds_read_b64_tr_b16 a[216:217], v118 offset:45056
    v_cvt_pk_bf16_f32 v137, v138, v139
    v_mfma_f32_16x16x32_bf16 v[84:87], a[184:187], v[148:151], v[84:87]
    ds_read_b64_tr_b16 a[218:219], v118 offset:47104
    s_mov_b32 s77, 768
    buffer_load_dwordx4 v41, s[48:51], s77 offen lds
    v_mfma_f32_16x16x32_bf16 v[88:91], a[188:191], v[144:147], v[88:91]
    ds_read_b64_tr_b16 a[220:221], v119 offset:45056
    v_cvt_pk_bf16_f32 v138, v152, v153
    v_mfma_f32_16x16x32_bf16 v[92:95], a[188:191], v[148:151], v[92:95]
    ds_read_b64_tr_b16 a[222:223], v119 offset:47104
    v_cvt_pk_bf16_f32 v139, v154, v155
    s_mov_b32 s78, 14336
    s_waitcnt lgkmcnt(8)
    v_mfma_f32_16x16x32_bf16 v[64:67], a[192:195], v[160:163], v[64:67]
    ds_read_b64_tr_b16 a[176:177], v112 offset:0
    buffer_store_dwordx4 v[136:139], v42, s[52:55], s78 offen offset:0 sc1
    v_mfma_f32_16x16x32_bf16 v[68:71], a[192:195], v[164:167], v[68:71]
    ds_read_b64_tr_b16 a[178:179], v112 offset:2048
    v_mul_f32 v168, v168, v44
    v_mfma_f32_16x16x32_bf16 v[72:75], a[196:199], v[160:163], v[72:75]
    ds_read_b64_tr_b16 a[180:181], v113 offset:0
    v_mul_f32 v169, v169, v44
    v_mfma_f32_16x16x32_bf16 v[76:79], a[196:199], v[164:167], v[76:79]
    ds_read_b64_tr_b16 a[182:183], v113 offset:2048
    v_mul_f32 v170, v170, v44
    v_mfma_f32_16x16x32_bf16 v[80:83], a[200:203], v[160:163], v[80:83]
    ds_read_b64_tr_b16 a[184:185], v114 offset:0
    s_add_u32 m0, s73, 53248
    v_mul_f32 v171, v171, v44
    v_mfma_f32_16x16x32_bf16 v[84:87], a[200:203], v[164:167], v[84:87]
    ds_read_b64_tr_b16 a[186:187], v114 offset:2048
    v_mul_f32 v184, v184, v44
    v_mfma_f32_16x16x32_bf16 v[88:91], a[204:207], v[160:163], v[88:91]
    ds_read_b64_tr_b16 a[188:189], v115 offset:0
    v_mul_f32 v185, v185, v44
    v_mfma_f32_16x16x32_bf16 v[92:95], a[204:207], v[164:167], v[92:95]
    ds_read_b64_tr_b16 a[190:191], v115 offset:2048
    s_mov_b32 s77, 29440
    buffer_load_dwordx4 v41, s[48:51], s77 offen lds
    s_waitcnt lgkmcnt(8)
    v_mfma_f32_16x16x32_bf16 v[64:67], a[208:211], v[176:179], v[64:67]
    ds_read_b64_tr_b16 a[192:193], v112 offset:4096
    v_mul_f32 v186, v186, v44
    v_mfma_f32_16x16x32_bf16 v[68:71], a[208:211], v[180:183], v[68:71]
    ds_read_b64_tr_b16 a[194:195], v112 offset:6144
    v_mul_f32 v187, v187, v44
    v_mfma_f32_16x16x32_bf16 v[72:75], a[212:215], v[176:179], v[72:75]
    ds_read_b64_tr_b16 a[196:197], v113 offset:4096
    v_cvt_pk_bf16_f32 v168, v168, v169
    v_mfma_f32_16x16x32_bf16 v[76:79], a[212:215], v[180:183], v[76:79]
    ds_read_b64_tr_b16 a[198:199], v113 offset:6144
    v_cvt_pk_bf16_f32 v169, v170, v171
    v_mfma_f32_16x16x32_bf16 v[80:83], a[216:219], v[176:179], v[80:83]
    ds_read_b64_tr_b16 a[200:201], v114 offset:4096
    v_cvt_pk_bf16_f32 v170, v184, v185
    v_mfma_f32_16x16x32_bf16 v[84:87], a[216:219], v[180:183], v[84:87]
    ds_read_b64_tr_b16 a[202:203], v114 offset:6144
    s_add_u32 m0, s73, 147456
    v_cvt_pk_bf16_f32 v171, v186, v187
    s_mov_b32 s78, 21504
    v_mfma_f32_16x16x32_bf16 v[88:91], a[220:223], v[176:179], v[88:91]
    ds_read_b64_tr_b16 a[204:205], v115 offset:4096
    buffer_store_dwordx4 v[168:171], v42, s[52:55], s78 offen offset:0 sc1
    v_mfma_f32_16x16x32_bf16 v[92:95], a[220:223], v[180:183], v[92:95]
    ds_read_b64_tr_b16 a[206:207], v115 offset:6144
    v_mul_f32 v140, v140, v45
    s_waitcnt lgkmcnt(8)
    v_mfma_f32_16x16x32_bf16 v[64:67], a[176:179], v[192:195], v[64:67]
    ds_read_b64_tr_b16 a[208:209], v112 offset:8192
    s_mov_b32 s77, 115456
    buffer_load_dwordx4 v41, s[48:51], s77 offen lds
    v_mfma_f32_16x16x32_bf16 v[68:71], a[176:179], v[196:199], v[68:71]
    ds_read_b64_tr_b16 a[210:211], v112 offset:10240
    v_mul_f32 v141, v141, v45
    v_mfma_f32_16x16x32_bf16 v[72:75], a[180:183], v[192:195], v[72:75]
    ds_read_b64_tr_b16 a[212:213], v113 offset:8192
    v_mul_f32 v142, v142, v45
    v_mfma_f32_16x16x32_bf16 v[76:79], a[180:183], v[196:199], v[76:79]
    ds_read_b64_tr_b16 a[214:215], v113 offset:10240
    v_mul_f32 v143, v143, v45
    v_mfma_f32_16x16x32_bf16 v[80:83], a[184:187], v[192:195], v[80:83]
    ds_read_b64_tr_b16 a[216:217], v114 offset:8192
    v_mul_f32 v156, v156, v45
    v_mfma_f32_16x16x32_bf16 v[84:87], a[184:187], v[196:199], v[84:87]
    ds_read_b64_tr_b16 a[218:219], v114 offset:10240
    v_mul_f32 v157, v157, v45
    v_mfma_f32_16x16x32_bf16 v[88:91], a[188:191], v[192:195], v[88:91]
    ds_read_b64_tr_b16 a[220:221], v115 offset:8192
    s_add_u32 m0, s73, 151552
    v_mul_f32 v158, v158, v45
    v_mfma_f32_16x16x32_bf16 v[92:95], a[188:191], v[196:199], v[92:95]
    ds_read_b64_tr_b16 a[222:223], v115 offset:10240
    v_mul_f32 v159, v159, v45
    s_waitcnt lgkmcnt(8)
    v_mfma_f32_16x16x32_bf16 v[64:67], a[192:195], v[208:211], v[64:67]
    ds_read_b64_tr_b16 a[176:177], v112 offset:12288
    v_cvt_pk_bf16_f32 v140, v140, v141
    v_mfma_f32_16x16x32_bf16 v[68:71], a[192:195], v[212:215], v[68:71]
    ds_read_b64_tr_b16 a[178:179], v112 offset:14336
    s_mov_b32 s77, 144128
    buffer_load_dwordx4 v41, s[48:51], s77 offen lds
    v_mfma_f32_16x16x32_bf16 v[72:75], a[196:199], v[208:211], v[72:75]
    ds_read_b64_tr_b16 a[180:181], v113 offset:12288
    v_cvt_pk_bf16_f32 v141, v142, v143
    v_mfma_f32_16x16x32_bf16 v[76:79], a[196:199], v[212:215], v[76:79]
    ds_read_b64_tr_b16 a[182:183], v113 offset:14336
    v_cvt_pk_bf16_f32 v142, v156, v157
    v_mfma_f32_16x16x32_bf16 v[80:83], a[200:203], v[208:211], v[80:83]
    ds_read_b64_tr_b16 a[184:185], v114 offset:12288
    v_cvt_pk_bf16_f32 v143, v158, v159
    s_mov_b32 s78, 14336
    v_mfma_f32_16x16x32_bf16 v[84:87], a[200:203], v[212:215], v[84:87]
    ds_read_b64_tr_b16 a[186:187], v114 offset:14336
    buffer_store_dwordx4 v[140:143], v42, s[52:55], s78 offen offset:1024 sc1
    v_mfma_f32_16x16x32_bf16 v[88:91], a[204:207], v[208:211], v[88:91]
    ds_read_b64_tr_b16 a[188:189], v115 offset:12288
    v_mul_f32 v172, v172, v45
    v_mul_f32 v173, v173, v45
    v_mul_f32 v174, v174, v45
    v_mul_f32 v175, v175, v45
    v_mul_f32 v188, v188, v45
    v_mul_f32 v189, v189, v45
    v_mul_f32 v190, v190, v45
    v_mul_f32 v191, v191, v45
    v_cvt_pk_bf16_f32 v172, v172, v173
    v_cvt_pk_bf16_f32 v173, v174, v175
    v_cvt_pk_bf16_f32 v174, v188, v189
    v_cvt_pk_bf16_f32 v175, v190, v191
    s_mov_b32 s78, 21504
    buffer_store_dwordx4 v[172:175], v42, s[52:55], s78 offen offset:1024 sc1
    v_mfma_f32_16x16x32_bf16 v[92:95], a[204:207], v[212:215], v[92:95]
    ds_read_b64_tr_b16 a[190:191], v115 offset:14336
    s_waitcnt lgkmcnt(8)
    v_mfma_f32_16x16x32_bf16 v[64:67], a[208:211], v[224:227], v[64:67]
    s_waitcnt vmcnt(20)
    s_barrier
    ds_read_b64_tr_b16 a[192:193], v116 offset:0
    v_mfma_f32_16x16x32_bf16 v[68:71], a[208:211], v[228:231], v[68:71]
    ds_read_b64_tr_b16 a[194:195], v116 offset:2048
    v_mfma_f32_16x16x32_bf16 v[72:75], a[212:215], v[224:227], v[72:75]
    ds_read_b64_tr_b16 a[196:197], v117 offset:0
    v_mfma_f32_16x16x32_bf16 v[76:79], a[212:215], v[228:231], v[76:79]
    ds_read_b64_tr_b16 a[198:199], v117 offset:2048
    v_mfma_f32_16x16x32_bf16 v[80:83], a[216:219], v[224:227], v[80:83]
    ds_read_b64_tr_b16 a[200:201], v118 offset:0
    v_mfma_f32_16x16x32_bf16 v[84:87], a[216:219], v[228:231], v[84:87]
    ds_read_b64_tr_b16 a[202:203], v118 offset:2048
    v_mfma_f32_16x16x32_bf16 v[88:91], a[220:223], v[224:227], v[88:91]
    ds_read_b64_tr_b16 a[204:205], v119 offset:0
    v_mfma_f32_16x16x32_bf16 v[92:95], a[220:223], v[228:231], v[92:95]
    ds_read_b64_tr_b16 a[206:207], v119 offset:2048
    s_waitcnt lgkmcnt(8)
    v_mfma_f32_16x16x32_bf16 v[64:67], a[176:179], v[240:243], v[64:67]
    ds_read_b64_tr_b16 a[208:209], v116 offset:4096
    v_mfma_f32_16x16x32_bf16 v[68:71], a[176:179], v[244:247], v[68:71]
    ds_read_b64_tr_b16 a[210:211], v116 offset:6144
    v_mfma_f32_16x16x32_bf16 v[72:75], a[180:183], v[240:243], v[72:75]
    ds_read_b64_tr_b16 a[212:213], v117 offset:4096
    v_mfma_f32_16x16x32_bf16 v[76:79], a[180:183], v[244:247], v[76:79]
    ds_read_b64_tr_b16 a[214:215], v117 offset:6144
    v_mfma_f32_16x16x32_bf16 v[80:83], a[184:187], v[240:243], v[80:83]
    ds_read_b64_tr_b16 a[216:217], v118 offset:4096
    v_mfma_f32_16x16x32_bf16 v[84:87], a[184:187], v[244:247], v[84:87]
    ds_read_b64_tr_b16 a[218:219], v118 offset:6144
    v_mfma_f32_16x16x32_bf16 v[88:91], a[188:191], v[240:243], v[88:91]
    ds_read_b64_tr_b16 a[220:221], v119 offset:4096
    v_mfma_f32_16x16x32_bf16 v[92:95], a[188:191], v[244:247], v[92:95]
    ds_read_b64_tr_b16 a[222:223], v119 offset:6144
    s_waitcnt lgkmcnt(8)
    v_mfma_f32_16x16x32_bf16 v[136:139], a[192:195], v[128:131], 0
    ds_read_b64_tr_b16 a[176:177], v116 offset:8192
    v_mfma_f32_16x16x32_bf16 v[140:143], a[192:195], v[132:135], 0
    ds_read_b64_tr_b16 a[178:179], v116 offset:10240
    v_mfma_f32_16x16x32_bf16 v[152:155], a[196:199], v[128:131], 0
    ds_read_b64_tr_b16 a[180:181], v117 offset:8192
    v_mul_f32 v64, v64, v44
    v_mfma_f32_16x16x32_bf16 v[156:159], a[196:199], v[132:135], 0
    ds_read_b64_tr_b16 a[182:183], v117 offset:10240
    v_mul_f32 v65, v65, v44
    v_mfma_f32_16x16x32_bf16 v[168:171], a[200:203], v[128:131], 0
    ds_read_b64_tr_b16 a[184:185], v118 offset:8192
    v_mul_f32 v66, v66, v44
    v_mfma_f32_16x16x32_bf16 v[172:175], a[200:203], v[132:135], 0
    ds_read_b64_tr_b16 a[186:187], v118 offset:10240
    v_mul_f32 v67, v67, v44
    v_mfma_f32_16x16x32_bf16 v[184:187], a[204:207], v[128:131], 0
    ds_read_b64_tr_b16 a[188:189], v119 offset:8192
    v_mul_f32 v72, v72, v44
    v_mfma_f32_16x16x32_bf16 v[188:191], a[204:207], v[132:135], 0
    ds_read_b64_tr_b16 a[190:191], v119 offset:10240
    v_mul_f32 v73, v73, v44
    s_waitcnt lgkmcnt(8)
    v_mfma_f32_16x16x32_bf16 v[136:139], a[208:211], v[144:147], v[136:139]
    ds_read_b64_tr_b16 a[192:193], v116 offset:12288
    v_mul_f32 v74, v74, v44
    v_mfma_f32_16x16x32_bf16 v[140:143], a[208:211], v[148:151], v[140:143]
    ds_read_b64_tr_b16 a[194:195], v116 offset:14336
    v_mul_f32 v75, v75, v44
    v_mfma_f32_16x16x32_bf16 v[152:155], a[212:215], v[144:147], v[152:155]
    ds_read_b64_tr_b16 a[196:197], v117 offset:12288
    v_cvt_pk_bf16_f32 v64, v64, v65
    v_mfma_f32_16x16x32_bf16 v[156:159], a[212:215], v[148:151], v[156:159]
    ds_read_b64_tr_b16 a[198:199], v117 offset:14336
    v_cvt_pk_bf16_f32 v65, v66, v67
    v_mfma_f32_16x16x32_bf16 v[168:171], a[216:219], v[144:147], v[168:171]
    ds_read_b64_tr_b16 a[200:201], v118 offset:12288
    v_cvt_pk_bf16_f32 v66, v72, v73
    v_mfma_f32_16x16x32_bf16 v[172:175], a[216:219], v[148:151], v[172:175]
    ds_read_b64_tr_b16 a[202:203], v118 offset:14336
    v_cvt_pk_bf16_f32 v67, v74, v75
    s_mov_b32 s78, 28672
    v_mfma_f32_16x16x32_bf16 v[184:187], a[220:223], v[144:147], v[184:187]
    ds_read_b64_tr_b16 a[204:205], v119 offset:12288
    buffer_store_dwordx4 v[64:67], v42, s[52:55], s78 offen offset:0 sc1
    v_mfma_f32_16x16x32_bf16 v[188:191], a[220:223], v[148:151], v[188:191]
    ds_read_b64_tr_b16 a[206:207], v119 offset:14336
    v_mul_f32 v80, v80, v44
    s_waitcnt lgkmcnt(8)
    v_mfma_f32_16x16x32_bf16 v[136:139], a[176:179], v[160:163], v[136:139]
    ds_read_b64_tr_b16 a[208:209], v116 offset:16384
    v_mul_f32 v81, v81, v44
    v_mfma_f32_16x16x32_bf16 v[140:143], a[176:179], v[164:167], v[140:143]
    ds_read_b64_tr_b16 a[210:211], v116 offset:18432
    v_mul_f32 v82, v82, v44
    v_mfma_f32_16x16x32_bf16 v[152:155], a[180:183], v[160:163], v[152:155]
    ds_read_b64_tr_b16 a[212:213], v117 offset:16384
    v_mul_f32 v83, v83, v44
    v_mfma_f32_16x16x32_bf16 v[156:159], a[180:183], v[164:167], v[156:159]
    ds_read_b64_tr_b16 a[214:215], v117 offset:18432
    v_mul_f32 v88, v88, v44
    v_mfma_f32_16x16x32_bf16 v[168:171], a[184:187], v[160:163], v[168:171]
    ds_read_b64_tr_b16 a[216:217], v118 offset:16384
    v_mul_f32 v89, v89, v44
    v_mfma_f32_16x16x32_bf16 v[172:175], a[184:187], v[164:167], v[172:175]
    ds_read_b64_tr_b16 a[218:219], v118 offset:18432
    v_mul_f32 v90, v90, v44
    v_mfma_f32_16x16x32_bf16 v[184:187], a[188:191], v[160:163], v[184:187]
    ds_read_b64_tr_b16 a[220:221], v119 offset:16384
    v_mul_f32 v91, v91, v44
    v_mfma_f32_16x16x32_bf16 v[188:191], a[188:191], v[164:167], v[188:191]
    ds_read_b64_tr_b16 a[222:223], v119 offset:18432
    v_cvt_pk_bf16_f32 v80, v80, v81
    s_waitcnt lgkmcnt(8)
    v_mfma_f32_16x16x32_bf16 v[136:139], a[192:195], v[176:179], v[136:139]
    ds_read_b64_tr_b16 a[176:177], v116 offset:20480
    v_cvt_pk_bf16_f32 v81, v82, v83
    v_mfma_f32_16x16x32_bf16 v[140:143], a[192:195], v[180:183], v[140:143]
    ds_read_b64_tr_b16 a[178:179], v116 offset:22528
    v_cvt_pk_bf16_f32 v82, v88, v89
    v_mfma_f32_16x16x32_bf16 v[152:155], a[196:199], v[176:179], v[152:155]
    ds_read_b64_tr_b16 a[180:181], v117 offset:20480
    v_cvt_pk_bf16_f32 v83, v90, v91
    s_mov_b32 s78, 35840
    v_mfma_f32_16x16x32_bf16 v[156:159], a[196:199], v[180:183], v[156:159]
    ds_read_b64_tr_b16 a[182:183], v117 offset:22528
    buffer_store_dwordx4 v[80:83], v42, s[52:55], s78 offen offset:0 sc1
    v_mfma_f32_16x16x32_bf16 v[168:171], a[200:203], v[176:179], v[168:171]
    ds_read_b64_tr_b16 a[184:185], v118 offset:20480
    v_mul_f32 v68, v68, v45
    v_mfma_f32_16x16x32_bf16 v[172:175], a[200:203], v[180:183], v[172:175]
    ds_read_b64_tr_b16 a[186:187], v118 offset:22528
    v_mul_f32 v69, v69, v45
    v_mfma_f32_16x16x32_bf16 v[184:187], a[204:207], v[176:179], v[184:187]
    ds_read_b64_tr_b16 a[188:189], v119 offset:20480
    v_mul_f32 v70, v70, v45
    v_mfma_f32_16x16x32_bf16 v[188:191], a[204:207], v[180:183], v[188:191]
    ds_read_b64_tr_b16 a[190:191], v119 offset:22528
    v_mul_f32 v71, v71, v45
    s_waitcnt lgkmcnt(8)
    v_mfma_f32_16x16x32_bf16 v[136:139], a[208:211], v[192:195], v[136:139]
    ds_read_b64_tr_b16 a[192:193], v116 offset:24576
    v_mul_f32 v76, v76, v45
    v_mfma_f32_16x16x32_bf16 v[140:143], a[208:211], v[196:199], v[140:143]
    ds_read_b64_tr_b16 a[194:195], v116 offset:26624
    v_mul_f32 v77, v77, v45
    v_mfma_f32_16x16x32_bf16 v[152:155], a[212:215], v[192:195], v[152:155]
    ds_read_b64_tr_b16 a[196:197], v117 offset:24576
    v_mul_f32 v78, v78, v45
    v_mfma_f32_16x16x32_bf16 v[156:159], a[212:215], v[196:199], v[156:159]
    ds_read_b64_tr_b16 a[198:199], v117 offset:26624
    v_mul_f32 v79, v79, v45
    v_mfma_f32_16x16x32_bf16 v[168:171], a[216:219], v[192:195], v[168:171]
    ds_read_b64_tr_b16 a[200:201], v118 offset:24576
    v_cvt_pk_bf16_f32 v68, v68, v69
    v_mfma_f32_16x16x32_bf16 v[172:175], a[216:219], v[196:199], v[172:175]
    ds_read_b64_tr_b16 a[202:203], v118 offset:26624
    v_cvt_pk_bf16_f32 v69, v70, v71
    v_mfma_f32_16x16x32_bf16 v[184:187], a[220:223], v[192:195], v[184:187]
    ds_read_b64_tr_b16 a[204:205], v119 offset:24576
    v_cvt_pk_bf16_f32 v70, v76, v77
    v_mfma_f32_16x16x32_bf16 v[188:191], a[220:223], v[196:199], v[188:191]
    ds_read_b64_tr_b16 a[206:207], v119 offset:26624
    v_cvt_pk_bf16_f32 v71, v78, v79
    s_mov_b32 s78, 28672
    s_waitcnt lgkmcnt(8)
    v_mfma_f32_16x16x32_bf16 v[136:139], a[176:179], v[208:211], v[136:139]
    ds_read_b64_tr_b16 a[208:209], v116 offset:28672
    buffer_store_dwordx4 v[68:71], v42, s[52:55], s78 offen offset:1024 sc1
    v_mfma_f32_16x16x32_bf16 v[140:143], a[176:179], v[212:215], v[140:143]
    ds_read_b64_tr_b16 a[210:211], v116 offset:30720
    v_mul_f32 v84, v84, v45
    v_mfma_f32_16x16x32_bf16 v[152:155], a[180:183], v[208:211], v[152:155]
    ds_read_b64_tr_b16 a[212:213], v117 offset:28672
    v_mul_f32 v85, v85, v45
    v_mfma_f32_16x16x32_bf16 v[156:159], a[180:183], v[212:215], v[156:159]
    ds_read_b64_tr_b16 a[214:215], v117 offset:30720
    v_mul_f32 v86, v86, v45
    v_mfma_f32_16x16x32_bf16 v[168:171], a[184:187], v[208:211], v[168:171]
    ds_read_b64_tr_b16 a[216:217], v118 offset:28672
    v_mul_f32 v87, v87, v45
    v_mfma_f32_16x16x32_bf16 v[172:175], a[184:187], v[212:215], v[172:175]
    ds_read_b64_tr_b16 a[218:219], v118 offset:30720
    v_mul_f32 v92, v92, v45
    v_mfma_f32_16x16x32_bf16 v[184:187], a[188:191], v[208:211], v[184:187]
    ds_read_b64_tr_b16 a[220:221], v119 offset:28672
    v_mul_f32 v93, v93, v45
    v_mul_f32 v94, v94, v45
    v_mul_f32 v95, v95, v45
    v_cvt_pk_bf16_f32 v84, v84, v85
    v_cvt_pk_bf16_f32 v85, v86, v87
    v_cvt_pk_bf16_f32 v86, v92, v93
    v_cvt_pk_bf16_f32 v87, v94, v95
    s_mov_b32 s78, 35840
    buffer_store_dwordx4 v[84:87], v42, s[52:55], s78 offen offset:1024 sc1
    v_mfma_f32_16x16x32_bf16 v[188:191], a[188:191], v[212:215], v[188:191]
    ds_read_b64_tr_b16 a[222:223], v119 offset:30720
    s_waitcnt lgkmcnt(8)
    v_mfma_f32_16x16x32_bf16 v[136:139], a[192:195], v[224:227], v[136:139]
    s_waitcnt vmcnt(12)
    s_barrier
    ds_read_b64_tr_b16 a[176:177], v120 offset:0
    v_mfma_f32_16x16x32_bf16 v[140:143], a[192:195], v[228:231], v[140:143]
    ds_read_b64_tr_b16 a[178:179], v120 offset:2048
    v_mfma_f32_16x16x32_bf16 v[152:155], a[196:199], v[224:227], v[152:155]
    ds_read_b64_tr_b16 a[180:181], v121 offset:0
    v_mfma_f32_16x16x32_bf16 v[156:159], a[196:199], v[228:231], v[156:159]
    ds_read_b64_tr_b16 a[182:183], v121 offset:2048
    v_mfma_f32_16x16x32_bf16 v[168:171], a[200:203], v[224:227], v[168:171]
    ds_read_b64_tr_b16 a[184:185], v122 offset:0
    v_mfma_f32_16x16x32_bf16 v[172:175], a[200:203], v[228:231], v[172:175]
    ds_read_b64_tr_b16 a[186:187], v122 offset:2048
    v_mfma_f32_16x16x32_bf16 v[184:187], a[204:207], v[224:227], v[184:187]
    ds_read_b64_tr_b16 a[188:189], v123 offset:0
    v_mfma_f32_16x16x32_bf16 v[188:191], a[204:207], v[228:231], v[188:191]
    ds_read_b64_tr_b16 a[190:191], v123 offset:2048
    s_waitcnt lgkmcnt(8)
    v_mfma_f32_16x16x32_bf16 v[136:139], a[208:211], v[240:243], v[136:139]
    ds_read_b64_tr_b16 a[192:193], v120 offset:4096
    v_mfma_f32_16x16x32_bf16 v[140:143], a[208:211], v[244:247], v[140:143]
    ds_read_b64_tr_b16 a[194:195], v120 offset:6144
    v_mfma_f32_16x16x32_bf16 v[152:155], a[212:215], v[240:243], v[152:155]
    ds_read_b64_tr_b16 a[196:197], v121 offset:4096
    v_mfma_f32_16x16x32_bf16 v[156:159], a[212:215], v[244:247], v[156:159]
    ds_read_b64_tr_b16 a[198:199], v121 offset:6144
    v_mfma_f32_16x16x32_bf16 v[168:171], a[216:219], v[240:243], v[168:171]
    ds_read_b64_tr_b16 a[200:201], v122 offset:4096
    v_mfma_f32_16x16x32_bf16 v[172:175], a[216:219], v[244:247], v[172:175]
    ds_read_b64_tr_b16 a[202:203], v122 offset:6144
    v_mfma_f32_16x16x32_bf16 v[184:187], a[220:223], v[240:243], v[184:187]
    ds_read_b64_tr_b16 a[204:205], v123 offset:4096
    v_mfma_f32_16x16x32_bf16 v[188:191], a[220:223], v[244:247], v[188:191]
    ds_read_b64_tr_b16 a[206:207], v123 offset:6144
    s_waitcnt lgkmcnt(8)
    v_mfma_f32_16x16x32_bf16 v[64:67], a[176:179], v[128:131], 0
    ds_read_b64_tr_b16 a[208:209], v120 offset:8192
    v_mfma_f32_16x16x32_bf16 v[68:71], a[176:179], v[132:135], 0
    ds_read_b64_tr_b16 a[210:211], v120 offset:10240
    v_mfma_f32_16x16x32_bf16 v[72:75], a[180:183], v[128:131], 0
    ds_read_b64_tr_b16 a[212:213], v121 offset:8192
    v_mul_f32 v136, v136, v44
    v_mfma_f32_16x16x32_bf16 v[76:79], a[180:183], v[132:135], 0
    ds_read_b64_tr_b16 a[214:215], v121 offset:10240
    v_mul_f32 v137, v137, v44
    v_mfma_f32_16x16x32_bf16 v[80:83], a[184:187], v[128:131], 0
    ds_read_b64_tr_b16 a[216:217], v122 offset:8192
    v_mul_f32 v138, v138, v44
    v_mfma_f32_16x16x32_bf16 v[84:87], a[184:187], v[132:135], 0
    ds_read_b64_tr_b16 a[218:219], v122 offset:10240
    v_mul_f32 v139, v139, v44
    v_mfma_f32_16x16x32_bf16 v[88:91], a[188:191], v[128:131], 0
    ds_read_b64_tr_b16 a[220:221], v123 offset:8192
    v_mul_f32 v152, v152, v44
    v_mfma_f32_16x16x32_bf16 v[92:95], a[188:191], v[132:135], 0
    ds_read_b64_tr_b16 a[222:223], v123 offset:10240
    v_mul_f32 v153, v153, v44
    s_waitcnt lgkmcnt(8)
    v_mfma_f32_16x16x32_bf16 v[64:67], a[192:195], v[144:147], v[64:67]
    ds_read_b64_tr_b16 a[176:177], v120 offset:12288
    v_mul_f32 v154, v154, v44
    v_mfma_f32_16x16x32_bf16 v[68:71], a[192:195], v[148:151], v[68:71]
    ds_read_b64_tr_b16 a[178:179], v120 offset:14336
    v_mul_f32 v155, v155, v44
    v_mfma_f32_16x16x32_bf16 v[72:75], a[196:199], v[144:147], v[72:75]
    ds_read_b64_tr_b16 a[180:181], v121 offset:12288
    v_cvt_pk_bf16_f32 v136, v136, v137
    v_mfma_f32_16x16x32_bf16 v[76:79], a[196:199], v[148:151], v[76:79]
    ds_read_b64_tr_b16 a[182:183], v121 offset:14336
    v_cvt_pk_bf16_f32 v137, v138, v139
    v_mfma_f32_16x16x32_bf16 v[80:83], a[200:203], v[144:147], v[80:83]
    ds_read_b64_tr_b16 a[184:185], v122 offset:12288
    v_cvt_pk_bf16_f32 v138, v152, v153
    v_mfma_f32_16x16x32_bf16 v[84:87], a[200:203], v[148:151], v[84:87]
    ds_read_b64_tr_b16 a[186:187], v122 offset:14336
    v_cvt_pk_bf16_f32 v139, v154, v155
    s_mov_b32 s78, 43008
    v_mfma_f32_16x16x32_bf16 v[88:91], a[204:207], v[144:147], v[88:91]
    ds_read_b64_tr_b16 a[188:189], v123 offset:12288
    buffer_store_dwordx4 v[136:139], v42, s[52:55], s78 offen offset:0 sc1
    v_mfma_f32_16x16x32_bf16 v[92:95], a[204:207], v[148:151], v[92:95]
    ds_read_b64_tr_b16 a[190:191], v123 offset:14336
    v_mul_f32 v168, v168, v44
    s_waitcnt lgkmcnt(8)
    v_mfma_f32_16x16x32_bf16 v[64:67], a[208:211], v[160:163], v[64:67]
    ds_read_b64_tr_b16 a[192:193], v116 offset:49152
    v_mul_f32 v169, v169, v44
    v_mfma_f32_16x16x32_bf16 v[68:71], a[208:211], v[164:167], v[68:71]
    ds_read_b64_tr_b16 a[194:195], v116 offset:51200
    v_mul_f32 v170, v170, v44
    v_mfma_f32_16x16x32_bf16 v[72:75], a[212:215], v[160:163], v[72:75]
    ds_read_b64_tr_b16 a[196:197], v117 offset:49152
    v_mul_f32 v171, v171, v44
    v_mfma_f32_16x16x32_bf16 v[76:79], a[212:215], v[164:167], v[76:79]
    ds_read_b64_tr_b16 a[198:199], v117 offset:51200
    v_mul_f32 v184, v184, v44
    v_mfma_f32_16x16x32_bf16 v[80:83], a[216:219], v[160:163], v[80:83]
    ds_read_b64_tr_b16 a[200:201], v118 offset:49152
    v_mul_f32 v185, v185, v44
    v_mfma_f32_16x16x32_bf16 v[84:87], a[216:219], v[164:167], v[84:87]
    ds_read_b64_tr_b16 a[202:203], v118 offset:51200
    v_mul_f32 v186, v186, v44
    v_mfma_f32_16x16x32_bf16 v[88:91], a[220:223], v[160:163], v[88:91]
    ds_read_b64_tr_b16 a[204:205], v119 offset:49152
    v_mul_f32 v187, v187, v44
    v_mfma_f32_16x16x32_bf16 v[92:95], a[220:223], v[164:167], v[92:95]
    ds_read_b64_tr_b16 a[206:207], v119 offset:51200
    v_cvt_pk_bf16_f32 v168, v168, v169
    s_waitcnt lgkmcnt(8)
    v_mfma_f32_16x16x32_bf16 v[64:67], a[176:179], v[176:179], v[64:67]
    ds_read_b64_tr_b16 a[208:209], v116 offset:53248
    v_cvt_pk_bf16_f32 v169, v170, v171
    v_mfma_f32_16x16x32_bf16 v[68:71], a[176:179], v[180:183], v[68:71]
    ds_read_b64_tr_b16 a[210:211], v116 offset:55296
    v_cvt_pk_bf16_f32 v170, v184, v185
    v_mfma_f32_16x16x32_bf16 v[72:75], a[180:183], v[176:179], v[72:75]
    ds_read_b64_tr_b16 a[212:213], v117 offset:53248
    v_cvt_pk_bf16_f32 v171, v186, v187
    s_mov_b32 s78, 50176
    v_mfma_f32_16x16x32_bf16 v[76:79], a[180:183], v[180:183], v[76:79]
    ds_read_b64_tr_b16 a[214:215], v117 offset:55296
    buffer_store_dwordx4 v[168:171], v42, s[52:55], s78 offen offset:0 sc1
    v_mfma_f32_16x16x32_bf16 v[80:83], a[184:187], v[176:179], v[80:83]
    ds_read_b64_tr_b16 a[216:217], v118 offset:53248
    v_mul_f32 v140, v140, v45
    v_mfma_f32_16x16x32_bf16 v[84:87], a[184:187], v[180:183], v[84:87]
    ds_read_b64_tr_b16 a[218:219], v118 offset:55296
    v_mul_f32 v141, v141, v45
    v_mfma_f32_16x16x32_bf16 v[88:91], a[188:191], v[176:179], v[88:91]
    ds_read_b64_tr_b16 a[220:221], v119 offset:53248
    v_mul_f32 v142, v142, v45
    v_mfma_f32_16x16x32_bf16 v[92:95], a[188:191], v[180:183], v[92:95]
    ds_read_b64_tr_b16 a[222:223], v119 offset:55296
    v_mul_f32 v143, v143, v45
    s_waitcnt lgkmcnt(8)
    v_mfma_f32_16x16x32_bf16 v[64:67], a[192:195], v[192:195], v[64:67]
    ds_read_b64_tr_b16 a[176:177], v116 offset:57344
    v_mul_f32 v156, v156, v45
    v_mfma_f32_16x16x32_bf16 v[68:71], a[192:195], v[196:199], v[68:71]
    ds_read_b64_tr_b16 a[178:179], v116 offset:59392
    v_mul_f32 v157, v157, v45
    v_mfma_f32_16x16x32_bf16 v[72:75], a[196:199], v[192:195], v[72:75]
    ds_read_b64_tr_b16 a[180:181], v117 offset:57344
    v_mul_f32 v158, v158, v45
    v_mfma_f32_16x16x32_bf16 v[76:79], a[196:199], v[196:199], v[76:79]
    ds_read_b64_tr_b16 a[182:183], v117 offset:59392
    v_mul_f32 v159, v159, v45
    v_mfma_f32_16x16x32_bf16 v[80:83], a[200:203], v[192:195], v[80:83]
    ds_read_b64_tr_b16 a[184:185], v118 offset:57344
    v_cvt_pk_bf16_f32 v140, v140, v141
    v_mfma_f32_16x16x32_bf16 v[84:87], a[200:203], v[196:199], v[84:87]
    ds_read_b64_tr_b16 a[186:187], v118 offset:59392
    v_cvt_pk_bf16_f32 v141, v142, v143
    v_mfma_f32_16x16x32_bf16 v[88:91], a[204:207], v[192:195], v[88:91]
    ds_read_b64_tr_b16 a[188:189], v119 offset:57344
    v_cvt_pk_bf16_f32 v142, v156, v157
    v_mfma_f32_16x16x32_bf16 v[92:95], a[204:207], v[196:199], v[92:95]
    ds_read_b64_tr_b16 a[190:191], v119 offset:59392
    v_cvt_pk_bf16_f32 v143, v158, v159
    s_mov_b32 s78, 43008
    s_waitcnt lgkmcnt(8)
    v_mfma_f32_16x16x32_bf16 v[64:67], a[208:211], v[208:211], v[64:67]
    ds_read_b64_tr_b16 a[192:193], v116 offset:61440
    buffer_store_dwordx4 v[140:143], v42, s[52:55], s78 offen offset:1024 sc1
    v_mfma_f32_16x16x32_bf16 v[68:71], a[208:211], v[212:215], v[68:71]
    ds_read_b64_tr_b16 a[194:195], v116 offset:63488
    v_mul_f32 v172, v172, v45
    v_mfma_f32_16x16x32_bf16 v[72:75], a[212:215], v[208:211], v[72:75]
    ds_read_b64_tr_b16 a[196:197], v117 offset:61440
    v_mul_f32 v173, v173, v45
    v_mfma_f32_16x16x32_bf16 v[76:79], a[212:215], v[212:215], v[76:79]
    ds_read_b64_tr_b16 a[198:199], v117 offset:63488
    v_mul_f32 v174, v174, v45
    v_mfma_f32_16x16x32_bf16 v[80:83], a[216:219], v[208:211], v[80:83]
    ds_read_b64_tr_b16 a[200:201], v118 offset:61440
    v_mul_f32 v175, v175, v45
    v_mfma_f32_16x16x32_bf16 v[84:87], a[216:219], v[212:215], v[84:87]
    ds_read_b64_tr_b16 a[202:203], v118 offset:63488
    v_mul_f32 v188, v188, v45
    v_mfma_f32_16x16x32_bf16 v[88:91], a[220:223], v[208:211], v[88:91]
    ds_read_b64_tr_b16 a[204:205], v119 offset:61440
    v_mul_f32 v189, v189, v45
    v_mul_f32 v190, v190, v45
    v_mul_f32 v191, v191, v45
    v_cvt_pk_bf16_f32 v172, v172, v173
    v_cvt_pk_bf16_f32 v173, v174, v175
    v_cvt_pk_bf16_f32 v174, v188, v189
    v_cvt_pk_bf16_f32 v175, v190, v191
    s_mov_b32 s78, 50176
    buffer_store_dwordx4 v[172:175], v42, s[52:55], s78 offen offset:1024 sc1
    v_mfma_f32_16x16x32_bf16 v[92:95], a[220:223], v[212:215], v[92:95]
    ds_read_b64_tr_b16 a[206:207], v119 offset:63488
    s_waitcnt lgkmcnt(8)
    v_mfma_f32_16x16x32_bf16 v[64:67], a[176:179], v[224:227], v[64:67]
    s_barrier
    ds_read_b64_tr_b16 a[208:209], v112 offset:16384
    v_mfma_f32_16x16x32_bf16 v[68:71], a[176:179], v[228:231], v[68:71]
    ds_read_b64_tr_b16 a[210:211], v112 offset:18432
    v_mfma_f32_16x16x32_bf16 v[72:75], a[180:183], v[224:227], v[72:75]
    ds_read_b64_tr_b16 a[212:213], v113 offset:16384
    v_mfma_f32_16x16x32_bf16 v[76:79], a[180:183], v[228:231], v[76:79]
    ds_read_b64_tr_b16 a[214:215], v113 offset:18432
    v_mfma_f32_16x16x32_bf16 v[80:83], a[184:187], v[224:227], v[80:83]
    ds_read_b64_tr_b16 a[216:217], v114 offset:16384
    v_mfma_f32_16x16x32_bf16 v[84:87], a[184:187], v[228:231], v[84:87]
    ds_read_b64_tr_b16 a[218:219], v114 offset:18432
    v_mfma_f32_16x16x32_bf16 v[88:91], a[188:191], v[224:227], v[88:91]
    ds_read_b64_tr_b16 a[220:221], v115 offset:16384
    v_mfma_f32_16x16x32_bf16 v[92:95], a[188:191], v[228:231], v[92:95]
    ds_read_b64_tr_b16 a[222:223], v115 offset:18432
    s_waitcnt lgkmcnt(8)
    v_mfma_f32_16x16x32_bf16 v[64:67], a[192:195], v[240:243], v[64:67]
    ds_read_b64_tr_b16 a[176:177], v112 offset:20480
    v_mfma_f32_16x16x32_bf16 v[68:71], a[192:195], v[244:247], v[68:71]
    ds_read_b64_tr_b16 a[178:179], v112 offset:22528
    v_mfma_f32_16x16x32_bf16 v[72:75], a[196:199], v[240:243], v[72:75]
    ds_read_b64_tr_b16 a[180:181], v113 offset:20480
    v_mfma_f32_16x16x32_bf16 v[76:79], a[196:199], v[244:247], v[76:79]
    ds_read_b64_tr_b16 a[182:183], v113 offset:22528
    v_mfma_f32_16x16x32_bf16 v[80:83], a[200:203], v[240:243], v[80:83]
    ds_read_b64_tr_b16 a[184:185], v114 offset:20480
    v_mfma_f32_16x16x32_bf16 v[84:87], a[200:203], v[244:247], v[84:87]
    ds_read_b64_tr_b16 a[186:187], v114 offset:22528
    v_mfma_f32_16x16x32_bf16 v[88:91], a[204:207], v[240:243], v[88:91]
    ds_read_b64_tr_b16 a[188:189], v115 offset:20480
    v_mfma_f32_16x16x32_bf16 v[92:95], a[204:207], v[244:247], v[92:95]
    ds_read_b64_tr_b16 a[190:191], v115 offset:22528
    s_waitcnt lgkmcnt(8)
    v_mfma_f32_16x16x32_bf16 v[136:139], a[208:211], v[128:131], 0
    ds_read_b64_tr_b16 a[192:193], v112 offset:24576
    v_mfma_f32_16x16x32_bf16 v[140:143], a[208:211], v[132:135], 0
    ds_read_b64_tr_b16 a[194:195], v112 offset:26624
    v_mfma_f32_16x16x32_bf16 v[152:155], a[212:215], v[128:131], 0
    ds_read_b64_tr_b16 a[196:197], v113 offset:24576
    v_mul_f32 v64, v64, v44
    v_mfma_f32_16x16x32_bf16 v[156:159], a[212:215], v[132:135], 0
    ds_read_b64_tr_b16 a[198:199], v113 offset:26624
    v_mul_f32 v65, v65, v44
    v_mfma_f32_16x16x32_bf16 v[168:171], a[216:219], v[128:131], 0
    ds_read_b64_tr_b16 a[200:201], v114 offset:24576
    v_mul_f32 v66, v66, v44
    v_mfma_f32_16x16x32_bf16 v[172:175], a[216:219], v[132:135], 0
    ds_read_b64_tr_b16 a[202:203], v114 offset:26624
    v_mul_f32 v67, v67, v44
    v_mfma_f32_16x16x32_bf16 v[184:187], a[220:223], v[128:131], 0
    ds_read_b64_tr_b16 a[204:205], v115 offset:24576
    v_mul_f32 v72, v72, v44
    v_mfma_f32_16x16x32_bf16 v[188:191], a[220:223], v[132:135], 0
    ds_read_b64_tr_b16 a[206:207], v115 offset:26624
    v_mul_f32 v73, v73, v44
    s_waitcnt lgkmcnt(8)
    v_mfma_f32_16x16x32_bf16 v[136:139], a[176:179], v[144:147], v[136:139]
    ds_read_b64_tr_b16 a[208:209], v112 offset:28672
    v_mul_f32 v74, v74, v44
    v_mfma_f32_16x16x32_bf16 v[140:143], a[176:179], v[148:151], v[140:143]
    ds_read_b64_tr_b16 a[210:211], v112 offset:30720
    v_mul_f32 v75, v75, v44
    v_mfma_f32_16x16x32_bf16 v[152:155], a[180:183], v[144:147], v[152:155]
    ds_read_b64_tr_b16 a[212:213], v113 offset:28672
    v_cvt_pk_bf16_f32 v64, v64, v65
    v_mfma_f32_16x16x32_bf16 v[156:159], a[180:183], v[148:151], v[156:159]
    ds_read_b64_tr_b16 a[214:215], v113 offset:30720
    v_cvt_pk_bf16_f32 v65, v66, v67
    v_mfma_f32_16x16x32_bf16 v[168:171], a[184:187], v[144:147], v[168:171]
    ds_read_b64_tr_b16 a[216:217], v114 offset:28672
    v_cvt_pk_bf16_f32 v66, v72, v73
    v_mfma_f32_16x16x32_bf16 v[172:175], a[184:187], v[148:151], v[172:175]
    ds_read_b64_tr_b16 a[218:219], v114 offset:30720
    v_cvt_pk_bf16_f32 v67, v74, v75
    s_mov_b32 s78, 57344
    v_mfma_f32_16x16x32_bf16 v[184:187], a[188:191], v[144:147], v[184:187]
    ds_read_b64_tr_b16 a[220:221], v115 offset:28672
    buffer_store_dwordx4 v[64:67], v42, s[52:55], s78 offen offset:0 sc1
    v_mfma_f32_16x16x32_bf16 v[188:191], a[188:191], v[148:151], v[188:191]
    ds_read_b64_tr_b16 a[222:223], v115 offset:30720
    v_mul_f32 v80, v80, v44
    s_waitcnt lgkmcnt(8)
    v_mfma_f32_16x16x32_bf16 v[136:139], a[192:195], v[160:163], v[136:139]
    ds_read_b64_tr_b16 a[176:177], v112 offset:32768
    v_mul_f32 v81, v81, v44
    v_mfma_f32_16x16x32_bf16 v[140:143], a[192:195], v[164:167], v[140:143]
    ds_read_b64_tr_b16 a[178:179], v112 offset:34816
    v_mul_f32 v82, v82, v44
    v_mfma_f32_16x16x32_bf16 v[152:155], a[196:199], v[160:163], v[152:155]
    ds_read_b64_tr_b16 a[180:181], v113 offset:32768
    v_mul_f32 v83, v83, v44
    v_mfma_f32_16x16x32_bf16 v[156:159], a[196:199], v[164:167], v[156:159]
    ds_read_b64_tr_b16 a[182:183], v113 offset:34816
    v_mul_f32 v88, v88, v44
    v_mfma_f32_16x16x32_bf16 v[168:171], a[200:203], v[160:163], v[168:171]
    ds_read_b64_tr_b16 a[184:185], v114 offset:32768
    v_mul_f32 v89, v89, v44
    v_mfma_f32_16x16x32_bf16 v[172:175], a[200:203], v[164:167], v[172:175]
    ds_read_b64_tr_b16 a[186:187], v114 offset:34816
    v_mul_f32 v90, v90, v44
    v_mfma_f32_16x16x32_bf16 v[184:187], a[204:207], v[160:163], v[184:187]
    ds_read_b64_tr_b16 a[188:189], v115 offset:32768
    v_mul_f32 v91, v91, v44
    v_mfma_f32_16x16x32_bf16 v[188:191], a[204:207], v[164:167], v[188:191]
    ds_read_b64_tr_b16 a[190:191], v115 offset:34816
    v_cvt_pk_bf16_f32 v80, v80, v81
    s_waitcnt lgkmcnt(8)
    v_mfma_f32_16x16x32_bf16 v[136:139], a[208:211], v[176:179], v[136:139]
    ds_read_b64_tr_b16 a[192:193], v112 offset:36864
    v_cvt_pk_bf16_f32 v81, v82, v83
    v_mfma_f32_16x16x32_bf16 v[140:143], a[208:211], v[180:183], v[140:143]
    ds_read_b64_tr_b16 a[194:195], v112 offset:38912
    v_cvt_pk_bf16_f32 v82, v88, v89
    v_mfma_f32_16x16x32_bf16 v[152:155], a[212:215], v[176:179], v[152:155]
    ds_read_b64_tr_b16 a[196:197], v113 offset:36864
    v_cvt_pk_bf16_f32 v83, v90, v91
    s_mov_b32 s78, 64512
    v_mfma_f32_16x16x32_bf16 v[156:159], a[212:215], v[180:183], v[156:159]
    ds_read_b64_tr_b16 a[198:199], v113 offset:38912
    buffer_store_dwordx4 v[80:83], v42, s[52:55], s78 offen offset:0 sc1
    v_mfma_f32_16x16x32_bf16 v[168:171], a[216:219], v[176:179], v[168:171]
    ds_read_b64_tr_b16 a[200:201], v114 offset:36864
    v_mul_f32 v68, v68, v45
    v_mfma_f32_16x16x32_bf16 v[172:175], a[216:219], v[180:183], v[172:175]
    ds_read_b64_tr_b16 a[202:203], v114 offset:38912
    v_mul_f32 v69, v69, v45
    v_mfma_f32_16x16x32_bf16 v[184:187], a[220:223], v[176:179], v[184:187]
    ds_read_b64_tr_b16 a[204:205], v115 offset:36864
    v_mul_f32 v70, v70, v45
    v_mfma_f32_16x16x32_bf16 v[188:191], a[220:223], v[180:183], v[188:191]
    ds_read_b64_tr_b16 a[206:207], v115 offset:38912
    v_mul_f32 v71, v71, v45
    s_waitcnt lgkmcnt(8)
    v_mfma_f32_16x16x32_bf16 v[136:139], a[176:179], v[192:195], v[136:139]
    ds_read_b64_tr_b16 a[208:209], v112 offset:40960
    v_mul_f32 v76, v76, v45
    v_mfma_f32_16x16x32_bf16 v[140:143], a[176:179], v[196:199], v[140:143]
    ds_read_b64_tr_b16 a[210:211], v112 offset:43008
    v_mul_f32 v77, v77, v45
    v_mfma_f32_16x16x32_bf16 v[152:155], a[180:183], v[192:195], v[152:155]
    ds_read_b64_tr_b16 a[212:213], v113 offset:40960
    v_mul_f32 v78, v78, v45
    v_mfma_f32_16x16x32_bf16 v[156:159], a[180:183], v[196:199], v[156:159]
    ds_read_b64_tr_b16 a[214:215], v113 offset:43008
    v_mul_f32 v79, v79, v45
    v_mfma_f32_16x16x32_bf16 v[168:171], a[184:187], v[192:195], v[168:171]
    ds_read_b64_tr_b16 a[216:217], v114 offset:40960
    v_cvt_pk_bf16_f32 v68, v68, v69
    v_mfma_f32_16x16x32_bf16 v[172:175], a[184:187], v[196:199], v[172:175]
    ds_read_b64_tr_b16 a[218:219], v114 offset:43008
    v_cvt_pk_bf16_f32 v69, v70, v71
    v_mfma_f32_16x16x32_bf16 v[184:187], a[188:191], v[192:195], v[184:187]
    ds_read_b64_tr_b16 a[220:221], v115 offset:40960
    v_cvt_pk_bf16_f32 v70, v76, v77
    v_mfma_f32_16x16x32_bf16 v[188:191], a[188:191], v[196:199], v[188:191]
    ds_read_b64_tr_b16 a[222:223], v115 offset:43008
    v_cvt_pk_bf16_f32 v71, v78, v79
    s_mov_b32 s78, 57344
    s_waitcnt lgkmcnt(8)
    v_mfma_f32_16x16x32_bf16 v[136:139], a[192:195], v[208:211], v[136:139]
    ds_read_b64_tr_b16 a[176:177], v112 offset:45056
    buffer_store_dwordx4 v[68:71], v42, s[52:55], s78 offen offset:1024 sc1
    v_mfma_f32_16x16x32_bf16 v[140:143], a[192:195], v[212:215], v[140:143]
    ds_read_b64_tr_b16 a[178:179], v112 offset:47104
    v_mul_f32 v84, v84, v45
    v_mfma_f32_16x16x32_bf16 v[152:155], a[196:199], v[208:211], v[152:155]
    ds_read_b64_tr_b16 a[180:181], v113 offset:45056
    v_mul_f32 v85, v85, v45
    v_mfma_f32_16x16x32_bf16 v[156:159], a[196:199], v[212:215], v[156:159]
    ds_read_b64_tr_b16 a[182:183], v113 offset:47104
    v_mul_f32 v86, v86, v45
    v_mfma_f32_16x16x32_bf16 v[168:171], a[200:203], v[208:211], v[168:171]
    ds_read_b64_tr_b16 a[184:185], v114 offset:45056
    v_mul_f32 v87, v87, v45
    v_mfma_f32_16x16x32_bf16 v[172:175], a[200:203], v[212:215], v[172:175]
    ds_read_b64_tr_b16 a[186:187], v114 offset:47104
    v_mul_f32 v92, v92, v45
    v_mfma_f32_16x16x32_bf16 v[184:187], a[204:207], v[208:211], v[184:187]
    ds_read_b64_tr_b16 a[188:189], v115 offset:45056
    v_mul_f32 v93, v93, v45
    v_mul_f32 v94, v94, v45
    v_mul_f32 v95, v95, v45
    v_cvt_pk_bf16_f32 v84, v84, v85
    v_cvt_pk_bf16_f32 v85, v86, v87
    v_cvt_pk_bf16_f32 v86, v92, v93
    v_cvt_pk_bf16_f32 v87, v94, v95
    s_mov_b32 s78, 64512
    buffer_store_dwordx4 v[84:87], v42, s[52:55], s78 offen offset:1024 sc1
    v_mfma_f32_16x16x32_bf16 v[188:191], a[204:207], v[212:215], v[188:191]
    ds_read_b64_tr_b16 a[190:191], v115 offset:47104
    s_waitcnt lgkmcnt(8)
    v_mfma_f32_16x16x32_bf16 v[136:139], a[208:211], v[224:227], v[136:139]
    s_waitcnt vmcnt(14)
    s_barrier
    ds_read_b64_tr_b16 a[192:193], v112 offset:49152
    v_mfma_f32_16x16x32_bf16 v[140:143], a[208:211], v[228:231], v[140:143]
    ds_read_b64_tr_b16 a[194:195], v112 offset:51200
    v_mfma_f32_16x16x32_bf16 v[152:155], a[212:215], v[224:227], v[152:155]
    ds_read_b64_tr_b16 a[196:197], v113 offset:49152
    v_mfma_f32_16x16x32_bf16 v[156:159], a[212:215], v[228:231], v[156:159]
    ds_read_b64_tr_b16 a[198:199], v113 offset:51200
    v_mfma_f32_16x16x32_bf16 v[168:171], a[216:219], v[224:227], v[168:171]
    ds_read_b64_tr_b16 a[200:201], v114 offset:49152
    v_mfma_f32_16x16x32_bf16 v[172:175], a[216:219], v[228:231], v[172:175]
    ds_read_b64_tr_b16 a[202:203], v114 offset:51200
    v_mfma_f32_16x16x32_bf16 v[184:187], a[220:223], v[224:227], v[184:187]
    ds_read_b64_tr_b16 a[204:205], v115 offset:49152
    v_mfma_f32_16x16x32_bf16 v[188:191], a[220:223], v[228:231], v[188:191]
    ds_read_b64_tr_b16 a[206:207], v115 offset:51200
    s_waitcnt lgkmcnt(8)
    v_mfma_f32_16x16x32_bf16 v[136:139], a[176:179], v[240:243], v[136:139]
    ds_read_b64_tr_b16 a[208:209], v112 offset:53248
    v_mfma_f32_16x16x32_bf16 v[140:143], a[176:179], v[244:247], v[140:143]
    ds_read_b64_tr_b16 a[210:211], v112 offset:55296
    v_mfma_f32_16x16x32_bf16 v[152:155], a[180:183], v[240:243], v[152:155]
    ds_read_b64_tr_b16 a[212:213], v113 offset:53248
    v_mfma_f32_16x16x32_bf16 v[156:159], a[180:183], v[244:247], v[156:159]
    ds_read_b64_tr_b16 a[214:215], v113 offset:55296
    v_mfma_f32_16x16x32_bf16 v[168:171], a[184:187], v[240:243], v[168:171]
    ds_read_b64_tr_b16 a[216:217], v114 offset:53248
    v_mfma_f32_16x16x32_bf16 v[172:175], a[184:187], v[244:247], v[172:175]
    ds_read_b64_tr_b16 a[218:219], v114 offset:55296
    v_mfma_f32_16x16x32_bf16 v[184:187], a[188:191], v[240:243], v[184:187]
    ds_read_b64_tr_b16 a[220:221], v115 offset:53248
    v_mfma_f32_16x16x32_bf16 v[188:191], a[188:191], v[244:247], v[188:191]
    ds_read_b64_tr_b16 a[222:223], v115 offset:55296
    s_waitcnt lgkmcnt(8)
    v_mfma_f32_16x16x32_bf16 v[64:67], a[192:195], v[128:131], 0
    ds_read_b64_tr_b16 a[176:177], v112 offset:57344
    v_mfma_f32_16x16x32_bf16 v[68:71], a[192:195], v[132:135], 0
    ds_read_b64_tr_b16 a[178:179], v112 offset:59392
    v_mfma_f32_16x16x32_bf16 v[72:75], a[196:199], v[128:131], 0
    ds_read_b64_tr_b16 a[180:181], v113 offset:57344
    v_mul_f32 v136, v136, v44
    v_mfma_f32_16x16x32_bf16 v[76:79], a[196:199], v[132:135], 0
    ds_read_b64_tr_b16 a[182:183], v113 offset:59392
    v_mul_f32 v137, v137, v44
    v_mfma_f32_16x16x32_bf16 v[80:83], a[200:203], v[128:131], 0
    ds_read_b64_tr_b16 a[184:185], v114 offset:57344
    v_mul_f32 v138, v138, v44
    v_mfma_f32_16x16x32_bf16 v[84:87], a[200:203], v[132:135], 0
    ds_read_b64_tr_b16 a[186:187], v114 offset:59392
    v_mul_f32 v139, v139, v44
    v_mfma_f32_16x16x32_bf16 v[88:91], a[204:207], v[128:131], 0
    ds_read_b64_tr_b16 a[188:189], v115 offset:57344
    v_mul_f32 v152, v152, v44
    v_mfma_f32_16x16x32_bf16 v[92:95], a[204:207], v[132:135], 0
    ds_read_b64_tr_b16 a[190:191], v115 offset:59392
    v_mul_f32 v153, v153, v44
    s_waitcnt lgkmcnt(8)
    v_mfma_f32_16x16x32_bf16 v[64:67], a[208:211], v[144:147], v[64:67]
    ds_read_b64_tr_b16 a[192:193], v112 offset:61440
    v_mul_f32 v154, v154, v44
    v_mfma_f32_16x16x32_bf16 v[68:71], a[208:211], v[148:151], v[68:71]
    ds_read_b64_tr_b16 a[194:195], v112 offset:63488
    v_mul_f32 v155, v155, v44
    v_mfma_f32_16x16x32_bf16 v[72:75], a[212:215], v[144:147], v[72:75]
    ds_read_b64_tr_b16 a[196:197], v113 offset:61440
    v_cvt_pk_bf16_f32 v136, v136, v137
    v_mfma_f32_16x16x32_bf16 v[76:79], a[212:215], v[148:151], v[76:79]
    ds_read_b64_tr_b16 a[198:199], v113 offset:63488
    v_cvt_pk_bf16_f32 v137, v138, v139
    v_mfma_f32_16x16x32_bf16 v[80:83], a[216:219], v[144:147], v[80:83]
    ds_read_b64_tr_b16 a[200:201], v114 offset:61440
    v_cvt_pk_bf16_f32 v138, v152, v153
    v_mfma_f32_16x16x32_bf16 v[84:87], a[216:219], v[148:151], v[84:87]
    ds_read_b64_tr_b16 a[202:203], v114 offset:63488
    v_cvt_pk_bf16_f32 v139, v154, v155
    s_mov_b32 s78, 71680
    v_mfma_f32_16x16x32_bf16 v[88:91], a[220:223], v[144:147], v[88:91]
    ds_read_b64_tr_b16 a[204:205], v115 offset:61440
    buffer_store_dwordx4 v[136:139], v42, s[52:55], s78 offen offset:0 sc1
    v_mfma_f32_16x16x32_bf16 v[92:95], a[220:223], v[148:151], v[92:95]
    ds_read_b64_tr_b16 a[206:207], v115 offset:63488
    v_mul_f32 v168, v168, v44
    s_waitcnt lgkmcnt(8)
    v_mfma_f32_16x16x32_bf16 v[64:67], a[176:179], v[160:163], v[64:67]
    ds_read_b64_tr_b16 a[208:209], v120 offset:16384
    v_mul_f32 v169, v169, v44
    v_mfma_f32_16x16x32_bf16 v[68:71], a[176:179], v[164:167], v[68:71]
    ds_read_b64_tr_b16 a[210:211], v120 offset:18432
    v_mul_f32 v170, v170, v44
    v_mfma_f32_16x16x32_bf16 v[72:75], a[180:183], v[160:163], v[72:75]
    ds_read_b64_tr_b16 a[212:213], v121 offset:16384
    v_mul_f32 v171, v171, v44
    v_mfma_f32_16x16x32_bf16 v[76:79], a[180:183], v[164:167], v[76:79]
    ds_read_b64_tr_b16 a[214:215], v121 offset:18432
    v_mul_f32 v184, v184, v44
    v_mfma_f32_16x16x32_bf16 v[80:83], a[184:187], v[160:163], v[80:83]
    ds_read_b64_tr_b16 a[216:217], v122 offset:16384
    v_mul_f32 v185, v185, v44
    v_mfma_f32_16x16x32_bf16 v[84:87], a[184:187], v[164:167], v[84:87]
    ds_read_b64_tr_b16 a[218:219], v122 offset:18432
    v_mul_f32 v186, v186, v44
    v_mfma_f32_16x16x32_bf16 v[88:91], a[188:191], v[160:163], v[88:91]
    ds_read_b64_tr_b16 a[220:221], v123 offset:16384
    v_mul_f32 v187, v187, v44
    v_mfma_f32_16x16x32_bf16 v[92:95], a[188:191], v[164:167], v[92:95]
    ds_read_b64_tr_b16 a[222:223], v123 offset:18432
    v_cvt_pk_bf16_f32 v168, v168, v169
    s_waitcnt lgkmcnt(8)
    v_mfma_f32_16x16x32_bf16 v[64:67], a[192:195], v[176:179], v[64:67]
    ds_read_b64_tr_b16 a[176:177], v120 offset:20480
    v_cvt_pk_bf16_f32 v169, v170, v171
    v_mfma_f32_16x16x32_bf16 v[68:71], a[192:195], v[180:183], v[68:71]
    ds_read_b64_tr_b16 a[178:179], v120 offset:22528
    v_cvt_pk_bf16_f32 v170, v184, v185
    v_mfma_f32_16x16x32_bf16 v[72:75], a[196:199], v[176:179], v[72:75]
    ds_read_b64_tr_b16 a[180:181], v121 offset:20480
    v_cvt_pk_bf16_f32 v171, v186, v187
    s_mov_b32 s78, 78848
    v_mfma_f32_16x16x32_bf16 v[76:79], a[196:199], v[180:183], v[76:79]
    ds_read_b64_tr_b16 a[182:183], v121 offset:22528
    buffer_store_dwordx4 v[168:171], v42, s[52:55], s78 offen offset:0 sc1
    v_mfma_f32_16x16x32_bf16 v[80:83], a[200:203], v[176:179], v[80:83]
    ds_read_b64_tr_b16 a[184:185], v122 offset:20480
    v_mul_f32 v140, v140, v45
    v_mfma_f32_16x16x32_bf16 v[84:87], a[200:203], v[180:183], v[84:87]
    ds_read_b64_tr_b16 a[186:187], v122 offset:22528
    v_mul_f32 v141, v141, v45
    v_mfma_f32_16x16x32_bf16 v[88:91], a[204:207], v[176:179], v[88:91]
    ds_read_b64_tr_b16 a[188:189], v123 offset:20480
    v_mul_f32 v142, v142, v45
    v_mul_f32 v143, v143, v45
    v_mul_f32 v156, v156, v45
    v_mul_f32 v157, v157, v45
    v_mul_f32 v158, v158, v45
    v_mul_f32 v159, v159, v45
    v_cvt_pk_bf16_f32 v140, v140, v141
    v_cvt_pk_bf16_f32 v141, v142, v143
    v_cvt_pk_bf16_f32 v142, v156, v157
    v_cvt_pk_bf16_f32 v143, v158, v159
    s_mov_b32 s78, 71680
    buffer_store_dwordx4 v[140:143], v42, s[52:55], s78 offen offset:1024 sc1
    v_mul_f32 v172, v172, v45
    v_mul_f32 v173, v173, v45
    v_mul_f32 v174, v174, v45
    v_mul_f32 v175, v175, v45
    v_mul_f32 v188, v188, v45
    v_mul_f32 v189, v189, v45
    v_mul_f32 v190, v190, v45
    v_mul_f32 v191, v191, v45
    v_cvt_pk_bf16_f32 v172, v172, v173
    v_cvt_pk_bf16_f32 v173, v174, v175
    v_cvt_pk_bf16_f32 v174, v188, v189
    v_cvt_pk_bf16_f32 v175, v190, v191
    s_mov_b32 s78, 78848
    buffer_store_dwordx4 v[172:175], v42, s[52:55], s78 offen offset:1024 sc1
    v_mfma_f32_16x16x32_bf16 v[92:95], a[204:207], v[180:183], v[92:95]
    ds_read_b64_tr_b16 a[190:191], v123 offset:22528
    s_waitcnt lgkmcnt(8)
    v_mfma_f32_16x16x32_bf16 v[64:67], a[208:211], v[192:195], v[64:67]
    ds_read_b64_tr_b16 a[192:193], v120 offset:24576
    v_mfma_f32_16x16x32_bf16 v[68:71], a[208:211], v[196:199], v[68:71]
    ds_read_b64_tr_b16 a[194:195], v120 offset:26624
    v_mfma_f32_16x16x32_bf16 v[72:75], a[212:215], v[192:195], v[72:75]
    ds_read_b64_tr_b16 a[196:197], v121 offset:24576
    v_mfma_f32_16x16x32_bf16 v[76:79], a[212:215], v[196:199], v[76:79]
    ds_read_b64_tr_b16 a[198:199], v121 offset:26624
    v_mfma_f32_16x16x32_bf16 v[80:83], a[216:219], v[192:195], v[80:83]
    ds_read_b64_tr_b16 a[200:201], v122 offset:24576
    v_mfma_f32_16x16x32_bf16 v[84:87], a[216:219], v[196:199], v[84:87]
    ds_read_b64_tr_b16 a[202:203], v122 offset:26624
    v_mfma_f32_16x16x32_bf16 v[88:91], a[220:223], v[192:195], v[88:91]
    ds_read_b64_tr_b16 a[204:205], v123 offset:24576
    v_mfma_f32_16x16x32_bf16 v[92:95], a[220:223], v[196:199], v[92:95]
    ds_read_b64_tr_b16 a[206:207], v123 offset:26624
    s_waitcnt lgkmcnt(8)
    v_mfma_f32_16x16x32_bf16 v[64:67], a[176:179], v[208:211], v[64:67]
    ds_read_b64_tr_b16 a[208:209], v120 offset:28672
    v_mfma_f32_16x16x32_bf16 v[68:71], a[176:179], v[212:215], v[68:71]
    ds_read_b64_tr_b16 a[210:211], v120 offset:30720
    v_mfma_f32_16x16x32_bf16 v[72:75], a[180:183], v[208:211], v[72:75]
    ds_read_b64_tr_b16 a[212:213], v121 offset:28672
    v_mfma_f32_16x16x32_bf16 v[76:79], a[180:183], v[212:215], v[76:79]
    ds_read_b64_tr_b16 a[214:215], v121 offset:30720
    v_mfma_f32_16x16x32_bf16 v[80:83], a[184:187], v[208:211], v[80:83]
    ds_read_b64_tr_b16 a[216:217], v122 offset:28672
    v_mfma_f32_16x16x32_bf16 v[84:87], a[184:187], v[212:215], v[84:87]
    ds_read_b64_tr_b16 a[218:219], v122 offset:30720
    v_mfma_f32_16x16x32_bf16 v[88:91], a[188:191], v[208:211], v[88:91]
    ds_read_b64_tr_b16 a[220:221], v123 offset:28672
    v_mfma_f32_16x16x32_bf16 v[92:95], a[188:191], v[212:215], v[92:95]
    ds_read_b64_tr_b16 a[222:223], v123 offset:30720
    s_waitcnt lgkmcnt(8)
    v_mfma_f32_16x16x32_bf16 v[64:67], a[192:195], v[224:227], v[64:67]
    v_mfma_f32_16x16x32_bf16 v[68:71], a[192:195], v[228:231], v[68:71]
    v_mfma_f32_16x16x32_bf16 v[72:75], a[196:199], v[224:227], v[72:75]
    v_mfma_f32_16x16x32_bf16 v[76:79], a[196:199], v[228:231], v[76:79]
    v_mfma_f32_16x16x32_bf16 v[80:83], a[200:203], v[224:227], v[80:83]
    v_mfma_f32_16x16x32_bf16 v[84:87], a[200:203], v[228:231], v[84:87]
    v_mfma_f32_16x16x32_bf16 v[88:91], a[204:207], v[224:227], v[88:91]
    v_mfma_f32_16x16x32_bf16 v[92:95], a[204:207], v[228:231], v[92:95]
    s_waitcnt lgkmcnt(0)
    v_mfma_f32_16x16x32_bf16 v[64:67], a[208:211], v[240:243], v[64:67]
    v_mfma_f32_16x16x32_bf16 v[68:71], a[208:211], v[244:247], v[68:71]
    v_mfma_f32_16x16x32_bf16 v[72:75], a[212:215], v[240:243], v[72:75]
    v_mfma_f32_16x16x32_bf16 v[76:79], a[212:215], v[244:247], v[76:79]
    v_mfma_f32_16x16x32_bf16 v[80:83], a[216:219], v[240:243], v[80:83]
    v_mfma_f32_16x16x32_bf16 v[84:87], a[216:219], v[244:247], v[84:87]
    v_mfma_f32_16x16x32_bf16 v[88:91], a[220:223], v[240:243], v[88:91]
    v_mfma_f32_16x16x32_bf16 v[92:95], a[220:223], v[244:247], v[92:95]
    s_nop 7
    v_mul_f32 v64, v64, v44
    v_mul_f32 v65, v65, v44
    v_mul_f32 v66, v66, v44
    v_mul_f32 v67, v67, v44
    v_mul_f32 v72, v72, v44
    v_mul_f32 v73, v73, v44
    v_mul_f32 v74, v74, v44
    v_mul_f32 v75, v75, v44
    v_cvt_pk_bf16_f32 v64, v64, v65
    v_cvt_pk_bf16_f32 v65, v66, v67
    v_cvt_pk_bf16_f32 v66, v72, v73
    v_cvt_pk_bf16_f32 v67, v74, v75
    s_mov_b32 s78, 86016
    buffer_store_dwordx4 v[64:67], v42, s[52:55], s78 offen offset:0 sc1
    v_mul_f32 v80, v80, v44
    v_mul_f32 v81, v81, v44
    v_mul_f32 v82, v82, v44
    v_mul_f32 v83, v83, v44
    v_mul_f32 v88, v88, v44
    v_mul_f32 v89, v89, v44
    v_mul_f32 v90, v90, v44
    v_mul_f32 v91, v91, v44
    v_cvt_pk_bf16_f32 v80, v80, v81
    v_cvt_pk_bf16_f32 v81, v82, v83
    v_cvt_pk_bf16_f32 v82, v88, v89
    v_cvt_pk_bf16_f32 v83, v90, v91
    s_mov_b32 s78, 93184
    buffer_store_dwordx4 v[80:83], v42, s[52:55], s78 offen offset:0 sc1
    v_mul_f32 v68, v68, v45
    v_mul_f32 v69, v69, v45
    v_mul_f32 v70, v70, v45
    v_mul_f32 v71, v71, v45
    v_mul_f32 v76, v76, v45
    v_mul_f32 v77, v77, v45
    v_mul_f32 v78, v78, v45
    v_mul_f32 v79, v79, v45
    v_cvt_pk_bf16_f32 v68, v68, v69
    v_cvt_pk_bf16_f32 v69, v70, v71
    v_cvt_pk_bf16_f32 v70, v76, v77
    v_cvt_pk_bf16_f32 v71, v78, v79
    s_mov_b32 s78, 86016
    buffer_store_dwordx4 v[68:71], v42, s[52:55], s78 offen offset:1024 sc1
    v_mul_f32 v84, v84, v45
    v_mul_f32 v85, v85, v45
    v_mul_f32 v86, v86, v45
    v_mul_f32 v87, v87, v45
    v_mul_f32 v92, v92, v45
    v_mul_f32 v93, v93, v45
    v_mul_f32 v94, v94, v45
    v_mul_f32 v95, v95, v45
    v_cvt_pk_bf16_f32 v84, v84, v85
    v_cvt_pk_bf16_f32 v85, v86, v87
    v_cvt_pk_bf16_f32 v86, v92, v93
    v_cvt_pk_bf16_f32 v87, v94, v95
    s_mov_b32 s78, 93184
    buffer_store_dwordx4 v[84:87], v42, s[52:55], s78 offen offset:1024 sc1
    s_branch L_epi
L_fb_F:
    s_waitcnt vmcnt(0) lgkmcnt(0)
    s_nop 7
    v_mbcnt_lo_u32_b32 v3, -1, 0
    v_mbcnt_hi_u32_b32 v3, -1, v3
    v_and_b32 v1, 15, v3
    v_lshrrev_b32 v2, 4, v3
    v_and_b32 v0, 1, v2
    v_lshlrev_b32 v0, 1, v0
    v_lshrrev_b32 v2, 1, v2
    v_or_b32 v2, v2, v0
    v_lshlrev_b32 v2, 4, v2
    v_lshl_add_u32 v2, v1, 9, v2
    v_mov_b32 v46, 0xff800000
    v_mov_b32 v47, 0xff800000
    s_mov_b32 s77, 0
L_fbl_F:
    buffer_load_dwordx4 a[176:179], v2, s[36:39], s77 offen offset:0
    buffer_load_dwordx4 a[180:183], v2, s[36:39], s77 offen offset:64
    buffer_load_dwordx4 a[184:187], v2, s[36:39], s77 offen offset:128
    buffer_load_dwordx4 a[188:191], v2, s[36:39], s77 offen offset:192
    buffer_load_dwordx4 a[192:195], v2, s[36:39], s77 offen offset:256
    buffer_load_dwordx4 a[196:199], v2, s[36:39], s77 offen offset:320
    buffer_load_dwordx4 a[200:203], v2, s[36:39], s77 offen offset:384
    buffer_load_dwordx4 a[204:207], v2, s[36:39], s77 offen offset:448
    s_waitcnt vmcnt(0)
    v_mfma_f32_16x16x32_bf16 v[64:67], a[176:179], a[112:115], 0
    v_mfma_f32_16x16x32_bf16 v[68:71], a[176:179], a[116:119], 0
    v_mfma_f32_16x16x32_bf16 v[64:67], a[180:183], a[120:123], v[64:67]
    v_mfma_f32_16x16x32_bf16 v[68:71], a[180:183], a[124:127], v[68:71]
    v_mfma_f32_16x16x32_bf16 v[64:67], a[184:187], a[128:131], v[64:67]
    v_mfma_f32_16x16x32_bf16 v[68:71], a[184:187], a[132:135], v[68:71]
    v_mfma_f32_16x16x32_bf16 v[64:67], a[188:191], a[136:139], v[64:67]
    v_mfma_f32_16x16x32_bf16 v[68:71], a[188:191], a[140:143], v[68:71]
    v_mfma_f32_16x16x32_bf16 v[64:67], a[192:195], a[144:147], v[64:67]
    v_mfma_f32_16x16x32_bf16 v[68:71], a[192:195], a[148:151], v[68:71]
    v_mfma_f32_16x16x32_bf16 v[64:67], a[196:199], a[152:155], v[64:67]
    v_mfma_f32_16x16x32_bf16 v[68:71], a[196:199], a[156:159], v[68:71]
    v_mfma_f32_16x16x32_bf16 v[64:67], a[200:203], a[160:163], v[64:67]
    v_mfma_f32_16x16x32_bf16 v[68:71], a[200:203], a[164:167], v[68:71]
    v_mfma_f32_16x16x32_bf16 v[64:67], a[204:207], a[168:171], v[64:67]
    v_mfma_f32_16x16x32_bf16 v[68:71], a[204:207], a[172:175], v[68:71]
    s_nop 7
    s_nop 7
    v_max3_f32 v46, v46, v64, v65
    v_max3_f32 v46, v46, v66, v67
    v_max3_f32 v47, v47, v68, v69
    v_max3_f32 v47, v47, v70, v71
    s_add_u32 s77, s77, 8192
    s_cmp_lt_u32 s77, 262144
    s_cbranch_scc1 L_fbl_F
    s_nop 1
    v_mov_b32 v1, v46
    s_nop 1
    v_permlane32_swap_b32 v46, v1
    s_nop 1
    v_max_f32 v46, v46, v1
    v_mov_b32 v1, v46
    s_nop 1
    v_permlane16_swap_b32 v46, v1
    s_nop 1
    v_max_f32 v46, v46, v1
    v_sub_f32 v48, 0, v46
    v_sub_f32 v49, 0, v46
    v_sub_f32 v50, 0, v46
    v_sub_f32 v51, 0, v46
    s_nop 1
    v_mov_b32 v1, v47
    s_nop 1
    v_permlane32_swap_b32 v47, v1
    s_nop 1
    v_max_f32 v47, v47, v1
    v_mov_b32 v1, v47
    s_nop 1
    v_permlane16_swap_b32 v47, v1
    s_nop 1
    v_max_f32 v47, v47, v1
    v_sub_f32 v52, 0, v47
    v_sub_f32 v53, 0, v47
    v_sub_f32 v54, 0, v47
    v_sub_f32 v55, 0, v47
    s_mov_b32 s76, 0
    s_mov_b32 s82, 0
    s_barrier
    s_branch L_restart_F
L_H:
    v_mov_b32 v48, 0
    v_mov_b32 v49, 0
    v_mov_b32 v50, 0
    v_mov_b32 v51, 0
L_restart_H:
    v_mbcnt_lo_u32_b32 v0, -1, 0
    v_mbcnt_hi_u32_b32 v0, -1, v0
    v_and_b32 v3, 63, v0
    v_lshrrev_b32 v4, 3, v3
    v_bfe_u32 v5, v3, 1, 2
    v_bfe_u32 v6, v3, 4, 1
    v_xor_b32 v6, v5, v6
    v_and_b32 v7, 1, v3
    v_lshlrev_b32 v7, 4, v7
    v_lshl_add_u32 v8, v6, 5, v7
    v_lshl_add_u32 v8, v4, 13, v8
    v_mov_b32 v196, v8
    v_xor_b32 v9, 64, v8
    v_add_u32 v204, 64512, v9
    v_add_u32 v212, 129024, v8
    v_add_u32 v220, 193536, v9
    v_and_b32 v9, 7, v3
    v_lshrrev_b32 v10, 4, v3
    v_xor_b32 v9, v9, v10
    v_lshlrev_b32 v9, 4, v9
    v_mul_u32_u24 v11, 896, v4
    s_mul_i32 s83, s72, 28672
    v_add3_u32 v197, v11, v9, s83
    v_xor_b32 v9, 64, v197
    v_add_u32 v205, 6144, v9
    v_and_b32 v9, 15, v3
    v_lshrrev_b32 v11, 1, v9
    v_xor_b32 v11, v11, v10
    v_lshlrev_b32 v11, 4, v11
    v_lshl_add_u32 v11, v9, 7, v11
    v_add_u32 v198, s74, v11
    v_xor_b32 v206, 64, v198
    v_add_u32 v214, 0x20000, v198
    v_add_u32 v222, 0x20000, v206
    s_mul_i32 s83, s81, 56
    v_min_u32 v2, 55, v3
    v_add_u32 v1, s83, v2
    s_lshl_b32 s84, s72, 7
    v_lshlrev_b32 v1, 13, v1
    v_add_u32 v1, s84, v1
    s_mul_i32 s83, s81, 224
    v_add_u32 v2, s83, v2
    v_lshlrev_b32 v2, 7, v2
    s_waitcnt lgkmcnt(0)
    s_lshl_b32 s84, s79, 9
    s_add_u32 s44, s14, s84
    s_addc_u32 s45, s15, 0
    s_sub_u32 s46, 3670016, s84
    s_mov_b32 s47, 0x20000
    s_mov_b32 m0, 65536
    s_mov_b32 s77, 0
    buffer_load_dwordx4 v220, s[44:47], s77 offen offset:3072 lds
    s_mov_b32 m0, 69632
    s_mov_b32 s77, 262144
    buffer_load_dwordx4 v220, s[44:47], s77 offen offset:3072 lds
    s_mov_b32 m0, 73728
    s_mov_b32 s77, 524288
    buffer_load_dwordx4 v220, s[44:47], s77 offen offset:3072 lds
    s_mov_b32 m0, 77824
    s_mov_b32 s77, 786432
    buffer_load_dwordx4 v220, s[44:47], s77 offen offset:3072 lds
    s_mul_i32 s84, s81, 100352
    s_add_u32 s32, s8, s84
    s_addc_u32 s33, s9, 0
    s_mov_b32 s34, 100352
    s_mov_b32 s35, 0x20000
    s_add_u32 m0, s74, 49152
    s_mov_b32 s77, 0
    buffer_load_dwordx4 v197, s[32:35], s77 offen offset:0 lds
    buffer_load_dwordx4 v205, s[32:35], s77 offen offset:1024 lds
    s_add_u32 m0, s74, 0
    s_mov_b32 s77, 128
    buffer_load_dwordx4 v197, s[32:35], s77 offen offset:0 lds
    buffer_load_dwordx4 v205, s[32:35], s77 offen offset:1024 lds
    s_mov_b32 m0, 81920
    s_mov_b32 s77, 1048576
    buffer_load_dwordx4 v220, s[44:47], s77 offen offset:3072 lds
    s_mov_b32 m0, 86016
    s_mov_b32 s77, 1310720
    buffer_load_dwordx4 v220, s[44:47], s77 offen offset:3072 lds
    s_mov_b32 m0, 90112
    s_mov_b32 s77, 1572864
    buffer_load_dwordx4 v220, s[44:47], s77 offen offset:3072 lds
    s_mov_b32 m0, 94208
    s_mov_b32 s77, 1835008
    buffer_load_dwordx4 v220, s[44:47], s77 offen offset:3072 lds
    s_add_u32 m0, s74, 16384
    s_mov_b32 s77, 256
    buffer_load_dwordx4 v197, s[32:35], s77 offen offset:0 lds
    buffer_load_dwordx4 v205, s[32:35], s77 offen offset:1024 lds
    s_add_u32 m0, s74, 131072
    s_mov_b32 s77, 384
    buffer_load_dwordx4 v197, s[32:35], s77 offen offset:0 lds
    buffer_load_dwordx4 v205, s[32:35], s77 offen offset:1024 lds
    v_and_b32 v44, 15, v3
    v_lshrrev_b32 v45, 4, v3
    v_bfe_u32 v46, v3, 2, 2
    v_and_b32 v47, 3, v3
    v_lshrrev_b32 v126, 5, v3
    v_and_b32 v127, 31, v3
    v_xor_b32 v127, v127, v126
    v_lshlrev_b32 v127, 4, v127
    v_lshl_add_u32 v127, v126, 9, v127
    v_xor_b32 v132, 0, v127
    v_xor_b32 v140, 32, v127
    v_xor_b32 v148, 64, v127
    v_xor_b32 v156, 96, v127
    v_xor_b32 v164, 128, v127
    v_xor_b32 v172, 160, v127
    v_xor_b32 v180, 192, v127
    v_xor_b32 v188, 224, v127
    v_bfe_u32 v127, v3, 1, 4
    v_xor_b32 v127, v127, v126
    v_lshlrev_b32 v127, 5, v127
    v_lshl_add_u32 v127, v126, 9, v127
    v_and_b32 v125, 1, v3
    v_lshl_add_u32 v127, v125, 4, v127
    v_xor_b32 v32, 0, v127
    v_xor_b32 v33, 64, v127
    v_xor_b32 v34, 128, v127
    v_xor_b32 v35, 192, v127
    v_bfe_u32 v127, v3, 1, 2
    v_xor_b32 v127, v127, v45
    v_lshlrev_b32 v127, 5, v127
    v_lshl_add_u32 v127, v125, 4, v127
    v_lshrrev_b32 v125, 3, v3
    v_mul_u32_u24 v125, 896, v125
    v_add_u32 v127, v127, v125
    v_add_u32 v228, 0, v127
    v_add_u32 v236, 6144, v127
    v_add_u32 v244, 12288, v127
    v_add_u32 v252, 18432, v127
    v_and_b32 v127, 1, v45
    v_lshlrev_b32 v127, 1, v127
    v_lshrrev_b32 v125, 1, v45
    v_or_b32 v127, v127, v125
    v_xor_b32 v127, v127, v44
    v_lshlrev_b32 v127, 4, v127
    v_lshl_add_u32 v127, v44, 9, v127
    v_xor_b32 v4, 0, v127
    v_add_u32 v8, 0x10000, v4
    v_xor_b32 v5, 64, v127
    v_add_u32 v9, 0x10000, v5
    v_xor_b32 v6, 128, v127
    v_add_u32 v10, 0x10000, v6
    v_xor_b32 v7, 192, v127
    v_add_u32 v11, 0x10000, v7
    v_lshl_add_u32 v127, v45, 2, v46
    v_and_b32 v125, 7, v127
    v_lshlrev_b32 v125, 5, v125
    v_lshl_add_u32 v125, v127, 9, v125
    v_lshl_add_u32 v125, v47, 3, v125
    v_add_u32 v125, 0x10000, v125
    v_xor_b32 v12, 0, v125
    v_add_u32 v20, 32768, v12
    v_xor_b32 v13, 32, v125
    v_add_u32 v21, 32768, v13
    v_xor_b32 v14, 64, v125
    v_add_u32 v22, 32768, v14
    v_xor_b32 v15, 96, v125
    v_add_u32 v23, 32768, v15
    v_xor_b32 v16, 128, v125
    v_add_u32 v24, 32768, v16
    v_xor_b32 v17, 160, v125
    v_add_u32 v25, 32768, v17
    v_xor_b32 v18, 192, v125
    v_add_u32 v26, 32768, v18
    v_xor_b32 v19, 224, v125
    v_add_u32 v27, 32768, v19
    v_bfe_u32 v125, v127, 1, 2
    v_lshlrev_b32 v125, 5, v125
    v_lshl_add_u32 v125, v127, 7, v125
    v_lshl_add_u32 v125, v47, 3, v125
    v_xor_b32 v112, 0, v125
    v_add_u32 v116, 0x10000, v112
    v_add_u32 v120, 0x20000, v112
    v_xor_b32 v113, 32, v125
    v_add_u32 v117, 0x10000, v113
    v_add_u32 v121, 0x20000, v113
    v_xor_b32 v114, 64, v125
    v_add_u32 v118, 0x10000, v114
    v_add_u32 v122, 0x20000, v114
    v_xor_b32 v115, 96, v125
    v_add_u32 v119, 0x10000, v115
    v_add_u32 v123, 0x20000, v115
    v_lshl_add_u32 v127, v45, 3, v46
    v_lshrrev_b32 v125, 1, v46
    v_and_b32 v126, 1, v45
    v_lshl_or_b32 v125, v126, 1, v125
    v_lshlrev_b32 v125, 5, v125
    v_lshl_add_u32 v125, v127, 7, v125
    v_lshl_add_u32 v125, v47, 3, v125
    v_add_u32 v125, 0x10000, v125
    v_xor_b32 v28, 0, v125
    v_xor_b32 v29, 32, v125
    v_xor_b32 v30, 64, v125
    v_xor_b32 v31, 96, v125
    v_lshlrev_b32 v42, 4, v3
    v_add_u32 v42, 6144, v42
    s_lshl_b32 s83, s72, 2
    s_add_u32 s83, s83, 114688
    v_mov_b32 v124, s83
    v_mov_b32 v125, 114688
    v_mov_b32 v127, 0x3f803f80
    v_accvgpr_write_b32 a224, v127
    v_accvgpr_write_b32 a225, v127
    v_accvgpr_write_b32 a226, v127
    v_accvgpr_write_b32 a227, v127
    buffer_load_dword a255, v1, s[44:47], 0 offen
    s_mov_b32 m0, 98304
    s_mov_b32 s77, 2097152
    buffer_load_dwordx4 v220, s[44:47], s77 offen offset:3072 lds
    s_mov_b32 m0, 102400
    s_mov_b32 s77, 2359296
    buffer_load_dwordx4 v220, s[44:47], s77 offen offset:3072 lds
    s_mov_b32 m0, 106496
    s_mov_b32 s77, 2621440
    buffer_load_dwordx4 v220, s[44:47], s77 offen offset:3072 lds
    s_mov_b32 m0, 110592
    s_mov_b32 s77, 2883584
    buffer_load_dwordx4 v220, s[44:47], s77 offen offset:3072 lds
    s_add_u32 m0, s74, 32768
    s_mov_b32 s77, 512
    buffer_load_dwordx4 v197, s[32:35], s77 offen offset:0 lds
    buffer_load_dwordx4 v205, s[32:35], s77 offen offset:1024 lds
    s_add_u32 m0, s74, 147456
    s_mov_b32 s77, 640
    buffer_load_dwordx4 v197, s[32:35], s77 offen offset:0 lds
    buffer_load_dwordx4 v205, s[32:35], s77 offen offset:1024 lds
    s_mov_b32 m0, 114688
    s_mov_b32 s77, 3145728
    buffer_load_dwordx4 v220, s[44:47], s77 offen offset:3072 lds
    s_mov_b32 m0, 118784
    s_mov_b32 s77, 3407872
    buffer_load_dwordx4 v220, s[44:47], s77 offen offset:3072 lds
    s_mov_b32 m0, 122880
    s_mov_b32 s77, 128
    buffer_load_dwordx4 v220, s[44:47], s77 offen offset:3072 lds
    s_mov_b32 m0, 126976
    s_mov_b32 s77, 262272
    buffer_load_dwordx4 v220, s[44:47], s77 offen offset:3072 lds
    s_lshl_b32 s83, s81, 3
    s_add_u32 s83, s83, s30
    s_lshl_b32 s84, s81, 4
    s_add_u32 s84, s84, s79
    s_cmp_eq_u32 s80, 0
    s_cselect_b32 s83, s83, s84
    s_lshl_b32 s83, s83, 18
    s_add_u32 s36, s10, s83
    s_addc_u32 s37, s11, 0
    s_mov_b32 s38, 262144
    s_mov_b32 s39, 0x20000
    s_add_u32 s40, s12, s83
    s_addc_u32 s41, s13, 0
    s_mov_b32 s42, 262144
    s_mov_b32 s43, 0x20000
    s_mul_i32 s84, s79, 229376
    s_add_u32 s48, s16, s84
    s_addc_u32 s49, s17, 0
    s_mov_b32 s50, 229376
    s_mov_b32 s51, 0x20000
    s_lshl_b32 s83, s87, 4
    s_add_u32 s84, s83, s79
    s_mul_i32 s84, s84, 100352
    s_add_u32 s84, s84, 1048576
    s_add_u32 s52, s28, s84
    s_addc_u32 s53, s29, 0
    s_mov_b32 s54, 100352
    s_mov_b32 s55, 0x20000
    s_mul_i32 s83, s83, 100352
    s_mul_i32 s84, s79, 7168
    s_add_u32 s83, s83, s84
    s_add_u32 s83, s83, 1048576
    s_add_u32 s56, s28, s83
    s_addc_u32 s57, s29, 0
    s_sub_u32 s58, 1605632, s84
    s_mov_b32 s59, 0x20000
    s_mul_i32 s83, s80, 896
    s_lshl_b32 s84, s79, 6
    s_add_u32 s84, s83, s84
    s_mul_i32 s83, s81, 200704
    s_add_u32 s83, s83, s84
    s_add_u32 s60, s24, s83
    s_addc_u32 s61, s25, 0
    s_sub_u32 s62, 200704, s84
    s_mov_b32 s63, 0x20000
    s_mov_b32 s64, s26
    s_mov_b32 s65, s27
    s_mov_b32 s66, 256
    s_mov_b32 s67, 0x20000
    s_waitcnt vmcnt(25)
    s_barrier
    s_waitcnt vmcnt(23)
    ds_read_b128 a[0:3], v198 offset:49152
    ds_read_b64_tr_b16 a[176:177], v28 offset:0
    ds_read_b64_tr_b16 a[178:179], v28 offset:512
    ds_read_b64_tr_b16 a[180:181], v29 offset:0
    ds_read_b64_tr_b16 a[182:183], v29 offset:512
    ds_read_b64_tr_b16 a[184:185], v30 offset:0
    ds_read_b64_tr_b16 a[186:187], v30 offset:512
    ds_read_b64_tr_b16 a[188:189], v31 offset:0
    ds_read_b64_tr_b16 a[190:191], v31 offset:512
    ds_read_b128 a[8:11], v206 offset:49152
    ds_read_b64_tr_b16 a[192:193], v28 offset:4096
    ds_read_b64_tr_b16 a[194:195], v28 offset:4608
    ds_read_b64_tr_b16 a[196:197], v29 offset:4096
    ds_read_b64_tr_b16 a[198:199], v29 offset:4608
    ds_read_b64_tr_b16 a[200:201], v30 offset:4096
    ds_read_b64_tr_b16 a[202:203], v30 offset:4608
    ds_read_b64_tr_b16 a[204:205], v31 offset:4096
    ds_read_b64_tr_b16 a[206:207], v31 offset:4608
    s_waitcnt lgkmcnt(9)
    v_mfma_f32_16x16x32_bf16 v[128:131], a[176:179], a[0:3], 0
    ds_read_b64_tr_b16 a[208:209], v28 offset:8192
    ds_read_b64_tr_b16 a[210:211], v28 offset:8704
    v_mfma_f32_16x16x32_bf16 v[136:139], a[180:183], a[0:3], 0
    ds_read_b64_tr_b16 a[212:213], v29 offset:8192
    ds_read_b64_tr_b16 a[214:215], v29 offset:8704
    s_waitcnt vmcnt(21)
    ds_read_b128 a[16:19], v198 offset:0
    v_mfma_f32_16x16x32_bf16 v[144:147], a[184:187], a[0:3], 0
    ds_read_b64_tr_b16 a[216:217], v30 offset:8192
    ds_read_b64_tr_b16 a[218:219], v30 offset:8704
    v_mfma_f32_16x16x32_bf16 v[152:155], a[188:191], a[0:3], 0
    ds_read_b64_tr_b16 a[220:221], v31 offset:8192
    ds_read_b64_tr_b16 a[222:223], v31 offset:8704
    s_waitcnt lgkmcnt(9)
    v_mfma_f32_16x16x32_bf16 v[128:131], a[192:195], a[8:11], v[128:131]
    ds_read_b64_tr_b16 a[176:177], v28 offset:12288
    ds_read_b64_tr_b16 a[178:179], v28 offset:12800
    s_add_u32 m0, s74, 49152
    s_mov_b32 s77, 768
    buffer_load_dwordx4 v197, s[32:35], s77 offen offset:0 lds
    v_mfma_f32_16x16x32_bf16 v[136:139], a[196:199], a[8:11], v[136:139]
    ds_read_b64_tr_b16 a[180:181], v29 offset:12288
    ds_read_b64_tr_b16 a[182:183], v29 offset:12800
    ds_read_b128 a[24:27], v206 offset:0
    buffer_load_dwordx4 v205, s[32:35], s77 offen offset:1024 lds
    v_mfma_f32_16x16x32_bf16 v[144:147], a[200:203], a[8:11], v[144:147]
    ds_read_b64_tr_b16 a[184:185], v30 offset:12288
    ds_read_b64_tr_b16 a[186:187], v30 offset:12800
    v_mfma_f32_16x16x32_bf16 v[152:155], a[204:207], a[8:11], v[152:155]
    ds_read_b64_tr_b16 a[188:189], v31 offset:12288
    ds_read_b64_tr_b16 a[190:191], v31 offset:12800
    s_waitcnt lgkmcnt(9)
    v_mfma_f32_16x16x32_bf16 v[128:131], a[208:211], a[16:19], v[128:131]
    s_waitcnt vmcnt(19) lgkmcnt(4)
    s_barrier
    ds_read_b64_tr_b16 a[192:193], v28 offset:16384
    ds_read_b64_tr_b16 a[194:195], v28 offset:16896
    v_mfma_f32_16x16x32_bf16 v[136:139], a[212:215], a[16:19], v[136:139]
    ds_read_b64_tr_b16 a[196:197], v29 offset:16384
    ds_read_b64_tr_b16 a[198:199], v29 offset:16896
    s_waitcnt vmcnt(17)
    ds_read_b128 a[32:35], v198 offset:16384
    v_mfma_f32_16x16x32_bf16 v[144:147], a[216:219], a[16:19], v[144:147]
    ds_read_b64_tr_b16 a[200:201], v30 offset:16384
    ds_read_b64_tr_b16 a[202:203], v30 offset:16896
    v_mfma_f32_16x16x32_bf16 v[152:155], a[220:223], a[16:19], v[152:155]
    ds_read_b64_tr_b16 a[204:205], v31 offset:16384
    ds_read_b64_tr_b16 a[206:207], v31 offset:16896
    s_waitcnt lgkmcnt(9)
    v_mfma_f32_16x16x32_bf16 v[128:131], a[176:179], a[24:27], v[128:131]
    ds_read_b64_tr_b16 a[208:209], v28 offset:20480
    ds_read_b64_tr_b16 a[210:211], v28 offset:20992
    s_mov_b32 m0, 0
    s_mov_b32 s77, 0
    v_mfma_f32_16x16x32_bf16 v[136:139], a[180:183], a[24:27], v[136:139]
    ds_read_b64_tr_b16 a[212:213], v29 offset:20480
    ds_read_b64_tr_b16 a[214:215], v29 offset:20992
    ds_read_b128 a[40:43], v206 offset:16384
    buffer_load_dwordx4 v132, s[36:39], s77 offen offset:0 nt lds
    v_mfma_f32_16x16x32_bf16 v[144:147], a[184:187], a[24:27], v[144:147]
    ds_read_b64_tr_b16 a[216:217], v30 offset:20480
    ds_read_b64_tr_b16 a[218:219], v30 offset:20992
    buffer_load_dwordx4 v140, s[36:39], s77 offen offset:1024 nt lds
    v_mfma_f32_16x16x32_bf16 v[152:155], a[188:191], a[24:27], v[152:155]
    ds_read_b64_tr_b16 a[220:221], v31 offset:20480
    ds_read_b64_tr_b16 a[222:223], v31 offset:20992
    buffer_load_dwordx4 v148, s[36:39], s77 offen offset:2048 nt lds
    s_waitcnt lgkmcnt(9)
    v_mfma_f32_16x16x32_bf16 v[128:131], a[192:195], a[32:35], v[128:131]
    ds_read_b64_tr_b16 a[176:177], v28 offset:24576
    ds_read_b64_tr_b16 a[178:179], v28 offset:25088
    buffer_load_dwordx4 v156, s[36:39], s77 offen offset:3072 nt lds
    s_mov_b32 m0, 4096
    s_mov_b32 s77, 4096
    v_mfma_f32_16x16x32_bf16 v[136:139], a[196:199], a[32:35], v[136:139]
    ds_read_b64_tr_b16 a[180:181], v29 offset:24576
    ds_read_b64_tr_b16 a[182:183], v29 offset:25088
    s_waitcnt vmcnt(19)
    ds_read_b128 a[48:51], v214 offset:0
    buffer_load_dwordx4 v164, s[36:39], s77 offen offset:0 nt lds
    v_mfma_f32_16x16x32_bf16 v[144:147], a[200:203], a[32:35], v[144:147]
    ds_read_b64_tr_b16 a[184:185], v30 offset:24576
    ds_read_b64_tr_b16 a[186:187], v30 offset:25088
    buffer_load_dwordx4 v172, s[36:39], s77 offen offset:1024 nt lds
    v_mfma_f32_16x16x32_bf16 v[152:155], a[204:207], a[32:35], v[152:155]
    ds_read_b64_tr_b16 a[188:189], v31 offset:24576
    ds_read_b64_tr_b16 a[190:191], v31 offset:25088
    buffer_load_dwordx4 v180, s[36:39], s77 offen offset:2048 nt lds
    s_waitcnt lgkmcnt(9)
    v_mfma_f32_16x16x32_bf16 v[128:131], a[208:211], a[40:43], v[128:131]
    ds_read_b64_tr_b16 a[192:193], v28 offset:28672
    ds_read_b64_tr_b16 a[194:195], v28 offset:29184
    buffer_load_dwordx4 v188, s[36:39], s77 offen offset:3072 nt lds
    s_mov_b32 m0, 8192
    s_mov_b32 s77, 8192
    v_mfma_f32_16x16x32_bf16 v[136:139], a[212:215], a[40:43], v[136:139]
    ds_read_b64_tr_b16 a[196:197], v29 offset:28672
    ds_read_b64_tr_b16 a[198:199], v29 offset:29184
    ds_read_b128 a[56:59], v222 offset:0
    buffer_load_dwordx4 v132, s[36:39], s77 offen offset:0 nt lds
    v_mfma_f32_16x16x32_bf16 v[144:147], a[216:219], a[40:43], v[144:147]
    ds_read_b64_tr_b16 a[200:201], v30 offset:28672
    ds_read_b64_tr_b16 a[202:203], v30 offset:29184
    buffer_load_dwordx4 v140, s[36:39], s77 offen offset:1024 nt lds
    v_mfma_f32_16x16x32_bf16 v[152:155], a[220:223], a[40:43], v[152:155]
    ds_read_b64_tr_b16 a[204:205], v31 offset:28672
    ds_read_b64_tr_b16 a[206:207], v31 offset:29184
    buffer_load_dwordx4 v148, s[36:39], s77 offen offset:2048 nt lds
    buffer_load_dwordx4 v156, s[36:39], s77 offen offset:3072 nt lds
    s_mov_b32 m0, 12288
    s_mov_b32 s77, 12288
    buffer_load_dwordx4 v164, s[36:39], s77 offen offset:0 nt lds
    buffer_load_dwordx4 v172, s[36:39], s77 offen offset:1024 nt lds
    buffer_load_dwordx4 v180, s[36:39], s77 offen offset:2048 nt lds
    buffer_load_dwordx4 v188, s[36:39], s77 offen offset:3072 nt lds
    s_waitcnt lgkmcnt(9)
    v_mfma_f32_16x16x32_bf16 v[128:131], a[176:179], a[48:51], v[128:131]
    s_waitcnt vmcnt(26) lgkmcnt(4)
    s_barrier
    ds_read_b64_tr_b16 a[208:209], v28 offset:32768
    ds_read_b64_tr_b16 a[210:211], v28 offset:33280
    v_mfma_f32_16x16x32_bf16 v[136:139], a[180:183], a[48:51], v[136:139]
    ds_read_b64_tr_b16 a[212:213], v29 offset:32768
    ds_read_b64_tr_b16 a[214:215], v29 offset:33280
    s_waitcnt vmcnt(24)
    ds_read_b128 a[64:67], v198 offset:32768
    v_mfma_f32_16x16x32_bf16 v[144:147], a[184:187], a[48:51], v[144:147]
    ds_read_b64_tr_b16 a[216:217], v30 offset:32768
    ds_read_b64_tr_b16 a[218:219], v30 offset:33280
    v_mfma_f32_16x16x32_bf16 v[152:155], a[188:191], a[48:51], v[152:155]
    ds_read_b64_tr_b16 a[220:221], v31 offset:32768
    ds_read_b64_tr_b16 a[222:223], v31 offset:33280
    s_waitcnt lgkmcnt(9)
    v_mfma_f32_16x16x32_bf16 v[128:131], a[192:195], a[56:59], v[128:131]
    ds_read_b64_tr_b16 a[176:177], v28 offset:36864
    ds_read_b64_tr_b16 a[178:179], v28 offset:37376
    s_mov_b32 m0, 16384
    s_mov_b32 s77, 16384
    v_mfma_f32_16x16x32_bf16 v[136:139], a[196:199], a[56:59], v[136:139]
    ds_read_b64_tr_b16 a[180:181], v29 offset:36864
    ds_read_b64_tr_b16 a[182:183], v29 offset:37376
    ds_read_b128 a[72:75], v206 offset:32768
    buffer_load_dwordx4 v132, s[36:39], s77 offen offset:0 nt lds
    v_mfma_f32_16x16x32_bf16 v[144:147], a[200:203], a[56:59], v[144:147]
    ds_read_b64_tr_b16 a[184:185], v30 offset:36864
    ds_read_b64_tr_b16 a[186:187], v30 offset:37376
    buffer_load_dwordx4 v140, s[36:39], s77 offen offset:1024 nt lds
    v_mfma_f32_16x16x32_bf16 v[152:155], a[204:207], a[56:59], v[152:155]
    ds_read_b64_tr_b16 a[188:189], v31 offset:36864
    ds_read_b64_tr_b16 a[190:191], v31 offset:37376
    buffer_load_dwordx4 v148, s[36:39], s77 offen offset:2048 nt lds
    s_waitcnt lgkmcnt(9)
    v_mfma_f32_16x16x32_bf16 v[128:131], a[208:211], a[64:67], v[128:131]
    ds_read_b64_tr_b16 a[192:193], v28 offset:40960
    ds_read_b64_tr_b16 a[194:195], v28 offset:41472
    buffer_load_dwordx4 v156, s[36:39], s77 offen offset:3072 nt lds
    s_mov_b32 m0, 20480
    s_mov_b32 s77, 20480
    v_mfma_f32_16x16x32_bf16 v[136:139], a[212:215], a[64:67], v[136:139]
    ds_read_b64_tr_b16 a[196:197], v29 offset:40960
    ds_read_b64_tr_b16 a[198:199], v29 offset:41472
    s_waitcnt vmcnt(26)
    ds_read_b128 a[80:83], v214 offset:16384
    buffer_load_dwordx4 v164, s[36:39], s77 offen offset:0 nt lds
    v_mfma_f32_16x16x32_bf16 v[144:147], a[216:219], a[64:67], v[144:147]
    ds_read_b64_tr_b16 a[200:201], v30 offset:40960
    ds_read_b64_tr_b16 a[202:203], v30 offset:41472
    buffer_load_dwordx4 v172, s[36:39], s77 offen offset:1024 nt lds
    v_mfma_f32_16x16x32_bf16 v[152:155], a[220:223], a[64:67], v[152:155]
    ds_read_b64_tr_b16 a[204:205], v31 offset:40960
    ds_read_b64_tr_b16 a[206:207], v31 offset:41472
    buffer_load_dwordx4 v180, s[36:39], s77 offen offset:2048 nt lds
    s_waitcnt lgkmcnt(9)
    v_mfma_f32_16x16x32_bf16 v[128:131], a[176:179], a[72:75], v[128:131]
    ds_read_b64_tr_b16 a[208:209], v28 offset:45056
    ds_read_b64_tr_b16 a[210:211], v28 offset:45568
    buffer_load_dwordx4 v188, s[36:39], s77 offen offset:3072 nt lds
    s_mov_b32 m0, 24576
    s_mov_b32 s77, 24576
    v_mfma_f32_16x16x32_bf16 v[136:139], a[180:183], a[72:75], v[136:139]
    ds_read_b64_tr_b16 a[212:213], v29 offset:45056
    ds_read_b64_tr_b16 a[214:215], v29 offset:45568
    ds_read_b128 a[88:91], v222 offset:16384
    buffer_load_dwordx4 v132, s[36:39], s77 offen offset:0 nt lds
    v_mfma_f32_16x16x32_bf16 v[144:147], a[184:187], a[72:75], v[144:147]
    ds_read_b64_tr_b16 a[216:217], v30 offset:45056
    ds_read_b64_tr_b16 a[218:219], v30 offset:45568
    buffer_load_dwordx4 v140, s[36:39], s77 offen offset:1024 nt lds
    v_mfma_f32_16x16x32_bf16 v[152:155], a[188:191], a[72:75], v[152:155]
    ds_read_b64_tr_b16 a[220:221], v31 offset:45056
    ds_read_b64_tr_b16 a[222:223], v31 offset:45568
    buffer_load_dwordx4 v148, s[36:39], s77 offen offset:2048 nt lds
    buffer_load_dwordx4 v156, s[36:39], s77 offen offset:3072 nt lds
    s_mov_b32 m0, 28672
    s_mov_b32 s77, 28672
    buffer_load_dwordx4 v164, s[36:39], s77 offen offset:0 nt lds
    buffer_load_dwordx4 v172, s[36:39], s77 offen offset:1024 nt lds
    buffer_load_dwordx4 v180, s[36:39], s77 offen offset:2048 nt lds
    buffer_load_dwordx4 v188, s[36:39], s77 offen offset:3072 nt lds
    s_waitcnt lgkmcnt(9)
    v_mfma_f32_16x16x32_bf16 v[128:131], a[192:195], a[80:83], v[128:131]
    s_waitcnt vmcnt(34) lgkmcnt(4)
    s_barrier
    ds_read_b64_tr_b16 a[176:177], v28 offset:49152
    ds_read_b64_tr_b16 a[178:179], v28 offset:49664
    v_mfma_f32_16x16x32_bf16 v[136:139], a[196:199], a[80:83], v[136:139]
    ds_read_b64_tr_b16 a[180:181], v29 offset:49152
    ds_read_b64_tr_b16 a[182:183], v29 offset:49664
    s_waitcnt vmcnt(32)
    ds_read_b128 a[96:99], v198 offset:49152
    v_mfma_f32_16x16x32_bf16 v[144:147], a[200:203], a[80:83], v[144:147]
    ds_read_b64_tr_b16 a[184:185], v30 offset:49152
    ds_read_b64_tr_b16 a[186:187], v30 offset:49664
    v_mfma_f32_16x16x32_bf16 v[152:155], a[204:207], a[80:83], v[152:155]
    ds_read_b64_tr_b16 a[188:189], v31 offset:49152
    ds_read_b64_tr_b16 a[190:191], v31 offset:49664
    s_waitcnt lgkmcnt(9)
    v_mfma_f32_16x16x32_bf16 v[128:131], a[208:211], a[88:91], v[128:131]
    ds_read_b64_tr_b16 a[192:193], v28 offset:53248
    ds_read_b64_tr_b16 a[194:195], v28 offset:53760
    s_mov_b32 m0, 131072
    s_mov_b32 s77, 0
    v_mfma_f32_16x16x32_bf16 v[136:139], a[212:215], a[88:91], v[136:139]
    ds_read_b64_tr_b16 a[196:197], v29 offset:53248
    ds_read_b64_tr_b16 a[198:199], v29 offset:53760
    ds_read_b128 a[104:107], v206 offset:49152
    buffer_load_dwordx4 v32, s[40:43], s77 offen offset:0 nt lds
    v_mfma_f32_16x16x32_bf16 v[144:147], a[216:219], a[88:91], v[144:147]
    ds_read_b64_tr_b16 a[200:201], v30 offset:53248
    ds_read_b64_tr_b16 a[202:203], v30 offset:53760
    buffer_load_dwordx4 v33, s[40:43], s77 offen offset:1024 nt lds
    v_mfma_f32_16x16x32_bf16 v[152:155], a[220:223], a[88:91], v[152:155]
    ds_read_b64_tr_b16 a[204:205], v31 offset:53248
    ds_read_b64_tr_b16 a[206:207], v31 offset:53760
    buffer_load_dwordx4 v34, s[40:43], s77 offen offset:2048 nt lds
    s_waitcnt lgkmcnt(9)
    v_mfma_f32_16x16x32_bf16 v[128:131], a[176:179], a[96:99], v[128:131]
    ds_read_b64_tr_b16 a[208:209], v28 offset:57344
    ds_read_b64_tr_b16 a[210:211], v28 offset:57856
    buffer_load_dwordx4 v35, s[40:43], s77 offen offset:3072 nt lds
    s_mov_b32 m0, 135168
    s_mov_b32 s77, 4096
    v_mfma_f32_16x16x32_bf16 v[136:139], a[180:183], a[96:99], v[136:139]
    ds_read_b64_tr_b16 a[212:213], v29 offset:57344
    ds_read_b64_tr_b16 a[214:215], v29 offset:57856
    buffer_load_dwordx4 v32, s[40:43], s77 offen offset:0 nt lds
    v_mfma_f32_16x16x32_bf16 v[144:147], a[184:187], a[96:99], v[144:147]
    ds_read_b64_tr_b16 a[216:217], v30 offset:57344
    ds_read_b64_tr_b16 a[218:219], v30 offset:57856
    buffer_load_dwordx4 v33, s[40:43], s77 offen offset:1024 nt lds
    v_mfma_f32_16x16x32_bf16 v[152:155], a[188:191], a[96:99], v[152:155]
    ds_read_b64_tr_b16 a[220:221], v31 offset:57344
    ds_read_b64_tr_b16 a[222:223], v31 offset:57856
    buffer_load_dwordx4 v34, s[40:43], s77 offen offset:2048 nt lds
    s_waitcnt lgkmcnt(8)
    v_mfma_f32_16x16x32_bf16 v[128:131], a[192:195], a[104:107], v[128:131]
    ds_read_b64_tr_b16 a[176:177], v28 offset:61440
    ds_read_b64_tr_b16 a[178:179], v28 offset:61952
    buffer_load_dwordx4 v35, s[40:43], s77 offen offset:3072 nt lds
    s_mov_b32 m0, 139264
    s_mov_b32 s77, 8192
    v_mfma_f32_16x16x32_bf16 v[136:139], a[196:199], a[104:107], v[136:139]
    ds_read_b64_tr_b16 a[180:181], v29 offset:61440
    ds_read_b64_tr_b16 a[182:183], v29 offset:61952
    buffer_load_dwordx4 v32, s[40:43], s77 offen offset:0 nt lds
    v_mfma_f32_16x16x32_bf16 v[144:147], a[200:203], a[104:107], v[144:147]
    ds_read_b64_tr_b16 a[184:185], v30 offset:61440
    ds_read_b64_tr_b16 a[186:187], v30 offset:61952
    buffer_load_dwordx4 v33, s[40:43], s77 offen offset:1024 nt lds
    v_mfma_f32_16x16x32_bf16 v[152:155], a[204:207], a[104:107], v[152:155]
    ds_read_b64_tr_b16 a[188:189], v31 offset:61440
    ds_read_b64_tr_b16 a[190:191], v31 offset:61952
    buffer_load_dwordx4 v34, s[40:43], s77 offen offset:2048 nt lds
    buffer_load_dwordx4 v35, s[40:43], s77 offen offset:3072 nt lds
    s_mov_b32 m0, 143360
    s_mov_b32 s77, 12288
    buffer_load_dwordx4 v32, s[40:43], s77 offen offset:0 nt lds
    buffer_load_dwordx4 v33, s[40:43], s77 offen offset:1024 nt lds
    buffer_load_dwordx4 v34, s[40:43], s77 offen offset:2048 nt lds
    buffer_load_dwordx4 v35, s[40:43], s77 offen offset:3072 nt lds
    s_waitcnt lgkmcnt(8)
    v_mfma_f32_16x16x32_bf16 v[160:163], a[208:211], a[0:3], 0
    s_barrier
    ds_read_b64_tr_b16 a[192:193], v28 offset:0
    ds_read_b64_tr_b16 a[194:195], v28 offset:512
    v_mfma_f32_16x16x32_bf16 v[168:171], a[212:215], a[0:3], 0
    ds_read_b64_tr_b16 a[196:197], v29 offset:0
    ds_read_b64_tr_b16 a[198:199], v29 offset:512
    v_mfma_f32_16x16x32_bf16 v[176:179], a[216:219], a[0:3], 0
    ds_read_b64_tr_b16 a[200:201], v30 offset:0
    ds_read_b64_tr_b16 a[202:203], v30 offset:512
    v_mul_f32 v128, s75, v128
    v_mfma_f32_16x16x32_bf16 v[184:187], a[220:223], a[0:3], 0
    ds_read_b64_tr_b16 a[204:205], v31 offset:0
    ds_read_b64_tr_b16 a[206:207], v31 offset:512
    v_mul_f32 v129, s75, v129
    s_waitcnt lgkmcnt(8)
    v_mfma_f32_16x16x32_bf16 v[160:163], a[176:179], a[8:11], v[160:163]
    ds_read_b64_tr_b16 a[208:209], v28 offset:4096
    ds_read_b64_tr_b16 a[210:211], v28 offset:4608
    v_mul_f32 v130, s75, v130
    v_mfma_f32_16x16x32_bf16 v[168:171], a[180:183], a[8:11], v[168:171]
    ds_read_b64_tr_b16 a[212:213], v29 offset:4096
    ds_read_b64_tr_b16 a[214:215], v29 offset:4608
    v_mul_f32 v131, s75, v131
    v_mfma_f32_16x16x32_bf16 v[176:179], a[184:187], a[8:11], v[176:179]
    ds_read_b64_tr_b16 a[216:217], v30 offset:4096
    ds_read_b64_tr_b16 a[218:219], v30 offset:4608
    v_mul_f32 v136, s75, v136
    v_mfma_f32_16x16x32_bf16 v[184:187], a[188:191], a[8:11], v[184:187]
    ds_read_b64_tr_b16 a[220:221], v31 offset:4096
    ds_read_b64_tr_b16 a[222:223], v31 offset:4608
    v_mul_f32 v137, s75, v137
    s_waitcnt lgkmcnt(8)
    v_mfma_f32_16x16x32_bf16 v[160:163], a[192:195], a[16:19], v[160:163]
    ds_read_b64_tr_b16 a[176:177], v28 offset:8192
    ds_read_b64_tr_b16 a[178:179], v28 offset:8704
    v_mul_f32 v138, s75, v138
    v_mfma_f32_16x16x32_bf16 v[168:171], a[196:199], a[16:19], v[168:171]
    ds_read_b64_tr_b16 a[180:181], v29 offset:8192
    ds_read_b64_tr_b16 a[182:183], v29 offset:8704
    v_mul_f32 v139, s75, v139
    v_mfma_f32_16x16x32_bf16 v[176:179], a[200:203], a[16:19], v[176:179]
    ds_read_b64_tr_b16 a[184:185], v30 offset:8192
    ds_read_b64_tr_b16 a[186:187], v30 offset:8704
    v_cvt_pk_bf16_f32 v128, v128, v129
    v_mfma_f32_16x16x32_bf16 v[184:187], a[204:207], a[16:19], v[184:187]
    ds_read_b64_tr_b16 a[188:189], v31 offset:8192
    ds_read_b64_tr_b16 a[190:191], v31 offset:8704
    v_cvt_pk_bf16_f32 v136, v136, v137
    s_waitcnt lgkmcnt(8)
    v_mfma_f32_16x16x32_bf16 v[160:163], a[208:211], a[24:27], v[160:163]
    ds_read_b64_tr_b16 a[192:193], v28 offset:12288
    ds_read_b64_tr_b16 a[194:195], v28 offset:12800
    v_cvt_pk_bf16_f32 v129, v130, v131
    v_mfma_f32_16x16x32_bf16 v[168:171], a[212:215], a[24:27], v[168:171]
    ds_read_b64_tr_b16 a[196:197], v29 offset:12288
    ds_read_b64_tr_b16 a[198:199], v29 offset:12800
    v_cvt_pk_bf16_f32 v137, v138, v139
    v_mfma_f32_16x16x32_bf16 v[176:179], a[216:219], a[24:27], v[176:179]
    ds_read_b64_tr_b16 a[200:201], v30 offset:12288
    ds_read_b64_tr_b16 a[202:203], v30 offset:12800
    v_permlane16_swap_b32 v128, v136
    v_mfma_f32_16x16x32_bf16 v[184:187], a[220:223], a[24:27], v[184:187]
    ds_read_b64_tr_b16 a[204:205], v31 offset:12288
    ds_read_b64_tr_b16 a[206:207], v31 offset:12800
    v_permlane16_swap_b32 v129, v137
    s_waitcnt lgkmcnt(8)
    v_mfma_f32_16x16x32_bf16 v[160:163], a[176:179], a[32:35], v[160:163]
    s_barrier
    ds_read_b64_tr_b16 a[208:209], v28 offset:16384
    ds_read_b64_tr_b16 a[210:211], v28 offset:16896
    v_accvgpr_write_b32 a112, v128
    v_mfma_f32_16x16x32_bf16 v[168:171], a[180:183], a[32:35], v[168:171]
    ds_read_b64_tr_b16 a[212:213], v29 offset:16384
    ds_read_b64_tr_b16 a[214:215], v29 offset:16896
    v_accvgpr_write_b32 a114, v136
    v_mfma_f32_16x16x32_bf16 v[176:179], a[184:187], a[32:35], v[176:179]
    ds_read_b64_tr_b16 a[216:217], v30 offset:16384
    ds_read_b64_tr_b16 a[218:219], v30 offset:16896
    v_accvgpr_write_b32 a113, v129
    v_mfma_f32_16x16x32_bf16 v[184:187], a[188:191], a[32:35], v[184:187]
    ds_read_b64_tr_b16 a[220:221], v31 offset:16384
    ds_read_b64_tr_b16 a[222:223], v31 offset:16896
    v_accvgpr_write_b32 a115, v137
    s_waitcnt lgkmcnt(8)
    v_mfma_f32_16x16x32_bf16 v[160:163], a[192:195], a[40:43], v[160:163]
    ds_read_b64_tr_b16 a[176:177], v28 offset:20480
    ds_read_b64_tr_b16 a[178:179], v28 offset:20992
    s_mov_b32 m0, 32768
    s_mov_b32 s77, 32768
    v_mfma_f32_16x16x32_bf16 v[168:171], a[196:199], a[40:43], v[168:171]
    ds_read_b64_tr_b16 a[180:181], v29 offset:20480
    ds_read_b64_tr_b16 a[182:183], v29 offset:20992
    v_mul_f32 v144, s75, v144
    buffer_load_dwordx4 v132, s[36:39], s77 offen offset:0 nt lds
    v_mfma_f32_16x16x32_bf16 v[176:179], a[200:203], a[40:43], v[176:179]
    ds_read_b64_tr_b16 a[184:185], v30 offset:20480
    ds_read_b64_tr_b16 a[186:187], v30 offset:20992
    v_mul_f32 v145, s75, v145
    buffer_load_dwordx4 v140, s[36:39], s77 offen offset:1024 nt lds
    v_mfma_f32_16x16x32_bf16 v[184:187], a[204:207], a[40:43], v[184:187]
    ds_read_b64_tr_b16 a[188:189], v31 offset:20480
    ds_read_b64_tr_b16 a[190:191], v31 offset:20992
    v_mul_f32 v146, s75, v146
    buffer_load_dwordx4 v148, s[36:39], s77 offen offset:2048 nt lds
    s_waitcnt lgkmcnt(8)
    v_mfma_f32_16x16x32_bf16 v[160:163], a[208:211], a[48:51], v[160:163]
    ds_read_b64_tr_b16 a[192:193], v28 offset:24576
    ds_read_b64_tr_b16 a[194:195], v28 offset:25088
    v_mul_f32 v147, s75, v147
    buffer_load_dwordx4 v156, s[36:39], s77 offen offset:3072 nt lds
    s_mov_b32 m0, 36864
    s_mov_b32 s77, 36864
    v_mfma_f32_16x16x32_bf16 v[168:171], a[212:215], a[48:51], v[168:171]
    ds_read_b64_tr_b16 a[196:197], v29 offset:24576
    ds_read_b64_tr_b16 a[198:199], v29 offset:25088
    v_mul_f32 v152, s75, v152
    buffer_load_dwordx4 v164, s[36:39], s77 offen offset:0 nt lds
    v_mfma_f32_16x16x32_bf16 v[176:179], a[216:219], a[48:51], v[176:179]
    ds_read_b64_tr_b16 a[200:201], v30 offset:24576
    ds_read_b64_tr_b16 a[202:203], v30 offset:25088
    v_mul_f32 v153, s75, v153
    buffer_load_dwordx4 v172, s[36:39], s77 offen offset:1024 nt lds
    v_mfma_f32_16x16x32_bf16 v[184:187], a[220:223], a[48:51], v[184:187]
    ds_read_b64_tr_b16 a[204:205], v31 offset:24576
    ds_read_b64_tr_b16 a[206:207], v31 offset:25088
    v_mul_f32 v154, s75, v154
    buffer_load_dwordx4 v180, s[36:39], s77 offen offset:2048 nt lds
    s_waitcnt lgkmcnt(8)
    v_mfma_f32_16x16x32_bf16 v[160:163], a[176:179], a[56:59], v[160:163]
    ds_read_b64_tr_b16 a[208:209], v28 offset:28672
    ds_read_b64_tr_b16 a[210:211], v28 offset:29184
    v_mul_f32 v155, s75, v155
    buffer_load_dwordx4 v188, s[36:39], s77 offen offset:3072 nt lds
    s_mov_b32 m0, 40960
    s_mov_b32 s77, 40960
    v_mfma_f32_16x16x32_bf16 v[168:171], a[180:183], a[56:59], v[168:171]
    ds_read_b64_tr_b16 a[212:213], v29 offset:28672
    ds_read_b64_tr_b16 a[214:215], v29 offset:29184
    v_cvt_pk_bf16_f32 v144, v144, v145
    buffer_load_dwordx4 v132, s[36:39], s77 offen offset:0 nt lds
    v_mfma_f32_16x16x32_bf16 v[176:179], a[184:187], a[56:59], v[176:179]
    ds_read_b64_tr_b16 a[216:217], v30 offset:28672
    ds_read_b64_tr_b16 a[218:219], v30 offset:29184
    v_cvt_pk_bf16_f32 v152, v152, v153
    buffer_load_dwordx4 v140, s[36:39], s77 offen offset:1024 nt lds
    v_mfma_f32_16x16x32_bf16 v[184:187], a[188:191], a[56:59], v[184:187]
    ds_read_b64_tr_b16 a[220:221], v31 offset:28672
    ds_read_b64_tr_b16 a[222:223], v31 offset:29184
    v_cvt_pk_bf16_f32 v145, v146, v147
    buffer_load_dwordx4 v148, s[36:39], s77 offen offset:2048 nt lds
    buffer_load_dwordx4 v156, s[36:39], s77 offen offset:3072 nt lds
    s_mov_b32 m0, 45056
    s_mov_b32 s77, 45056
    buffer_load_dwordx4 v164, s[36:39], s77 offen offset:0 nt lds
    buffer_load_dwordx4 v172, s[36:39], s77 offen offset:1024 nt lds
    buffer_load_dwordx4 v180, s[36:39], s77 offen offset:2048 nt lds
    buffer_load_dwordx4 v188, s[36:39], s77 offen offset:3072 nt lds
    s_waitcnt lgkmcnt(8)
    v_mfma_f32_16x16x32_bf16 v[160:163], a[192:195], a[64:67], v[160:163]
    s_barrier
    ds_read_b64_tr_b16 a[176:177], v28 offset:32768
    ds_read_b64_tr_b16 a[178:179], v28 offset:33280
    v_cvt_pk_bf16_f32 v153, v154, v155
    v_mfma_f32_16x16x32_bf16 v[168:171], a[196:199], a[64:67], v[168:171]
    ds_read_b64_tr_b16 a[180:181], v29 offset:32768
    ds_read_b64_tr_b16 a[182:183], v29 offset:33280
    v_permlane16_swap_b32 v144, v152
    v_mfma_f32_16x16x32_bf16 v[176:179], a[200:203], a[64:67], v[176:179]
    ds_read_b64_tr_b16 a[184:185], v30 offset:32768
    ds_read_b64_tr_b16 a[186:187], v30 offset:33280
    v_permlane16_swap_b32 v145, v153
    v_mfma_f32_16x16x32_bf16 v[184:187], a[204:207], a[64:67], v[184:187]
    ds_read_b64_tr_b16 a[188:189], v31 offset:32768
    ds_read_b64_tr_b16 a[190:191], v31 offset:33280
    v_accvgpr_write_b32 a120, v144
    s_waitcnt lgkmcnt(8)
    v_mfma_f32_16x16x32_bf16 v[160:163], a[208:211], a[72:75], v[160:163]
    ds_read_b64_tr_b16 a[192:193], v28 offset:36864
    ds_read_b64_tr_b16 a[194:195], v28 offset:37376
    v_accvgpr_write_b32 a122, v152
    v_mfma_f32_16x16x32_bf16 v[168:171], a[212:215], a[72:75], v[168:171]
    ds_read_b64_tr_b16 a[196:197], v29 offset:36864
    ds_read_b64_tr_b16 a[198:199], v29 offset:37376
    v_accvgpr_write_b32 a121, v145
    v_mfma_f32_16x16x32_bf16 v[176:179], a[216:219], a[72:75], v[176:179]
    ds_read_b64_tr_b16 a[200:201], v30 offset:36864
    ds_read_b64_tr_b16 a[202:203], v30 offset:37376
    v_accvgpr_write_b32 a123, v153
    v_mfma_f32_16x16x32_bf16 v[184:187], a[220:223], a[72:75], v[184:187]
    ds_read_b64_tr_b16 a[204:205], v31 offset:36864
    ds_read_b64_tr_b16 a[206:207], v31 offset:37376
    s_waitcnt lgkmcnt(8)
    v_mfma_f32_16x16x32_bf16 v[160:163], a[176:179], a[80:83], v[160:163]
    ds_read_b64_tr_b16 a[208:209], v28 offset:40960
    ds_read_b64_tr_b16 a[210:211], v28 offset:41472
    v_mfma_f32_16x16x32_bf16 v[168:171], a[180:183], a[80:83], v[168:171]
    ds_read_b64_tr_b16 a[212:213], v29 offset:40960
    ds_read_b64_tr_b16 a[214:215], v29 offset:41472
    v_mfma_f32_16x16x32_bf16 v[176:179], a[184:187], a[80:83], v[176:179]
    ds_read_b64_tr_b16 a[216:217], v30 offset:40960
    ds_read_b64_tr_b16 a[218:219], v30 offset:41472
    v_mfma_f32_16x16x32_bf16 v[184:187], a[188:191], a[80:83], v[184:187]
    ds_read_b64_tr_b16 a[220:221], v31 offset:40960
    ds_read_b64_tr_b16 a[222:223], v31 offset:41472
    s_waitcnt lgkmcnt(8)
    v_mfma_f32_16x16x32_bf16 v[160:163], a[192:195], a[88:91], v[160:163]
    ds_read_b64_tr_b16 a[176:177], v28 offset:45056
    ds_read_b64_tr_b16 a[178:179], v28 offset:45568
    v_mfma_f32_16x16x32_bf16 v[168:171], a[196:199], a[88:91], v[168:171]
    ds_read_b64_tr_b16 a[180:181], v29 offset:45056
    ds_read_b64_tr_b16 a[182:183], v29 offset:45568
    v_mfma_f32_16x16x32_bf16 v[176:179], a[200:203], a[88:91], v[176:179]
    ds_read_b64_tr_b16 a[184:185], v30 offset:45056
    ds_read_b64_tr_b16 a[186:187], v30 offset:45568
    v_mfma_f32_16x16x32_bf16 v[184:187], a[204:207], a[88:91], v[184:187]
    ds_read_b64_tr_b16 a[188:189], v31 offset:45056
    ds_read_b64_tr_b16 a[190:191], v31 offset:45568
    s_waitcnt lgkmcnt(8)
    v_mfma_f32_16x16x32_bf16 v[160:163], a[208:211], a[96:99], v[160:163]
    s_barrier
    ds_read_b64_tr_b16 a[192:193], v28 offset:49152
    ds_read_b64_tr_b16 a[194:195], v28 offset:49664
    v_mfma_f32_16x16x32_bf16 v[168:171], a[212:215], a[96:99], v[168:171]
    ds_read_b64_tr_b16 a[196:197], v29 offset:49152
    ds_read_b64_tr_b16 a[198:199], v29 offset:49664
    v_mfma_f32_16x16x32_bf16 v[176:179], a[216:219], a[96:99], v[176:179]
    ds_read_b64_tr_b16 a[200:201], v30 offset:49152
    ds_read_b64_tr_b16 a[202:203], v30 offset:49664
    v_mfma_f32_16x16x32_bf16 v[184:187], a[220:223], a[96:99], v[184:187]
    ds_read_b64_tr_b16 a[204:205], v31 offset:49152
    ds_read_b64_tr_b16 a[206:207], v31 offset:49664
    s_waitcnt lgkmcnt(8)
    v_mfma_f32_16x16x32_bf16 v[160:163], a[176:179], a[104:107], v[160:163]
    ds_read_b64_tr_b16 a[208:209], v28 offset:53248
    ds_read_b64_tr_b16 a[210:211], v28 offset:53760
    s_mov_b32 m0, 147456
    s_mov_b32 s77, 16384
    v_mfma_f32_16x16x32_bf16 v[168:171], a[180:183], a[104:107], v[168:171]
    ds_read_b64_tr_b16 a[212:213], v29 offset:53248
    ds_read_b64_tr_b16 a[214:215], v29 offset:53760
    buffer_load_dwordx4 v32, s[40:43], s77 offen offset:0 nt lds
    v_mfma_f32_16x16x32_bf16 v[176:179], a[184:187], a[104:107], v[176:179]
    ds_read_b64_tr_b16 a[216:217], v30 offset:53248
    ds_read_b64_tr_b16 a[218:219], v30 offset:53760
    buffer_load_dwordx4 v33, s[40:43], s77 offen offset:1024 nt lds
    v_mfma_f32_16x16x32_bf16 v[184:187], a[188:191], a[104:107], v[184:187]
    ds_read_b64_tr_b16 a[220:221], v31 offset:53248
    ds_read_b64_tr_b16 a[222:223], v31 offset:53760
    buffer_load_dwordx4 v34, s[40:43], s77 offen offset:2048 nt lds
    s_waitcnt lgkmcnt(8)
    v_mfma_f32_16x16x32_bf16 v[128:131], a[192:195], a[0:3], 0
    ds_read_b64_tr_b16 a[176:177], v28 offset:57344
    ds_read_b64_tr_b16 a[178:179], v28 offset:57856
    buffer_load_dwordx4 v35, s[40:43], s77 offen offset:3072 nt lds
    s_mov_b32 m0, 151552
    s_mov_b32 s77, 20480
    v_mfma_f32_16x16x32_bf16 v[136:139], a[196:199], a[0:3], 0
    ds_read_b64_tr_b16 a[180:181], v29 offset:57344
    ds_read_b64_tr_b16 a[182:183], v29 offset:57856
    buffer_load_dwordx4 v32, s[40:43], s77 offen offset:0 nt lds
    v_mfma_f32_16x16x32_bf16 v[144:147], a[200:203], a[0:3], 0
    ds_read_b64_tr_b16 a[184:185], v30 offset:57344
    ds_read_b64_tr_b16 a[186:187], v30 offset:57856
    v_mul_f32 v160, s75, v160
    buffer_load_dwordx4 v33, s[40:43], s77 offen offset:1024 nt lds
    v_mfma_f32_16x16x32_bf16 v[152:155], a[204:207], a[0:3], 0
    ds_read_b64_tr_b16 a[188:189], v31 offset:57344
    ds_read_b64_tr_b16 a[190:191], v31 offset:57856
    v_mul_f32 v161, s75, v161
    buffer_load_dwordx4 v34, s[40:43], s77 offen offset:2048 nt lds
    s_waitcnt lgkmcnt(8)
    v_mfma_f32_16x16x32_bf16 v[128:131], a[208:211], a[8:11], v[128:131]
    ds_read_b64_tr_b16 a[192:193], v28 offset:61440
    ds_read_b64_tr_b16 a[194:195], v28 offset:61952
    v_mul_f32 v162, s75, v162
    buffer_load_dwordx4 v35, s[40:43], s77 offen offset:3072 nt lds
    s_mov_b32 m0, 155648
    s_mov_b32 s77, 24576
    v_mfma_f32_16x16x32_bf16 v[136:139], a[212:215], a[8:11], v[136:139]
    ds_read_b64_tr_b16 a[196:197], v29 offset:61440
    ds_read_b64_tr_b16 a[198:199], v29 offset:61952
    v_mul_f32 v163, s75, v163
    buffer_load_dwordx4 v32, s[40:43], s77 offen offset:0 nt lds
    v_mfma_f32_16x16x32_bf16 v[144:147], a[216:219], a[8:11], v[144:147]
    ds_read_b64_tr_b16 a[200:201], v30 offset:61440
    ds_read_b64_tr_b16 a[202:203], v30 offset:61952
    v_mul_f32 v168, s75, v168
    buffer_load_dwordx4 v33, s[40:43], s77 offen offset:1024 nt lds
    v_mfma_f32_16x16x32_bf16 v[152:155], a[220:223], a[8:11], v[152:155]
    ds_read_b64_tr_b16 a[204:205], v31 offset:61440
    ds_read_b64_tr_b16 a[206:207], v31 offset:61952
    v_mul_f32 v169, s75, v169
    buffer_load_dwordx4 v34, s[40:43], s77 offen offset:2048 nt lds
    buffer_load_dwordx4 v35, s[40:43], s77 offen offset:3072 nt lds
    s_mov_b32 m0, 159744
    s_mov_b32 s77, 28672
    buffer_load_dwordx4 v32, s[40:43], s77 offen offset:0 nt lds
    buffer_load_dwordx4 v33, s[40:43], s77 offen offset:1024 nt lds
    buffer_load_dwordx4 v34, s[40:43], s77 offen offset:2048 nt lds
    buffer_load_dwordx4 v35, s[40:43], s77 offen offset:3072 nt lds
    s_waitcnt lgkmcnt(8)
    v_mfma_f32_16x16x32_bf16 v[128:131], a[176:179], a[16:19], v[128:131]
    s_barrier
    ds_read_b64_tr_b16 a[208:209], v28 offset:0
    ds_read_b64_tr_b16 a[210:211], v28 offset:512
    v_mul_f32 v170, s75, v170
    v_mfma_f32_16x16x32_bf16 v[136:139], a[180:183], a[16:19], v[136:139]
    ds_read_b64_tr_b16 a[212:213], v29 offset:0
    ds_read_b64_tr_b16 a[214:215], v29 offset:512
    v_mul_f32 v171, s75, v171
    v_mfma_f32_16x16x32_bf16 v[144:147], a[184:187], a[16:19], v[144:147]
    ds_read_b64_tr_b16 a[216:217], v30 offset:0
    ds_read_b64_tr_b16 a[218:219], v30 offset:512
    v_cvt_pk_bf16_f32 v160, v160, v161
    v_mfma_f32_16x16x32_bf16 v[152:155], a[188:191], a[16:19], v[152:155]
    ds_read_b64_tr_b16 a[220:221], v31 offset:0
    ds_read_b64_tr_b16 a[222:223], v31 offset:512
    v_cvt_pk_bf16_f32 v168, v168, v169
    s_waitcnt lgkmcnt(8)
    v_mfma_f32_16x16x32_bf16 v[128:131], a[192:195], a[24:27], v[128:131]
    ds_read_b64_tr_b16 a[176:177], v28 offset:4096
    ds_read_b64_tr_b16 a[178:179], v28 offset:4608
    v_cvt_pk_bf16_f32 v161, v162, v163
    s_mov_b32 s77, 0
    v_mfma_f32_16x16x32_bf16 v[136:139], a[196:199], a[24:27], v[136:139]
    ds_read_b64_tr_b16 a[180:181], v29 offset:4096
    ds_read_b64_tr_b16 a[182:183], v29 offset:4608
    v_cvt_pk_bf16_f32 v169, v170, v171
    buffer_load_dword a255, v2, s[48:51], s77 offen
    v_mfma_f32_16x16x32_bf16 v[144:147], a[200:203], a[24:27], v[144:147]
    ds_read_b64_tr_b16 a[184:185], v30 offset:4096
    ds_read_b64_tr_b16 a[186:187], v30 offset:4608
    v_permlane16_swap_b32 v160, v168
    v_mfma_f32_16x16x32_bf16 v[152:155], a[204:207], a[24:27], v[152:155]
    ds_read_b64_tr_b16 a[188:189], v31 offset:4096
    ds_read_b64_tr_b16 a[190:191], v31 offset:4608
    v_permlane16_swap_b32 v161, v169
    s_mov_b32 s77, 7168
    s_waitcnt lgkmcnt(8)
    v_mfma_f32_16x16x32_bf16 v[128:131], a[208:211], a[32:35], v[128:131]
    ds_read_b64_tr_b16 a[192:193], v28 offset:8192
    ds_read_b64_tr_b16 a[194:195], v28 offset:8704
    v_accvgpr_write_b32 a128, v160
    buffer_load_dword a255, v2, s[48:51], s77 offen
    v_mfma_f32_16x16x32_bf16 v[136:139], a[212:215], a[32:35], v[136:139]
    ds_read_b64_tr_b16 a[196:197], v29 offset:8192
    ds_read_b64_tr_b16 a[198:199], v29 offset:8704
    v_accvgpr_write_b32 a130, v168
    v_mfma_f32_16x16x32_bf16 v[144:147], a[216:219], a[32:35], v[144:147]
    ds_read_b64_tr_b16 a[200:201], v30 offset:8192
    ds_read_b64_tr_b16 a[202:203], v30 offset:8704
    v_accvgpr_write_b32 a129, v161
    s_mov_b32 s77, 14336
    v_mfma_f32_16x16x32_bf16 v[152:155], a[220:223], a[32:35], v[152:155]
    ds_read_b64_tr_b16 a[204:205], v31 offset:8192
    ds_read_b64_tr_b16 a[206:207], v31 offset:8704
    v_accvgpr_write_b32 a131, v169
    buffer_load_dword a255, v2, s[48:51], s77 offen
    s_waitcnt lgkmcnt(8)
    v_mfma_f32_16x16x32_bf16 v[128:131], a[176:179], a[40:43], v[128:131]
    ds_read_b64_tr_b16 a[208:209], v28 offset:12288
    ds_read_b64_tr_b16 a[210:211], v28 offset:12800
    v_mfma_f32_16x16x32_bf16 v[136:139], a[180:183], a[40:43], v[136:139]
    ds_read_b64_tr_b16 a[212:213], v29 offset:12288
    ds_read_b64_tr_b16 a[214:215], v29 offset:12800
    v_mul_f32 v176, s75, v176
    s_mov_b32 s77, 21504
    v_mfma_f32_16x16x32_bf16 v[144:147], a[184:187], a[40:43], v[144:147]
    ds_read_b64_tr_b16 a[216:217], v30 offset:12288
    ds_read_b64_tr_b16 a[218:219], v30 offset:12800
    v_mul_f32 v177, s75, v177
    buffer_load_dword a255, v2, s[48:51], s77 offen
    v_mfma_f32_16x16x32_bf16 v[152:155], a[188:191], a[40:43], v[152:155]
    ds_read_b64_tr_b16 a[220:221], v31 offset:12288
    ds_read_b64_tr_b16 a[222:223], v31 offset:12800
    v_mul_f32 v178, s75, v178
    s_waitcnt lgkmcnt(8)
    v_mfma_f32_16x16x32_bf16 v[128:131], a[192:195], a[48:51], v[128:131]
    s_barrier
    ds_read_b64_tr_b16 a[176:177], v28 offset:16384
    ds_read_b64_tr_b16 a[178:179], v28 offset:16896
    v_mul_f32 v179, s75, v179
    v_mfma_f32_16x16x32_bf16 v[136:139], a[196:199], a[48:51], v[136:139]
    ds_read_b64_tr_b16 a[180:181], v29 offset:16384
    ds_read_b64_tr_b16 a[182:183], v29 offset:16896
    v_mul_f32 v184, s75, v184
    v_mfma_f32_16x16x32_bf16 v[144:147], a[200:203], a[48:51], v[144:147]
    ds_read_b64_tr_b16 a[184:185], v30 offset:16384
    ds_read_b64_tr_b16 a[186:187], v30 offset:16896
    v_mul_f32 v185, s75, v185
    v_mfma_f32_16x16x32_bf16 v[152:155], a[204:207], a[48:51], v[152:155]
    ds_read_b64_tr_b16 a[188:189], v31 offset:16384
    ds_read_b64_tr_b16 a[190:191], v31 offset:16896
    v_mul_f32 v186, s75, v186
    s_waitcnt lgkmcnt(8)
    v_mfma_f32_16x16x32_bf16 v[128:131], a[208:211], a[56:59], v[128:131]
    ds_read_b64_tr_b16 a[192:193], v28 offset:20480
    ds_read_b64_tr_b16 a[194:195], v28 offset:20992
    v_mul_f32 v187, s75, v187
    s_mov_b32 m0, 49152
    s_mov_b32 s77, 49152
    v_mfma_f32_16x16x32_bf16 v[136:139], a[212:215], a[56:59], v[136:139]
    ds_read_b64_tr_b16 a[196:197], v29 offset:20480
    ds_read_b64_tr_b16 a[198:199], v29 offset:20992
    v_cvt_pk_bf16_f32 v176, v176, v177
    buffer_load_dwordx4 v132, s[36:39], s77 offen offset:0 nt lds
    v_mfma_f32_16x16x32_bf16 v[144:147], a[216:219], a[56:59], v[144:147]
    ds_read_b64_tr_b16 a[200:201], v30 offset:20480
    ds_read_b64_tr_b16 a[202:203], v30 offset:20992
    v_cvt_pk_bf16_f32 v184, v184, v185
    buffer_load_dwordx4 v140, s[36:39], s77 offen offset:1024 nt lds
    v_mfma_f32_16x16x32_bf16 v[152:155], a[220:223], a[56:59], v[152:155]
    ds_read_b64_tr_b16 a[204:205], v31 offset:20480
    ds_read_b64_tr_b16 a[206:207], v31 offset:20992
    v_cvt_pk_bf16_f32 v177, v178, v179
    buffer_load_dwordx4 v148, s[36:39], s77 offen offset:2048 nt lds
    s_waitcnt lgkmcnt(8)
    v_mfma_f32_16x16x32_bf16 v[128:131], a[176:179], a[64:67], v[128:131]
    ds_read_b64_tr_b16 a[208:209], v28 offset:24576
    ds_read_b64_tr_b16 a[210:211], v28 offset:25088
    v_cvt_pk_bf16_f32 v185, v186, v187
    buffer_load_dwordx4 v156, s[36:39], s77 offen offset:3072 nt lds
    s_mov_b32 m0, 53248
    s_mov_b32 s77, 53248
    v_mfma_f32_16x16x32_bf16 v[136:139], a[180:183], a[64:67], v[136:139]
    ds_read_b64_tr_b16 a[212:213], v29 offset:24576
    ds_read_b64_tr_b16 a[214:215], v29 offset:25088
    v_permlane16_swap_b32 v176, v184
    buffer_load_dwordx4 v164, s[36:39], s77 offen offset:0 nt lds
    v_mfma_f32_16x16x32_bf16 v[144:147], a[184:187], a[64:67], v[144:147]
    ds_read_b64_tr_b16 a[216:217], v30 offset:24576
    ds_read_b64_tr_b16 a[218:219], v30 offset:25088
    v_permlane16_swap_b32 v177, v185
    buffer_load_dwordx4 v172, s[36:39], s77 offen offset:1024 nt lds
    v_mfma_f32_16x16x32_bf16 v[152:155], a[188:191], a[64:67], v[152:155]
    ds_read_b64_tr_b16 a[220:221], v31 offset:24576
    ds_read_b64_tr_b16 a[222:223], v31 offset:25088
    v_accvgpr_write_b32 a136, v176
    buffer_load_dwordx4 v180, s[36:39], s77 offen offset:2048 nt lds
    s_waitcnt lgkmcnt(8)
    v_mfma_f32_16x16x32_bf16 v[128:131], a[192:195], a[72:75], v[128:131]
    ds_read_b64_tr_b16 a[176:177], v28 offset:28672
    ds_read_b64_tr_b16 a[178:179], v28 offset:29184
    v_accvgpr_write_b32 a138, v184
    buffer_load_dwordx4 v188, s[36:39], s77 offen offset:3072 nt lds
    s_mov_b32 m0, 57344
    s_mov_b32 s77, 57344
    v_mfma_f32_16x16x32_bf16 v[136:139], a[196:199], a[72:75], v[136:139]
    ds_read_b64_tr_b16 a[180:181], v29 offset:28672
    ds_read_b64_tr_b16 a[182:183], v29 offset:29184
    v_accvgpr_write_b32 a137, v177
    buffer_load_dwordx4 v132, s[36:39], s77 offen offset:0 nt lds
    v_mfma_f32_16x16x32_bf16 v[144:147], a[200:203], a[72:75], v[144:147]
    ds_read_b64_tr_b16 a[184:185], v30 offset:28672
    ds_read_b64_tr_b16 a[186:187], v30 offset:29184
    v_accvgpr_write_b32 a139, v185
    buffer_load_dwordx4 v140, s[36:39], s77 offen offset:1024 nt lds
    v_mfma_f32_16x16x32_bf16 v[152:155], a[204:207], a[72:75], v[152:155]
    ds_read_b64_tr_b16 a[188:189], v31 offset:28672
    ds_read_b64_tr_b16 a[190:191], v31 offset:29184
    buffer_load_dwordx4 v148, s[36:39], s77 offen offset:2048 nt lds
    buffer_load_dwordx4 v156, s[36:39], s77 offen offset:3072 nt lds
    s_mov_b32 m0, 61440
    s_mov_b32 s77, 61440
    buffer_load_dwordx4 v164, s[36:39], s77 offen offset:0 nt lds
    buffer_load_dwordx4 v172, s[36:39], s77 offen offset:1024 nt lds
    buffer_load_dwordx4 v180, s[36:39], s77 offen offset:2048 nt lds
    buffer_load_dwordx4 v188, s[36:39], s77 offen offset:3072 nt lds
    s_waitcnt lgkmcnt(8)
    v_mfma_f32_16x16x32_bf16 v[128:131], a[208:211], a[80:83], v[128:131]
    s_barrier
    ds_read_b64_tr_b16 a[192:193], v28 offset:32768
    ds_read_b64_tr_b16 a[194:195], v28 offset:33280
    v_mfma_f32_16x16x32_bf16 v[136:139], a[212:215], a[80:83], v[136:139]
    ds_read_b64_tr_b16 a[196:197], v29 offset:32768
    ds_read_b64_tr_b16 a[198:199], v29 offset:33280
    v_mfma_f32_16x16x32_bf16 v[144:147], a[216:219], a[80:83], v[144:147]
    ds_read_b64_tr_b16 a[200:201], v30 offset:32768
    ds_read_b64_tr_b16 a[202:203], v30 offset:33280
    v_mfma_f32_16x16x32_bf16 v[152:155], a[220:223], a[80:83], v[152:155]
    ds_read_b64_tr_b16 a[204:205], v31 offset:32768
    ds_read_b64_tr_b16 a[206:207], v31 offset:33280
    s_waitcnt lgkmcnt(8)
    v_mfma_f32_16x16x32_bf16 v[128:131], a[176:179], a[88:91], v[128:131]
    ds_read_b64_tr_b16 a[208:209], v28 offset:36864
    ds_read_b64_tr_b16 a[210:211], v28 offset:37376
    v_mfma_f32_16x16x32_bf16 v[136:139], a[180:183], a[88:91], v[136:139]
    ds_read_b64_tr_b16 a[212:213], v29 offset:36864
    ds_read_b64_tr_b16 a[214:215], v29 offset:37376
    v_mfma_f32_16x16x32_bf16 v[144:147], a[184:187], a[88:91], v[144:147]
    ds_read_b64_tr_b16 a[216:217], v30 offset:36864
    ds_read_b64_tr_b16 a[218:219], v30 offset:37376
    v_mfma_f32_16x16x32_bf16 v[152:155], a[188:191], a[88:91], v[152:155]
    ds_read_b64_tr_b16 a[220:221], v31 offset:36864
    ds_read_b64_tr_b16 a[222:223], v31 offset:37376
    s_waitcnt lgkmcnt(8)
    v_mfma_f32_16x16x32_bf16 v[128:131], a[192:195], a[96:99], v[128:131]
    ds_read_b64_tr_b16 a[176:177], v28 offset:40960
    ds_read_b64_tr_b16 a[178:179], v28 offset:41472
    v_mfma_f32_16x16x32_bf16 v[136:139], a[196:199], a[96:99], v[136:139]
    ds_read_b64_tr_b16 a[180:181], v29 offset:40960
    ds_read_b64_tr_b16 a[182:183], v29 offset:41472
    v_mfma_f32_16x16x32_bf16 v[144:147], a[200:203], a[96:99], v[144:147]
    ds_read_b64_tr_b16 a[184:185], v30 offset:40960
    ds_read_b64_tr_b16 a[186:187], v30 offset:41472
    v_mfma_f32_16x16x32_bf16 v[152:155], a[204:207], a[96:99], v[152:155]
    ds_read_b64_tr_b16 a[188:189], v31 offset:40960
    ds_read_b64_tr_b16 a[190:191], v31 offset:41472
    s_waitcnt lgkmcnt(8)
    v_mfma_f32_16x16x32_bf16 v[128:131], a[208:211], a[104:107], v[128:131]
    ds_read_b64_tr_b16 a[192:193], v28 offset:45056
    ds_read_b64_tr_b16 a[194:195], v28 offset:45568
    v_mfma_f32_16x16x32_bf16 v[136:139], a[212:215], a[104:107], v[136:139]
    ds_read_b64_tr_b16 a[196:197], v29 offset:45056
    ds_read_b64_tr_b16 a[198:199], v29 offset:45568
    v_mfma_f32_16x16x32_bf16 v[144:147], a[216:219], a[104:107], v[144:147]
    ds_read_b64_tr_b16 a[200:201], v30 offset:45056
    ds_read_b64_tr_b16 a[202:203], v30 offset:45568
    v_mfma_f32_16x16x32_bf16 v[152:155], a[220:223], a[104:107], v[152:155]
    ds_read_b64_tr_b16 a[204:205], v31 offset:45056
    ds_read_b64_tr_b16 a[206:207], v31 offset:45568
    s_waitcnt lgkmcnt(8)
    v_mfma_f32_16x16x32_bf16 v[160:163], a[176:179], a[0:3], 0
    s_barrier
    ds_read_b64_tr_b16 a[208:209], v28 offset:49152
    ds_read_b64_tr_b16 a[210:211], v28 offset:49664
    v_mfma_f32_16x16x32_bf16 v[168:171], a[180:183], a[0:3], 0
    ds_read_b64_tr_b16 a[212:213], v29 offset:49152
    ds_read_b64_tr_b16 a[214:215], v29 offset:49664
    v_mfma_f32_16x16x32_bf16 v[176:179], a[184:187], a[0:3], 0
    ds_read_b64_tr_b16 a[216:217], v30 offset:49152
    ds_read_b64_tr_b16 a[218:219], v30 offset:49664
    v_mul_f32 v128, s75, v128
    v_mfma_f32_16x16x32_bf16 v[184:187], a[188:191], a[0:3], 0
    ds_read_b64_tr_b16 a[220:221], v31 offset:49152
    ds_read_b64_tr_b16 a[222:223], v31 offset:49664
    v_mul_f32 v129, s75, v129
    s_waitcnt lgkmcnt(8)
    v_mfma_f32_16x16x32_bf16 v[160:163], a[192:195], a[8:11], v[160:163]
    ds_read_b64_tr_b16 a[176:177], v28 offset:53248
    ds_read_b64_tr_b16 a[178:179], v28 offset:53760
    v_mul_f32 v130, s75, v130
    s_mov_b32 m0, 98304
    s_mov_b32 s77, 32768
    v_mfma_f32_16x16x32_bf16 v[168:171], a[196:199], a[8:11], v[168:171]
    ds_read_b64_tr_b16 a[180:181], v29 offset:53248
    ds_read_b64_tr_b16 a[182:183], v29 offset:53760
    v_mul_f32 v131, s75, v131
    buffer_load_dwordx4 v32, s[40:43], s77 offen offset:0 nt lds
    v_mfma_f32_16x16x32_bf16 v[176:179], a[200:203], a[8:11], v[176:179]
    ds_read_b64_tr_b16 a[184:185], v30 offset:53248
    ds_read_b64_tr_b16 a[186:187], v30 offset:53760
    v_mul_f32 v136, s75, v136
    buffer_load_dwordx4 v33, s[40:43], s77 offen offset:1024 nt lds
    v_mfma_f32_16x16x32_bf16 v[184:187], a[204:207], a[8:11], v[184:187]
    ds_read_b64_tr_b16 a[188:189], v31 offset:53248
    ds_read_b64_tr_b16 a[190:191], v31 offset:53760
    v_mul_f32 v137, s75, v137
    buffer_load_dwordx4 v34, s[40:43], s77 offen offset:2048 nt lds
    s_waitcnt lgkmcnt(8)
    v_mfma_f32_16x16x32_bf16 v[160:163], a[208:211], a[16:19], v[160:163]
    ds_read_b64_tr_b16 a[192:193], v28 offset:57344
    ds_read_b64_tr_b16 a[194:195], v28 offset:57856
    v_mul_f32 v138, s75, v138
    buffer_load_dwordx4 v35, s[40:43], s77 offen offset:3072 nt lds
    s_mov_b32 m0, 102400
    s_mov_b32 s77, 36864
    v_mfma_f32_16x16x32_bf16 v[168:171], a[212:215], a[16:19], v[168:171]
    ds_read_b64_tr_b16 a[196:197], v29 offset:57344
    ds_read_b64_tr_b16 a[198:199], v29 offset:57856
    v_mul_f32 v139, s75, v139
    buffer_load_dwordx4 v32, s[40:43], s77 offen offset:0 nt lds
    v_mfma_f32_16x16x32_bf16 v[176:179], a[216:219], a[16:19], v[176:179]
    ds_read_b64_tr_b16 a[200:201], v30 offset:57344
    ds_read_b64_tr_b16 a[202:203], v30 offset:57856
    v_cvt_pk_bf16_f32 v128, v128, v129
    buffer_load_dwordx4 v33, s[40:43], s77 offen offset:1024 nt lds
    v_mfma_f32_16x16x32_bf16 v[184:187], a[220:223], a[16:19], v[184:187]
    ds_read_b64_tr_b16 a[204:205], v31 offset:57344
    ds_read_b64_tr_b16 a[206:207], v31 offset:57856
    v_cvt_pk_bf16_f32 v136, v136, v137
    buffer_load_dwordx4 v34, s[40:43], s77 offen offset:2048 nt lds
    s_waitcnt lgkmcnt(8)
    v_mfma_f32_16x16x32_bf16 v[160:163], a[176:179], a[24:27], v[160:163]
    ds_read_b64_tr_b16 a[208:209], v28 offset:61440
    ds_read_b64_tr_b16 a[210:211], v28 offset:61952
    v_cvt_pk_bf16_f32 v129, v130, v131
    buffer_load_dwordx4 v35, s[40:43], s77 offen offset:3072 nt lds
    s_mov_b32 m0, 106496
    s_mov_b32 s77, 40960
    v_mfma_f32_16x16x32_bf16 v[168:171], a[180:183], a[24:27], v[168:171]
    ds_read_b64_tr_b16 a[212:213], v29 offset:61440
    ds_read_b64_tr_b16 a[214:215], v29 offset:61952
    v_cvt_pk_bf16_f32 v137, v138, v139
    buffer_load_dwordx4 v32, s[40:43], s77 offen offset:0 nt lds
    v_mfma_f32_16x16x32_bf16 v[176:179], a[184:187], a[24:27], v[176:179]
    ds_read_b64_tr_b16 a[216:217], v30 offset:61440
    ds_read_b64_tr_b16 a[218:219], v30 offset:61952
    v_permlane16_swap_b32 v128, v136
    buffer_load_dwordx4 v33, s[40:43], s77 offen offset:1024 nt lds
    v_mfma_f32_16x16x32_bf16 v[184:187], a[188:191], a[24:27], v[184:187]
    ds_read_b64_tr_b16 a[220:221], v31 offset:61440
    ds_read_b64_tr_b16 a[222:223], v31 offset:61952
    v_permlane16_swap_b32 v129, v137
    buffer_load_dwordx4 v34, s[40:43], s77 offen offset:2048 nt lds
    buffer_load_dwordx4 v35, s[40:43], s77 offen offset:3072 nt lds
    s_mov_b32 m0, 110592
    s_mov_b32 s77, 45056
    buffer_load_dwordx4 v32, s[40:43], s77 offen offset:0 nt lds
    buffer_load_dwordx4 v33, s[40:43], s77 offen offset:1024 nt lds
    buffer_load_dwordx4 v34, s[40:43], s77 offen offset:2048 nt lds
    buffer_load_dwordx4 v35, s[40:43], s77 offen offset:3072 nt lds
    s_waitcnt lgkmcnt(8)
    v_mfma_f32_16x16x32_bf16 v[160:163], a[192:195], a[32:35], v[160:163]
    s_barrier
    ds_read_b64_tr_b16 a[176:177], v28 offset:0
    ds_read_b64_tr_b16 a[178:179], v28 offset:512
    v_accvgpr_write_b32 a144, v128
    v_mfma_f32_16x16x32_bf16 v[168:171], a[196:199], a[32:35], v[168:171]
    ds_read_b64_tr_b16 a[180:181], v29 offset:0
    ds_read_b64_tr_b16 a[182:183], v29 offset:512
    v_accvgpr_write_b32 a146, v136
    v_mfma_f32_16x16x32_bf16 v[176:179], a[200:203], a[32:35], v[176:179]
    ds_read_b64_tr_b16 a[184:185], v30 offset:0
    ds_read_b64_tr_b16 a[186:187], v30 offset:512
    v_accvgpr_write_b32 a145, v129
    v_mfma_f32_16x16x32_bf16 v[184:187], a[204:207], a[32:35], v[184:187]
    ds_read_b64_tr_b16 a[188:189], v31 offset:0
    ds_read_b64_tr_b16 a[190:191], v31 offset:512
    v_accvgpr_write_b32 a147, v137
    s_waitcnt lgkmcnt(8)
    v_mfma_f32_16x16x32_bf16 v[160:163], a[208:211], a[40:43], v[160:163]
    ds_read_b64_tr_b16 a[192:193], v28 offset:4096
    ds_read_b64_tr_b16 a[194:195], v28 offset:4608
    s_mov_b32 m0, 114688
    s_mov_b32 s77, 65536
    v_mfma_f32_16x16x32_bf16 v[168:171], a[212:215], a[40:43], v[168:171]
    ds_read_b64_tr_b16 a[196:197], v29 offset:4096
    ds_read_b64_tr_b16 a[198:199], v29 offset:4608
    v_mul_f32 v144, s75, v144
    buffer_load_dwordx4 v132, s[36:39], s77 offen offset:0 nt lds
    v_mfma_f32_16x16x32_bf16 v[176:179], a[216:219], a[40:43], v[176:179]
    ds_read_b64_tr_b16 a[200:201], v30 offset:4096
    ds_read_b64_tr_b16 a[202:203], v30 offset:4608
    v_mul_f32 v145, s75, v145
    buffer_load_dwordx4 v140, s[36:39], s77 offen offset:1024 nt lds
    v_mfma_f32_16x16x32_bf16 v[184:187], a[220:223], a[40:43], v[184:187]
    ds_read_b64_tr_b16 a[204:205], v31 offset:4096
    ds_read_b64_tr_b16 a[206:207], v31 offset:4608
    v_mul_f32 v146, s75, v146
    buffer_load_dwordx4 v148, s[36:39], s77 offen offset:2048 nt lds
    s_waitcnt lgkmcnt(8)
    v_mfma_f32_16x16x32_bf16 v[160:163], a[176:179], a[48:51], v[160:163]
    ds_read_b64_tr_b16 a[208:209], v28 offset:8192
    ds_read_b64_tr_b16 a[210:211], v28 offset:8704
    v_mul_f32 v147, s75, v147
    buffer_load_dwordx4 v156, s[36:39], s77 offen offset:3072 nt lds
    s_mov_b32 m0, 118784
    s_mov_b32 s77, 69632
    v_mfma_f32_16x16x32_bf16 v[168:171], a[180:183], a[48:51], v[168:171]
    ds_read_b64_tr_b16 a[212:213], v29 offset:8192
    ds_read_b64_tr_b16 a[214:215], v29 offset:8704
    v_mul_f32 v152, s75, v152
    buffer_load_dwordx4 v164, s[36:39], s77 offen offset:0 nt lds
    v_mfma_f32_16x16x32_bf16 v[176:179], a[184:187], a[48:51], v[176:179]
    ds_read_b64_tr_b16 a[216:217], v30 offset:8192
    ds_read_b64_tr_b16 a[218:219], v30 offset:8704
    v_mul_f32 v153, s75, v153
    buffer_load_dwordx4 v172, s[36:39], s77 offen offset:1024 nt lds
    v_mfma_f32_16x16x32_bf16 v[184:187], a[188:191], a[48:51], v[184:187]
    ds_read_b64_tr_b16 a[220:221], v31 offset:8192
    ds_read_b64_tr_b16 a[222:223], v31 offset:8704
    v_mul_f32 v154, s75, v154
    buffer_load_dwordx4 v180, s[36:39], s77 offen offset:2048 nt lds
    s_waitcnt lgkmcnt(8)
    v_mfma_f32_16x16x32_bf16 v[160:163], a[192:195], a[56:59], v[160:163]
    ds_read_b64_tr_b16 a[176:177], v28 offset:12288
    ds_read_b64_tr_b16 a[178:179], v28 offset:12800
    v_mul_f32 v155, s75, v155
    buffer_load_dwordx4 v188, s[36:39], s77 offen offset:3072 nt lds
    s_mov_b32 m0, 122880
    s_mov_b32 s77, 73728
    v_mfma_f32_16x16x32_bf16 v[168:171], a[196:199], a[56:59], v[168:171]
    ds_read_b64_tr_b16 a[180:181], v29 offset:12288
    ds_read_b64_tr_b16 a[182:183], v29 offset:12800
    v_cvt_pk_bf16_f32 v144, v144, v145
    buffer_load_dwordx4 v132, s[36:39], s77 offen offset:0 nt lds
    v_mfma_f32_16x16x32_bf16 v[176:179], a[200:203], a[56:59], v[176:179]
    ds_read_b64_tr_b16 a[184:185], v30 offset:12288
    ds_read_b64_tr_b16 a[186:187], v30 offset:12800
    v_cvt_pk_bf16_f32 v152, v152, v153
    buffer_load_dwordx4 v140, s[36:39], s77 offen offset:1024 nt lds
    v_mfma_f32_16x16x32_bf16 v[184:187], a[204:207], a[56:59], v[184:187]
    ds_read_b64_tr_b16 a[188:189], v31 offset:12288
    ds_read_b64_tr_b16 a[190:191], v31 offset:12800
    v_cvt_pk_bf16_f32 v145, v146, v147
    buffer_load_dwordx4 v148, s[36:39], s77 offen offset:2048 nt lds
    buffer_load_dwordx4 v156, s[36:39], s77 offen offset:3072 nt lds
    s_mov_b32 m0, 126976
    s_mov_b32 s77, 77824
    buffer_load_dwordx4 v164, s[36:39], s77 offen offset:0 nt lds
    buffer_load_dwordx4 v172, s[36:39], s77 offen offset:1024 nt lds
    buffer_load_dwordx4 v180, s[36:39], s77 offen offset:2048 nt lds
    buffer_load_dwordx4 v188, s[36:39], s77 offen offset:3072 nt lds
    s_waitcnt lgkmcnt(8)
    v_mfma_f32_16x16x32_bf16 v[160:163], a[208:211], a[64:67], v[160:163]
    s_barrier
    ds_read_b64_tr_b16 a[192:193], v28 offset:16384
    ds_read_b64_tr_b16 a[194:195], v28 offset:16896
    v_cvt_pk_bf16_f32 v153, v154, v155
    v_mfma_f32_16x16x32_bf16 v[168:171], a[212:215], a[64:67], v[168:171]
    ds_read_b64_tr_b16 a[196:197], v29 offset:16384
    ds_read_b64_tr_b16 a[198:199], v29 offset:16896
    v_permlane16_swap_b32 v144, v152
    v_mfma_f32_16x16x32_bf16 v[176:179], a[216:219], a[64:67], v[176:179]
    ds_read_b64_tr_b16 a[200:201], v30 offset:16384
    ds_read_b64_tr_b16 a[202:203], v30 offset:16896
    v_permlane16_swap_b32 v145, v153
    v_mfma_f32_16x16x32_bf16 v[184:187], a[220:223], a[64:67], v[184:187]
    ds_read_b64_tr_b16 a[204:205], v31 offset:16384
    ds_read_b64_tr_b16 a[206:207], v31 offset:16896
    v_accvgpr_write_b32 a152, v144
    s_waitcnt lgkmcnt(8)
    v_mfma_f32_16x16x32_bf16 v[160:163], a[176:179], a[72:75], v[160:163]
    ds_read_b64_tr_b16 a[208:209], v28 offset:20480
    ds_read_b64_tr_b16 a[210:211], v28 offset:20992
    v_accvgpr_write_b32 a154, v152
    s_mov_b32 m0, 65536
    s_mov_b32 s77, 49152
    v_mfma_f32_16x16x32_bf16 v[168:171], a[180:183], a[72:75], v[168:171]
    ds_read_b64_tr_b16 a[212:213], v29 offset:20480
    ds_read_b64_tr_b16 a[214:215], v29 offset:20992
    v_accvgpr_write_b32 a153, v145
    buffer_load_dwordx4 v32, s[40:43], s77 offen offset:0 nt lds
    v_mfma_f32_16x16x32_bf16 v[176:179], a[184:187], a[72:75], v[176:179]
    ds_read_b64_tr_b16 a[216:217], v30 offset:20480
    ds_read_b64_tr_b16 a[218:219], v30 offset:20992
    v_accvgpr_write_b32 a155, v153
    buffer_load_dwordx4 v33, s[40:43], s77 offen offset:1024 nt lds
    v_mfma_f32_16x16x32_bf16 v[184:187], a[188:191], a[72:75], v[184:187]
    ds_read_b64_tr_b16 a[220:221], v31 offset:20480
    ds_read_b64_tr_b16 a[222:223], v31 offset:20992
    buffer_load_dwordx4 v34, s[40:43], s77 offen offset:2048 nt lds
    s_waitcnt lgkmcnt(8)
    v_mfma_f32_16x16x32_bf16 v[160:163], a[192:195], a[80:83], v[160:163]
    ds_read_b64_tr_b16 a[176:177], v28 offset:24576
    ds_read_b64_tr_b16 a[178:179], v28 offset:25088
    buffer_load_dwordx4 v35, s[40:43], s77 offen offset:3072 nt lds
    s_mov_b32 m0, 69632
    s_mov_b32 s77, 53248
    v_mfma_f32_16x16x32_bf16 v[168:171], a[196:199], a[80:83], v[168:171]
    ds_read_b64_tr_b16 a[180:181], v29 offset:24576
    ds_read_b64_tr_b16 a[182:183], v29 offset:25088
    buffer_load_dwordx4 v32, s[40:43], s77 offen offset:0 nt lds
    v_mfma_f32_16x16x32_bf16 v[176:179], a[200:203], a[80:83], v[176:179]
    ds_read_b64_tr_b16 a[184:185], v30 offset:24576
    ds_read_b64_tr_b16 a[186:187], v30 offset:25088
    buffer_load_dwordx4 v33, s[40:43], s77 offen offset:1024 nt lds
    v_mfma_f32_16x16x32_bf16 v[184:187], a[204:207], a[80:83], v[184:187]
    ds_read_b64_tr_b16 a[188:189], v31 offset:24576
    ds_read_b64_tr_b16 a[190:191], v31 offset:25088
    buffer_load_dwordx4 v34, s[40:43], s77 offen offset:2048 nt lds
    s_waitcnt lgkmcnt(8)
    v_mfma_f32_16x16x32_bf16 v[160:163], a[208:211], a[88:91], v[160:163]
    ds_read_b64_tr_b16 a[192:193], v28 offset:28672
    ds_read_b64_tr_b16 a[194:195], v28 offset:29184
    buffer_load_dwordx4 v35, s[40:43], s77 offen offset:3072 nt lds
    s_mov_b32 m0, 73728
    s_mov_b32 s77, 57344
    v_mfma_f32_16x16x32_bf16 v[168:171], a[212:215], a[88:91], v[168:171]
    ds_read_b64_tr_b16 a[196:197], v29 offset:28672
    ds_read_b64_tr_b16 a[198:199], v29 offset:29184
    buffer_load_dwordx4 v32, s[40:43], s77 offen offset:0 nt lds
    v_mfma_f32_16x16x32_bf16 v[176:179], a[216:219], a[88:91], v[176:179]
    ds_read_b64_tr_b16 a[200:201], v30 offset:28672
    ds_read_b64_tr_b16 a[202:203], v30 offset:29184
    buffer_load_dwordx4 v33, s[40:43], s77 offen offset:1024 nt lds
    v_mfma_f32_16x16x32_bf16 v[184:187], a[220:223], a[88:91], v[184:187]
    ds_read_b64_tr_b16 a[204:205], v31 offset:28672
    ds_read_b64_tr_b16 a[206:207], v31 offset:29184
    buffer_load_dwordx4 v34, s[40:43], s77 offen offset:2048 nt lds
    buffer_load_dwordx4 v35, s[40:43], s77 offen offset:3072 nt lds
    s_mov_b32 m0, 77824
    s_mov_b32 s77, 61440
    buffer_load_dwordx4 v32, s[40:43], s77 offen offset:0 nt lds
    buffer_load_dwordx4 v33, s[40:43], s77 offen offset:1024 nt lds
    buffer_load_dwordx4 v34, s[40:43], s77 offen offset:2048 nt lds
    buffer_load_dwordx4 v35, s[40:43], s77 offen offset:3072 nt lds
    s_waitcnt lgkmcnt(8)
    v_mfma_f32_16x16x32_bf16 v[160:163], a[176:179], a[96:99], v[160:163]
    s_waitcnt vmcnt(63)
    s_barrier
    ds_read_b128 a[208:211], v4 offset:0
    v_mfma_f32_16x16x32_bf16 v[168:171], a[180:183], a[96:99], v[168:171]
    ds_read_b128 a[212:215], v4 offset:8192
    v_mfma_f32_16x16x32_bf16 v[176:179], a[184:187], a[96:99], v[176:179]
    ds_read_b128 a[216:219], v5 offset:0
    v_mfma_f32_16x16x32_bf16 v[184:187], a[188:191], a[96:99], v[184:187]
    ds_read_b128 a[220:223], v5 offset:8192
    s_waitcnt lgkmcnt(4)
    v_mfma_f32_16x16x32_bf16 v[160:163], a[192:195], a[104:107], v[160:163]
    ds_read_b128 a[176:179], v6 offset:0
    s_mov_b32 m0, 81920
    v_mfma_f32_16x16x32_bf16 v[168:171], a[196:199], a[104:107], v[168:171]
    ds_read_b128 a[180:183], v6 offset:8192
    s_mov_b32 s77, 65536
    v_mfma_f32_16x16x32_bf16 v[176:179], a[200:203], a[104:107], v[176:179]
    ds_read_b128 a[184:187], v7 offset:0
    buffer_load_dwordx4 v32, s[40:43], s77 offen offset:0 nt lds
    v_mfma_f32_16x16x32_bf16 v[184:187], a[204:207], a[104:107], v[184:187]
    ds_read_b128 a[188:191], v7 offset:8192
    buffer_load_dwordx4 v33, s[40:43], s77 offen offset:1024 nt lds
    s_waitcnt lgkmcnt(4)
    v_mfma_f32_16x16x32_bf16 v[64:67], a[208:211], a[112:115], v[48:51]
    ds_read_b128 a[192:195], v4 offset:256
    buffer_load_dwordx4 v34, s[40:43], s77 offen offset:2048 nt lds
    v_mfma_f32_16x16x32_bf16 v[72:75], a[212:215], a[112:115], v[48:51]
    ds_read_b128 a[196:199], v4 offset:8448
    buffer_load_dwordx4 v35, s[40:43], s77 offen offset:3072 nt lds
    v_mfma_f32_16x16x32_bf16 v[64:67], a[216:219], a[120:123], v[64:67]
    ds_read_b128 a[200:203], v5 offset:256
    v_mul_f32 v160, s75, v160
    v_mul_f32 v161, s75, v161
    v_mul_f32 v162, s75, v162
    v_mul_f32 v163, s75, v163
    v_mfma_f32_16x16x32_bf16 v[72:75], a[220:223], a[120:123], v[72:75]
    ds_read_b128 a[204:207], v5 offset:8448
    v_mul_f32 v168, s75, v168
    v_mul_f32 v169, s75, v169
    v_mul_f32 v170, s75, v170
    v_mul_f32 v171, s75, v171
    s_mov_b32 m0, 86016
    s_waitcnt lgkmcnt(4)
    v_mfma_f32_16x16x32_bf16 v[64:67], a[176:179], a[128:131], v[64:67]
    ds_read_b128 a[208:211], v6 offset:256
    v_cvt_pk_bf16_f32 v160, v160, v161
    v_cvt_pk_bf16_f32 v168, v168, v169
    v_cvt_pk_bf16_f32 v161, v162, v163
    v_cvt_pk_bf16_f32 v169, v170, v171
    s_mov_b32 s77, 69632
    v_mfma_f32_16x16x32_bf16 v[72:75], a[180:183], a[128:131], v[72:75]
    ds_read_b128 a[212:215], v6 offset:8448
    v_permlane16_swap_b32 v160, v168
    v_permlane16_swap_b32 v161, v169
    v_accvgpr_write_b32 a160, v160
    v_accvgpr_write_b32 a162, v168
    v_mfma_f32_16x16x32_bf16 v[64:67], a[184:187], a[136:139], v[64:67]
    ds_read_b128 a[216:219], v7 offset:256
    v_accvgpr_write_b32 a161, v161
    v_accvgpr_write_b32 a163, v169
    v_mul_f32 v176, s75, v176
    v_mul_f32 v177, s75, v177
    v_mfma_f32_16x16x32_bf16 v[72:75], a[188:191], a[136:139], v[72:75]
    ds_read_b128 a[220:223], v7 offset:8448
    v_mul_f32 v178, s75, v178
    v_mul_f32 v179, s75, v179
    v_mul_f32 v184, s75, v184
    v_mul_f32 v185, s75, v185
    s_waitcnt lgkmcnt(4)
    v_mfma_f32_16x16x32_bf16 v[64:67], a[192:195], a[144:147], v[64:67]
    ds_read_b128 a[176:179], v4 offset:16384
    v_mul_f32 v186, s75, v186
    v_mul_f32 v187, s75, v187
    v_cvt_pk_bf16_f32 v176, v176, v177
    v_cvt_pk_bf16_f32 v184, v184, v185
    v_mfma_f32_16x16x32_bf16 v[72:75], a[196:199], a[144:147], v[72:75]
    ds_read_b128 a[180:183], v4 offset:24576
    v_cvt_pk_bf16_f32 v177, v178, v179
    v_cvt_pk_bf16_f32 v185, v186, v187
    v_permlane16_swap_b32 v176, v184
    s_nop 0
    v_permlane16_swap_b32 v177, v185
    v_mfma_f32_16x16x32_bf16 v[64:67], a[200:203], a[152:155], v[64:67]
    ds_read_b128 a[184:187], v5 offset:16384
    v_accvgpr_write_b32 a168, v176
    v_accvgpr_write_b32 a170, v184
    v_accvgpr_write_b32 a169, v177
    v_accvgpr_write_b32 a171, v185
    v_mfma_f32_16x16x32_bf16 v[72:75], a[204:207], a[152:155], v[72:75]
    ds_read_b128 a[188:191], v5 offset:24576
    buffer_load_dwordx4 v32, s[40:43], s77 offen offset:0 nt lds
    buffer_load_dwordx4 v33, s[40:43], s77 offen offset:1024 nt lds
    s_waitcnt lgkmcnt(4)
    v_mfma_f32_16x16x32_bf16 v[64:67], a[208:211], a[160:163], v[64:67]
    ds_read_b128 a[192:195], v6 offset:16384
    buffer_load_dwordx4 v34, s[40:43], s77 offen offset:2048 nt lds
    buffer_load_dwordx4 v35, s[40:43], s77 offen offset:3072 nt lds
    s_mov_b32 m0, 90112
    s_mov_b32 s77, 73728
    v_mfma_f32_16x16x32_bf16 v[72:75], a[212:215], a[160:163], v[72:75]
    ds_read_b128 a[196:199], v6 offset:24576
    buffer_load_dwordx4 v32, s[40:43], s77 offen offset:0 nt lds
    buffer_load_dwordx4 v33, s[40:43], s77 offen offset:1024 nt lds
    v_mfma_f32_16x16x32_bf16 v[64:67], a[216:219], a[168:171], v[64:67]
    ds_read_b128 a[200:203], v7 offset:16384
    buffer_load_dwordx4 v34, s[40:43], s77 offen offset:2048 nt lds
    v_mfma_f32_16x16x32_bf16 v[72:75], a[220:223], a[168:171], v[72:75]
    ds_read_b128 a[204:207], v7 offset:24576
    buffer_load_dwordx4 v35, s[40:43], s77 offen offset:3072 nt lds
    s_waitcnt lgkmcnt(4)
    v_mfma_f32_16x16x32_bf16 v[80:83], a[176:179], a[112:115], v[48:51]
    ds_read_b128 a[208:211], v4 offset:16640
    v_mfma_f32_16x16x32_bf16 v[88:91], a[180:183], a[112:115], v[48:51]
    ds_read_b128 a[212:215], v4 offset:24832
    s_mov_b32 m0, 94208
    v_mfma_f32_16x16x32_bf16 v[80:83], a[184:187], a[120:123], v[80:83]
    ds_read_b128 a[216:219], v5 offset:16640
    v_max3_f32 v46, v64, v65, v66
    v_max3_f32 v46, v46, v67, v72
    v_max3_f32 v46, v46, v73, v74
    v_max_f32 v46, v46, v75
    s_mov_b32 s77, 77824
    v_mfma_f32_16x16x32_bf16 v[88:91], a[188:191], a[120:123], v[88:91]
    ds_read_b128 a[220:223], v5 offset:24832
    v_mov_b32 v1, v46
    s_nop 1
    v_permlane32_swap_b32 v46, v1
    v_max_f32 v46, v46, v1
    v_mov_b32 v1, v46
    s_waitcnt lgkmcnt(4)
    v_mfma_f32_16x16x32_bf16 v[80:83], a[192:195], a[128:131], v[80:83]
    ds_read_b128 a[176:179], v6 offset:16640
    v_permlane16_swap_b32 v46, v1
    v_max_f32 v46, v46, v1
    v_mul_f32 v46, s76, v46
    v_sub_f32 v64, v64, v46
    v_mfma_f32_16x16x32_bf16 v[88:91], a[196:199], a[128:131], v[88:91]
    ds_read_b128 a[180:183], v6 offset:24832
    v_sub_f32 v65, v65, v46
    v_exp_f32 v64, v64
    v_sub_f32 v66, v66, v46
    v_mfma_f32_16x16x32_bf16 v[80:83], a[200:203], a[136:139], v[80:83]
    ds_read_b128 a[184:187], v7 offset:16640
    v_exp_f32 v65, v65
    v_sub_f32 v67, v67, v46
    buffer_load_dwordx4 v32, s[40:43], s77 offen offset:0 nt lds
    v_mfma_f32_16x16x32_bf16 v[88:91], a[204:207], a[136:139], v[88:91]
    ds_read_b128 a[188:191], v7 offset:24832
    v_exp_f32 v66, v66
    v_cvt_pk_bf16_f32 v96, v64, v65
    v_sub_f32 v72, v72, v46
    buffer_load_dwordx4 v33, s[40:43], s77 offen offset:1024 nt lds
    buffer_load_dwordx4 v34, s[40:43], s77 offen offset:2048 nt lds
    buffer_load_dwordx4 v35, s[40:43], s77 offen offset:3072 nt lds
    s_waitcnt lgkmcnt(4)
    v_mfma_f32_16x16x32_bf16 v[80:83], a[208:211], a[144:147], v[80:83]
    s_barrier
    ds_read_b64_tr_b16 a[192:193], v20 offset:32768
    ds_read_b64_tr_b16 a[194:195], v20 offset:40960
    v_exp_f32 v67, v67
    v_sub_f32 v73, v73, v46
    v_mfma_f32_16x16x32_bf16 v[88:91], a[212:215], a[144:147], v[88:91]
    ds_read_b64_tr_b16 a[196:197], v21 offset:32768
    ds_read_b64_tr_b16 a[198:199], v21 offset:40960
    v_exp_f32 v72, v72
    v_cvt_pk_bf16_f32 v97, v66, v67
    v_mfma_f32_16x16x32_bf16 v[80:83], a[216:219], a[152:155], v[80:83]
    ds_read_b64_tr_b16 a[200:201], v22 offset:32768
    ds_read_b64_tr_b16 a[202:203], v22 offset:40960
    v_sub_f32 v74, v74, v46
    v_exp_f32 v73, v73
    v_mfma_f32_16x16x32_bf16 v[88:91], a[220:223], a[152:155], v[88:91]
    ds_read_b64_tr_b16 a[204:205], v23 offset:32768
    ds_read_b64_tr_b16 a[206:207], v23 offset:40960
    v_sub_f32 v75, v75, v46
    v_exp_f32 v74, v74
    s_waitcnt lgkmcnt(8)
    v_mfma_f32_16x16x32_bf16 v[80:83], a[176:179], a[160:163], v[80:83]
    ds_read_b64_tr_b16 a[208:209], v24 offset:32768
    ds_read_b64_tr_b16 a[210:211], v24 offset:40960
    v_cvt_pk_bf16_f32 v98, v72, v73
    v_exp_f32 v75, v75
    s_mov_b32 m0, 12288
    v_mfma_f32_16x16x32_bf16 v[88:91], a[180:183], a[160:163], v[88:91]
    ds_read_b64_tr_b16 a[212:213], v25 offset:32768
    ds_read_b64_tr_b16 a[214:215], v25 offset:40960
    v_cvt_pk_bf16_f32 v99, v74, v75
    v_mfma_f32_16x16x32_bf16 v[80:83], a[184:187], a[168:171], v[80:83]
    ds_read_b64_tr_b16 a[216:217], v26 offset:32768
    ds_read_b64_tr_b16 a[218:219], v26 offset:40960
    s_mov_b32 s77, 94208
    v_mfma_f32_16x16x32_bf16 v[88:91], a[188:191], a[168:171], v[88:91]
    ds_read_b64_tr_b16 a[220:221], v27 offset:32768
    ds_read_b64_tr_b16 a[222:223], v27 offset:40960
    v_mfma_f32_16x16x32_bf16 v[56:59], a[224:227], v[96:99], 0
    ds_read_b64_tr_b16 a[176:177], v20 offset:33024
    ds_read_b64_tr_b16 a[178:179], v20 offset:41216
    v_sub_f32 v48, v48, v46
    buffer_load_dwordx4 v164, s[36:39], s77 offen offset:0 nt lds
    s_waitcnt lgkmcnt(10)
    v_mfma_f32_16x16x32_bf16 v[128:131], a[192:195], v[96:99], 0
    ds_read_b64_tr_b16 a[180:181], v21 offset:33024
    ds_read_b64_tr_b16 a[182:183], v21 offset:41216
    v_mfma_f32_16x16x32_bf16 v[136:139], a[196:199], v[96:99], 0
    ds_read_b64_tr_b16 a[184:185], v22 offset:33024
    ds_read_b64_tr_b16 a[186:187], v22 offset:41216
    v_sub_f32 v80, v80, v46
    v_mfma_f32_16x16x32_bf16 v[144:147], a[200:203], v[96:99], 0
    ds_read_b64_tr_b16 a[188:189], v23 offset:33024
    ds_read_b64_tr_b16 a[190:191], v23 offset:41216
    v_sub_f32 v81, v81, v46
    buffer_load_dwordx4 v172, s[36:39], s77 offen offset:1024 nt lds
    v_mfma_f32_16x16x32_bf16 v[152:155], a[204:207], v[96:99], 0
    v_sub_f32 v49, v49, v46
    s_waitcnt lgkmcnt(8)
    v_mfma_f32_16x16x32_bf16 v[160:163], a[208:211], v[96:99], 0
    ds_read_b64_tr_b16 a[192:193], v24 offset:33024
    ds_read_b64_tr_b16 a[194:195], v24 offset:41216
    v_exp_f32 v80, v80
    v_mfma_f32_16x16x32_bf16 v[168:171], a[212:215], v[96:99], 0
    ds_read_b64_tr_b16 a[196:197], v25 offset:33024
    ds_read_b64_tr_b16 a[198:199], v25 offset:41216
    v_sub_f32 v82, v82, v46
    buffer_load_dwordx4 v180, s[36:39], s77 offen offset:2048 nt lds
    v_mfma_f32_16x16x32_bf16 v[176:179], a[216:219], v[96:99], 0
    ds_read_b64_tr_b16 a[200:201], v26 offset:33024
    ds_read_b64_tr_b16 a[202:203], v26 offset:41216
    v_mfma_f32_16x16x32_bf16 v[184:187], a[220:223], v[96:99], 0
    ds_read_b64_tr_b16 a[204:205], v27 offset:33024
    ds_read_b64_tr_b16 a[206:207], v27 offset:41216
    v_sub_f32 v50, v50, v46
    v_exp_f32 v81, v81
    s_waitcnt lgkmcnt(8)
    v_mfma_f32_16x16x32_bf16 v[192:195], a[176:179], v[96:99], 0
    ds_read_b128 a[208:211], v4 offset:32768
    v_sub_f32 v83, v83, v46
    buffer_load_dwordx4 v188, s[36:39], s77 offen offset:3072 nt lds
    v_mfma_f32_16x16x32_bf16 v[200:203], a[180:183], v[96:99], 0
    ds_read_b128 a[212:215], v4 offset:40960
    s_mov_b32 m0, 28672
    v_mfma_f32_16x16x32_bf16 v[208:211], a[184:187], v[96:99], 0
    ds_read_b128 a[216:219], v5 offset:32768
    v_exp_f32 v82, v82
    v_mfma_f32_16x16x32_bf16 v[216:219], a[188:191], v[96:99], 0
    ds_read_b128 a[220:223], v5 offset:40960
    v_sub_f32 v51, v51, v46
    v_cvt_pk_bf16_f32 v104, v80, v81
    s_mov_b32 s77, 110592
    s_waitcnt lgkmcnt(4)
    v_mfma_f32_16x16x32_bf16 v[224:227], a[192:195], v[96:99], 0
    ds_read_b128 a[176:179], v6 offset:32768
    v_mfma_f32_16x16x32_bf16 v[232:235], a[196:199], v[96:99], 0
    ds_read_b128 a[180:183], v6 offset:40960
    v_sub_f32 v88, v88, v46
    v_mfma_f32_16x16x32_bf16 v[240:243], a[200:203], v[96:99], 0
    ds_read_b128 a[184:187], v7 offset:32768
    v_exp_f32 v83, v83
    buffer_load_dwordx4 v164, s[36:39], s77 offen offset:0 nt lds
    v_mfma_f32_16x16x32_bf16 v[248:251], a[204:207], v[96:99], 0
    ds_read_b128 a[188:191], v7 offset:40960
    s_waitcnt lgkmcnt(4)
    v_mfma_f32_16x16x32_bf16 v[64:67], a[208:211], a[112:115], v[48:51]
    ds_read_b128 a[192:195], v4 offset:33024
    v_sub_f32 v89, v89, v46
    buffer_load_dwordx4 v172, s[36:39], s77 offen offset:1024 nt lds
    v_mfma_f32_16x16x32_bf16 v[72:75], a[212:215], a[112:115], v[48:51]
    ds_read_b128 a[196:199], v4 offset:41216
    v_mfma_f32_16x16x32_bf16 v[64:67], a[216:219], a[120:123], v[64:67]
    ds_read_b128 a[200:203], v5 offset:33024
    v_exp_f32 v88, v88
    v_mfma_f32_16x16x32_bf16 v[72:75], a[220:223], a[120:123], v[72:75]
    ds_read_b128 a[204:207], v5 offset:41216
    v_cvt_pk_bf16_f32 v105, v82, v83
    buffer_load_dwordx4 v180, s[36:39], s77 offen offset:2048 nt lds
    s_waitcnt lgkmcnt(4)
    v_mfma_f32_16x16x32_bf16 v[64:67], a[176:179], a[128:131], v[64:67]
    ds_read_b128 a[208:211], v6 offset:33024
    v_mfma_f32_16x16x32_bf16 v[72:75], a[180:183], a[128:131], v[72:75]
    ds_read_b128 a[212:215], v6 offset:41216
    v_sub_f32 v90, v90, v46
    buffer_load_dwordx4 v188, s[36:39], s77 offen offset:3072 nt lds
    v_mfma_f32_16x16x32_bf16 v[64:67], a[184:187], a[136:139], v[64:67]
    ds_read_b128 a[216:219], v7 offset:33024
    v_exp_f32 v89, v89
    v_mfma_f32_16x16x32_bf16 v[72:75], a[188:191], a[136:139], v[72:75]
    ds_read_b128 a[220:223], v7 offset:41216
    s_waitcnt lgkmcnt(4)
    v_mfma_f32_16x16x32_bf16 v[64:67], a[192:195], a[144:147], v[64:67]
    s_waitcnt vmcnt(63)
    s_barrier
    ds_read_b64_tr_b16 a[176:177], v20 offset:49152
    ds_read_b64_tr_b16 a[178:179], v20 offset:57344
    v_sub_f32 v91, v91, v46
    v_mfma_f32_16x16x32_bf16 v[72:75], a[196:199], a[144:147], v[72:75]
    ds_read_b64_tr_b16 a[180:181], v21 offset:49152
    ds_read_b64_tr_b16 a[182:183], v21 offset:57344
    v_exp_f32 v90, v90
    v_mfma_f32_16x16x32_bf16 v[64:67], a[200:203], a[152:155], v[64:67]
    ds_read_b64_tr_b16 a[184:185], v22 offset:49152
    ds_read_b64_tr_b16 a[186:187], v22 offset:57344
    v_mfma_f32_16x16x32_bf16 v[72:75], a[204:207], a[152:155], v[72:75]
    ds_read_b64_tr_b16 a[188:189], v23 offset:49152
    ds_read_b64_tr_b16 a[190:191], v23 offset:57344
    v_cvt_pk_bf16_f32 v106, v88, v89
    s_waitcnt lgkmcnt(8)
    v_mfma_f32_16x16x32_bf16 v[64:67], a[208:211], a[160:163], v[64:67]
    ds_read_b64_tr_b16 a[192:193], v24 offset:49152
    ds_read_b64_tr_b16 a[194:195], v24 offset:57344
    v_exp_f32 v91, v91
    s_mov_b32 m0, 143360
    s_mov_b32 s77, 94208
    v_mfma_f32_16x16x32_bf16 v[72:75], a[212:215], a[160:163], v[72:75]
    ds_read_b64_tr_b16 a[196:197], v25 offset:49152
    ds_read_b64_tr_b16 a[198:199], v25 offset:57344
    buffer_load_dwordx4 v32, s[40:43], s77 offen offset:0 nt lds
    v_mfma_f32_16x16x32_bf16 v[64:67], a[216:219], a[168:171], v[64:67]
    ds_read_b64_tr_b16 a[200:201], v26 offset:49152
    ds_read_b64_tr_b16 a[202:203], v26 offset:57344
    v_cvt_pk_bf16_f32 v107, v90, v91
    buffer_load_dwordx4 v33, s[40:43], s77 offen offset:1024 nt lds
    v_mfma_f32_16x16x32_bf16 v[72:75], a[220:223], a[168:171], v[72:75]
    ds_read_b64_tr_b16 a[204:205], v27 offset:49152
    ds_read_b64_tr_b16 a[206:207], v27 offset:57344
    buffer_load_dwordx4 v34, s[40:43], s77 offen offset:2048 nt lds
    v_mfma_f32_16x16x32_bf16 v[56:59], a[224:227], v[104:107], v[56:59]
    ds_read_b64_tr_b16 a[208:209], v20 offset:49408
    ds_read_b64_tr_b16 a[210:211], v20 offset:57600
    buffer_load_dwordx4 v35, s[40:43], s77 offen offset:3072 nt lds
    s_waitcnt lgkmcnt(10)
    v_mfma_f32_16x16x32_bf16 v[128:131], a[176:179], v[104:107], v[128:131]
    ds_read_b64_tr_b16 a[212:213], v21 offset:49408
    ds_read_b64_tr_b16 a[214:215], v21 offset:57600
    s_mov_b32 m0, 32768
    v_mfma_f32_16x16x32_bf16 v[136:139], a[180:183], v[104:107], v[136:139]
    ds_read_b64_tr_b16 a[216:217], v22 offset:49408
    ds_read_b64_tr_b16 a[218:219], v22 offset:57600
    v_exp_f32 v64, v64
    s_mov_b32 s77, 114688
    v_mfma_f32_16x16x32_bf16 v[144:147], a[184:187], v[104:107], v[144:147]
    ds_read_b64_tr_b16 a[220:221], v23 offset:49408
    ds_read_b64_tr_b16 a[222:223], v23 offset:57600
    buffer_load_dwordx4 v132, s[36:39], s77 offen offset:0 nt lds
    v_mfma_f32_16x16x32_bf16 v[152:155], a[188:191], v[104:107], v[152:155]
    v_exp_f32 v65, v65
    buffer_load_dwordx4 v140, s[36:39], s77 offen offset:1024 nt lds
    s_waitcnt lgkmcnt(8)
    v_mfma_f32_16x16x32_bf16 v[160:163], a[192:195], v[104:107], v[160:163]
    ds_read_b64_tr_b16 a[176:177], v24 offset:49408
    ds_read_b64_tr_b16 a[178:179], v24 offset:57600
    buffer_load_dwordx4 v148, s[36:39], s77 offen offset:2048 nt lds
    v_mfma_f32_16x16x32_bf16 v[168:171], a[196:199], v[104:107], v[168:171]
    ds_read_b64_tr_b16 a[180:181], v25 offset:49408
    ds_read_b64_tr_b16 a[182:183], v25 offset:57600
    buffer_load_dwordx4 v156, s[36:39], s77 offen offset:3072 nt lds
    v_mfma_f32_16x16x32_bf16 v[176:179], a[200:203], v[104:107], v[176:179]
    ds_read_b64_tr_b16 a[184:185], v26 offset:49408
    ds_read_b64_tr_b16 a[186:187], v26 offset:57600
    v_exp_f32 v66, v66
    s_mov_b32 m0, 36864
    v_mfma_f32_16x16x32_bf16 v[184:187], a[204:207], v[104:107], v[184:187]
    ds_read_b64_tr_b16 a[188:189], v27 offset:49408
    ds_read_b64_tr_b16 a[190:191], v27 offset:57600
    s_mov_b32 s77, 118784
    s_waitcnt lgkmcnt(8)
    v_mfma_f32_16x16x32_bf16 v[192:195], a[208:211], v[104:107], v[192:195]
    ds_read_b128 a[192:195], v4 offset:49152
    v_cvt_pk_bf16_f32 v96, v64, v65
    buffer_load_dwordx4 v164, s[36:39], s77 offen offset:0 nt lds
    v_mfma_f32_16x16x32_bf16 v[200:203], a[212:215], v[104:107], v[200:203]
    ds_read_b128 a[196:199], v4 offset:57344
    buffer_load_dwordx4 v172, s[36:39], s77 offen offset:1024 nt lds
    v_mfma_f32_16x16x32_bf16 v[208:211], a[216:219], v[104:107], v[208:211]
    ds_read_b128 a[200:203], v5 offset:49152
    buffer_load_dwordx4 v180, s[36:39], s77 offen offset:2048 nt lds
    v_mfma_f32_16x16x32_bf16 v[216:219], a[220:223], v[104:107], v[216:219]
    ds_read_b128 a[204:207], v5 offset:57344
    v_exp_f32 v67, v67
    buffer_load_dwordx4 v188, s[36:39], s77 offen offset:3072 nt lds
    s_waitcnt lgkmcnt(4)
    v_mfma_f32_16x16x32_bf16 v[224:227], a[176:179], v[104:107], v[224:227]
    ds_read_b128 a[208:211], v6 offset:49152
    s_mov_b32 m0, 40960
    v_mfma_f32_16x16x32_bf16 v[232:235], a[180:183], v[104:107], v[232:235]
    ds_read_b128 a[212:215], v6 offset:57344
    v_exp_f32 v72, v72
    s_mov_b32 s77, 122880
    v_mfma_f32_16x16x32_bf16 v[240:243], a[184:187], v[104:107], v[240:243]
    ds_read_b128 a[216:219], v7 offset:49152
    buffer_load_dwordx4 v132, s[36:39], s77 offen offset:0 nt lds
    v_mfma_f32_16x16x32_bf16 v[248:251], a[188:191], v[104:107], v[248:251]
    ds_read_b128 a[220:223], v7 offset:57344
    buffer_load_dwordx4 v140, s[36:39], s77 offen offset:1024 nt lds
    s_waitcnt lgkmcnt(4)
    v_mfma_f32_16x16x32_bf16 v[80:83], a[192:195], a[112:115], v[48:51]
    ds_read_b128 a[176:179], v4 offset:49408
    v_cvt_pk_bf16_f32 v97, v66, v67
    buffer_load_dwordx4 v148, s[36:39], s77 offen offset:2048 nt lds
    v_mfma_f32_16x16x32_bf16 v[88:91], a[196:199], a[112:115], v[48:51]
    ds_read_b128 a[180:183], v4 offset:57600
    buffer_load_dwordx4 v156, s[36:39], s77 offen offset:3072 nt lds
    v_mfma_f32_16x16x32_bf16 v[80:83], a[200:203], a[120:123], v[80:83]
    ds_read_b128 a[184:187], v5 offset:49408
    s_mov_b32 m0, 45056
    v_mfma_f32_16x16x32_bf16 v[88:91], a[204:207], a[120:123], v[88:91]
    ds_read_b128 a[188:191], v5 offset:57600
    v_exp_f32 v73, v73
    s_mov_b32 s77, 126976
    s_waitcnt lgkmcnt(4)
    v_mfma_f32_16x16x32_bf16 v[80:83], a[208:211], a[128:131], v[80:83]
    ds_read_b128 a[192:195], v6 offset:49408
    buffer_load_dwordx4 v164, s[36:39], s77 offen offset:0 nt lds
    v_mfma_f32_16x16x32_bf16 v[88:91], a[212:215], a[128:131], v[88:91]
    ds_read_b128 a[196:199], v6 offset:57600
    v_exp_f32 v74, v74
    buffer_load_dwordx4 v172, s[36:39], s77 offen offset:1024 nt lds
    v_mfma_f32_16x16x32_bf16 v[80:83], a[216:219], a[136:139], v[80:83]
    ds_read_b128 a[200:203], v7 offset:49408
    buffer_load_dwordx4 v180, s[36:39], s77 offen offset:2048 nt lds
    v_mfma_f32_16x16x32_bf16 v[88:91], a[220:223], a[136:139], v[88:91]
    ds_read_b128 a[204:207], v7 offset:57600
    buffer_load_dwordx4 v188, s[36:39], s77 offen offset:3072 nt lds
    s_waitcnt lgkmcnt(4)
    v_mfma_f32_16x16x32_bf16 v[80:83], a[176:179], a[144:147], v[80:83]
    s_waitcnt vmcnt(60)
    s_barrier
    ds_read_b64_tr_b16 a[208:209], v12 offset:32768
    ds_read_b64_tr_b16 a[210:211], v12 offset:40960
    v_cvt_pk_bf16_f32 v98, v72, v73
    v_mfma_f32_16x16x32_bf16 v[88:91], a[180:183], a[144:147], v[88:91]
    ds_read_b64_tr_b16 a[212:213], v13 offset:32768
    ds_read_b64_tr_b16 a[214:215], v13 offset:40960
    v_mfma_f32_16x16x32_bf16 v[80:83], a[184:187], a[152:155], v[80:83]
    ds_read_b64_tr_b16 a[216:217], v14 offset:32768
    ds_read_b64_tr_b16 a[218:219], v14 offset:40960
    v_exp_f32 v75, v75
    v_mfma_f32_16x16x32_bf16 v[88:91], a[188:191], a[152:155], v[88:91]
    ds_read_b64_tr_b16 a[220:221], v15 offset:32768
    ds_read_b64_tr_b16 a[222:223], v15 offset:40960
    s_waitcnt lgkmcnt(8)
    v_mfma_f32_16x16x32_bf16 v[80:83], a[192:195], a[160:163], v[80:83]
    ds_read_b64_tr_b16 a[176:177], v16 offset:32768
    ds_read_b64_tr_b16 a[178:179], v16 offset:40960
    s_mov_b32 m0, 159744
    s_mov_b32 s77, 110592
    v_mfma_f32_16x16x32_bf16 v[88:91], a[196:199], a[160:163], v[88:91]
    ds_read_b64_tr_b16 a[180:181], v17 offset:32768
    ds_read_b64_tr_b16 a[182:183], v17 offset:40960
    v_cvt_pk_bf16_f32 v99, v74, v75
    buffer_load_dwordx4 v32, s[40:43], s77 offen offset:0 nt lds
    v_mfma_f32_16x16x32_bf16 v[80:83], a[200:203], a[168:171], v[80:83]
    ds_read_b64_tr_b16 a[184:185], v18 offset:32768
    ds_read_b64_tr_b16 a[186:187], v18 offset:40960
    buffer_load_dwordx4 v33, s[40:43], s77 offen offset:1024 nt lds
    v_mfma_f32_16x16x32_bf16 v[88:91], a[204:207], a[168:171], v[88:91]
    ds_read_b64_tr_b16 a[188:189], v19 offset:32768
    ds_read_b64_tr_b16 a[190:191], v19 offset:40960
    buffer_load_dwordx4 v34, s[40:43], s77 offen offset:2048 nt lds
    v_mfma_f32_16x16x32_bf16 v[56:59], a[224:227], v[96:99], v[56:59]
    ds_read_b64_tr_b16 a[192:193], v12 offset:33024
    ds_read_b64_tr_b16 a[194:195], v12 offset:41216
    buffer_load_dwordx4 v35, s[40:43], s77 offen offset:3072 nt lds
    s_waitcnt lgkmcnt(10)
    v_mfma_f32_16x16x32_bf16 v[128:131], a[208:211], v[96:99], v[128:131]
    ds_read_b64_tr_b16 a[196:197], v13 offset:33024
    ds_read_b64_tr_b16 a[198:199], v13 offset:41216
    s_mov_b32 m0, 49152
    v_mfma_f32_16x16x32_bf16 v[136:139], a[212:215], v[96:99], v[136:139]
    ds_read_b64_tr_b16 a[200:201], v14 offset:33024
    ds_read_b64_tr_b16 a[202:203], v14 offset:41216
    v_exp_f32 v80, v80
    s_mov_b32 s77, 131072
    v_mfma_f32_16x16x32_bf16 v[144:147], a[216:219], v[96:99], v[144:147]
    ds_read_b64_tr_b16 a[204:205], v15 offset:33024
    ds_read_b64_tr_b16 a[206:207], v15 offset:41216
    buffer_load_dwordx4 v132, s[36:39], s77 offen offset:0 nt lds
    v_mfma_f32_16x16x32_bf16 v[152:155], a[220:223], v[96:99], v[152:155]
    v_exp_f32 v81, v81
    buffer_load_dwordx4 v140, s[36:39], s77 offen offset:1024 nt lds
    s_waitcnt lgkmcnt(8)
    v_mfma_f32_16x16x32_bf16 v[160:163], a[176:179], v[96:99], v[160:163]
    ds_read_b64_tr_b16 a[208:209], v16 offset:33024
    ds_read_b64_tr_b16 a[210:211], v16 offset:41216
    buffer_load_dwordx4 v148, s[36:39], s77 offen offset:2048 nt lds
    v_mfma_f32_16x16x32_bf16 v[168:171], a[180:183], v[96:99], v[168:171]
    ds_read_b64_tr_b16 a[212:213], v17 offset:33024
    ds_read_b64_tr_b16 a[214:215], v17 offset:41216
    buffer_load_dwordx4 v156, s[36:39], s77 offen offset:3072 nt lds
    v_mfma_f32_16x16x32_bf16 v[176:179], a[184:187], v[96:99], v[176:179]
    ds_read_b64_tr_b16 a[216:217], v18 offset:33024
    ds_read_b64_tr_b16 a[218:219], v18 offset:41216
    v_exp_f32 v82, v82
    s_mov_b32 m0, 53248
    v_mfma_f32_16x16x32_bf16 v[184:187], a[188:191], v[96:99], v[184:187]
    ds_read_b64_tr_b16 a[220:221], v19 offset:33024
    ds_read_b64_tr_b16 a[222:223], v19 offset:41216
    s_mov_b32 s77, 135168
    s_waitcnt lgkmcnt(8)
    v_mfma_f32_16x16x32_bf16 v[192:195], a[192:195], v[96:99], v[192:195]
    ds_read_b128 a[176:179], v8 offset:49152
    v_cvt_pk_bf16_f32 v104, v80, v81
    buffer_load_dwordx4 v164, s[36:39], s77 offen offset:0 nt lds
    v_mfma_f32_16x16x32_bf16 v[200:203], a[196:199], v[96:99], v[200:203]
    ds_read_b128 a[180:183], v8 offset:57344
    buffer_load_dwordx4 v172, s[36:39], s77 offen offset:1024 nt lds
    v_mfma_f32_16x16x32_bf16 v[208:211], a[200:203], v[96:99], v[208:211]
    ds_read_b128 a[184:187], v9 offset:49152
    buffer_load_dwordx4 v180, s[36:39], s77 offen offset:2048 nt lds
    v_mfma_f32_16x16x32_bf16 v[216:219], a[204:207], v[96:99], v[216:219]
    ds_read_b128 a[188:191], v9 offset:57344
    v_exp_f32 v83, v83
    buffer_load_dwordx4 v188, s[36:39], s77 offen offset:3072 nt lds
    s_waitcnt lgkmcnt(4)
    v_mfma_f32_16x16x32_bf16 v[224:227], a[208:211], v[96:99], v[224:227]
    ds_read_b128 a[192:195], v10 offset:49152
    s_mov_b32 m0, 57344
    v_mfma_f32_16x16x32_bf16 v[232:235], a[212:215], v[96:99], v[232:235]
    ds_read_b128 a[196:199], v10 offset:57344
    v_exp_f32 v88, v88
    s_mov_b32 s77, 139264
    v_mfma_f32_16x16x32_bf16 v[240:243], a[216:219], v[96:99], v[240:243]
    ds_read_b128 a[200:203], v11 offset:49152
    buffer_load_dwordx4 v132, s[36:39], s77 offen offset:0 nt lds
    v_mfma_f32_16x16x32_bf16 v[248:251], a[220:223], v[96:99], v[248:251]
    ds_read_b128 a[204:207], v11 offset:57344
    buffer_load_dwordx4 v140, s[36:39], s77 offen offset:1024 nt lds
    s_waitcnt lgkmcnt(4)
    v_mfma_f32_16x16x32_bf16 v[64:67], a[176:179], a[112:115], v[48:51]
    ds_read_b128 a[208:211], v8 offset:49408
    v_cvt_pk_bf16_f32 v105, v82, v83
    buffer_load_dwordx4 v148, s[36:39], s77 offen offset:2048 nt lds
    v_mfma_f32_16x16x32_bf16 v[72:75], a[180:183], a[112:115], v[48:51]
    ds_read_b128 a[212:215], v8 offset:57600
    buffer_load_dwordx4 v156, s[36:39], s77 offen offset:3072 nt lds
    v_mfma_f32_16x16x32_bf16 v[64:67], a[184:187], a[120:123], v[64:67]
    ds_read_b128 a[216:219], v9 offset:49408
    s_mov_b32 m0, 61440
    v_mfma_f32_16x16x32_bf16 v[72:75], a[188:191], a[120:123], v[72:75]
    ds_read_b128 a[220:223], v9 offset:57600
    v_exp_f32 v89, v89
    s_mov_b32 s77, 143360
    s_waitcnt lgkmcnt(4)
    v_mfma_f32_16x16x32_bf16 v[64:67], a[192:195], a[128:131], v[64:67]
    ds_read_b128 a[176:179], v10 offset:49408
    buffer_load_dwordx4 v164, s[36:39], s77 offen offset:0 nt lds
    v_mfma_f32_16x16x32_bf16 v[72:75], a[196:199], a[128:131], v[72:75]
    ds_read_b128 a[180:183], v10 offset:57600
    v_exp_f32 v90, v90
    buffer_load_dwordx4 v172, s[36:39], s77 offen offset:1024 nt lds
    v_mfma_f32_16x16x32_bf16 v[64:67], a[200:203], a[136:139], v[64:67]
    ds_read_b128 a[184:187], v11 offset:49408
    buffer_load_dwordx4 v180, s[36:39], s77 offen offset:2048 nt lds
    v_mfma_f32_16x16x32_bf16 v[72:75], a[204:207], a[136:139], v[72:75]
    ds_read_b128 a[188:191], v11 offset:57600
    buffer_load_dwordx4 v188, s[36:39], s77 offen offset:3072 nt lds
    s_waitcnt lgkmcnt(4)
    v_mfma_f32_16x16x32_bf16 v[64:67], a[208:211], a[144:147], v[64:67]
    s_waitcnt vmcnt(44)
    s_barrier
    ds_read_b64_tr_b16 a[192:193], v12 offset:0
    ds_read_b64_tr_b16 a[194:195], v12 offset:8192
    v_cvt_pk_bf16_f32 v106, v88, v89
    v_mfma_f32_16x16x32_bf16 v[72:75], a[212:215], a[144:147], v[72:75]
    ds_read_b64_tr_b16 a[196:197], v13 offset:0
    ds_read_b64_tr_b16 a[198:199], v13 offset:8192
    v_mfma_f32_16x16x32_bf16 v[64:67], a[216:219], a[152:155], v[64:67]
    ds_read_b64_tr_b16 a[200:201], v14 offset:0
    ds_read_b64_tr_b16 a[202:203], v14 offset:8192
    v_exp_f32 v91, v91
    v_mfma_f32_16x16x32_bf16 v[72:75], a[220:223], a[152:155], v[72:75]
    ds_read_b64_tr_b16 a[204:205], v15 offset:0
    ds_read_b64_tr_b16 a[206:207], v15 offset:8192
    s_waitcnt lgkmcnt(8)
    v_mfma_f32_16x16x32_bf16 v[64:67], a[176:179], a[160:163], v[64:67]
    ds_read_b64_tr_b16 a[208:209], v16 offset:0
    ds_read_b64_tr_b16 a[210:211], v16 offset:8192
    s_mov_b32 m0, 110592
    s_mov_b32 s77, 126976
    v_mfma_f32_16x16x32_bf16 v[72:75], a[180:183], a[160:163], v[72:75]
    ds_read_b64_tr_b16 a[212:213], v17 offset:0
    ds_read_b64_tr_b16 a[214:215], v17 offset:8192
    v_cvt_pk_bf16_f32 v107, v90, v91
    buffer_load_dwordx4 v32, s[40:43], s77 offen offset:0 nt lds
    v_mfma_f32_16x16x32_bf16 v[64:67], a[184:187], a[168:171], v[64:67]
    ds_read_b64_tr_b16 a[216:217], v18 offset:0
    ds_read_b64_tr_b16 a[218:219], v18 offset:8192
    buffer_load_dwordx4 v33, s[40:43], s77 offen offset:1024 nt lds
    v_mfma_f32_16x16x32_bf16 v[72:75], a[188:191], a[168:171], v[72:75]
    ds_read_b64_tr_b16 a[220:221], v19 offset:0
    ds_read_b64_tr_b16 a[222:223], v19 offset:8192
    buffer_load_dwordx4 v34, s[40:43], s77 offen offset:2048 nt lds
    v_mfma_f32_16x16x32_bf16 v[56:59], a[224:227], v[104:107], v[56:59]
    ds_read_b64_tr_b16 a[176:177], v12 offset:256
    ds_read_b64_tr_b16 a[178:179], v12 offset:8448
    buffer_load_dwordx4 v35, s[40:43], s77 offen offset:3072 nt lds
    s_waitcnt lgkmcnt(10)
    v_mfma_f32_16x16x32_bf16 v[128:131], a[192:195], v[104:107], v[128:131]
    ds_read_b64_tr_b16 a[180:181], v13 offset:256
    ds_read_b64_tr_b16 a[182:183], v13 offset:8448
    s_mov_b32 m0, 114688
    v_mfma_f32_16x16x32_bf16 v[136:139], a[196:199], v[104:107], v[136:139]
    ds_read_b64_tr_b16 a[184:185], v14 offset:256
    ds_read_b64_tr_b16 a[186:187], v14 offset:8448
    v_exp_f32 v64, v64
    s_mov_b32 s77, 147456
    v_mfma_f32_16x16x32_bf16 v[144:147], a[200:203], v[104:107], v[144:147]
    ds_read_b64_tr_b16 a[188:189], v15 offset:256
    ds_read_b64_tr_b16 a[190:191], v15 offset:8448
    buffer_load_dwordx4 v132, s[36:39], s77 offen offset:0 nt lds
    v_mfma_f32_16x16x32_bf16 v[152:155], a[204:207], v[104:107], v[152:155]
    v_exp_f32 v65, v65
    buffer_load_dwordx4 v140, s[36:39], s77 offen offset:1024 nt lds
    s_waitcnt lgkmcnt(8)
    v_mfma_f32_16x16x32_bf16 v[160:163], a[208:211], v[104:107], v[160:163]
    ds_read_b64_tr_b16 a[192:193], v16 offset:256
    ds_read_b64_tr_b16 a[194:195], v16 offset:8448
    buffer_load_dwordx4 v148, s[36:39], s77 offen offset:2048 nt lds
    v_mfma_f32_16x16x32_bf16 v[168:171], a[212:215], v[104:107], v[168:171]
    ds_read_b64_tr_b16 a[196:197], v17 offset:256
    ds_read_b64_tr_b16 a[198:199], v17 offset:8448
    buffer_load_dwordx4 v156, s[36:39], s77 offen offset:3072 nt lds
    v_mfma_f32_16x16x32_bf16 v[176:179], a[216:219], v[104:107], v[176:179]
    ds_read_b64_tr_b16 a[200:201], v18 offset:256
    ds_read_b64_tr_b16 a[202:203], v18 offset:8448
    v_exp_f32 v66, v66
    s_mov_b32 m0, 118784
    v_mfma_f32_16x16x32_bf16 v[184:187], a[220:223], v[104:107], v[184:187]
    ds_read_b64_tr_b16 a[204:205], v19 offset:256
    ds_read_b64_tr_b16 a[206:207], v19 offset:8448
    s_mov_b32 s77, 151552
    s_waitcnt lgkmcnt(8)
    v_mfma_f32_16x16x32_bf16 v[192:195], a[176:179], v[104:107], v[192:195]
    ds_read_b128 a[208:211], v4 offset:0
    v_cvt_pk_bf16_f32 v96, v64, v65
    buffer_load_dwordx4 v164, s[36:39], s77 offen offset:0 nt lds
    v_mfma_f32_16x16x32_bf16 v[200:203], a[180:183], v[104:107], v[200:203]
    ds_read_b128 a[212:215], v4 offset:8192
    buffer_load_dwordx4 v172, s[36:39], s77 offen offset:1024 nt lds
    v_mfma_f32_16x16x32_bf16 v[208:211], a[184:187], v[104:107], v[208:211]
    ds_read_b128 a[216:219], v5 offset:0
    buffer_load_dwordx4 v180, s[36:39], s77 offen offset:2048 nt lds
    v_mfma_f32_16x16x32_bf16 v[216:219], a[188:191], v[104:107], v[216:219]
    ds_read_b128 a[220:223], v5 offset:8192
    v_exp_f32 v67, v67
    buffer_load_dwordx4 v188, s[36:39], s77 offen offset:3072 nt lds
    s_waitcnt lgkmcnt(4)
    v_mfma_f32_16x16x32_bf16 v[224:227], a[192:195], v[104:107], v[224:227]
    ds_read_b128 a[176:179], v6 offset:0
    s_mov_b32 m0, 122880
    v_mfma_f32_16x16x32_bf16 v[232:235], a[196:199], v[104:107], v[232:235]
    ds_read_b128 a[180:183], v6 offset:8192
    v_exp_f32 v72, v72
    s_mov_b32 s77, 155648
    v_mfma_f32_16x16x32_bf16 v[240:243], a[200:203], v[104:107], v[240:243]
    ds_read_b128 a[184:187], v7 offset:0
    buffer_load_dwordx4 v132, s[36:39], s77 offen offset:0 nt lds
    v_mfma_f32_16x16x32_bf16 v[248:251], a[204:207], v[104:107], v[248:251]
    ds_read_b128 a[188:191], v7 offset:8192
    buffer_load_dwordx4 v140, s[36:39], s77 offen offset:1024 nt lds
    s_waitcnt lgkmcnt(4)
    v_mfma_f32_16x16x32_bf16 v[80:83], a[208:211], a[112:115], v[48:51]
    ds_read_b128 a[192:195], v4 offset:256
    v_cvt_pk_bf16_f32 v97, v66, v67
    buffer_load_dwordx4 v148, s[36:39], s77 offen offset:2048 nt lds
    v_mfma_f32_16x16x32_bf16 v[88:91], a[212:215], a[112:115], v[48:51]
    ds_read_b128 a[196:199], v4 offset:8448
    buffer_load_dwordx4 v156, s[36:39], s77 offen offset:3072 nt lds
    v_mfma_f32_16x16x32_bf16 v[80:83], a[216:219], a[120:123], v[80:83]
    ds_read_b128 a[200:203], v5 offset:256
    s_mov_b32 m0, 126976
    v_mfma_f32_16x16x32_bf16 v[88:91], a[220:223], a[120:123], v[88:91]
    ds_read_b128 a[204:207], v5 offset:8448
    v_exp_f32 v73, v73
    s_mov_b32 s77, 159744
    s_waitcnt lgkmcnt(4)
    v_mfma_f32_16x16x32_bf16 v[80:83], a[176:179], a[128:131], v[80:83]
    ds_read_b128 a[208:211], v6 offset:256
    buffer_load_dwordx4 v164, s[36:39], s77 offen offset:0 nt lds
    v_mfma_f32_16x16x32_bf16 v[88:91], a[180:183], a[128:131], v[88:91]
    ds_read_b128 a[212:215], v6 offset:8448
    v_exp_f32 v74, v74
    buffer_load_dwordx4 v172, s[36:39], s77 offen offset:1024 nt lds
    v_mfma_f32_16x16x32_bf16 v[80:83], a[184:187], a[136:139], v[80:83]
    ds_read_b128 a[216:219], v7 offset:256
    buffer_load_dwordx4 v180, s[36:39], s77 offen offset:2048 nt lds
    v_mfma_f32_16x16x32_bf16 v[88:91], a[188:191], a[136:139], v[88:91]
    ds_read_b128 a[220:223], v7 offset:8448
    buffer_load_dwordx4 v188, s[36:39], s77 offen offset:3072 nt lds
    s_waitcnt lgkmcnt(4)
    v_mfma_f32_16x16x32_bf16 v[80:83], a[192:195], a[144:147], v[80:83]
    s_waitcnt vmcnt(60)
    s_barrier
    ds_read_b64_tr_b16 a[176:177], v12 offset:16384
    ds_read_b64_tr_b16 a[178:179], v12 offset:24576
    v_cvt_pk_bf16_f32 v98, v72, v73
    v_mfma_f32_16x16x32_bf16 v[88:91], a[196:199], a[144:147], v[88:91]
    ds_read_b64_tr_b16 a[180:181], v13 offset:16384
    ds_read_b64_tr_b16 a[182:183], v13 offset:24576
    v_mfma_f32_16x16x32_bf16 v[80:83], a[200:203], a[152:155], v[80:83]
    ds_read_b64_tr_b16 a[184:185], v14 offset:16384
    ds_read_b64_tr_b16 a[186:187], v14 offset:24576
    v_exp_f32 v75, v75
    v_mfma_f32_16x16x32_bf16 v[88:91], a[204:207], a[152:155], v[88:91]
    ds_read_b64_tr_b16 a[188:189], v15 offset:16384
    ds_read_b64_tr_b16 a[190:191], v15 offset:24576
    s_waitcnt lgkmcnt(8)
    v_mfma_f32_16x16x32_bf16 v[80:83], a[208:211], a[160:163], v[80:83]
    ds_read_b64_tr_b16 a[192:193], v16 offset:16384
    ds_read_b64_tr_b16 a[194:195], v16 offset:24576
    s_mov_b32 m0, 77824
    s_mov_b32 s77, 143360
    v_mfma_f32_16x16x32_bf16 v[88:91], a[212:215], a[160:163], v[88:91]
    ds_read_b64_tr_b16 a[196:197], v17 offset:16384
    ds_read_b64_tr_b16 a[198:199], v17 offset:24576
    v_cvt_pk_bf16_f32 v99, v74, v75
    buffer_load_dwordx4 v32, s[40:43], s77 offen offset:0 nt lds
    v_mfma_f32_16x16x32_bf16 v[80:83], a[216:219], a[168:171], v[80:83]
    ds_read_b64_tr_b16 a[200:201], v18 offset:16384
    ds_read_b64_tr_b16 a[202:203], v18 offset:24576
    buffer_load_dwordx4 v33, s[40:43], s77 offen offset:1024 nt lds
    v_mfma_f32_16x16x32_bf16 v[88:91], a[220:223], a[168:171], v[88:91]
    ds_read_b64_tr_b16 a[204:205], v19 offset:16384
    ds_read_b64_tr_b16 a[206:207], v19 offset:24576
    buffer_load_dwordx4 v34, s[40:43], s77 offen offset:2048 nt lds
    v_mfma_f32_16x16x32_bf16 v[56:59], a[224:227], v[96:99], v[56:59]
    ds_read_b64_tr_b16 a[208:209], v12 offset:16640
    ds_read_b64_tr_b16 a[210:211], v12 offset:24832
    buffer_load_dwordx4 v35, s[40:43], s77 offen offset:3072 nt lds
    s_waitcnt lgkmcnt(10)
    v_mfma_f32_16x16x32_bf16 v[128:131], a[176:179], v[96:99], v[128:131]
    ds_read_b64_tr_b16 a[212:213], v13 offset:16640
    ds_read_b64_tr_b16 a[214:215], v13 offset:24832
    s_mov_b32 m0, 0
    v_mfma_f32_16x16x32_bf16 v[136:139], a[180:183], v[96:99], v[136:139]
    ds_read_b64_tr_b16 a[216:217], v14 offset:16640
    ds_read_b64_tr_b16 a[218:219], v14 offset:24832
    v_exp_f32 v80, v80
    s_mov_b32 s77, 163840
    v_mfma_f32_16x16x32_bf16 v[144:147], a[184:187], v[96:99], v[144:147]
    ds_read_b64_tr_b16 a[220:221], v15 offset:16640
    ds_read_b64_tr_b16 a[222:223], v15 offset:24832
    buffer_load_dwordx4 v132, s[36:39], s77 offen offset:0 nt lds
    v_mfma_f32_16x16x32_bf16 v[152:155], a[188:191], v[96:99], v[152:155]
    v_exp_f32 v81, v81
    buffer_load_dwordx4 v140, s[36:39], s77 offen offset:1024 nt lds
    s_waitcnt lgkmcnt(8)
    v_mfma_f32_16x16x32_bf16 v[160:163], a[192:195], v[96:99], v[160:163]
    ds_read_b64_tr_b16 a[176:177], v16 offset:16640
    ds_read_b64_tr_b16 a[178:179], v16 offset:24832
    buffer_load_dwordx4 v148, s[36:39], s77 offen offset:2048 nt lds
    v_mfma_f32_16x16x32_bf16 v[168:171], a[196:199], v[96:99], v[168:171]
    ds_read_b64_tr_b16 a[180:181], v17 offset:16640
    ds_read_b64_tr_b16 a[182:183], v17 offset:24832
    buffer_load_dwordx4 v156, s[36:39], s77 offen offset:3072 nt lds
    v_mfma_f32_16x16x32_bf16 v[176:179], a[200:203], v[96:99], v[176:179]
    ds_read_b64_tr_b16 a[184:185], v18 offset:16640
    ds_read_b64_tr_b16 a[186:187], v18 offset:24832
    v_exp_f32 v82, v82
    s_mov_b32 m0, 4096
    v_mfma_f32_16x16x32_bf16 v[184:187], a[204:207], v[96:99], v[184:187]
    ds_read_b64_tr_b16 a[188:189], v19 offset:16640
    ds_read_b64_tr_b16 a[190:191], v19 offset:24832
    s_mov_b32 s77, 167936
    s_waitcnt lgkmcnt(8)
    v_mfma_f32_16x16x32_bf16 v[192:195], a[208:211], v[96:99], v[192:195]
    ds_read_b128 a[192:195], v4 offset:16384
    v_cvt_pk_bf16_f32 v104, v80, v81
    buffer_load_dwordx4 v164, s[36:39], s77 offen offset:0 nt lds
    v_mfma_f32_16x16x32_bf16 v[200:203], a[212:215], v[96:99], v[200:203]
    ds_read_b128 a[196:199], v4 offset:24576
    buffer_load_dwordx4 v172, s[36:39], s77 offen offset:1024 nt lds
    v_mfma_f32_16x16x32_bf16 v[208:211], a[216:219], v[96:99], v[208:211]
    ds_read_b128 a[200:203], v5 offset:16384
    buffer_load_dwordx4 v180, s[36:39], s77 offen offset:2048 nt lds
    v_mfma_f32_16x16x32_bf16 v[216:219], a[220:223], v[96:99], v[216:219]
    ds_read_b128 a[204:207], v5 offset:24576
    v_exp_f32 v83, v83
    buffer_load_dwordx4 v188, s[36:39], s77 offen offset:3072 nt lds
    s_waitcnt lgkmcnt(4)
    v_mfma_f32_16x16x32_bf16 v[224:227], a[176:179], v[96:99], v[224:227]
    ds_read_b128 a[208:211], v6 offset:16384
    s_mov_b32 m0, 8192
    v_mfma_f32_16x16x32_bf16 v[232:235], a[180:183], v[96:99], v[232:235]
    ds_read_b128 a[212:215], v6 offset:24576
    v_exp_f32 v88, v88
    s_mov_b32 s77, 172032
    v_mfma_f32_16x16x32_bf16 v[240:243], a[184:187], v[96:99], v[240:243]
    ds_read_b128 a[216:219], v7 offset:16384
    buffer_load_dwordx4 v132, s[36:39], s77 offen offset:0 nt lds
    v_mfma_f32_16x16x32_bf16 v[248:251], a[188:191], v[96:99], v[248:251]
    ds_read_b128 a[220:223], v7 offset:24576
    buffer_load_dwordx4 v140, s[36:39], s77 offen offset:1024 nt lds
    s_waitcnt lgkmcnt(4)
    v_mfma_f32_16x16x32_bf16 v[64:67], a[192:195], a[112:115], v[48:51]
    ds_read_b128 a[176:179], v4 offset:16640
    v_cvt_pk_bf16_f32 v105, v82, v83
    buffer_load_dwordx4 v148, s[36:39], s77 offen offset:2048 nt lds
    v_mfma_f32_16x16x32_bf16 v[72:75], a[196:199], a[112:115], v[48:51]
    ds_read_b128 a[180:183], v4 offset:24832
    buffer_load_dwordx4 v156, s[36:39], s77 offen offset:3072 nt lds
    v_mfma_f32_16x16x32_bf16 v[64:67], a[200:203], a[120:123], v[64:67]
    ds_read_b128 a[184:187], v5 offset:16640
    s_mov_b32 m0, 12288
    v_mfma_f32_16x16x32_bf16 v[72:75], a[204:207], a[120:123], v[72:75]
    ds_read_b128 a[188:191], v5 offset:24832
    v_exp_f32 v89, v89
    s_mov_b32 s77, 176128
    s_waitcnt lgkmcnt(4)
    v_mfma_f32_16x16x32_bf16 v[64:67], a[208:211], a[128:131], v[64:67]
    ds_read_b128 a[192:195], v6 offset:16640
    buffer_load_dwordx4 v164, s[36:39], s77 offen offset:0 nt lds
    v_mfma_f32_16x16x32_bf16 v[72:75], a[212:215], a[128:131], v[72:75]
    ds_read_b128 a[196:199], v6 offset:24832
    v_exp_f32 v90, v90
    buffer_load_dwordx4 v172, s[36:39], s77 offen offset:1024 nt lds
    v_mfma_f32_16x16x32_bf16 v[64:67], a[216:219], a[136:139], v[64:67]
    ds_read_b128 a[200:203], v7 offset:16640
    buffer_load_dwordx4 v180, s[36:39], s77 offen offset:2048 nt lds
    v_mfma_f32_16x16x32_bf16 v[72:75], a[220:223], a[136:139], v[72:75]
    ds_read_b128 a[204:207], v7 offset:24832
    buffer_load_dwordx4 v188, s[36:39], s77 offen offset:3072 nt lds
    s_waitcnt lgkmcnt(4)
    v_mfma_f32_16x16x32_bf16 v[64:67], a[176:179], a[144:147], v[64:67]
    s_waitcnt vmcnt(60)
    s_barrier
    ds_read_b64_tr_b16 a[208:209], v20 offset:32768
    ds_read_b64_tr_b16 a[210:211], v20 offset:40960
    v_cvt_pk_bf16_f32 v106, v88, v89
    v_mfma_f32_16x16x32_bf16 v[72:75], a[180:183], a[144:147], v[72:75]
    ds_read_b64_tr_b16 a[212:213], v21 offset:32768
    ds_read_b64_tr_b16 a[214:215], v21 offset:40960
    v_mfma_f32_16x16x32_bf16 v[64:67], a[184:187], a[152:155], v[64:67]
    ds_read_b64_tr_b16 a[216:217], v22 offset:32768
    ds_read_b64_tr_b16 a[218:219], v22 offset:40960
    v_exp_f32 v91, v91
    v_mfma_f32_16x16x32_bf16 v[72:75], a[188:191], a[152:155], v[72:75]
    ds_read_b64_tr_b16 a[220:221], v23 offset:32768
    ds_read_b64_tr_b16 a[222:223], v23 offset:40960
    s_waitcnt lgkmcnt(8)
    v_mfma_f32_16x16x32_bf16 v[64:67], a[192:195], a[160:163], v[64:67]
    ds_read_b64_tr_b16 a[176:177], v24 offset:32768
    ds_read_b64_tr_b16 a[178:179], v24 offset:40960
    s_mov_b32 m0, 94208
    s_mov_b32 s77, 159744
    v_mfma_f32_16x16x32_bf16 v[72:75], a[196:199], a[160:163], v[72:75]
    ds_read_b64_tr_b16 a[180:181], v25 offset:32768
    ds_read_b64_tr_b16 a[182:183], v25 offset:40960
    v_cvt_pk_bf16_f32 v107, v90, v91
    buffer_load_dwordx4 v32, s[40:43], s77 offen offset:0 nt lds
    v_mfma_f32_16x16x32_bf16 v[64:67], a[200:203], a[168:171], v[64:67]
    ds_read_b64_tr_b16 a[184:185], v26 offset:32768
    ds_read_b64_tr_b16 a[186:187], v26 offset:40960
    buffer_load_dwordx4 v33, s[40:43], s77 offen offset:1024 nt lds
    v_mfma_f32_16x16x32_bf16 v[72:75], a[204:207], a[168:171], v[72:75]
    ds_read_b64_tr_b16 a[188:189], v27 offset:32768
    ds_read_b64_tr_b16 a[190:191], v27 offset:40960
    buffer_load_dwordx4 v34, s[40:43], s77 offen offset:2048 nt lds
    v_mfma_f32_16x16x32_bf16 v[56:59], a[224:227], v[104:107], v[56:59]
    ds_read_b64_tr_b16 a[192:193], v20 offset:33024
    ds_read_b64_tr_b16 a[194:195], v20 offset:41216
    buffer_load_dwordx4 v35, s[40:43], s77 offen offset:3072 nt lds
    s_waitcnt lgkmcnt(10)
    v_mfma_f32_16x16x32_bf16 v[128:131], a[208:211], v[104:107], v[128:131]
    ds_read_b64_tr_b16 a[196:197], v21 offset:33024
    ds_read_b64_tr_b16 a[198:199], v21 offset:41216
    s_mov_b32 m0, 16384
    v_mfma_f32_16x16x32_bf16 v[136:139], a[212:215], v[104:107], v[136:139]
    ds_read_b64_tr_b16 a[200:201], v22 offset:33024
    ds_read_b64_tr_b16 a[202:203], v22 offset:41216
    v_exp_f32 v64, v64
    s_mov_b32 s77, 180224
    v_mfma_f32_16x16x32_bf16 v[144:147], a[216:219], v[104:107], v[144:147]
    ds_read_b64_tr_b16 a[204:205], v23 offset:33024
    ds_read_b64_tr_b16 a[206:207], v23 offset:41216
    buffer_load_dwordx4 v132, s[36:39], s77 offen offset:0 nt lds
    v_mfma_f32_16x16x32_bf16 v[152:155], a[220:223], v[104:107], v[152:155]
    v_exp_f32 v65, v65
    buffer_load_dwordx4 v140, s[36:39], s77 offen offset:1024 nt lds
    s_waitcnt lgkmcnt(8)
    v_mfma_f32_16x16x32_bf16 v[160:163], a[176:179], v[104:107], v[160:163]
    ds_read_b64_tr_b16 a[208:209], v24 offset:33024
    ds_read_b64_tr_b16 a[210:211], v24 offset:41216
    buffer_load_dwordx4 v148, s[36:39], s77 offen offset:2048 nt lds
    v_mfma_f32_16x16x32_bf16 v[168:171], a[180:183], v[104:107], v[168:171]
    ds_read_b64_tr_b16 a[212:213], v25 offset:33024
    ds_read_b64_tr_b16 a[214:215], v25 offset:41216
    buffer_load_dwordx4 v156, s[36:39], s77 offen offset:3072 nt lds
    v_mfma_f32_16x16x32_bf16 v[176:179], a[184:187], v[104:107], v[176:179]
    ds_read_b64_tr_b16 a[216:217], v26 offset:33024
    ds_read_b64_tr_b16 a[218:219], v26 offset:41216
    v_exp_f32 v66, v66
    s_mov_b32 m0, 20480
    v_mfma_f32_16x16x32_bf16 v[184:187], a[188:191], v[104:107], v[184:187]
    ds_read_b64_tr_b16 a[220:221], v27 offset:33024
    ds_read_b64_tr_b16 a[222:223], v27 offset:41216
    s_mov_b32 s77, 184320
    s_waitcnt lgkmcnt(8)
    v_mfma_f32_16x16x32_bf16 v[192:195], a[192:195], v[104:107], v[192:195]
    ds_read_b128 a[176:179], v4 offset:32768
    v_cvt_pk_bf16_f32 v96, v64, v65
    buffer_load_dwordx4 v164, s[36:39], s77 offen offset:0 nt lds
    v_mfma_f32_16x16x32_bf16 v[200:203], a[196:199], v[104:107], v[200:203]
    ds_read_b128 a[180:183], v4 offset:40960
    buffer_load_dwordx4 v172, s[36:39], s77 offen offset:1024 nt lds
    v_mfma_f32_16x16x32_bf16 v[208:211], a[200:203], v[104:107], v[208:211]
    ds_read_b128 a[184:187], v5 offset:32768
    buffer_load_dwordx4 v180, s[36:39], s77 offen offset:2048 nt lds
    v_mfma_f32_16x16x32_bf16 v[216:219], a[204:207], v[104:107], v[216:219]
    ds_read_b128 a[188:191], v5 offset:40960
    v_exp_f32 v67, v67
    buffer_load_dwordx4 v188, s[36:39], s77 offen offset:3072 nt lds
    s_waitcnt lgkmcnt(4)
    v_mfma_f32_16x16x32_bf16 v[224:227], a[208:211], v[104:107], v[224:227]
    ds_read_b128 a[192:195], v6 offset:32768
    s_mov_b32 m0, 24576
    v_mfma_f32_16x16x32_bf16 v[232:235], a[212:215], v[104:107], v[232:235]
    ds_read_b128 a[196:199], v6 offset:40960
    v_exp_f32 v72, v72
    s_mov_b32 s77, 188416
    v_mfma_f32_16x16x32_bf16 v[240:243], a[216:219], v[104:107], v[240:243]
    ds_read_b128 a[200:203], v7 offset:32768
    buffer_load_dwordx4 v132, s[36:39], s77 offen offset:0 nt lds
    v_mfma_f32_16x16x32_bf16 v[248:251], a[220:223], v[104:107], v[248:251]
    ds_read_b128 a[204:207], v7 offset:40960
    buffer_load_dwordx4 v140, s[36:39], s77 offen offset:1024 nt lds
    s_waitcnt lgkmcnt(4)
    v_mfma_f32_16x16x32_bf16 v[80:83], a[176:179], a[112:115], v[48:51]
    ds_read_b128 a[208:211], v4 offset:33024
    v_cvt_pk_bf16_f32 v97, v66, v67
    buffer_load_dwordx4 v148, s[36:39], s77 offen offset:2048 nt lds
    v_mfma_f32_16x16x32_bf16 v[88:91], a[180:183], a[112:115], v[48:51]
    ds_read_b128 a[212:215], v4 offset:41216
    buffer_load_dwordx4 v156, s[36:39], s77 offen offset:3072 nt lds
    v_mfma_f32_16x16x32_bf16 v[80:83], a[184:187], a[120:123], v[80:83]
    ds_read_b128 a[216:219], v5 offset:33024
    s_mov_b32 m0, 28672
    v_mfma_f32_16x16x32_bf16 v[88:91], a[188:191], a[120:123], v[88:91]
    ds_read_b128 a[220:223], v5 offset:41216
    v_exp_f32 v73, v73
    s_mov_b32 s77, 192512
    s_waitcnt lgkmcnt(4)
    v_mfma_f32_16x16x32_bf16 v[80:83], a[192:195], a[128:131], v[80:83]
    ds_read_b128 a[176:179], v6 offset:33024
    buffer_load_dwordx4 v164, s[36:39], s77 offen offset:0 nt lds
    v_mfma_f32_16x16x32_bf16 v[88:91], a[196:199], a[128:131], v[88:91]
    ds_read_b128 a[180:183], v6 offset:41216
    v_exp_f32 v74, v74
    buffer_load_dwordx4 v172, s[36:39], s77 offen offset:1024 nt lds
    v_mfma_f32_16x16x32_bf16 v[80:83], a[200:203], a[136:139], v[80:83]
    ds_read_b128 a[184:187], v7 offset:33024
    buffer_load_dwordx4 v180, s[36:39], s77 offen offset:2048 nt lds
    v_mfma_f32_16x16x32_bf16 v[88:91], a[204:207], a[136:139], v[88:91]
    ds_read_b128 a[188:191], v7 offset:41216
    buffer_load_dwordx4 v188, s[36:39], s77 offen offset:3072 nt lds
    s_waitcnt lgkmcnt(4)
    v_mfma_f32_16x16x32_bf16 v[80:83], a[208:211], a[144:147], v[80:83]
    s_waitcnt vmcnt(60)
    s_barrier
    ds_read_b64_tr_b16 a[192:193], v20 offset:49152
    ds_read_b64_tr_b16 a[194:195], v20 offset:57344
    v_cvt_pk_bf16_f32 v98, v72, v73
    v_mfma_f32_16x16x32_bf16 v[88:91], a[212:215], a[144:147], v[88:91]
    ds_read_b64_tr_b16 a[196:197], v21 offset:49152
    ds_read_b64_tr_b16 a[198:199], v21 offset:57344
    v_mfma_f32_16x16x32_bf16 v[80:83], a[216:219], a[152:155], v[80:83]
    ds_read_b64_tr_b16 a[200:201], v22 offset:49152
    ds_read_b64_tr_b16 a[202:203], v22 offset:57344
    v_exp_f32 v75, v75
    v_mfma_f32_16x16x32_bf16 v[88:91], a[220:223], a[152:155], v[88:91]
    ds_read_b64_tr_b16 a[204:205], v23 offset:49152
    ds_read_b64_tr_b16 a[206:207], v23 offset:57344
    s_waitcnt lgkmcnt(8)
    v_mfma_f32_16x16x32_bf16 v[80:83], a[176:179], a[160:163], v[80:83]
    ds_read_b64_tr_b16 a[208:209], v24 offset:49152
    ds_read_b64_tr_b16 a[210:211], v24 offset:57344
    s_mov_b32 m0, 143360
    s_mov_b32 s77, 176128
    v_mfma_f32_16x16x32_bf16 v[88:91], a[180:183], a[160:163], v[88:91]
    ds_read_b64_tr_b16 a[212:213], v25 offset:49152
    ds_read_b64_tr_b16 a[214:215], v25 offset:57344
    v_cvt_pk_bf16_f32 v99, v74, v75
    buffer_load_dwordx4 v32, s[40:43], s77 offen offset:0 nt lds
    v_mfma_f32_16x16x32_bf16 v[80:83], a[184:187], a[168:171], v[80:83]
    ds_read_b64_tr_b16 a[216:217], v26 offset:49152
    ds_read_b64_tr_b16 a[218:219], v26 offset:57344
    buffer_load_dwordx4 v33, s[40:43], s77 offen offset:1024 nt lds
    v_mfma_f32_16x16x32_bf16 v[88:91], a[188:191], a[168:171], v[88:91]
    ds_read_b64_tr_b16 a[220:221], v27 offset:49152
    ds_read_b64_tr_b16 a[222:223], v27 offset:57344
    buffer_load_dwordx4 v34, s[40:43], s77 offen offset:2048 nt lds
    v_mfma_f32_16x16x32_bf16 v[56:59], a[224:227], v[96:99], v[56:59]
    ds_read_b64_tr_b16 a[176:177], v20 offset:49408
    ds_read_b64_tr_b16 a[178:179], v20 offset:57600
    buffer_load_dwordx4 v35, s[40:43], s77 offen offset:3072 nt lds
    s_waitcnt lgkmcnt(10)
    v_mfma_f32_16x16x32_bf16 v[128:131], a[192:195], v[96:99], v[128:131]
    ds_read_b64_tr_b16 a[180:181], v21 offset:49408
    ds_read_b64_tr_b16 a[182:183], v21 offset:57600
    s_mov_b32 m0, 32768
    v_mfma_f32_16x16x32_bf16 v[136:139], a[196:199], v[96:99], v[136:139]
    ds_read_b64_tr_b16 a[184:185], v22 offset:49408
    ds_read_b64_tr_b16 a[186:187], v22 offset:57600
    v_exp_f32 v80, v80
    s_mov_b32 s77, 196608
    v_mfma_f32_16x16x32_bf16 v[144:147], a[200:203], v[96:99], v[144:147]
    ds_read_b64_tr_b16 a[188:189], v23 offset:49408
    ds_read_b64_tr_b16 a[190:191], v23 offset:57600
    buffer_load_dwordx4 v132, s[36:39], s77 offen offset:0 nt lds
    v_mfma_f32_16x16x32_bf16 v[152:155], a[204:207], v[96:99], v[152:155]
    v_exp_f32 v81, v81
    buffer_load_dwordx4 v140, s[36:39], s77 offen offset:1024 nt lds
    s_waitcnt lgkmcnt(8)
    v_mfma_f32_16x16x32_bf16 v[160:163], a[208:211], v[96:99], v[160:163]
    ds_read_b64_tr_b16 a[192:193], v24 offset:49408
    ds_read_b64_tr_b16 a[194:195], v24 offset:57600
    buffer_load_dwordx4 v148, s[36:39], s77 offen offset:2048 nt lds
    v_mfma_f32_16x16x32_bf16 v[168:171], a[212:215], v[96:99], v[168:171]
    ds_read_b64_tr_b16 a[196:197], v25 offset:49408
    ds_read_b64_tr_b16 a[198:199], v25 offset:57600
    buffer_load_dwordx4 v156, s[36:39], s77 offen offset:3072 nt lds
    v_mfma_f32_16x16x32_bf16 v[176:179], a[216:219], v[96:99], v[176:179]
    ds_read_b64_tr_b16 a[200:201], v26 offset:49408
    ds_read_b64_tr_b16 a[202:203], v26 offset:57600
    v_exp_f32 v82, v82
    s_mov_b32 m0, 36864
    v_mfma_f32_16x16x32_bf16 v[184:187], a[220:223], v[96:99], v[184:187]
    ds_read_b64_tr_b16 a[204:205], v27 offset:49408
    ds_read_b64_tr_b16 a[206:207], v27 offset:57600
    s_mov_b32 s77, 200704
    s_waitcnt lgkmcnt(8)
    v_mfma_f32_16x16x32_bf16 v[192:195], a[176:179], v[96:99], v[192:195]
    ds_read_b128 a[208:211], v4 offset:49152
    v_cvt_pk_bf16_f32 v104, v80, v81
    buffer_load_dwordx4 v164, s[36:39], s77 offen offset:0 nt lds
    v_mfma_f32_16x16x32_bf16 v[200:203], a[180:183], v[96:99], v[200:203]
    ds_read_b128 a[212:215], v4 offset:57344
    buffer_load_dwordx4 v172, s[36:39], s77 offen offset:1024 nt lds
    v_mfma_f32_16x16x32_bf16 v[208:211], a[184:187], v[96:99], v[208:211]
    ds_read_b128 a[216:219], v5 offset:49152
    buffer_load_dwordx4 v180, s[36:39], s77 offen offset:2048 nt lds
    v_mfma_f32_16x16x32_bf16 v[216:219], a[188:191], v[96:99], v[216:219]
    ds_read_b128 a[220:223], v5 offset:57344
    v_exp_f32 v83, v83
    buffer_load_dwordx4 v188, s[36:39], s77 offen offset:3072 nt lds
    s_waitcnt lgkmcnt(4)
    v_mfma_f32_16x16x32_bf16 v[224:227], a[192:195], v[96:99], v[224:227]
    ds_read_b128 a[176:179], v6 offset:49152
    s_mov_b32 m0, 40960
    v_mfma_f32_16x16x32_bf16 v[232:235], a[196:199], v[96:99], v[232:235]
    ds_read_b128 a[180:183], v6 offset:57344
    v_exp_f32 v88, v88
    s_mov_b32 s77, 204800
    v_mfma_f32_16x16x32_bf16 v[240:243], a[200:203], v[96:99], v[240:243]
    ds_read_b128 a[184:187], v7 offset:49152
    buffer_load_dwordx4 v132, s[36:39], s77 offen offset:0 nt lds
    v_mfma_f32_16x16x32_bf16 v[248:251], a[204:207], v[96:99], v[248:251]
    ds_read_b128 a[188:191], v7 offset:57344
    buffer_load_dwordx4 v140, s[36:39], s77 offen offset:1024 nt lds
    s_waitcnt lgkmcnt(4)
    v_mfma_f32_16x16x32_bf16 v[64:67], a[208:211], a[112:115], v[48:51]
    ds_read_b128 a[192:195], v4 offset:49408
    v_cvt_pk_bf16_f32 v105, v82, v83
    buffer_load_dwordx4 v148, s[36:39], s77 offen offset:2048 nt lds
    v_mfma_f32_16x16x32_bf16 v[72:75], a[212:215], a[112:115], v[48:51]
    ds_read_b128 a[196:199], v4 offset:57600
    buffer_load_dwordx4 v156, s[36:39], s77 offen offset:3072 nt lds
    v_mfma_f32_16x16x32_bf16 v[64:67], a[216:219], a[120:123], v[64:67]
    ds_read_b128 a[200:203], v5 offset:49408
    s_mov_b32 m0, 45056
    v_mfma_f32_16x16x32_bf16 v[72:75], a[220:223], a[120:123], v[72:75]
    ds_read_b128 a[204:207], v5 offset:57600
    v_exp_f32 v89, v89
    s_mov_b32 s77, 208896
    s_waitcnt lgkmcnt(4)
    v_mfma_f32_16x16x32_bf16 v[64:67], a[176:179], a[128:131], v[64:67]
    ds_read_b128 a[208:211], v6 offset:49408
    buffer_load_dwordx4 v164, s[36:39], s77 offen offset:0 nt lds
    v_mfma_f32_16x16x32_bf16 v[72:75], a[180:183], a[128:131], v[72:75]
    ds_read_b128 a[212:215], v6 offset:57600
    v_exp_f32 v90, v90
    buffer_load_dwordx4 v172, s[36:39], s77 offen offset:1024 nt lds
    v_mfma_f32_16x16x32_bf16 v[64:67], a[184:187], a[136:139], v[64:67]
    ds_read_b128 a[216:219], v7 offset:49408
    buffer_load_dwordx4 v180, s[36:39], s77 offen offset:2048 nt lds
    v_mfma_f32_16x16x32_bf16 v[72:75], a[188:191], a[136:139], v[72:75]
    ds_read_b128 a[220:223], v7 offset:57600
    buffer_load_dwordx4 v188, s[36:39], s77 offen offset:3072 nt lds
    s_waitcnt lgkmcnt(4)
    v_mfma_f32_16x16x32_bf16 v[64:67], a[192:195], a[144:147], v[64:67]
    s_waitcnt vmcnt(60)
    s_barrier
    ds_read_b64_tr_b16 a[176:177], v12 offset:32768
    ds_read_b64_tr_b16 a[178:179], v12 offset:40960
    v_cvt_pk_bf16_f32 v106, v88, v89
    v_mfma_f32_16x16x32_bf16 v[72:75], a[196:199], a[144:147], v[72:75]
    ds_read_b64_tr_b16 a[180:181], v13 offset:32768
    ds_read_b64_tr_b16 a[182:183], v13 offset:40960
    v_mfma_f32_16x16x32_bf16 v[64:67], a[200:203], a[152:155], v[64:67]
    ds_read_b64_tr_b16 a[184:185], v14 offset:32768
    ds_read_b64_tr_b16 a[186:187], v14 offset:40960
    v_exp_f32 v91, v91
    v_mfma_f32_16x16x32_bf16 v[72:75], a[204:207], a[152:155], v[72:75]
    ds_read_b64_tr_b16 a[188:189], v15 offset:32768
    ds_read_b64_tr_b16 a[190:191], v15 offset:40960
    s_waitcnt lgkmcnt(8)
    v_mfma_f32_16x16x32_bf16 v[64:67], a[208:211], a[160:163], v[64:67]
    ds_read_b64_tr_b16 a[192:193], v16 offset:32768
    ds_read_b64_tr_b16 a[194:195], v16 offset:40960
    s_mov_b32 m0, 159744
    s_mov_b32 s77, 192512
    v_mfma_f32_16x16x32_bf16 v[72:75], a[212:215], a[160:163], v[72:75]
    ds_read_b64_tr_b16 a[196:197], v17 offset:32768
    ds_read_b64_tr_b16 a[198:199], v17 offset:40960
    v_cvt_pk_bf16_f32 v107, v90, v91
    buffer_load_dwordx4 v32, s[40:43], s77 offen offset:0 nt lds
    v_mfma_f32_16x16x32_bf16 v[64:67], a[216:219], a[168:171], v[64:67]
    ds_read_b64_tr_b16 a[200:201], v18 offset:32768
    ds_read_b64_tr_b16 a[202:203], v18 offset:40960
    buffer_load_dwordx4 v33, s[40:43], s77 offen offset:1024 nt lds
    v_mfma_f32_16x16x32_bf16 v[72:75], a[220:223], a[168:171], v[72:75]
    ds_read_b64_tr_b16 a[204:205], v19 offset:32768
    ds_read_b64_tr_b16 a[206:207], v19 offset:40960
    buffer_load_dwordx4 v34, s[40:43], s77 offen offset:2048 nt lds
    v_mfma_f32_16x16x32_bf16 v[56:59], a[224:227], v[104:107], v[56:59]
    ds_read_b64_tr_b16 a[208:209], v12 offset:33024
    ds_read_b64_tr_b16 a[210:211], v12 offset:41216
    buffer_load_dwordx4 v35, s[40:43], s77 offen offset:3072 nt lds
    s_waitcnt lgkmcnt(10)
    v_mfma_f32_16x16x32_bf16 v[128:131], a[176:179], v[104:107], v[128:131]
    ds_read_b64_tr_b16 a[212:213], v13 offset:33024
    ds_read_b64_tr_b16 a[214:215], v13 offset:41216
    s_mov_b32 m0, 49152
    v_mfma_f32_16x16x32_bf16 v[136:139], a[180:183], v[104:107], v[136:139]
    ds_read_b64_tr_b16 a[216:217], v14 offset:33024
    ds_read_b64_tr_b16 a[218:219], v14 offset:41216
    v_exp_f32 v64, v64
    s_mov_b32 s77, 212992
    v_mfma_f32_16x16x32_bf16 v[144:147], a[184:187], v[104:107], v[144:147]
    ds_read_b64_tr_b16 a[220:221], v15 offset:33024
    ds_read_b64_tr_b16 a[222:223], v15 offset:41216
    buffer_load_dwordx4 v132, s[36:39], s77 offen offset:0 nt lds
    v_mfma_f32_16x16x32_bf16 v[152:155], a[188:191], v[104:107], v[152:155]
    v_exp_f32 v65, v65
    buffer_load_dwordx4 v140, s[36:39], s77 offen offset:1024 nt lds
    s_waitcnt lgkmcnt(8)
    v_mfma_f32_16x16x32_bf16 v[160:163], a[192:195], v[104:107], v[160:163]
    ds_read_b64_tr_b16 a[176:177], v16 offset:33024
    ds_read_b64_tr_b16 a[178:179], v16 offset:41216
    buffer_load_dwordx4 v148, s[36:39], s77 offen offset:2048 nt lds
    v_mfma_f32_16x16x32_bf16 v[168:171], a[196:199], v[104:107], v[168:171]
    ds_read_b64_tr_b16 a[180:181], v17 offset:33024
    ds_read_b64_tr_b16 a[182:183], v17 offset:41216
    buffer_load_dwordx4 v156, s[36:39], s77 offen offset:3072 nt lds
    v_mfma_f32_16x16x32_bf16 v[176:179], a[200:203], v[104:107], v[176:179]
    ds_read_b64_tr_b16 a[184:185], v18 offset:33024
    ds_read_b64_tr_b16 a[186:187], v18 offset:41216
    v_exp_f32 v66, v66
    s_mov_b32 m0, 53248
    v_mfma_f32_16x16x32_bf16 v[184:187], a[204:207], v[104:107], v[184:187]
    ds_read_b64_tr_b16 a[188:189], v19 offset:33024
    ds_read_b64_tr_b16 a[190:191], v19 offset:41216
    s_mov_b32 s77, 217088
    s_waitcnt lgkmcnt(8)
    v_mfma_f32_16x16x32_bf16 v[192:195], a[208:211], v[104:107], v[192:195]
    ds_read_b128 a[192:195], v8 offset:49152
    v_cvt_pk_bf16_f32 v96, v64, v65
    buffer_load_dwordx4 v164, s[36:39], s77 offen offset:0 nt lds
    v_mfma_f32_16x16x32_bf16 v[200:203], a[212:215], v[104:107], v[200:203]
    ds_read_b128 a[196:199], v8 offset:57344
    buffer_load_dwordx4 v172, s[36:39], s77 offen offset:1024 nt lds
    v_mfma_f32_16x16x32_bf16 v[208:211], a[216:219], v[104:107], v[208:211]
    ds_read_b128 a[200:203], v9 offset:49152
    buffer_load_dwordx4 v180, s[36:39], s77 offen offset:2048 nt lds
    v_mfma_f32_16x16x32_bf16 v[216:219], a[220:223], v[104:107], v[216:219]
    ds_read_b128 a[204:207], v9 offset:57344
    v_exp_f32 v67, v67
    buffer_load_dwordx4 v188, s[36:39], s77 offen offset:3072 nt lds
    s_waitcnt lgkmcnt(4)
    v_mfma_f32_16x16x32_bf16 v[224:227], a[176:179], v[104:107], v[224:227]
    ds_read_b128 a[208:211], v10 offset:49152
    s_mov_b32 m0, 57344
    v_mfma_f32_16x16x32_bf16 v[232:235], a[180:183], v[104:107], v[232:235]
    ds_read_b128 a[212:215], v10 offset:57344
    v_exp_f32 v72, v72
    s_mov_b32 s77, 221184
    v_mfma_f32_16x16x32_bf16 v[240:243], a[184:187], v[104:107], v[240:243]
    ds_read_b128 a[216:219], v11 offset:49152
    buffer_load_dwordx4 v132, s[36:39], s77 offen offset:0 nt lds
    v_mfma_f32_16x16x32_bf16 v[248:251], a[188:191], v[104:107], v[248:251]
    ds_read_b128 a[220:223], v11 offset:57344
    buffer_load_dwordx4 v140, s[36:39], s77 offen offset:1024 nt lds
    s_waitcnt lgkmcnt(4)
    v_mfma_f32_16x16x32_bf16 v[80:83], a[192:195], a[112:115], v[48:51]
    ds_read_b128 a[176:179], v8 offset:49408
    v_cvt_pk_bf16_f32 v97, v66, v67
    buffer_load_dwordx4 v148, s[36:39], s77 offen offset:2048 nt lds
    v_mfma_f32_16x16x32_bf16 v[88:91], a[196:199], a[112:115], v[48:51]
    ds_read_b128 a[180:183], v8 offset:57600
    buffer_load_dwordx4 v156, s[36:39], s77 offen offset:3072 nt lds
    v_mfma_f32_16x16x32_bf16 v[80:83], a[200:203], a[120:123], v[80:83]
    ds_read_b128 a[184:187], v9 offset:49408
    s_mov_b32 m0, 61440
    v_mfma_f32_16x16x32_bf16 v[88:91], a[204:207], a[120:123], v[88:91]
    ds_read_b128 a[188:191], v9 offset:57600
    v_exp_f32 v73, v73
    s_mov_b32 s77, 225280
    s_waitcnt lgkmcnt(4)
    v_mfma_f32_16x16x32_bf16 v[80:83], a[208:211], a[128:131], v[80:83]
    ds_read_b128 a[192:195], v10 offset:49408
    buffer_load_dwordx4 v164, s[36:39], s77 offen offset:0 nt lds
    v_mfma_f32_16x16x32_bf16 v[88:91], a[212:215], a[128:131], v[88:91]
    ds_read_b128 a[196:199], v10 offset:57600
    v_exp_f32 v74, v74
    buffer_load_dwordx4 v172, s[36:39], s77 offen offset:1024 nt lds
    v_mfma_f32_16x16x32_bf16 v[80:83], a[216:219], a[136:139], v[80:83]
    ds_read_b128 a[200:203], v11 offset:49408
    buffer_load_dwordx4 v180, s[36:39], s77 offen offset:2048 nt lds
    v_mfma_f32_16x16x32_bf16 v[88:91], a[220:223], a[136:139], v[88:91]
    ds_read_b128 a[204:207], v11 offset:57600
    buffer_load_dwordx4 v188, s[36:39], s77 offen offset:3072 nt lds
    s_waitcnt lgkmcnt(4)
    v_mfma_f32_16x16x32_bf16 v[80:83], a[176:179], a[144:147], v[80:83]
    s_waitcnt vmcnt(60)
    s_barrier
    ds_read_b64_tr_b16 a[208:209], v12 offset:0
    ds_read_b64_tr_b16 a[210:211], v12 offset:8192
    v_cvt_pk_bf16_f32 v98, v72, v73
    v_mfma_f32_16x16x32_bf16 v[88:91], a[180:183], a[144:147], v[88:91]
    ds_read_b64_tr_b16 a[212:213], v13 offset:0
    ds_read_b64_tr_b16 a[214:215], v13 offset:8192
    v_mfma_f32_16x16x32_bf16 v[80:83], a[184:187], a[152:155], v[80:83]
    ds_read_b64_tr_b16 a[216:217], v14 offset:0
    ds_read_b64_tr_b16 a[218:219], v14 offset:8192
    v_exp_f32 v75, v75
    v_mfma_f32_16x16x32_bf16 v[88:91], a[188:191], a[152:155], v[88:91]
    ds_read_b64_tr_b16 a[220:221], v15 offset:0
    ds_read_b64_tr_b16 a[222:223], v15 offset:8192
    s_waitcnt lgkmcnt(8)
    v_mfma_f32_16x16x32_bf16 v[80:83], a[192:195], a[160:163], v[80:83]
    ds_read_b64_tr_b16 a[176:177], v16 offset:0
    ds_read_b64_tr_b16 a[178:179], v16 offset:8192
    s_mov_b32 m0, 110592
    s_mov_b32 s77, 208896
    v_mfma_f32_16x16x32_bf16 v[88:91], a[196:199], a[160:163], v[88:91]
    ds_read_b64_tr_b16 a[180:181], v17 offset:0
    ds_read_b64_tr_b16 a[182:183], v17 offset:8192
    v_cvt_pk_bf16_f32 v99, v74, v75
    buffer_load_dwordx4 v32, s[40:43], s77 offen offset:0 nt lds
    v_mfma_f32_16x16x32_bf16 v[80:83], a[200:203], a[168:171], v[80:83]
    ds_read_b64_tr_b16 a[184:185], v18 offset:0
    ds_read_b64_tr_b16 a[186:187], v18 offset:8192
    buffer_load_dwordx4 v33, s[40:43], s77 offen offset:1024 nt lds
    v_mfma_f32_16x16x32_bf16 v[88:91], a[204:207], a[168:171], v[88:91]
    ds_read_b64_tr_b16 a[188:189], v19 offset:0
    ds_read_b64_tr_b16 a[190:191], v19 offset:8192
    buffer_load_dwordx4 v34, s[40:43], s77 offen offset:2048 nt lds
    v_mfma_f32_16x16x32_bf16 v[56:59], a[224:227], v[96:99], v[56:59]
    ds_read_b64_tr_b16 a[192:193], v12 offset:256
    ds_read_b64_tr_b16 a[194:195], v12 offset:8448
    buffer_load_dwordx4 v35, s[40:43], s77 offen offset:3072 nt lds
    s_waitcnt lgkmcnt(10)
    v_mfma_f32_16x16x32_bf16 v[128:131], a[208:211], v[96:99], v[128:131]
    ds_read_b64_tr_b16 a[196:197], v13 offset:256
    ds_read_b64_tr_b16 a[198:199], v13 offset:8448
    s_mov_b32 m0, 114688
    v_mfma_f32_16x16x32_bf16 v[136:139], a[212:215], v[96:99], v[136:139]
    ds_read_b64_tr_b16 a[200:201], v14 offset:256
    ds_read_b64_tr_b16 a[202:203], v14 offset:8448
    v_exp_f32 v80, v80
    s_mov_b32 s77, 229376
    v_mfma_f32_16x16x32_bf16 v[144:147], a[216:219], v[96:99], v[144:147]
    ds_read_b64_tr_b16 a[204:205], v15 offset:256
    ds_read_b64_tr_b16 a[206:207], v15 offset:8448
    buffer_load_dwordx4 v132, s[36:39], s77 offen offset:0 nt lds
    v_mfma_f32_16x16x32_bf16 v[152:155], a[220:223], v[96:99], v[152:155]
    v_exp_f32 v81, v81
    buffer_load_dwordx4 v140, s[36:39], s77 offen offset:1024 nt lds
    s_waitcnt lgkmcnt(8)
    v_mfma_f32_16x16x32_bf16 v[160:163], a[176:179], v[96:99], v[160:163]
    ds_read_b64_tr_b16 a[208:209], v16 offset:256
    ds_read_b64_tr_b16 a[210:211], v16 offset:8448
    buffer_load_dwordx4 v148, s[36:39], s77 offen offset:2048 nt lds
    v_mfma_f32_16x16x32_bf16 v[168:171], a[180:183], v[96:99], v[168:171]
    ds_read_b64_tr_b16 a[212:213], v17 offset:256
    ds_read_b64_tr_b16 a[214:215], v17 offset:8448
    buffer_load_dwordx4 v156, s[36:39], s77 offen offset:3072 nt lds
    v_mfma_f32_16x16x32_bf16 v[176:179], a[184:187], v[96:99], v[176:179]
    ds_read_b64_tr_b16 a[216:217], v18 offset:256
    ds_read_b64_tr_b16 a[218:219], v18 offset:8448
    v_exp_f32 v82, v82
    s_mov_b32 m0, 118784
    v_mfma_f32_16x16x32_bf16 v[184:187], a[188:191], v[96:99], v[184:187]
    ds_read_b64_tr_b16 a[220:221], v19 offset:256
    ds_read_b64_tr_b16 a[222:223], v19 offset:8448
    s_mov_b32 s77, 233472
    s_waitcnt lgkmcnt(8)
    v_mfma_f32_16x16x32_bf16 v[192:195], a[192:195], v[96:99], v[192:195]
    ds_read_b128 a[176:179], v4 offset:0
    v_cvt_pk_bf16_f32 v104, v80, v81
    buffer_load_dwordx4 v164, s[36:39], s77 offen offset:0 nt lds
    v_mfma_f32_16x16x32_bf16 v[200:203], a[196:199], v[96:99], v[200:203]
    ds_read_b128 a[180:183], v4 offset:8192
    buffer_load_dwordx4 v172, s[36:39], s77 offen offset:1024 nt lds
    v_mfma_f32_16x16x32_bf16 v[208:211], a[200:203], v[96:99], v[208:211]
    ds_read_b128 a[184:187], v5 offset:0
    buffer_load_dwordx4 v180, s[36:39], s77 offen offset:2048 nt lds
    v_mfma_f32_16x16x32_bf16 v[216:219], a[204:207], v[96:99], v[216:219]
    ds_read_b128 a[188:191], v5 offset:8192
    v_exp_f32 v83, v83
    buffer_load_dwordx4 v188, s[36:39], s77 offen offset:3072 nt lds
    s_waitcnt lgkmcnt(4)
    v_mfma_f32_16x16x32_bf16 v[224:227], a[208:211], v[96:99], v[224:227]
    ds_read_b128 a[192:195], v6 offset:0
    s_mov_b32 m0, 122880
    v_mfma_f32_16x16x32_bf16 v[232:235], a[212:215], v[96:99], v[232:235]
    ds_read_b128 a[196:199], v6 offset:8192
    v_exp_f32 v88, v88
    s_mov_b32 s77, 237568
    v_mfma_f32_16x16x32_bf16 v[240:243], a[216:219], v[96:99], v[240:243]
    ds_read_b128 a[200:203], v7 offset:0
    buffer_load_dwordx4 v132, s[36:39], s77 offen offset:0 nt lds
    v_mfma_f32_16x16x32_bf16 v[248:251], a[220:223], v[96:99], v[248:251]
    ds_read_b128 a[204:207], v7 offset:8192
    buffer_load_dwordx4 v140, s[36:39], s77 offen offset:1024 nt lds
    s_waitcnt lgkmcnt(4)
    v_mfma_f32_16x16x32_bf16 v[64:67], a[176:179], a[112:115], v[48:51]
    ds_read_b128 a[208:211], v4 offset:256
    v_cvt_pk_bf16_f32 v105, v82, v83
    buffer_load_dwordx4 v148, s[36:39], s77 offen offset:2048 nt lds
    v_mfma_f32_16x16x32_bf16 v[72:75], a[180:183], a[112:115], v[48:51]
    ds_read_b128 a[212:215], v4 offset:8448
    buffer_load_dwordx4 v156, s[36:39], s77 offen offset:3072 nt lds
    v_mfma_f32_16x16x32_bf16 v[64:67], a[184:187], a[120:123], v[64:67]
    ds_read_b128 a[216:219], v5 offset:256
    s_mov_b32 m0, 126976
    v_mfma_f32_16x16x32_bf16 v[72:75], a[188:191], a[120:123], v[72:75]
    ds_read_b128 a[220:223], v5 offset:8448
    v_exp_f32 v89, v89
    s_mov_b32 s77, 241664
    s_waitcnt lgkmcnt(4)
    v_mfma_f32_16x16x32_bf16 v[64:67], a[192:195], a[128:131], v[64:67]
    ds_read_b128 a[176:179], v6 offset:256
    buffer_load_dwordx4 v164, s[36:39], s77 offen offset:0 nt lds
    v_mfma_f32_16x16x32_bf16 v[72:75], a[196:199], a[128:131], v[72:75]
    ds_read_b128 a[180:183], v6 offset:8448
    v_exp_f32 v90, v90
    buffer_load_dwordx4 v172, s[36:39], s77 offen offset:1024 nt lds
    v_mfma_f32_16x16x32_bf16 v[64:67], a[200:203], a[136:139], v[64:67]
    ds_read_b128 a[184:187], v7 offset:256
    buffer_load_dwordx4 v180, s[36:39], s77 offen offset:2048 nt lds
    v_mfma_f32_16x16x32_bf16 v[72:75], a[204:207], a[136:139], v[72:75]
    ds_read_b128 a[188:191], v7 offset:8448
    buffer_load_dwordx4 v188, s[36:39], s77 offen offset:3072 nt lds
    s_waitcnt lgkmcnt(4)
    v_mfma_f32_16x16x32_bf16 v[64:67], a[208:211], a[144:147], v[64:67]
    s_waitcnt vmcnt(60)
    s_barrier
    ds_read_b64_tr_b16 a[192:193], v12 offset:16384
    ds_read_b64_tr_b16 a[194:195], v12 offset:24576
    v_cvt_pk_bf16_f32 v106, v88, v89
    v_mfma_f32_16x16x32_bf16 v[72:75], a[212:215], a[144:147], v[72:75]
    ds_read_b64_tr_b16 a[196:197], v13 offset:16384
    ds_read_b64_tr_b16 a[198:199], v13 offset:24576
    v_mfma_f32_16x16x32_bf16 v[64:67], a[216:219], a[152:155], v[64:67]
    ds_read_b64_tr_b16 a[200:201], v14 offset:16384
    ds_read_b64_tr_b16 a[202:203], v14 offset:24576
    v_exp_f32 v91, v91
    v_mfma_f32_16x16x32_bf16 v[72:75], a[220:223], a[152:155], v[72:75]
    ds_read_b64_tr_b16 a[204:205], v15 offset:16384
    ds_read_b64_tr_b16 a[206:207], v15 offset:24576
    s_waitcnt lgkmcnt(8)
    v_mfma_f32_16x16x32_bf16 v[64:67], a[176:179], a[160:163], v[64:67]
    ds_read_b64_tr_b16 a[208:209], v16 offset:16384
    ds_read_b64_tr_b16 a[210:211], v16 offset:24576
    s_mov_b32 m0, 77824
    s_mov_b32 s77, 225280
    v_mfma_f32_16x16x32_bf16 v[72:75], a[180:183], a[160:163], v[72:75]
    ds_read_b64_tr_b16 a[212:213], v17 offset:16384
    ds_read_b64_tr_b16 a[214:215], v17 offset:24576
    v_cvt_pk_bf16_f32 v107, v90, v91
    buffer_load_dwordx4 v32, s[40:43], s77 offen offset:0 nt lds
    v_mfma_f32_16x16x32_bf16 v[64:67], a[184:187], a[168:171], v[64:67]
    ds_read_b64_tr_b16 a[216:217], v18 offset:16384
    ds_read_b64_tr_b16 a[218:219], v18 offset:24576
    buffer_load_dwordx4 v33, s[40:43], s77 offen offset:1024 nt lds
    v_mfma_f32_16x16x32_bf16 v[72:75], a[188:191], a[168:171], v[72:75]
    ds_read_b64_tr_b16 a[220:221], v19 offset:16384
    ds_read_b64_tr_b16 a[222:223], v19 offset:24576
    buffer_load_dwordx4 v34, s[40:43], s77 offen offset:2048 nt lds
    v_mfma_f32_16x16x32_bf16 v[56:59], a[224:227], v[104:107], v[56:59]
    ds_read_b64_tr_b16 a[176:177], v12 offset:16640
    ds_read_b64_tr_b16 a[178:179], v12 offset:24832
    buffer_load_dwordx4 v35, s[40:43], s77 offen offset:3072 nt lds
    s_waitcnt lgkmcnt(10)
    v_mfma_f32_16x16x32_bf16 v[128:131], a[192:195], v[104:107], v[128:131]
    ds_read_b64_tr_b16 a[180:181], v13 offset:16640
    ds_read_b64_tr_b16 a[182:183], v13 offset:24832
    s_mov_b32 m0, 0
    v_mfma_f32_16x16x32_bf16 v[136:139], a[196:199], v[104:107], v[136:139]
    ds_read_b64_tr_b16 a[184:185], v14 offset:16640
    ds_read_b64_tr_b16 a[186:187], v14 offset:24832
    v_exp_f32 v64, v64
    s_mov_b32 s77, 245760
    v_mfma_f32_16x16x32_bf16 v[144:147], a[200:203], v[104:107], v[144:147]
    ds_read_b64_tr_b16 a[188:189], v15 offset:16640
    ds_read_b64_tr_b16 a[190:191], v15 offset:24832
    buffer_load_dwordx4 v132, s[36:39], s77 offen offset:0 nt lds
    v_mfma_f32_16x16x32_bf16 v[152:155], a[204:207], v[104:107], v[152:155]
    v_exp_f32 v65, v65
    buffer_load_dwordx4 v140, s[36:39], s77 offen offset:1024 nt lds
    s_waitcnt lgkmcnt(8)
    v_mfma_f32_16x16x32_bf16 v[160:163], a[208:211], v[104:107], v[160:163]
    ds_read_b64_tr_b16 a[192:193], v16 offset:16640
    ds_read_b64_tr_b16 a[194:195], v16 offset:24832
    buffer_load_dwordx4 v148, s[36:39], s77 offen offset:2048 nt lds
    v_mfma_f32_16x16x32_bf16 v[168:171], a[212:215], v[104:107], v[168:171]
    ds_read_b64_tr_b16 a[196:197], v17 offset:16640
    ds_read_b64_tr_b16 a[198:199], v17 offset:24832
    buffer_load_dwordx4 v156, s[36:39], s77 offen offset:3072 nt lds
    v_mfma_f32_16x16x32_bf16 v[176:179], a[216:219], v[104:107], v[176:179]
    ds_read_b64_tr_b16 a[200:201], v18 offset:16640
    ds_read_b64_tr_b16 a[202:203], v18 offset:24832
    v_exp_f32 v66, v66
    s_mov_b32 m0, 4096
    v_mfma_f32_16x16x32_bf16 v[184:187], a[220:223], v[104:107], v[184:187]
    ds_read_b64_tr_b16 a[204:205], v19 offset:16640
    ds_read_b64_tr_b16 a[206:207], v19 offset:24832
    s_mov_b32 s77, 249856
    s_waitcnt lgkmcnt(8)
    v_mfma_f32_16x16x32_bf16 v[192:195], a[176:179], v[104:107], v[192:195]
    ds_read_b128 a[208:211], v4 offset:16384
    v_cvt_pk_bf16_f32 v96, v64, v65
    buffer_load_dwordx4 v164, s[36:39], s77 offen offset:0 nt lds
    v_mfma_f32_16x16x32_bf16 v[200:203], a[180:183], v[104:107], v[200:203]
    ds_read_b128 a[212:215], v4 offset:24576
    buffer_load_dwordx4 v172, s[36:39], s77 offen offset:1024 nt lds
    v_mfma_f32_16x16x32_bf16 v[208:211], a[184:187], v[104:107], v[208:211]
    ds_read_b128 a[216:219], v5 offset:16384
    buffer_load_dwordx4 v180, s[36:39], s77 offen offset:2048 nt lds
    v_mfma_f32_16x16x32_bf16 v[216:219], a[188:191], v[104:107], v[216:219]
    ds_read_b128 a[220:223], v5 offset:24576
    v_exp_f32 v67, v67
    buffer_load_dwordx4 v188, s[36:39], s77 offen offset:3072 nt lds
    s_waitcnt lgkmcnt(4)
    v_mfma_f32_16x16x32_bf16 v[224:227], a[192:195], v[104:107], v[224:227]
    ds_read_b128 a[176:179], v6 offset:16384
    s_mov_b32 m0, 8192
    v_mfma_f32_16x16x32_bf16 v[232:235], a[196:199], v[104:107], v[232:235]
    ds_read_b128 a[180:183], v6 offset:24576
    v_exp_f32 v72, v72
    s_mov_b32 s77, 253952
    v_mfma_f32_16x16x32_bf16 v[240:243], a[200:203], v[104:107], v[240:243]
    ds_read_b128 a[184:187], v7 offset:16384
    buffer_load_dwordx4 v132, s[36:39], s77 offen offset:0 nt lds
    v_mfma_f32_16x16x32_bf16 v[248:251], a[204:207], v[104:107], v[248:251]
    ds_read_b128 a[188:191], v7 offset:24576
    buffer_load_dwordx4 v140, s[36:39], s77 offen offset:1024 nt lds
    s_waitcnt lgkmcnt(4)
    v_mfma_f32_16x16x32_bf16 v[80:83], a[208:211], a[112:115], v[48:51]
    ds_read_b128 a[192:195], v4 offset:16640
    v_cvt_pk_bf16_f32 v97, v66, v67
    buffer_load_dwordx4 v148, s[36:39], s77 offen offset:2048 nt lds
    v_mfma_f32_16x16x32_bf16 v[88:91], a[212:215], a[112:115], v[48:51]
    ds_read_b128 a[196:199], v4 offset:24832
    buffer_load_dwordx4 v156, s[36:39], s77 offen offset:3072 nt lds
    v_mfma_f32_16x16x32_bf16 v[80:83], a[216:219], a[120:123], v[80:83]
    ds_read_b128 a[200:203], v5 offset:16640
    s_mov_b32 m0, 12288
    v_mfma_f32_16x16x32_bf16 v[88:91], a[220:223], a[120:123], v[88:91]
    ds_read_b128 a[204:207], v5 offset:24832
    v_exp_f32 v73, v73
    s_mov_b32 s77, 258048
    s_waitcnt lgkmcnt(4)
    v_mfma_f32_16x16x32_bf16 v[80:83], a[176:179], a[128:131], v[80:83]
    ds_read_b128 a[208:211], v6 offset:16640
    buffer_load_dwordx4 v164, s[36:39], s77 offen offset:0 nt lds
    v_mfma_f32_16x16x32_bf16 v[88:91], a[180:183], a[128:131], v[88:91]
    ds_read_b128 a[212:215], v6 offset:24832
    v_exp_f32 v74, v74
    buffer_load_dwordx4 v172, s[36:39], s77 offen offset:1024 nt lds
    v_mfma_f32_16x16x32_bf16 v[80:83], a[184:187], a[136:139], v[80:83]
    ds_read_b128 a[216:219], v7 offset:16640
    buffer_load_dwordx4 v180, s[36:39], s77 offen offset:2048 nt lds
    v_mfma_f32_16x16x32_bf16 v[88:91], a[188:191], a[136:139], v[88:91]
    ds_read_b128 a[220:223], v7 offset:24832
    buffer_load_dwordx4 v188, s[36:39], s77 offen offset:3072 nt lds
    s_waitcnt lgkmcnt(4)
    v_mfma_f32_16x16x32_bf16 v[80:83], a[192:195], a[144:147], v[80:83]
    s_waitcnt vmcnt(60)
    s_barrier
    ds_read_b64_tr_b16 a[176:177], v20 offset:32768
    ds_read_b64_tr_b16 a[178:179], v20 offset:40960
    v_cvt_pk_bf16_f32 v98, v72, v73
    v_mfma_f32_16x16x32_bf16 v[88:91], a[196:199], a[144:147], v[88:91]
    ds_read_b64_tr_b16 a[180:181], v21 offset:32768
    ds_read_b64_tr_b16 a[182:183], v21 offset:40960
    v_mfma_f32_16x16x32_bf16 v[80:83], a[200:203], a[152:155], v[80:83]
    ds_read_b64_tr_b16 a[184:185], v22 offset:32768
    ds_read_b64_tr_b16 a[186:187], v22 offset:40960
    v_exp_f32 v75, v75
    v_mfma_f32_16x16x32_bf16 v[88:91], a[204:207], a[152:155], v[88:91]
    ds_read_b64_tr_b16 a[188:189], v23 offset:32768
    ds_read_b64_tr_b16 a[190:191], v23 offset:40960
    s_waitcnt lgkmcnt(8)
    v_mfma_f32_16x16x32_bf16 v[80:83], a[208:211], a[160:163], v[80:83]
    ds_read_b64_tr_b16 a[192:193], v24 offset:32768
    ds_read_b64_tr_b16 a[194:195], v24 offset:40960
    s_mov_b32 m0, 94208
    v_mfma_f32_16x16x32_bf16 v[88:91], a[212:215], a[160:163], v[88:91]
    ds_read_b64_tr_b16 a[196:197], v25 offset:32768
    ds_read_b64_tr_b16 a[198:199], v25 offset:40960
    v_cvt_pk_bf16_f32 v99, v74, v75
    s_mov_b32 s77, 241664
    v_mfma_f32_16x16x32_bf16 v[80:83], a[216:219], a[168:171], v[80:83]
    ds_read_b64_tr_b16 a[200:201], v26 offset:32768
    ds_read_b64_tr_b16 a[202:203], v26 offset:40960
    buffer_load_dwordx4 v32, s[40:43], s77 offen offset:0 nt lds
    v_mfma_f32_16x16x32_bf16 v[88:91], a[220:223], a[168:171], v[88:91]
    ds_read_b64_tr_b16 a[204:205], v27 offset:32768
    ds_read_b64_tr_b16 a[206:207], v27 offset:40960
    buffer_load_dwordx4 v33, s[40:43], s77 offen offset:1024 nt lds
    v_mfma_f32_16x16x32_bf16 v[56:59], a[224:227], v[96:99], v[56:59]
    ds_read_b64_tr_b16 a[208:209], v20 offset:33024
    ds_read_b64_tr_b16 a[210:211], v20 offset:41216
    buffer_load_dwordx4 v34, s[40:43], s77 offen offset:2048 nt lds
    s_waitcnt lgkmcnt(10)
    v_mfma_f32_16x16x32_bf16 v[128:131], a[176:179], v[96:99], v[128:131]
    ds_read_b64_tr_b16 a[212:213], v21 offset:33024
    ds_read_b64_tr_b16 a[214:215], v21 offset:41216
    v_mfma_f32_16x16x32_bf16 v[136:139], a[180:183], v[96:99], v[136:139]
    ds_read_b64_tr_b16 a[216:217], v22 offset:33024
    ds_read_b64_tr_b16 a[218:219], v22 offset:41216
    v_exp_f32 v80, v80
    v_mfma_f32_16x16x32_bf16 v[144:147], a[184:187], v[96:99], v[144:147]
    ds_read_b64_tr_b16 a[220:221], v23 offset:33024
    ds_read_b64_tr_b16 a[222:223], v23 offset:41216
    buffer_load_dwordx4 v35, s[40:43], s77 offen offset:3072 nt lds
    s_mov_b32 m0, 16384
    v_mfma_f32_16x16x32_bf16 v[152:155], a[188:191], v[96:99], v[152:155]
    v_exp_f32 v81, v81
    s_mov_b32 s77, 0
    s_waitcnt lgkmcnt(8)
    v_mfma_f32_16x16x32_bf16 v[160:163], a[192:195], v[96:99], v[160:163]
    ds_read_b64_tr_b16 a[176:177], v24 offset:33024
    ds_read_b64_tr_b16 a[178:179], v24 offset:41216
    buffer_load_dwordx4 v252, s[48:51], s77 offen offset:3072 lds
    v_mfma_f32_16x16x32_bf16 v[168:171], a[196:199], v[96:99], v[168:171]
    ds_read_b64_tr_b16 a[180:181], v25 offset:33024
    ds_read_b64_tr_b16 a[182:183], v25 offset:41216
    s_mov_b32 m0, 20480
    v_mfma_f32_16x16x32_bf16 v[176:179], a[200:203], v[96:99], v[176:179]
    ds_read_b64_tr_b16 a[184:185], v26 offset:33024
    ds_read_b64_tr_b16 a[186:187], v26 offset:41216
    v_exp_f32 v82, v82
    v_mfma_f32_16x16x32_bf16 v[184:187], a[204:207], v[96:99], v[184:187]
    ds_read_b64_tr_b16 a[188:189], v27 offset:33024
    ds_read_b64_tr_b16 a[190:191], v27 offset:41216
    s_mov_b32 s77, 28672
    s_waitcnt lgkmcnt(8)
    v_mfma_f32_16x16x32_bf16 v[192:195], a[208:211], v[96:99], v[192:195]
    ds_read_b128 a[192:195], v4 offset:32768
    v_cvt_pk_bf16_f32 v104, v80, v81
    buffer_load_dwordx4 v252, s[48:51], s77 offen offset:3072 lds
    v_mfma_f32_16x16x32_bf16 v[200:203], a[212:215], v[96:99], v[200:203]
    ds_read_b128 a[196:199], v4 offset:40960
    s_mov_b32 m0, 24576
    v_mfma_f32_16x16x32_bf16 v[208:211], a[216:219], v[96:99], v[208:211]
    ds_read_b128 a[200:203], v5 offset:32768
    s_mov_b32 s77, 57344
    v_mfma_f32_16x16x32_bf16 v[216:219], a[220:223], v[96:99], v[216:219]
    ds_read_b128 a[204:207], v5 offset:40960
    v_exp_f32 v83, v83
    buffer_load_dwordx4 v228, s[48:51], s77 offen offset:0 lds
    s_waitcnt lgkmcnt(4)
    v_mfma_f32_16x16x32_bf16 v[224:227], a[176:179], v[96:99], v[224:227]
    ds_read_b128 a[208:211], v6 offset:32768
    v_mfma_f32_16x16x32_bf16 v[232:235], a[180:183], v[96:99], v[232:235]
    ds_read_b128 a[212:215], v6 offset:40960
    v_exp_f32 v88, v88
    buffer_load_dwordx4 v236, s[48:51], s77 offen offset:1024 lds
    v_mfma_f32_16x16x32_bf16 v[240:243], a[184:187], v[96:99], v[240:243]
    ds_read_b128 a[216:219], v7 offset:32768
    buffer_load_dwordx4 v244, s[48:51], s77 offen offset:2048 lds
    v_mfma_f32_16x16x32_bf16 v[248:251], a[188:191], v[96:99], v[248:251]
    ds_read_b128 a[220:223], v7 offset:40960
    buffer_load_dwordx4 v252, s[48:51], s77 offen offset:3072 lds
    s_waitcnt lgkmcnt(4)
    v_mfma_f32_16x16x32_bf16 v[64:67], a[192:195], a[112:115], v[48:51]
    ds_read_b128 a[176:179], v4 offset:33024
    v_cvt_pk_bf16_f32 v105, v82, v83
    s_mov_b32 m0, 28672
    v_mfma_f32_16x16x32_bf16 v[72:75], a[196:199], a[112:115], v[48:51]
    ds_read_b128 a[180:183], v4 offset:41216
    s_mov_b32 s77, 86016
    v_mfma_f32_16x16x32_bf16 v[64:67], a[200:203], a[120:123], v[64:67]
    ds_read_b128 a[184:187], v5 offset:33024
    v_mfma_f32_16x16x32_bf16 v[72:75], a[204:207], a[120:123], v[72:75]
    ds_read_b128 a[188:191], v5 offset:41216
    v_exp_f32 v89, v89
    buffer_load_dwordx4 v228, s[48:51], s77 offen offset:0 lds
    s_waitcnt lgkmcnt(4)
    v_mfma_f32_16x16x32_bf16 v[64:67], a[208:211], a[128:131], v[64:67]
    ds_read_b128 a[192:195], v6 offset:33024
    buffer_load_dwordx4 v236, s[48:51], s77 offen offset:1024 lds
    v_mfma_f32_16x16x32_bf16 v[72:75], a[212:215], a[128:131], v[72:75]
    ds_read_b128 a[196:199], v6 offset:41216
    v_exp_f32 v90, v90
    buffer_load_dwordx4 v244, s[48:51], s77 offen offset:2048 lds
    v_mfma_f32_16x16x32_bf16 v[64:67], a[216:219], a[136:139], v[64:67]
    ds_read_b128 a[200:203], v7 offset:33024
    buffer_load_dwordx4 v252, s[48:51], s77 offen offset:3072 lds
    v_mfma_f32_16x16x32_bf16 v[72:75], a[220:223], a[136:139], v[72:75]
    ds_read_b128 a[204:207], v7 offset:41216
    s_waitcnt lgkmcnt(4)
    v_mfma_f32_16x16x32_bf16 v[64:67], a[176:179], a[144:147], v[64:67]
    s_waitcnt vmcnt(54)
    s_barrier
    ds_read_b64_tr_b16 a[208:209], v20 offset:49152
    ds_read_b64_tr_b16 a[210:211], v20 offset:57344
    v_cvt_pk_bf16_f32 v106, v88, v89
    v_mfma_f32_16x16x32_bf16 v[72:75], a[180:183], a[144:147], v[72:75]
    ds_read_b64_tr_b16 a[212:213], v21 offset:49152
    ds_read_b64_tr_b16 a[214:215], v21 offset:57344
    v_mfma_f32_16x16x32_bf16 v[64:67], a[184:187], a[152:155], v[64:67]
    ds_read_b64_tr_b16 a[216:217], v22 offset:49152
    ds_read_b64_tr_b16 a[218:219], v22 offset:57344
    v_exp_f32 v91, v91
    v_mfma_f32_16x16x32_bf16 v[72:75], a[188:191], a[152:155], v[72:75]
    ds_read_b64_tr_b16 a[220:221], v23 offset:49152
    ds_read_b64_tr_b16 a[222:223], v23 offset:57344
    s_waitcnt lgkmcnt(8)
    v_mfma_f32_16x16x32_bf16 v[64:67], a[192:195], a[160:163], v[64:67]
    ds_read_b64_tr_b16 a[176:177], v24 offset:49152
    ds_read_b64_tr_b16 a[178:179], v24 offset:57344
    s_mov_b32 m0, 143360
    v_mfma_f32_16x16x32_bf16 v[72:75], a[196:199], a[160:163], v[72:75]
    ds_read_b64_tr_b16 a[180:181], v25 offset:49152
    ds_read_b64_tr_b16 a[182:183], v25 offset:57344
    v_cvt_pk_bf16_f32 v107, v90, v91
    s_mov_b32 s77, 258048
    v_mfma_f32_16x16x32_bf16 v[64:67], a[200:203], a[168:171], v[64:67]
    ds_read_b64_tr_b16 a[184:185], v26 offset:49152
    ds_read_b64_tr_b16 a[186:187], v26 offset:57344
    buffer_load_dwordx4 v32, s[40:43], s77 offen offset:0 nt lds
    v_mfma_f32_16x16x32_bf16 v[72:75], a[204:207], a[168:171], v[72:75]
    ds_read_b64_tr_b16 a[188:189], v27 offset:49152
    ds_read_b64_tr_b16 a[190:191], v27 offset:57344
    buffer_load_dwordx4 v33, s[40:43], s77 offen offset:1024 nt lds
    v_mfma_f32_16x16x32_bf16 v[56:59], a[224:227], v[104:107], v[56:59]
    ds_read_b64_tr_b16 a[192:193], v20 offset:49408
    ds_read_b64_tr_b16 a[194:195], v20 offset:57600
    buffer_load_dwordx4 v34, s[40:43], s77 offen offset:2048 nt lds
    s_waitcnt lgkmcnt(10)
    v_mfma_f32_16x16x32_bf16 v[128:131], a[208:211], v[104:107], v[128:131]
    ds_read_b64_tr_b16 a[196:197], v21 offset:49408
    ds_read_b64_tr_b16 a[198:199], v21 offset:57600
    v_mfma_f32_16x16x32_bf16 v[136:139], a[212:215], v[104:107], v[136:139]
    ds_read_b64_tr_b16 a[200:201], v22 offset:49408
    ds_read_b64_tr_b16 a[202:203], v22 offset:57600
    v_exp_f32 v64, v64
    v_mfma_f32_16x16x32_bf16 v[144:147], a[216:219], v[104:107], v[144:147]
    ds_read_b64_tr_b16 a[204:205], v23 offset:49408
    ds_read_b64_tr_b16 a[206:207], v23 offset:57600
    buffer_load_dwordx4 v35, s[40:43], s77 offen offset:3072 nt lds
    s_mov_b32 m0, 32768
    v_mfma_f32_16x16x32_bf16 v[152:155], a[220:223], v[104:107], v[152:155]
    v_exp_f32 v65, v65
    s_mov_b32 s77, 114688
    s_waitcnt lgkmcnt(8)
    v_mfma_f32_16x16x32_bf16 v[160:163], a[176:179], v[104:107], v[160:163]
    ds_read_b64_tr_b16 a[208:209], v24 offset:49408
    ds_read_b64_tr_b16 a[210:211], v24 offset:57600
    buffer_load_dwordx4 v252, s[48:51], s77 offen offset:3072 lds
    v_mfma_f32_16x16x32_bf16 v[168:171], a[180:183], v[104:107], v[168:171]
    ds_read_b64_tr_b16 a[212:213], v25 offset:49408
    ds_read_b64_tr_b16 a[214:215], v25 offset:57600
    s_mov_b32 m0, 36864
    v_mfma_f32_16x16x32_bf16 v[176:179], a[184:187], v[104:107], v[176:179]
    ds_read_b64_tr_b16 a[216:217], v26 offset:49408
    ds_read_b64_tr_b16 a[218:219], v26 offset:57600
    v_exp_f32 v66, v66
    v_mfma_f32_16x16x32_bf16 v[184:187], a[188:191], v[104:107], v[184:187]
    ds_read_b64_tr_b16 a[220:221], v27 offset:49408
    ds_read_b64_tr_b16 a[222:223], v27 offset:57600
    s_mov_b32 s77, 143360
    s_waitcnt lgkmcnt(8)
    v_mfma_f32_16x16x32_bf16 v[192:195], a[192:195], v[104:107], v[192:195]
    ds_read_b128 a[176:179], v4 offset:49152
    v_cvt_pk_bf16_f32 v96, v64, v65
    buffer_load_dwordx4 v252, s[48:51], s77 offen offset:3072 lds
    v_mfma_f32_16x16x32_bf16 v[200:203], a[196:199], v[104:107], v[200:203]
    ds_read_b128 a[180:183], v4 offset:57344
    s_mov_b32 m0, 40960
    v_mfma_f32_16x16x32_bf16 v[208:211], a[200:203], v[104:107], v[208:211]
    ds_read_b128 a[184:187], v5 offset:49152
    s_mov_b32 s77, 172032
    v_mfma_f32_16x16x32_bf16 v[216:219], a[204:207], v[104:107], v[216:219]
    ds_read_b128 a[188:191], v5 offset:57344
    v_exp_f32 v67, v67
    buffer_load_dwordx4 v228, s[48:51], s77 offen offset:0 lds
    s_waitcnt lgkmcnt(4)
    v_mfma_f32_16x16x32_bf16 v[224:227], a[208:211], v[104:107], v[224:227]
    ds_read_b128 a[192:195], v6 offset:49152
    v_mfma_f32_16x16x32_bf16 v[232:235], a[212:215], v[104:107], v[232:235]
    ds_read_b128 a[196:199], v6 offset:57344
    v_exp_f32 v72, v72
    buffer_load_dwordx4 v236, s[48:51], s77 offen offset:1024 lds
    v_mfma_f32_16x16x32_bf16 v[240:243], a[216:219], v[104:107], v[240:243]
    ds_read_b128 a[200:203], v7 offset:49152
    buffer_load_dwordx4 v244, s[48:51], s77 offen offset:2048 lds
    v_mfma_f32_16x16x32_bf16 v[248:251], a[220:223], v[104:107], v[248:251]
    ds_read_b128 a[204:207], v7 offset:57344
    buffer_load_dwordx4 v252, s[48:51], s77 offen offset:3072 lds
    s_waitcnt lgkmcnt(4)
    v_mfma_f32_16x16x32_bf16 v[80:83], a[176:179], a[112:115], v[48:51]
    ds_read_b128 a[208:211], v4 offset:49408
    v_cvt_pk_bf16_f32 v97, v66, v67
    s_mov_b32 m0, 45056
    v_mfma_f32_16x16x32_bf16 v[88:91], a[180:183], a[112:115], v[48:51]
    ds_read_b128 a[212:215], v4 offset:57600
    s_mov_b32 s77, 200704
    v_mfma_f32_16x16x32_bf16 v[80:83], a[184:187], a[120:123], v[80:83]
    ds_read_b128 a[216:219], v5 offset:49408
    v_mfma_f32_16x16x32_bf16 v[88:91], a[188:191], a[120:123], v[88:91]
    ds_read_b128 a[220:223], v5 offset:57600
    v_exp_f32 v73, v73
    buffer_load_dwordx4 v228, s[48:51], s77 offen offset:0 lds
    s_waitcnt lgkmcnt(4)
    v_mfma_f32_16x16x32_bf16 v[80:83], a[192:195], a[128:131], v[80:83]
    ds_read_b128 a[176:179], v6 offset:49408
    buffer_load_dwordx4 v236, s[48:51], s77 offen offset:1024 lds
    v_mfma_f32_16x16x32_bf16 v[88:91], a[196:199], a[128:131], v[88:91]
    ds_read_b128 a[180:183], v6 offset:57600
    v_exp_f32 v74, v74
    buffer_load_dwordx4 v244, s[48:51], s77 offen offset:2048 lds
    v_mfma_f32_16x16x32_bf16 v[80:83], a[200:203], a[136:139], v[80:83]
    ds_read_b128 a[184:187], v7 offset:49408
    buffer_load_dwordx4 v252, s[48:51], s77 offen offset:3072 lds
    v_mfma_f32_16x16x32_bf16 v[88:91], a[204:207], a[136:139], v[88:91]
    ds_read_b128 a[188:191], v7 offset:57600
    s_waitcnt lgkmcnt(4)
    v_mfma_f32_16x16x32_bf16 v[80:83], a[208:211], a[144:147], v[80:83]
    s_waitcnt vmcnt(48)
    s_barrier
    ds_read_b64_tr_b16 a[192:193], v12 offset:32768
    ds_read_b64_tr_b16 a[194:195], v12 offset:40960
    v_cvt_pk_bf16_f32 v98, v72, v73
    v_mfma_f32_16x16x32_bf16 v[88:91], a[212:215], a[144:147], v[88:91]
    ds_read_b64_tr_b16 a[196:197], v13 offset:32768
    ds_read_b64_tr_b16 a[198:199], v13 offset:40960
    v_mfma_f32_16x16x32_bf16 v[80:83], a[216:219], a[152:155], v[80:83]
    ds_read_b64_tr_b16 a[200:201], v14 offset:32768
    ds_read_b64_tr_b16 a[202:203], v14 offset:40960
    v_exp_f32 v75, v75
    v_mfma_f32_16x16x32_bf16 v[88:91], a[220:223], a[152:155], v[88:91]
    ds_read_b64_tr_b16 a[204:205], v15 offset:32768
    ds_read_b64_tr_b16 a[206:207], v15 offset:40960
    s_waitcnt lgkmcnt(8)
    v_mfma_f32_16x16x32_bf16 v[80:83], a[176:179], a[160:163], v[80:83]
    ds_read_b64_tr_b16 a[208:209], v16 offset:32768
    ds_read_b64_tr_b16 a[210:211], v16 offset:40960
    s_mov_b32 m0, 49152
    s_mov_b32 s77, 128
    v_mfma_f32_16x16x32_bf16 v[88:91], a[180:183], a[160:163], v[88:91]
    ds_read_b64_tr_b16 a[212:213], v17 offset:32768
    ds_read_b64_tr_b16 a[214:215], v17 offset:40960
    v_cvt_pk_bf16_f32 v99, v74, v75
    buffer_load_dwordx4 v252, s[48:51], s77 offen offset:3072 lds
    v_mfma_f32_16x16x32_bf16 v[80:83], a[184:187], a[168:171], v[80:83]
    ds_read_b64_tr_b16 a[216:217], v18 offset:32768
    ds_read_b64_tr_b16 a[218:219], v18 offset:40960
    s_mov_b32 m0, 53248
    v_mfma_f32_16x16x32_bf16 v[88:91], a[188:191], a[168:171], v[88:91]
    ds_read_b64_tr_b16 a[220:221], v19 offset:32768
    ds_read_b64_tr_b16 a[222:223], v19 offset:40960
    s_mov_b32 s77, 28800
    v_mfma_f32_16x16x32_bf16 v[56:59], a[224:227], v[96:99], v[56:59]
    ds_read_b64_tr_b16 a[176:177], v12 offset:33024
    ds_read_b64_tr_b16 a[178:179], v12 offset:41216
    buffer_load_dwordx4 v252, s[48:51], s77 offen offset:3072 lds
    s_mov_b32 m0, 57344
    s_waitcnt lgkmcnt(10)
    v_mfma_f32_16x16x32_bf16 v[128:131], a[192:195], v[96:99], v[128:131]
    ds_read_b64_tr_b16 a[180:181], v13 offset:33024
    ds_read_b64_tr_b16 a[182:183], v13 offset:41216
    s_mov_b32 s77, 57472
    v_mfma_f32_16x16x32_bf16 v[136:139], a[196:199], v[96:99], v[136:139]
    ds_read_b64_tr_b16 a[184:185], v14 offset:33024
    ds_read_b64_tr_b16 a[186:187], v14 offset:41216
    v_exp_f32 v80, v80
    v_mfma_f32_16x16x32_bf16 v[144:147], a[200:203], v[96:99], v[144:147]
    ds_read_b64_tr_b16 a[188:189], v15 offset:33024
    ds_read_b64_tr_b16 a[190:191], v15 offset:41216
    buffer_load_dwordx4 v228, s[48:51], s77 offen offset:0 lds
    v_mfma_f32_16x16x32_bf16 v[152:155], a[204:207], v[96:99], v[152:155]
    v_exp_f32 v81, v81
    buffer_load_dwordx4 v236, s[48:51], s77 offen offset:1024 lds
    s_waitcnt lgkmcnt(8)
    v_mfma_f32_16x16x32_bf16 v[160:163], a[208:211], v[96:99], v[160:163]
    ds_read_b64_tr_b16 a[192:193], v16 offset:33024
    ds_read_b64_tr_b16 a[194:195], v16 offset:41216
    buffer_load_dwordx4 v244, s[48:51], s77 offen offset:2048 lds
    v_mfma_f32_16x16x32_bf16 v[168:171], a[212:215], v[96:99], v[168:171]
    ds_read_b64_tr_b16 a[196:197], v17 offset:33024
    ds_read_b64_tr_b16 a[198:199], v17 offset:41216
    buffer_load_dwordx4 v252, s[48:51], s77 offen offset:3072 lds
    s_mov_b32 m0, 61440
    s_mov_b32 s77, 86144
    v_mfma_f32_16x16x32_bf16 v[176:179], a[216:219], v[96:99], v[176:179]
    ds_read_b64_tr_b16 a[200:201], v18 offset:33024
    ds_read_b64_tr_b16 a[202:203], v18 offset:41216
    v_exp_f32 v82, v82
    v_mfma_f32_16x16x32_bf16 v[184:187], a[220:223], v[96:99], v[184:187]
    ds_read_b64_tr_b16 a[204:205], v19 offset:33024
    ds_read_b64_tr_b16 a[206:207], v19 offset:41216
    buffer_load_dwordx4 v228, s[48:51], s77 offen offset:0 lds
    s_waitcnt lgkmcnt(8)
    v_mfma_f32_16x16x32_bf16 v[192:195], a[176:179], v[96:99], v[192:195]
    ds_read_b128 a[208:211], v8 offset:49152
    v_cvt_pk_bf16_f32 v104, v80, v81
    buffer_load_dwordx4 v236, s[48:51], s77 offen offset:1024 lds
    v_mfma_f32_16x16x32_bf16 v[200:203], a[180:183], v[96:99], v[200:203]
    ds_read_b128 a[212:215], v8 offset:57344
    buffer_load_dwordx4 v244, s[48:51], s77 offen offset:2048 lds
    buffer_load_dwordx4 v252, s[48:51], s77 offen offset:3072 lds
    s_mov_b32 m0, 147456
    v_mfma_f32_16x16x32_bf16 v[208:211], a[184:187], v[96:99], v[208:211]
    ds_read_b128 a[216:219], v9 offset:49152
    s_mov_b32 s77, 114816
    v_mfma_f32_16x16x32_bf16 v[216:219], a[188:191], v[96:99], v[216:219]
    ds_read_b128 a[220:223], v9 offset:57344
    v_exp_f32 v83, v83
    buffer_load_dwordx4 v252, s[48:51], s77 offen offset:3072 lds
    s_mov_b32 m0, 151552
    s_waitcnt lgkmcnt(4)
    v_mfma_f32_16x16x32_bf16 v[224:227], a[192:195], v[96:99], v[224:227]
    ds_read_b128 a[176:179], v10 offset:49152
    s_mov_b32 s77, 143488
    v_mfma_f32_16x16x32_bf16 v[232:235], a[196:199], v[96:99], v[232:235]
    ds_read_b128 a[180:183], v10 offset:57344
    v_exp_f32 v88, v88
    buffer_load_dwordx4 v252, s[48:51], s77 offen offset:3072 lds
    v_mfma_f32_16x16x32_bf16 v[240:243], a[200:203], v[96:99], v[240:243]
    ds_read_b128 a[184:187], v11 offset:49152
    s_mov_b32 m0, 155648
    v_mfma_f32_16x16x32_bf16 v[248:251], a[204:207], v[96:99], v[248:251]
    ds_read_b128 a[188:191], v11 offset:57344
    s_mov_b32 s77, 172160
    buffer_load_dwordx4 v228, s[48:51], s77 offen offset:0 lds
    s_waitcnt lgkmcnt(4)
    v_mfma_f32_16x16x32_bf16 v[64:67], a[208:211], a[112:115], v[48:51]
    ds_read_b128 a[192:195], v8 offset:49408
    v_cvt_pk_bf16_f32 v105, v82, v83
    buffer_load_dwordx4 v236, s[48:51], s77 offen offset:1024 lds
    v_mfma_f32_16x16x32_bf16 v[72:75], a[212:215], a[112:115], v[48:51]
    ds_read_b128 a[196:199], v8 offset:57600
    buffer_load_dwordx4 v244, s[48:51], s77 offen offset:2048 lds
    v_mfma_f32_16x16x32_bf16 v[64:67], a[216:219], a[120:123], v[64:67]
    ds_read_b128 a[200:203], v9 offset:49408
    buffer_load_dwordx4 v252, s[48:51], s77 offen offset:3072 lds
    v_mfma_f32_16x16x32_bf16 v[72:75], a[220:223], a[120:123], v[72:75]
    ds_read_b128 a[204:207], v9 offset:57600
    v_exp_f32 v89, v89
    s_mov_b32 m0, 159744
    s_mov_b32 s77, 200832
    s_waitcnt lgkmcnt(4)
    v_mfma_f32_16x16x32_bf16 v[64:67], a[176:179], a[128:131], v[64:67]
    ds_read_b128 a[208:211], v10 offset:49408
    buffer_load_dwordx4 v228, s[48:51], s77 offen offset:0 lds
    v_mfma_f32_16x16x32_bf16 v[72:75], a[180:183], a[128:131], v[72:75]
    ds_read_b128 a[212:215], v10 offset:57600
    v_exp_f32 v90, v90
    buffer_load_dwordx4 v236, s[48:51], s77 offen offset:1024 lds
    v_mfma_f32_16x16x32_bf16 v[64:67], a[184:187], a[136:139], v[64:67]
    ds_read_b128 a[216:219], v11 offset:49408
    buffer_load_dwordx4 v244, s[48:51], s77 offen offset:2048 lds
    v_mfma_f32_16x16x32_bf16 v[72:75], a[188:191], a[136:139], v[72:75]
    ds_read_b128 a[220:223], v11 offset:57600
    buffer_load_dwordx4 v252, s[48:51], s77 offen offset:3072 lds
    s_waitcnt lgkmcnt(4)
    v_mfma_f32_16x16x32_bf16 v[64:67], a[192:195], a[144:147], v[64:67]
    s_waitcnt vmcnt(48)
    s_barrier
    ds_read_b64_tr_b16 a[176:177], v12 offset:0
    ds_read_b64_tr_b16 a[178:179], v12 offset:8192
    v_cvt_pk_bf16_f32 v106, v88, v89
    v_mfma_f32_16x16x32_bf16 v[72:75], a[196:199], a[144:147], v[72:75]
    ds_read_b64_tr_b16 a[180:181], v13 offset:0
    ds_read_b64_tr_b16 a[182:183], v13 offset:8192
    v_mfma_f32_16x16x32_bf16 v[64:67], a[200:203], a[152:155], v[64:67]
    ds_read_b64_tr_b16 a[184:185], v14 offset:0
    ds_read_b64_tr_b16 a[186:187], v14 offset:8192
    v_exp_f32 v91, v91
    v_mfma_f32_16x16x32_bf16 v[72:75], a[204:207], a[152:155], v[72:75]
    ds_read_b64_tr_b16 a[188:189], v15 offset:0
    ds_read_b64_tr_b16 a[190:191], v15 offset:8192
    s_waitcnt lgkmcnt(8)
    v_mfma_f32_16x16x32_bf16 v[64:67], a[208:211], a[160:163], v[64:67]
    ds_read_b64_tr_b16 a[192:193], v16 offset:0
    ds_read_b64_tr_b16 a[194:195], v16 offset:8192
    s_mov_b32 m0, 98304
    v_mfma_f32_16x16x32_bf16 v[72:75], a[212:215], a[160:163], v[72:75]
    ds_read_b64_tr_b16 a[196:197], v17 offset:0
    ds_read_b64_tr_b16 a[198:199], v17 offset:8192
    v_cvt_pk_bf16_f32 v107, v90, v91
    s_mov_b32 s77, 256
    v_mfma_f32_16x16x32_bf16 v[64:67], a[216:219], a[168:171], v[64:67]
    ds_read_b64_tr_b16 a[200:201], v18 offset:0
    ds_read_b64_tr_b16 a[202:203], v18 offset:8192
    v_mfma_f32_16x16x32_bf16 v[72:75], a[220:223], a[168:171], v[72:75]
    ds_read_b64_tr_b16 a[204:205], v19 offset:0
    ds_read_b64_tr_b16 a[206:207], v19 offset:8192
    buffer_load_dwordx4 v252, s[48:51], s77 offen offset:3072 lds
    v_mfma_f32_16x16x32_bf16 v[56:59], a[224:227], v[104:107], v[56:59]
    ds_read_b64_tr_b16 a[208:209], v12 offset:256
    ds_read_b64_tr_b16 a[210:211], v12 offset:8448
    s_mov_b32 m0, 102400
    s_waitcnt lgkmcnt(10)
    v_mfma_f32_16x16x32_bf16 v[128:131], a[176:179], v[104:107], v[128:131]
    ds_read_b64_tr_b16 a[212:213], v13 offset:256
    ds_read_b64_tr_b16 a[214:215], v13 offset:8448
    v_mfma_f32_16x16x32_bf16 v[136:139], a[180:183], v[104:107], v[136:139]
    ds_read_b64_tr_b16 a[216:217], v14 offset:256
    ds_read_b64_tr_b16 a[218:219], v14 offset:8448
    v_exp_f32 v64, v64
    s_mov_b32 s77, 28928
    v_mfma_f32_16x16x32_bf16 v[144:147], a[184:187], v[104:107], v[144:147]
    ds_read_b64_tr_b16 a[220:221], v15 offset:256
    ds_read_b64_tr_b16 a[222:223], v15 offset:8448
    v_mfma_f32_16x16x32_bf16 v[152:155], a[188:191], v[104:107], v[152:155]
    v_exp_f32 v65, v65
    buffer_load_dwordx4 v252, s[48:51], s77 offen offset:3072 lds
    s_waitcnt lgkmcnt(8)
    v_mfma_f32_16x16x32_bf16 v[160:163], a[192:195], v[104:107], v[160:163]
    ds_read_b64_tr_b16 a[176:177], v16 offset:256
    ds_read_b64_tr_b16 a[178:179], v16 offset:8448
    s_mov_b32 m0, 106496
    v_mfma_f32_16x16x32_bf16 v[168:171], a[196:199], v[104:107], v[168:171]
    ds_read_b64_tr_b16 a[180:181], v17 offset:256
    ds_read_b64_tr_b16 a[182:183], v17 offset:8448
    v_mfma_f32_16x16x32_bf16 v[176:179], a[200:203], v[104:107], v[176:179]
    ds_read_b64_tr_b16 a[184:185], v18 offset:256
    ds_read_b64_tr_b16 a[186:187], v18 offset:8448
    v_exp_f32 v66, v66
    s_mov_b32 s77, 57600
    v_mfma_f32_16x16x32_bf16 v[184:187], a[204:207], v[104:107], v[184:187]
    ds_read_b64_tr_b16 a[188:189], v19 offset:256
    ds_read_b64_tr_b16 a[190:191], v19 offset:8448
    buffer_load_dwordx4 v228, s[48:51], s77 offen offset:0 lds
    s_waitcnt lgkmcnt(8)
    v_mfma_f32_16x16x32_bf16 v[192:195], a[208:211], v[104:107], v[192:195]
    ds_read_b128 a[192:195], v4 offset:0
    v_cvt_pk_bf16_f32 v96, v64, v65
    v_mfma_f32_16x16x32_bf16 v[200:203], a[212:215], v[104:107], v[200:203]
    ds_read_b128 a[196:199], v4 offset:8192
    buffer_load_dwordx4 v236, s[48:51], s77 offen offset:1024 lds
    v_mfma_f32_16x16x32_bf16 v[208:211], a[216:219], v[104:107], v[208:211]
    ds_read_b128 a[200:203], v5 offset:0
    v_mfma_f32_16x16x32_bf16 v[216:219], a[220:223], v[104:107], v[216:219]
    ds_read_b128 a[204:207], v5 offset:8192
    v_exp_f32 v67, v67
    buffer_load_dwordx4 v244, s[48:51], s77 offen offset:2048 lds
    s_waitcnt lgkmcnt(4)
    v_mfma_f32_16x16x32_bf16 v[224:227], a[176:179], v[104:107], v[224:227]
    ds_read_b128 a[208:211], v6 offset:0
    buffer_load_dwordx4 v252, s[48:51], s77 offen offset:3072 lds
    v_mfma_f32_16x16x32_bf16 v[232:235], a[180:183], v[104:107], v[232:235]
    ds_read_b128 a[212:215], v6 offset:8192
    v_exp_f32 v72, v72
    v_mfma_f32_16x16x32_bf16 v[240:243], a[184:187], v[104:107], v[240:243]
    ds_read_b128 a[216:219], v7 offset:0
    s_mov_b32 m0, 110592
    v_mfma_f32_16x16x32_bf16 v[248:251], a[188:191], v[104:107], v[248:251]
    ds_read_b128 a[220:223], v7 offset:8192
    s_mov_b32 s77, 86272
    s_waitcnt lgkmcnt(4)
    v_mfma_f32_16x16x32_bf16 v[80:83], a[192:195], a[112:115], v[48:51]
    ds_read_b128 a[176:179], v4 offset:256
    v_cvt_pk_bf16_f32 v97, v66, v67
    v_mfma_f32_16x16x32_bf16 v[88:91], a[196:199], a[112:115], v[48:51]
    ds_read_b128 a[180:183], v4 offset:8448
    buffer_load_dwordx4 v228, s[48:51], s77 offen offset:0 lds
    v_mfma_f32_16x16x32_bf16 v[80:83], a[200:203], a[120:123], v[80:83]
    ds_read_b128 a[184:187], v5 offset:256
    v_mfma_f32_16x16x32_bf16 v[88:91], a[204:207], a[120:123], v[88:91]
    ds_read_b128 a[188:191], v5 offset:8448
    v_exp_f32 v73, v73
    buffer_load_dwordx4 v236, s[48:51], s77 offen offset:1024 lds
    s_waitcnt lgkmcnt(4)
    v_mfma_f32_16x16x32_bf16 v[80:83], a[208:211], a[128:131], v[80:83]
    ds_read_b128 a[192:195], v6 offset:256
    buffer_load_dwordx4 v244, s[48:51], s77 offen offset:2048 lds
    v_mfma_f32_16x16x32_bf16 v[88:91], a[212:215], a[128:131], v[88:91]
    ds_read_b128 a[196:199], v6 offset:8448
    v_exp_f32 v74, v74
    v_mfma_f32_16x16x32_bf16 v[80:83], a[216:219], a[136:139], v[80:83]
    ds_read_b128 a[200:203], v7 offset:256
    buffer_load_dwordx4 v252, s[48:51], s77 offen offset:3072 lds
    v_mfma_f32_16x16x32_bf16 v[88:91], a[220:223], a[136:139], v[88:91]
    ds_read_b128 a[204:207], v7 offset:8448
    s_waitcnt lgkmcnt(4)
    v_mfma_f32_16x16x32_bf16 v[80:83], a[176:179], a[144:147], v[80:83]
    s_waitcnt vmcnt(40)
    s_barrier
    ds_read_b64_tr_b16 a[208:209], v12 offset:16384
    ds_read_b64_tr_b16 a[210:211], v12 offset:24576
    v_cvt_pk_bf16_f32 v98, v72, v73
    v_mfma_f32_16x16x32_bf16 v[88:91], a[180:183], a[144:147], v[88:91]
    ds_read_b64_tr_b16 a[212:213], v13 offset:16384
    ds_read_b64_tr_b16 a[214:215], v13 offset:24576
    v_mfma_f32_16x16x32_bf16 v[80:83], a[184:187], a[152:155], v[80:83]
    ds_read_b64_tr_b16 a[216:217], v14 offset:16384
    ds_read_b64_tr_b16 a[218:219], v14 offset:24576
    v_exp_f32 v75, v75
    v_mfma_f32_16x16x32_bf16 v[88:91], a[188:191], a[152:155], v[88:91]
    ds_read_b64_tr_b16 a[220:221], v15 offset:16384
    ds_read_b64_tr_b16 a[222:223], v15 offset:24576
    s_waitcnt lgkmcnt(8)
    v_mfma_f32_16x16x32_bf16 v[80:83], a[192:195], a[160:163], v[80:83]
    ds_read_b64_tr_b16 a[176:177], v16 offset:16384
    ds_read_b64_tr_b16 a[178:179], v16 offset:24576
    s_mov_b32 m0, 0
    s_mov_b32 s77, 114944
    v_mfma_f32_16x16x32_bf16 v[88:91], a[196:199], a[160:163], v[88:91]
    ds_read_b64_tr_b16 a[180:181], v17 offset:16384
    ds_read_b64_tr_b16 a[182:183], v17 offset:24576
    v_cvt_pk_bf16_f32 v99, v74, v75
    buffer_load_dwordx4 v252, s[48:51], s77 offen offset:3072 lds
    v_mfma_f32_16x16x32_bf16 v[80:83], a[200:203], a[168:171], v[80:83]
    ds_read_b64_tr_b16 a[184:185], v18 offset:16384
    ds_read_b64_tr_b16 a[186:187], v18 offset:24576
    s_mov_b32 m0, 4096
    v_mfma_f32_16x16x32_bf16 v[88:91], a[204:207], a[168:171], v[88:91]
    ds_read_b64_tr_b16 a[188:189], v19 offset:16384
    ds_read_b64_tr_b16 a[190:191], v19 offset:24576
    s_mov_b32 s77, 143616
    v_mfma_f32_16x16x32_bf16 v[56:59], a[224:227], v[96:99], v[56:59]
    ds_read_b64_tr_b16 a[192:193], v12 offset:16640
    ds_read_b64_tr_b16 a[194:195], v12 offset:24832
    buffer_load_dwordx4 v252, s[48:51], s77 offen offset:3072 lds
    s_waitcnt lgkmcnt(10)
    v_mfma_f32_16x16x32_bf16 v[128:131], a[208:211], v[96:99], v[128:131]
    ds_read_b64_tr_b16 a[196:197], v13 offset:16640
    ds_read_b64_tr_b16 a[198:199], v13 offset:24832
    s_mov_b32 m0, 8192
    s_mov_b32 s77, 172288
    v_mfma_f32_16x16x32_bf16 v[136:139], a[212:215], v[96:99], v[136:139]
    ds_read_b64_tr_b16 a[200:201], v14 offset:16640
    ds_read_b64_tr_b16 a[202:203], v14 offset:24832
    v_exp_f32 v80, v80
    v_mfma_f32_16x16x32_bf16 v[144:147], a[216:219], v[96:99], v[144:147]
    ds_read_b64_tr_b16 a[204:205], v15 offset:16640
    ds_read_b64_tr_b16 a[206:207], v15 offset:24832
    v_exp_f32 v81, v81
    v_mfma_f32_16x16x32_bf16 v[152:155], a[220:223], v[96:99], v[152:155]
    v_exp_f32 v82, v82
    buffer_load_dwordx4 v228, s[48:51], s77 offen offset:0 lds
    s_waitcnt lgkmcnt(8)
    v_mfma_f32_16x16x32_bf16 v[160:163], a[176:179], v[96:99], v[160:163]
    ds_read_b64_tr_b16 a[208:209], v16 offset:16640
    ds_read_b64_tr_b16 a[210:211], v16 offset:24832
    v_cvt_pk_bf16_f32 v104, v80, v81
    buffer_load_dwordx4 v236, s[48:51], s77 offen offset:1024 lds
    v_mfma_f32_16x16x32_bf16 v[168:171], a[180:183], v[96:99], v[168:171]
    ds_read_b64_tr_b16 a[212:213], v17 offset:16640
    ds_read_b64_tr_b16 a[214:215], v17 offset:24832
    buffer_load_dwordx4 v244, s[48:51], s77 offen offset:2048 lds
    v_mfma_f32_16x16x32_bf16 v[176:179], a[184:187], v[96:99], v[176:179]
    ds_read_b64_tr_b16 a[216:217], v18 offset:16640
    ds_read_b64_tr_b16 a[218:219], v18 offset:24832
    v_exp_f32 v83, v83
    v_mfma_f32_16x16x32_bf16 v[184:187], a[188:191], v[96:99], v[184:187]
    ds_read_b64_tr_b16 a[220:221], v19 offset:16640
    ds_read_b64_tr_b16 a[222:223], v19 offset:24832
    v_exp_f32 v88, v88
    s_waitcnt lgkmcnt(8)
    v_mfma_f32_16x16x32_bf16 v[192:195], a[192:195], v[96:99], v[192:195]
    ds_read_b64_tr_b16 a[176:177], v20 offset:32768
    ds_read_b64_tr_b16 a[178:179], v20 offset:40960
    v_cvt_pk_bf16_f32 v105, v82, v83
    buffer_load_dwordx4 v252, s[48:51], s77 offen offset:3072 lds
    s_mov_b32 m0, 12288
    s_mov_b32 s77, 200960
    v_mfma_f32_16x16x32_bf16 v[200:203], a[196:199], v[96:99], v[200:203]
    ds_read_b64_tr_b16 a[180:181], v21 offset:32768
    ds_read_b64_tr_b16 a[182:183], v21 offset:40960
    v_exp_f32 v89, v89
    v_mfma_f32_16x16x32_bf16 v[208:211], a[200:203], v[96:99], v[208:211]
    ds_read_b64_tr_b16 a[184:185], v22 offset:32768
    ds_read_b64_tr_b16 a[186:187], v22 offset:40960
    buffer_load_dwordx4 v228, s[48:51], s77 offen offset:0 lds
    v_mfma_f32_16x16x32_bf16 v[216:219], a[204:207], v[96:99], v[216:219]
    ds_read_b64_tr_b16 a[188:189], v23 offset:32768
    ds_read_b64_tr_b16 a[190:191], v23 offset:40960
    v_exp_f32 v90, v90
    s_waitcnt lgkmcnt(8)
    v_mfma_f32_16x16x32_bf16 v[224:227], a[208:211], v[96:99], v[224:227]
    ds_read_b64_tr_b16 a[192:193], v24 offset:32768
    ds_read_b64_tr_b16 a[194:195], v24 offset:40960
    v_cvt_pk_bf16_f32 v106, v88, v89
    buffer_load_dwordx4 v236, s[48:51], s77 offen offset:1024 lds
    v_mfma_f32_16x16x32_bf16 v[232:235], a[212:215], v[96:99], v[232:235]
    ds_read_b64_tr_b16 a[196:197], v25 offset:32768
    ds_read_b64_tr_b16 a[198:199], v25 offset:40960
    v_exp_f32 v91, v91
    v_mfma_f32_16x16x32_bf16 v[240:243], a[216:219], v[96:99], v[240:243]
    ds_read_b64_tr_b16 a[200:201], v26 offset:32768
    ds_read_b64_tr_b16 a[202:203], v26 offset:40960
    v_cvt_pk_bf16_f32 v107, v90, v91
    buffer_load_dwordx4 v244, s[48:51], s77 offen offset:2048 lds
    v_mfma_f32_16x16x32_bf16 v[248:251], a[220:223], v[96:99], v[248:251]
    ds_read_b64_tr_b16 a[204:205], v27 offset:32768
    ds_read_b64_tr_b16 a[206:207], v27 offset:40960
    buffer_load_dwordx4 v252, s[48:51], s77 offen offset:3072 lds
    s_mov_b32 m0, 65536
    s_mov_b32 s77, 384
    v_mfma_f32_16x16x32_bf16 v[56:59], a[224:227], v[104:107], v[56:59]
    ds_read_b64_tr_b16 a[208:209], v20 offset:33024
    ds_read_b64_tr_b16 a[210:211], v20 offset:41216
    buffer_load_dwordx4 v252, s[48:51], s77 offen offset:3072 lds
    s_mov_b32 m0, 69632
    s_mov_b32 s77, 29056
    s_waitcnt lgkmcnt(10)
    v_mfma_f32_16x16x32_bf16 v[128:131], a[176:179], v[104:107], v[128:131]
    ds_read_b64_tr_b16 a[212:213], v21 offset:33024
    ds_read_b64_tr_b16 a[214:215], v21 offset:41216
    buffer_load_dwordx4 v252, s[48:51], s77 offen offset:3072 lds
    s_mov_b32 m0, 73728
    s_mov_b32 s77, 57728
    v_mfma_f32_16x16x32_bf16 v[136:139], a[180:183], v[104:107], v[136:139]
    ds_read_b64_tr_b16 a[216:217], v22 offset:33024
    ds_read_b64_tr_b16 a[218:219], v22 offset:41216
    buffer_load_dwordx4 v228, s[48:51], s77 offen offset:0 lds
    v_mfma_f32_16x16x32_bf16 v[144:147], a[184:187], v[104:107], v[144:147]
    ds_read_b64_tr_b16 a[220:221], v23 offset:33024
    ds_read_b64_tr_b16 a[222:223], v23 offset:41216
    buffer_load_dwordx4 v236, s[48:51], s77 offen offset:1024 lds
    v_mfma_f32_16x16x32_bf16 v[152:155], a[188:191], v[104:107], v[152:155]
    buffer_load_dwordx4 v244, s[48:51], s77 offen offset:2048 lds
    buffer_load_dwordx4 v252, s[48:51], s77 offen offset:3072 lds
    s_mov_b32 m0, 77824
    s_mov_b32 s77, 86400
    v_cmp_ngt_f32 vcc, s85, v56
    s_nop 1
    s_cmp_lg_u64 vcc, 0
    s_cselect_b32 s83, 1, 0
    s_waitcnt lgkmcnt(8)
    v_mfma_f32_16x16x32_bf16 v[160:163], a[192:195], v[104:107], v[160:163]
    ds_read_b64_tr_b16 a[176:177], v24 offset:33024
    ds_read_b64_tr_b16 a[178:179], v24 offset:41216
    buffer_load_dwordx4 v228, s[48:51], s77 offen offset:0 lds
    v_mov_b32 v1, s83
    v_mfma_f32_16x16x32_bf16 v[168:171], a[196:199], v[104:107], v[168:171]
    ds_read_b64_tr_b16 a[180:181], v25 offset:33024
    ds_read_b64_tr_b16 a[182:183], v25 offset:41216
    buffer_load_dwordx4 v236, s[48:51], s77 offen offset:1024 lds
    ds_write_b32 v124, v1
    v_rcp_f32 v44, v56
    v_mfma_f32_16x16x32_bf16 v[176:179], a[200:203], v[104:107], v[176:179]
    ds_read_b64_tr_b16 a[184:185], v26 offset:33024
    ds_read_b64_tr_b16 a[186:187], v26 offset:41216
    buffer_load_dwordx4 v244, s[48:51], s77 offen offset:2048 lds
    v_cvt_pk_bf16_f32 v128, v128, v129
    v_mfma_f32_16x16x32_bf16 v[184:187], a[204:207], v[104:107], v[184:187]
    ds_read_b64_tr_b16 a[188:189], v27 offset:33024
    ds_read_b64_tr_b16 a[190:191], v27 offset:41216
    buffer_load_dwordx4 v252, s[48:51], s77 offen offset:3072 lds
    v_cvt_pk_bf16_f32 v129, v130, v131
    s_waitcnt lgkmcnt(9)
    v_mfma_f32_16x16x32_bf16 v[192:195], a[208:211], v[104:107], v[192:195]
    s_waitcnt vmcnt(50) lgkmcnt(4)
    s_barrier
    ds_read_b64_tr_b16 a[192:193], v112 offset:16384
    ds_read_b64_tr_b16 a[194:195], v112 offset:18432
    v_cvt_pk_bf16_f32 v130, v136, v137
    v_cvt_pk_bf16_f32 v131, v138, v139
    v_cvt_pk_bf16_f32 v144, v144, v145
    v_mfma_f32_16x16x32_bf16 v[200:203], a[212:215], v[104:107], v[200:203]
    ds_read_b64_tr_b16 a[196:197], v113 offset:16384
    ds_read_b64_tr_b16 a[198:199], v113 offset:18432
    v_cvt_pk_bf16_f32 v145, v146, v147
    v_cvt_pk_bf16_f32 v146, v152, v153
    v_cvt_pk_bf16_f32 v147, v154, v155
    v_mfma_f32_16x16x32_bf16 v[208:211], a[216:219], v[104:107], v[208:211]
    ds_read_b64_tr_b16 a[200:201], v114 offset:16384
    ds_read_b64_tr_b16 a[202:203], v114 offset:18432
    v_cvt_pk_bf16_f32 v160, v160, v161
    v_cvt_pk_bf16_f32 v161, v162, v163
    v_cvt_pk_bf16_f32 v162, v168, v169
    v_mfma_f32_16x16x32_bf16 v[216:219], a[220:223], v[104:107], v[216:219]
    ds_read_b64_tr_b16 a[204:205], v115 offset:16384
    ds_read_b64_tr_b16 a[206:207], v115 offset:18432
    v_cvt_pk_bf16_f32 v163, v170, v171
    v_cvt_pk_bf16_f32 v176, v176, v177
    v_cvt_pk_bf16_f32 v177, v178, v179
    s_waitcnt lgkmcnt(8)
    v_mfma_f32_16x16x32_bf16 v[224:227], a[176:179], v[104:107], v[224:227]
    ds_read_b64_tr_b16 a[208:209], v112 offset:20480
    ds_read_b64_tr_b16 a[210:211], v112 offset:22528
    s_mov_b32 m0, 81920
    s_mov_b32 s77, 115072
    v_cvt_pk_bf16_f32 v178, v184, v185
    v_cvt_pk_bf16_f32 v179, v186, v187
    ds_read_b128 v[0:3], v125
    v_mfma_f32_16x16x32_bf16 v[232:235], a[180:183], v[104:107], v[232:235]
    ds_read_b64_tr_b16 a[212:213], v113 offset:20480
    ds_read_b64_tr_b16 a[214:215], v113 offset:22528
    buffer_load_dwordx4 v252, s[48:51], s77 offen offset:3072 lds
    s_waitcnt lgkmcnt(2)
    v_or3_b32 v0, v0, v1, v2
    v_or_b32 v0, v0, v3
    v_mfma_f32_16x16x32_bf16 v[240:243], a[184:187], v[104:107], v[240:243]
    ds_read_b64_tr_b16 a[216:217], v114 offset:20480
    ds_read_b64_tr_b16 a[218:219], v114 offset:22528
    s_mov_b32 m0, 86016
    v_cvt_pk_bf16_f32 v192, v192, v193
    v_cvt_pk_bf16_f32 v193, v194, v195
    v_cvt_pk_bf16_f32 v194, v200, v201
    v_readfirstlane_b32 s83, v0
    v_mfma_f32_16x16x32_bf16 v[248:251], a[188:191], v[104:107], v[248:251]
    ds_read_b64_tr_b16 a[220:221], v115 offset:20480
    ds_read_b64_tr_b16 a[222:223], v115 offset:22528
    s_mov_b32 s77, 143744
    buffer_load_dwordx4 v252, s[48:51], s77 offen offset:3072 lds
    v_cvt_pk_bf16_f32 v195, v202, v203
    s_and_b32 s83, s83, s82
    s_cbranch_scc1 L_fb_H
    v_mfma_f32_16x16x32_bf16 v[64:67], a[192:195], v[128:131], 0
    ds_read_b64_tr_b16 a[176:177], v112 offset:24576
    ds_read_b64_tr_b16 a[178:179], v112 offset:26624
    s_mov_b32 m0, 90112
    v_cvt_pk_bf16_f32 v208, v208, v209
    v_cvt_pk_bf16_f32 v209, v210, v211
    v_cvt_pk_bf16_f32 v210, v216, v217
    v_mfma_f32_16x16x32_bf16 v[72:75], a[196:199], v[128:131], 0
    ds_read_b64_tr_b16 a[180:181], v113 offset:24576
    ds_read_b64_tr_b16 a[182:183], v113 offset:26624
    s_mov_b32 s77, 172416
    v_cvt_pk_bf16_f32 v211, v218, v219
    v_mfma_f32_16x16x32_bf16 v[80:83], a[200:203], v[128:131], 0
    ds_read_b64_tr_b16 a[184:185], v114 offset:24576
    ds_read_b64_tr_b16 a[186:187], v114 offset:26624
    buffer_load_dwordx4 v228, s[48:51], s77 offen offset:0 lds
    v_cvt_pk_bf16_f32 v224, v224, v225
    v_mfma_f32_16x16x32_bf16 v[88:91], a[204:207], v[128:131], 0
    ds_read_b64_tr_b16 a[188:189], v115 offset:24576
    ds_read_b64_tr_b16 a[190:191], v115 offset:26624
    buffer_load_dwordx4 v236, s[48:51], s77 offen offset:1024 lds
    v_cvt_pk_bf16_f32 v225, v226, v227
    s_waitcnt lgkmcnt(8)
    v_mfma_f32_16x16x32_bf16 v[64:67], a[208:211], v[144:147], v[64:67]
    ds_read_b64_tr_b16 a[192:193], v112 offset:28672
    ds_read_b64_tr_b16 a[194:195], v112 offset:30720
    buffer_load_dwordx4 v244, s[48:51], s77 offen offset:2048 lds
    v_cvt_pk_bf16_f32 v226, v232, v233
    v_mfma_f32_16x16x32_bf16 v[72:75], a[212:215], v[144:147], v[72:75]
    ds_read_b64_tr_b16 a[196:197], v113 offset:28672
    ds_read_b64_tr_b16 a[198:199], v113 offset:30720
    buffer_load_dwordx4 v252, s[48:51], s77 offen offset:3072 lds
    s_mov_b32 m0, 94208
    v_cvt_pk_bf16_f32 v227, v234, v235
    v_mfma_f32_16x16x32_bf16 v[80:83], a[216:219], v[144:147], v[80:83]
    ds_read_b64_tr_b16 a[200:201], v114 offset:28672
    ds_read_b64_tr_b16 a[202:203], v114 offset:30720
    s_mov_b32 s77, 201088
    buffer_load_dwordx4 v228, s[48:51], s77 offen offset:0 lds
    v_cvt_pk_bf16_f32 v240, v240, v241
    v_mfma_f32_16x16x32_bf16 v[88:91], a[220:223], v[144:147], v[88:91]
    ds_read_b64_tr_b16 a[204:205], v115 offset:28672
    ds_read_b64_tr_b16 a[206:207], v115 offset:30720
    buffer_load_dwordx4 v236, s[48:51], s77 offen offset:1024 lds
    v_cvt_pk_bf16_f32 v241, v242, v243
    s_waitcnt lgkmcnt(8)
    v_mfma_f32_16x16x32_bf16 v[64:67], a[176:179], v[160:163], v[64:67]
    ds_read_b64_tr_b16 a[208:209], v112 offset:32768
    ds_read_b64_tr_b16 a[210:211], v112 offset:34816
    buffer_load_dwordx4 v244, s[48:51], s77 offen offset:2048 lds
    v_cvt_pk_bf16_f32 v242, v248, v249
    v_mfma_f32_16x16x32_bf16 v[72:75], a[180:183], v[160:163], v[72:75]
    ds_read_b64_tr_b16 a[212:213], v113 offset:32768
    ds_read_b64_tr_b16 a[214:215], v113 offset:34816
    buffer_load_dwordx4 v252, s[48:51], s77 offen offset:3072 lds
    v_cvt_pk_bf16_f32 v243, v250, v251
    v_mfma_f32_16x16x32_bf16 v[80:83], a[184:187], v[160:163], v[80:83]
    ds_read_b64_tr_b16 a[216:217], v114 offset:32768
    ds_read_b64_tr_b16 a[218:219], v114 offset:34816
    s_mov_b32 m0, 131072
    s_mov_b32 s77, 512
    v_mfma_f32_16x16x32_bf16 v[88:91], a[188:191], v[160:163], v[88:91]
    ds_read_b64_tr_b16 a[220:221], v115 offset:32768
    ds_read_b64_tr_b16 a[222:223], v115 offset:34816
    buffer_load_dwordx4 v252, s[48:51], s77 offen offset:3072 lds
    s_waitcnt lgkmcnt(8)
    v_mfma_f32_16x16x32_bf16 v[64:67], a[192:195], v[176:179], v[64:67]
    ds_read_b64_tr_b16 a[176:177], v112 offset:36864
    ds_read_b64_tr_b16 a[178:179], v112 offset:38912
    s_mov_b32 m0, 135168
    v_mfma_f32_16x16x32_bf16 v[72:75], a[196:199], v[176:179], v[72:75]
    ds_read_b64_tr_b16 a[180:181], v113 offset:36864
    ds_read_b64_tr_b16 a[182:183], v113 offset:38912
    s_mov_b32 s77, 29184
    buffer_load_dwordx4 v252, s[48:51], s77 offen offset:3072 lds
    v_mfma_f32_16x16x32_bf16 v[80:83], a[200:203], v[176:179], v[80:83]
    ds_read_b64_tr_b16 a[184:185], v114 offset:36864
    ds_read_b64_tr_b16 a[186:187], v114 offset:38912
    s_mov_b32 m0, 139264
    v_mfma_f32_16x16x32_bf16 v[88:91], a[204:207], v[176:179], v[88:91]
    ds_read_b64_tr_b16 a[188:189], v115 offset:36864
    ds_read_b64_tr_b16 a[190:191], v115 offset:38912
    s_mov_b32 s77, 57856
    s_waitcnt lgkmcnt(8)
    v_mfma_f32_16x16x32_bf16 v[64:67], a[208:211], v[192:195], v[64:67]
    ds_read_b64_tr_b16 a[192:193], v112 offset:40960
    ds_read_b64_tr_b16 a[194:195], v112 offset:43008
    buffer_load_dwordx4 v228, s[48:51], s77 offen offset:0 lds
    v_mfma_f32_16x16x32_bf16 v[72:75], a[212:215], v[192:195], v[72:75]
    ds_read_b64_tr_b16 a[196:197], v113 offset:40960
    ds_read_b64_tr_b16 a[198:199], v113 offset:43008
    buffer_load_dwordx4 v236, s[48:51], s77 offen offset:1024 lds
    v_mfma_f32_16x16x32_bf16 v[80:83], a[216:219], v[192:195], v[80:83]
    ds_read_b64_tr_b16 a[200:201], v114 offset:40960
    ds_read_b64_tr_b16 a[202:203], v114 offset:43008
    buffer_load_dwordx4 v244, s[48:51], s77 offen offset:2048 lds
    v_mfma_f32_16x16x32_bf16 v[88:91], a[220:223], v[192:195], v[88:91]
    ds_read_b64_tr_b16 a[204:205], v115 offset:40960
    ds_read_b64_tr_b16 a[206:207], v115 offset:43008
    buffer_load_dwordx4 v252, s[48:51], s77 offen offset:3072 lds
    s_mov_b32 m0, 143360
    s_waitcnt lgkmcnt(8)
    v_mfma_f32_16x16x32_bf16 v[64:67], a[176:179], v[208:211], v[64:67]
    ds_read_b64_tr_b16 a[208:209], v112 offset:45056
    ds_read_b64_tr_b16 a[210:211], v112 offset:47104
    s_mov_b32 s77, 86528
    buffer_load_dwordx4 v228, s[48:51], s77 offen offset:0 lds
    v_mfma_f32_16x16x32_bf16 v[72:75], a[180:183], v[208:211], v[72:75]
    ds_read_b64_tr_b16 a[212:213], v113 offset:45056
    ds_read_b64_tr_b16 a[214:215], v113 offset:47104
    buffer_load_dwordx4 v236, s[48:51], s77 offen offset:1024 lds
    v_mfma_f32_16x16x32_bf16 v[80:83], a[184:187], v[208:211], v[80:83]
    ds_read_b64_tr_b16 a[216:217], v114 offset:45056
    ds_read_b64_tr_b16 a[218:219], v114 offset:47104
    buffer_load_dwordx4 v244, s[48:51], s77 offen offset:2048 lds
    v_mfma_f32_16x16x32_bf16 v[88:91], a[188:191], v[208:211], v[88:91]
    ds_read_b64_tr_b16 a[220:221], v115 offset:45056
    ds_read_b64_tr_b16 a[222:223], v115 offset:47104
    buffer_load_dwordx4 v252, s[48:51], s77 offen offset:3072 lds
    s_waitcnt lgkmcnt(8)
    v_mfma_f32_16x16x32_bf16 v[64:67], a[192:195], v[224:227], v[64:67]
    s_waitcnt vmcnt(50)
    s_barrier
    ds_read_b64_tr_b16 a[176:177], v112 offset:49152
    ds_read_b64_tr_b16 a[178:179], v112 offset:51200
    v_mfma_f32_16x16x32_bf16 v[72:75], a[196:199], v[224:227], v[72:75]
    ds_read_b64_tr_b16 a[180:181], v113 offset:49152
    ds_read_b64_tr_b16 a[182:183], v113 offset:51200
    v_mfma_f32_16x16x32_bf16 v[80:83], a[200:203], v[224:227], v[80:83]
    ds_read_b64_tr_b16 a[184:185], v114 offset:49152
    ds_read_b64_tr_b16 a[186:187], v114 offset:51200
    v_mfma_f32_16x16x32_bf16 v[88:91], a[204:207], v[224:227], v[88:91]
    ds_read_b64_tr_b16 a[188:189], v115 offset:49152
    ds_read_b64_tr_b16 a[190:191], v115 offset:51200
    s_waitcnt lgkmcnt(8)
    v_mfma_f32_16x16x32_bf16 v[64:67], a[208:211], v[240:243], v[64:67]
    ds_read_b64_tr_b16 a[192:193], v112 offset:53248
    ds_read_b64_tr_b16 a[194:195], v112 offset:55296
    s_mov_b32 m0, 16384
    s_mov_b32 s77, 640
    v_mfma_f32_16x16x32_bf16 v[72:75], a[212:215], v[240:243], v[72:75]
    ds_read_b64_tr_b16 a[196:197], v113 offset:53248
    ds_read_b64_tr_b16 a[198:199], v113 offset:55296
    buffer_load_dwordx4 v252, s[48:51], s77 offen offset:3072 lds
    v_mfma_f32_16x16x32_bf16 v[80:83], a[216:219], v[240:243], v[80:83]
    ds_read_b64_tr_b16 a[200:201], v114 offset:53248
    ds_read_b64_tr_b16 a[202:203], v114 offset:55296
    s_mov_b32 m0, 20480
    v_mfma_f32_16x16x32_bf16 v[88:91], a[220:223], v[240:243], v[88:91]
    ds_read_b64_tr_b16 a[204:205], v115 offset:53248
    ds_read_b64_tr_b16 a[206:207], v115 offset:55296
    s_mov_b32 s77, 29312
    buffer_load_dwordx4 v252, s[48:51], s77 offen offset:3072 lds
    s_waitcnt lgkmcnt(8)
    v_mfma_f32_16x16x32_bf16 v[136:139], a[176:179], v[128:131], 0
    ds_read_b64_tr_b16 a[208:209], v112 offset:57344
    ds_read_b64_tr_b16 a[210:211], v112 offset:59392
    s_mov_b32 m0, 24576
    v_mfma_f32_16x16x32_bf16 v[152:155], a[180:183], v[128:131], 0
    ds_read_b64_tr_b16 a[212:213], v113 offset:57344
    ds_read_b64_tr_b16 a[214:215], v113 offset:59392
    s_mov_b32 s77, 57984
    v_mfma_f32_16x16x32_bf16 v[168:171], a[184:187], v[128:131], 0
    ds_read_b64_tr_b16 a[216:217], v114 offset:57344
    ds_read_b64_tr_b16 a[218:219], v114 offset:59392
    buffer_load_dwordx4 v228, s[48:51], s77 offen offset:0 lds
    v_mul_f32 v64, v64, v44
    v_mfma_f32_16x16x32_bf16 v[184:187], a[188:191], v[128:131], 0
    ds_read_b64_tr_b16 a[220:221], v115 offset:57344
    ds_read_b64_tr_b16 a[222:223], v115 offset:59392
    buffer_load_dwordx4 v236, s[48:51], s77 offen offset:1024 lds
    v_mul_f32 v65, v65, v44
    s_waitcnt lgkmcnt(8)
    v_mfma_f32_16x16x32_bf16 v[136:139], a[192:195], v[144:147], v[136:139]
    ds_read_b64_tr_b16 a[176:177], v112 offset:61440
    ds_read_b64_tr_b16 a[178:179], v112 offset:63488
    buffer_load_dwordx4 v244, s[48:51], s77 offen offset:2048 lds
    v_mul_f32 v66, v66, v44
    v_mfma_f32_16x16x32_bf16 v[152:155], a[196:199], v[144:147], v[152:155]
    ds_read_b64_tr_b16 a[180:181], v113 offset:61440
    ds_read_b64_tr_b16 a[182:183], v113 offset:63488
    buffer_load_dwordx4 v252, s[48:51], s77 offen offset:3072 lds
    s_mov_b32 m0, 28672
    v_mul_f32 v67, v67, v44
    v_mfma_f32_16x16x32_bf16 v[168:171], a[200:203], v[144:147], v[168:171]
    ds_read_b64_tr_b16 a[184:185], v114 offset:61440
    ds_read_b64_tr_b16 a[186:187], v114 offset:63488
    s_mov_b32 s77, 86656
    buffer_load_dwordx4 v228, s[48:51], s77 offen offset:0 lds
    v_mul_f32 v72, v72, v44
    v_mfma_f32_16x16x32_bf16 v[184:187], a[204:207], v[144:147], v[184:187]
    ds_read_b64_tr_b16 a[188:189], v115 offset:61440
    ds_read_b64_tr_b16 a[190:191], v115 offset:63488
    buffer_load_dwordx4 v236, s[48:51], s77 offen offset:1024 lds
    v_mul_f32 v73, v73, v44
    s_waitcnt lgkmcnt(8)
    v_mfma_f32_16x16x32_bf16 v[136:139], a[208:211], v[160:163], v[136:139]
    ds_read_b64_tr_b16 a[192:193], v120 offset:16384
    ds_read_b64_tr_b16 a[194:195], v120 offset:18432
    buffer_load_dwordx4 v244, s[48:51], s77 offen offset:2048 lds
    v_mul_f32 v74, v74, v44
    v_mfma_f32_16x16x32_bf16 v[152:155], a[212:215], v[160:163], v[152:155]
    ds_read_b64_tr_b16 a[196:197], v121 offset:16384
    ds_read_b64_tr_b16 a[198:199], v121 offset:18432
    buffer_load_dwordx4 v252, s[48:51], s77 offen offset:3072 lds
    v_mul_f32 v75, v75, v44
    v_mfma_f32_16x16x32_bf16 v[168:171], a[216:219], v[160:163], v[168:171]
    ds_read_b64_tr_b16 a[200:201], v122 offset:16384
    ds_read_b64_tr_b16 a[202:203], v122 offset:18432
    s_mov_b32 m0, 32768
    s_mov_b32 s77, 115328
    v_cvt_pk_bf16_f32 v64, v64, v65
    v_cvt_pk_bf16_f32 v65, v66, v67
    v_cvt_pk_bf16_f32 v66, v72, v73
    v_mfma_f32_16x16x32_bf16 v[184:187], a[220:223], v[160:163], v[184:187]
    ds_read_b64_tr_b16 a[204:205], v123 offset:16384
    ds_read_b64_tr_b16 a[206:207], v123 offset:18432
    buffer_load_dwordx4 v252, s[48:51], s77 offen offset:3072 lds
    v_cvt_pk_bf16_f32 v67, v74, v75
    s_mov_b32 s78, 0
    s_waitcnt lgkmcnt(8)
    v_mfma_f32_16x16x32_bf16 v[136:139], a[176:179], v[176:179], v[136:139]
    ds_read_b64_tr_b16 a[208:209], v120 offset:20480
    ds_read_b64_tr_b16 a[210:211], v120 offset:22528
    s_mov_b32 m0, 36864
    buffer_store_dwordx4 v[64:67], v42, s[52:55], s78 offen offset:0 sc1
    v_mul_f32 v80, v80, v44
    v_mfma_f32_16x16x32_bf16 v[152:155], a[180:183], v[176:179], v[152:155]
    ds_read_b64_tr_b16 a[212:213], v121 offset:20480
    ds_read_b64_tr_b16 a[214:215], v121 offset:22528
    s_mov_b32 s77, 144000
    buffer_load_dwordx4 v252, s[48:51], s77 offen offset:3072 lds
    v_mul_f32 v81, v81, v44
    v_mfma_f32_16x16x32_bf16 v[168:171], a[184:187], v[176:179], v[168:171]
    ds_read_b64_tr_b16 a[216:217], v122 offset:20480
    ds_read_b64_tr_b16 a[218:219], v122 offset:22528
    s_mov_b32 m0, 40960
    v_mul_f32 v82, v82, v44
    v_mul_f32 v83, v83, v44
    v_mfma_f32_16x16x32_bf16 v[184:187], a[188:191], v[176:179], v[184:187]
    ds_read_b64_tr_b16 a[220:221], v123 offset:20480
    ds_read_b64_tr_b16 a[222:223], v123 offset:22528
    s_mov_b32 s77, 172672
    v_mul_f32 v88, v88, v44
    s_waitcnt lgkmcnt(8)
    v_mfma_f32_16x16x32_bf16 v[136:139], a[192:195], v[192:195], v[136:139]
    ds_read_b64_tr_b16 a[176:177], v120 offset:24576
    ds_read_b64_tr_b16 a[178:179], v120 offset:26624
    buffer_load_dwordx4 v228, s[48:51], s77 offen offset:0 lds
    v_mul_f32 v89, v89, v44
    v_mfma_f32_16x16x32_bf16 v[152:155], a[196:199], v[192:195], v[152:155]
    ds_read_b64_tr_b16 a[180:181], v121 offset:24576
    ds_read_b64_tr_b16 a[182:183], v121 offset:26624
    buffer_load_dwordx4 v236, s[48:51], s77 offen offset:1024 lds
    v_mul_f32 v90, v90, v44
    v_mfma_f32_16x16x32_bf16 v[168:171], a[200:203], v[192:195], v[168:171]
    ds_read_b64_tr_b16 a[184:185], v122 offset:24576
    ds_read_b64_tr_b16 a[186:187], v122 offset:26624
    buffer_load_dwordx4 v244, s[48:51], s77 offen offset:2048 lds
    v_mul_f32 v91, v91, v44
    v_mfma_f32_16x16x32_bf16 v[184:187], a[204:207], v[192:195], v[184:187]
    ds_read_b64_tr_b16 a[188:189], v123 offset:24576
    ds_read_b64_tr_b16 a[190:191], v123 offset:26624
    buffer_load_dwordx4 v252, s[48:51], s77 offen offset:3072 lds
    s_mov_b32 m0, 45056
    v_cvt_pk_bf16_f32 v80, v80, v81
    s_waitcnt lgkmcnt(8)
    v_mfma_f32_16x16x32_bf16 v[136:139], a[208:211], v[208:211], v[136:139]
    ds_read_b64_tr_b16 a[192:193], v120 offset:28672
    ds_read_b64_tr_b16 a[194:195], v120 offset:30720
    s_mov_b32 s77, 201344
    buffer_load_dwordx4 v228, s[48:51], s77 offen offset:0 lds
    v_cvt_pk_bf16_f32 v81, v82, v83
    v_mfma_f32_16x16x32_bf16 v[152:155], a[212:215], v[208:211], v[152:155]
    ds_read_b64_tr_b16 a[196:197], v121 offset:28672
    ds_read_b64_tr_b16 a[198:199], v121 offset:30720
    buffer_load_dwordx4 v236, s[48:51], s77 offen offset:1024 lds
    v_cvt_pk_bf16_f32 v82, v88, v89
    v_mfma_f32_16x16x32_bf16 v[168:171], a[216:219], v[208:211], v[168:171]
    ds_read_b64_tr_b16 a[200:201], v122 offset:28672
    ds_read_b64_tr_b16 a[202:203], v122 offset:30720
    buffer_load_dwordx4 v244, s[48:51], s77 offen offset:2048 lds
    v_cvt_pk_bf16_f32 v83, v90, v91
    s_mov_b32 s78, 7168
    buffer_store_dwordx4 v[80:83], v42, s[52:55], s78 offen offset:0 sc1
    v_mfma_f32_16x16x32_bf16 v[184:187], a[220:223], v[208:211], v[184:187]
    ds_read_b64_tr_b16 a[204:205], v123 offset:28672
    ds_read_b64_tr_b16 a[206:207], v123 offset:30720
    buffer_load_dwordx4 v252, s[48:51], s77 offen offset:3072 lds
    s_waitcnt lgkmcnt(8)
    v_mfma_f32_16x16x32_bf16 v[136:139], a[176:179], v[224:227], v[136:139]
    s_waitcnt vmcnt(52)
    s_barrier
    ds_read_b64_tr_b16 a[208:209], v116 offset:32768
    ds_read_b64_tr_b16 a[210:211], v116 offset:34816
    v_mfma_f32_16x16x32_bf16 v[152:155], a[180:183], v[224:227], v[152:155]
    ds_read_b64_tr_b16 a[212:213], v117 offset:32768
    ds_read_b64_tr_b16 a[214:215], v117 offset:34816
    v_mfma_f32_16x16x32_bf16 v[168:171], a[184:187], v[224:227], v[168:171]
    ds_read_b64_tr_b16 a[216:217], v118 offset:32768
    ds_read_b64_tr_b16 a[218:219], v118 offset:34816
    v_mfma_f32_16x16x32_bf16 v[184:187], a[188:191], v[224:227], v[184:187]
    ds_read_b64_tr_b16 a[220:221], v119 offset:32768
    ds_read_b64_tr_b16 a[222:223], v119 offset:34816
    s_waitcnt lgkmcnt(8)
    v_mfma_f32_16x16x32_bf16 v[136:139], a[192:195], v[240:243], v[136:139]
    ds_read_b64_tr_b16 a[176:177], v116 offset:36864
    ds_read_b64_tr_b16 a[178:179], v116 offset:38912
    s_mov_b32 m0, 114688
    s_mov_b32 s77, 115200
    v_mfma_f32_16x16x32_bf16 v[152:155], a[196:199], v[240:243], v[152:155]
    ds_read_b64_tr_b16 a[180:181], v117 offset:36864
    ds_read_b64_tr_b16 a[182:183], v117 offset:38912
    buffer_load_dwordx4 v252, s[48:51], s77 offen offset:3072 lds
    s_mov_b32 m0, 118784
    v_mfma_f32_16x16x32_bf16 v[168:171], a[200:203], v[240:243], v[168:171]
    ds_read_b64_tr_b16 a[184:185], v118 offset:36864
    ds_read_b64_tr_b16 a[186:187], v118 offset:38912
    s_mov_b32 s77, 143872
    buffer_load_dwordx4 v252, s[48:51], s77 offen offset:3072 lds
    v_mfma_f32_16x16x32_bf16 v[184:187], a[204:207], v[240:243], v[184:187]
    ds_read_b64_tr_b16 a[188:189], v119 offset:36864
    ds_read_b64_tr_b16 a[190:191], v119 offset:38912
    s_mov_b32 m0, 122880
    s_mov_b32 s77, 172544
    s_waitcnt lgkmcnt(8)
    v_mfma_f32_16x16x32_bf16 v[64:67], a[208:211], v[128:131], 0
    ds_read_b64_tr_b16 a[192:193], v116 offset:40960
    ds_read_b64_tr_b16 a[194:195], v116 offset:43008
    buffer_load_dwordx4 v228, s[48:51], s77 offen offset:0 lds
    v_mfma_f32_16x16x32_bf16 v[72:75], a[212:215], v[128:131], 0
    ds_read_b64_tr_b16 a[196:197], v117 offset:40960
    ds_read_b64_tr_b16 a[198:199], v117 offset:43008
    buffer_load_dwordx4 v236, s[48:51], s77 offen offset:1024 lds
    v_mfma_f32_16x16x32_bf16 v[80:83], a[216:219], v[128:131], 0
    ds_read_b64_tr_b16 a[200:201], v118 offset:40960
    ds_read_b64_tr_b16 a[202:203], v118 offset:43008
    buffer_load_dwordx4 v244, s[48:51], s77 offen offset:2048 lds
    v_mul_f32 v136, v136, v44
    v_mfma_f32_16x16x32_bf16 v[88:91], a[220:223], v[128:131], 0
    ds_read_b64_tr_b16 a[204:205], v119 offset:40960
    ds_read_b64_tr_b16 a[206:207], v119 offset:43008
    buffer_load_dwordx4 v252, s[48:51], s77 offen offset:3072 lds
    s_mov_b32 m0, 126976
    s_mov_b32 s77, 201216
    v_mul_f32 v137, v137, v44
    s_waitcnt lgkmcnt(8)
    v_mfma_f32_16x16x32_bf16 v[64:67], a[176:179], v[144:147], v[64:67]
    ds_read_b64_tr_b16 a[208:209], v116 offset:45056
    ds_read_b64_tr_b16 a[210:211], v116 offset:47104
    buffer_load_dwordx4 v228, s[48:51], s77 offen offset:0 lds
    v_mul_f32 v138, v138, v44
    v_mfma_f32_16x16x32_bf16 v[72:75], a[180:183], v[144:147], v[72:75]
    ds_read_b64_tr_b16 a[212:213], v117 offset:45056
    ds_read_b64_tr_b16 a[214:215], v117 offset:47104
    buffer_load_dwordx4 v236, s[48:51], s77 offen offset:1024 lds
    v_mul_f32 v139, v139, v44
    v_mfma_f32_16x16x32_bf16 v[80:83], a[184:187], v[144:147], v[80:83]
    ds_read_b64_tr_b16 a[216:217], v118 offset:45056
    ds_read_b64_tr_b16 a[218:219], v118 offset:47104
    buffer_load_dwordx4 v244, s[48:51], s77 offen offset:2048 lds
    v_mul_f32 v152, v152, v44
    v_mfma_f32_16x16x32_bf16 v[88:91], a[188:191], v[144:147], v[88:91]
    ds_read_b64_tr_b16 a[220:221], v119 offset:45056
    ds_read_b64_tr_b16 a[222:223], v119 offset:47104
    buffer_load_dwordx4 v252, s[48:51], s77 offen offset:3072 lds
    s_mov_b32 m0, 49152
    s_mov_b32 s77, 768
    v_mul_f32 v153, v153, v44
    s_waitcnt lgkmcnt(8)
    v_mfma_f32_16x16x32_bf16 v[64:67], a[192:195], v[160:163], v[64:67]
    ds_read_b64_tr_b16 a[176:177], v112 offset:0
    ds_read_b64_tr_b16 a[178:179], v112 offset:2048
    buffer_load_dwordx4 v252, s[48:51], s77 offen offset:3072 lds
    s_mov_b32 m0, 53248
    s_mov_b32 s77, 29440
    v_mul_f32 v154, v154, v44
    v_mfma_f32_16x16x32_bf16 v[72:75], a[196:199], v[160:163], v[72:75]
    ds_read_b64_tr_b16 a[180:181], v113 offset:0
    ds_read_b64_tr_b16 a[182:183], v113 offset:2048
    buffer_load_dwordx4 v252, s[48:51], s77 offen offset:3072 lds
    s_mov_b32 m0, 57344
    s_mov_b32 s77, 58112
    v_mul_f32 v155, v155, v44
    v_mfma_f32_16x16x32_bf16 v[80:83], a[200:203], v[160:163], v[80:83]
    ds_read_b64_tr_b16 a[184:185], v114 offset:0
    ds_read_b64_tr_b16 a[186:187], v114 offset:2048
    buffer_load_dwordx4 v228, s[48:51], s77 offen offset:0 lds
    v_cvt_pk_bf16_f32 v136, v136, v137
    v_mfma_f32_16x16x32_bf16 v[88:91], a[204:207], v[160:163], v[88:91]
    ds_read_b64_tr_b16 a[188:189], v115 offset:0
    ds_read_b64_tr_b16 a[190:191], v115 offset:2048
    buffer_load_dwordx4 v236, s[48:51], s77 offen offset:1024 lds
    v_cvt_pk_bf16_f32 v137, v138, v139
    s_waitcnt lgkmcnt(8)
    v_mfma_f32_16x16x32_bf16 v[64:67], a[208:211], v[176:179], v[64:67]
    ds_read_b64_tr_b16 a[192:193], v112 offset:4096
    ds_read_b64_tr_b16 a[194:195], v112 offset:6144
    buffer_load_dwordx4 v244, s[48:51], s77 offen offset:2048 lds
    v_cvt_pk_bf16_f32 v138, v152, v153
    v_mfma_f32_16x16x32_bf16 v[72:75], a[212:215], v[176:179], v[72:75]
    ds_read_b64_tr_b16 a[196:197], v113 offset:4096
    ds_read_b64_tr_b16 a[198:199], v113 offset:6144
    buffer_load_dwordx4 v252, s[48:51], s77 offen offset:3072 lds
    s_mov_b32 m0, 61440
    s_mov_b32 s77, 86784
    v_cvt_pk_bf16_f32 v139, v154, v155
    s_mov_b32 s78, 14336
    v_mfma_f32_16x16x32_bf16 v[80:83], a[216:219], v[176:179], v[80:83]
    ds_read_b64_tr_b16 a[200:201], v114 offset:4096
    ds_read_b64_tr_b16 a[202:203], v114 offset:6144
    buffer_load_dwordx4 v228, s[48:51], s77 offen offset:0 lds
    buffer_store_dwordx4 v[136:139], v42, s[52:55], s78 offen offset:0 sc1
    v_mfma_f32_16x16x32_bf16 v[88:91], a[220:223], v[176:179], v[88:91]
    ds_read_b64_tr_b16 a[204:205], v115 offset:4096
    ds_read_b64_tr_b16 a[206:207], v115 offset:6144
    buffer_load_dwordx4 v236, s[48:51], s77 offen offset:1024 lds
    v_mul_f32 v168, v168, v44
    s_waitcnt lgkmcnt(8)
    v_mfma_f32_16x16x32_bf16 v[64:67], a[176:179], v[192:195], v[64:67]
    ds_read_b64_tr_b16 a[208:209], v112 offset:8192
    ds_read_b64_tr_b16 a[210:211], v112 offset:10240
    buffer_load_dwordx4 v244, s[48:51], s77 offen offset:2048 lds
    v_mul_f32 v169, v169, v44
    v_mfma_f32_16x16x32_bf16 v[72:75], a[180:183], v[192:195], v[72:75]
    ds_read_b64_tr_b16 a[212:213], v113 offset:8192
    ds_read_b64_tr_b16 a[214:215], v113 offset:10240
    buffer_load_dwordx4 v252, s[48:51], s77 offen offset:3072 lds
    s_mov_b32 m0, 147456
    s_mov_b32 s77, 115456
    v_mul_f32 v170, v170, v44
    v_mfma_f32_16x16x32_bf16 v[80:83], a[184:187], v[192:195], v[80:83]
    ds_read_b64_tr_b16 a[216:217], v114 offset:8192
    ds_read_b64_tr_b16 a[218:219], v114 offset:10240
    buffer_load_dwordx4 v252, s[48:51], s77 offen offset:3072 lds
    s_mov_b32 m0, 151552
    s_mov_b32 s77, 144128
    v_mul_f32 v171, v171, v44
    v_mfma_f32_16x16x32_bf16 v[88:91], a[188:191], v[192:195], v[88:91]
    ds_read_b64_tr_b16 a[220:221], v115 offset:8192
    ds_read_b64_tr_b16 a[222:223], v115 offset:10240
    buffer_load_dwordx4 v252, s[48:51], s77 offen offset:3072 lds
    s_mov_b32 m0, 155648
    s_mov_b32 s77, 172800
    v_mul_f32 v184, v184, v44
    s_waitcnt lgkmcnt(8)
    v_mfma_f32_16x16x32_bf16 v[64:67], a[192:195], v[208:211], v[64:67]
    ds_read_b64_tr_b16 a[176:177], v112 offset:12288
    ds_read_b64_tr_b16 a[178:179], v112 offset:14336
    buffer_load_dwordx4 v228, s[48:51], s77 offen offset:0 lds
    v_mul_f32 v185, v185, v44
    v_mfma_f32_16x16x32_bf16 v[72:75], a[196:199], v[208:211], v[72:75]
    ds_read_b64_tr_b16 a[180:181], v113 offset:12288
    ds_read_b64_tr_b16 a[182:183], v113 offset:14336
    buffer_load_dwordx4 v236, s[48:51], s77 offen offset:1024 lds
    v_mul_f32 v186, v186, v44
    v_mfma_f32_16x16x32_bf16 v[80:83], a[200:203], v[208:211], v[80:83]
    ds_read_b64_tr_b16 a[184:185], v114 offset:12288
    ds_read_b64_tr_b16 a[186:187], v114 offset:14336
    buffer_load_dwordx4 v244, s[48:51], s77 offen offset:2048 lds
    v_mul_f32 v187, v187, v44
    v_cvt_pk_bf16_f32 v168, v168, v169
    v_cvt_pk_bf16_f32 v169, v170, v171
    v_cvt_pk_bf16_f32 v170, v184, v185
    v_cvt_pk_bf16_f32 v171, v186, v187
    s_mov_b32 s78, 21504
    buffer_store_dwordx4 v[168:171], v42, s[52:55], s78 offen offset:0 sc1
    v_mfma_f32_16x16x32_bf16 v[88:91], a[204:207], v[208:211], v[88:91]
    ds_read_b64_tr_b16 a[188:189], v115 offset:12288
    ds_read_b64_tr_b16 a[190:191], v115 offset:14336
    buffer_load_dwordx4 v252, s[48:51], s77 offen offset:3072 lds
    s_mov_b32 m0, 159744
    s_mov_b32 s77, 201472
    buffer_load_dwordx4 v228, s[48:51], s77 offen offset:0 lds
    buffer_load_dwordx4 v236, s[48:51], s77 offen offset:1024 lds
    buffer_load_dwordx4 v244, s[48:51], s77 offen offset:2048 lds
    buffer_load_dwordx4 v252, s[48:51], s77 offen offset:3072 lds
    s_waitcnt lgkmcnt(8)
    v_mfma_f32_16x16x32_bf16 v[64:67], a[208:211], v[224:227], v[64:67]
    s_waitcnt vmcnt(63)
    s_barrier
    ds_read_b64_tr_b16 a[192:193], v116 offset:0
    ds_read_b64_tr_b16 a[194:195], v116 offset:2048
    v_mfma_f32_16x16x32_bf16 v[72:75], a[212:215], v[224:227], v[72:75]
    ds_read_b64_tr_b16 a[196:197], v117 offset:0
    ds_read_b64_tr_b16 a[198:199], v117 offset:2048
    v_mfma_f32_16x16x32_bf16 v[80:83], a[216:219], v[224:227], v[80:83]
    ds_read_b64_tr_b16 a[200:201], v118 offset:0
    ds_read_b64_tr_b16 a[202:203], v118 offset:2048
    v_mfma_f32_16x16x32_bf16 v[88:91], a[220:223], v[224:227], v[88:91]
    ds_read_b64_tr_b16 a[204:205], v119 offset:0
    ds_read_b64_tr_b16 a[206:207], v119 offset:2048
    s_waitcnt lgkmcnt(8)
    v_mfma_f32_16x16x32_bf16 v[64:67], a[176:179], v[240:243], v[64:67]
    ds_read_b64_tr_b16 a[208:209], v116 offset:4096
    ds_read_b64_tr_b16 a[210:211], v116 offset:6144
    v_mfma_f32_16x16x32_bf16 v[72:75], a[180:183], v[240:243], v[72:75]
    ds_read_b64_tr_b16 a[212:213], v117 offset:4096
    ds_read_b64_tr_b16 a[214:215], v117 offset:6144
    v_mfma_f32_16x16x32_bf16 v[80:83], a[184:187], v[240:243], v[80:83]
    ds_read_b64_tr_b16 a[216:217], v118 offset:4096
    ds_read_b64_tr_b16 a[218:219], v118 offset:6144
    v_mfma_f32_16x16x32_bf16 v[88:91], a[188:191], v[240:243], v[88:91]
    ds_read_b64_tr_b16 a[220:221], v119 offset:4096
    ds_read_b64_tr_b16 a[222:223], v119 offset:6144
    s_waitcnt lgkmcnt(8)
    v_mfma_f32_16x16x32_bf16 v[136:139], a[192:195], v[128:131], 0
    ds_read_b64_tr_b16 a[176:177], v116 offset:8192
    ds_read_b64_tr_b16 a[178:179], v116 offset:10240
    v_mfma_f32_16x16x32_bf16 v[152:155], a[196:199], v[128:131], 0
    ds_read_b64_tr_b16 a[180:181], v117 offset:8192
    ds_read_b64_tr_b16 a[182:183], v117 offset:10240
    v_mfma_f32_16x16x32_bf16 v[168:171], a[200:203], v[128:131], 0
    ds_read_b64_tr_b16 a[184:185], v118 offset:8192
    ds_read_b64_tr_b16 a[186:187], v118 offset:10240
    v_mul_f32 v64, v64, v44
    v_mul_f32 v65, v65, v44
    v_mfma_f32_16x16x32_bf16 v[184:187], a[204:207], v[128:131], 0
    ds_read_b64_tr_b16 a[188:189], v119 offset:8192
    ds_read_b64_tr_b16 a[190:191], v119 offset:10240
    v_mul_f32 v66, v66, v44
    s_waitcnt lgkmcnt(8)
    v_mfma_f32_16x16x32_bf16 v[136:139], a[208:211], v[144:147], v[136:139]
    ds_read_b64_tr_b16 a[192:193], v116 offset:12288
    ds_read_b64_tr_b16 a[194:195], v116 offset:14336
    v_mul_f32 v67, v67, v44
    v_mfma_f32_16x16x32_bf16 v[152:155], a[212:215], v[144:147], v[152:155]
    ds_read_b64_tr_b16 a[196:197], v117 offset:12288
    ds_read_b64_tr_b16 a[198:199], v117 offset:14336
    v_mul_f32 v72, v72, v44
    v_mul_f32 v73, v73, v44
    v_mfma_f32_16x16x32_bf16 v[168:171], a[216:219], v[144:147], v[168:171]
    ds_read_b64_tr_b16 a[200:201], v118 offset:12288
    ds_read_b64_tr_b16 a[202:203], v118 offset:14336
    v_mul_f32 v74, v74, v44
    v_mfma_f32_16x16x32_bf16 v[184:187], a[220:223], v[144:147], v[184:187]
    ds_read_b64_tr_b16 a[204:205], v119 offset:12288
    ds_read_b64_tr_b16 a[206:207], v119 offset:14336
    v_mul_f32 v75, v75, v44
    s_waitcnt lgkmcnt(8)
    v_mfma_f32_16x16x32_bf16 v[136:139], a[176:179], v[160:163], v[136:139]
    ds_read_b64_tr_b16 a[208:209], v116 offset:16384
    ds_read_b64_tr_b16 a[210:211], v116 offset:18432
    v_cvt_pk_bf16_f32 v64, v64, v65
    v_cvt_pk_bf16_f32 v65, v66, v67
    v_mfma_f32_16x16x32_bf16 v[152:155], a[180:183], v[160:163], v[152:155]
    ds_read_b64_tr_b16 a[212:213], v117 offset:16384
    ds_read_b64_tr_b16 a[214:215], v117 offset:18432
    v_cvt_pk_bf16_f32 v66, v72, v73
    v_mfma_f32_16x16x32_bf16 v[168:171], a[184:187], v[160:163], v[168:171]
    ds_read_b64_tr_b16 a[216:217], v118 offset:16384
    ds_read_b64_tr_b16 a[218:219], v118 offset:18432
    v_cvt_pk_bf16_f32 v67, v74, v75
    v_mfma_f32_16x16x32_bf16 v[184:187], a[188:191], v[160:163], v[184:187]
    ds_read_b64_tr_b16 a[220:221], v119 offset:16384
    ds_read_b64_tr_b16 a[222:223], v119 offset:18432
    s_mov_b32 s78, 28672
    buffer_store_dwordx4 v[64:67], v42, s[52:55], s78 offen offset:0 sc1
    s_waitcnt lgkmcnt(8)
    v_mfma_f32_16x16x32_bf16 v[136:139], a[192:195], v[176:179], v[136:139]
    ds_read_b64_tr_b16 a[176:177], v116 offset:20480
    ds_read_b64_tr_b16 a[178:179], v116 offset:22528
    v_mul_f32 v80, v80, v44
    v_mfma_f32_16x16x32_bf16 v[152:155], a[196:199], v[176:179], v[152:155]
    ds_read_b64_tr_b16 a[180:181], v117 offset:20480
    ds_read_b64_tr_b16 a[182:183], v117 offset:22528
    v_mul_f32 v81, v81, v44
    v_mfma_f32_16x16x32_bf16 v[168:171], a[200:203], v[176:179], v[168:171]
    ds_read_b64_tr_b16 a[184:185], v118 offset:20480
    ds_read_b64_tr_b16 a[186:187], v118 offset:22528
    v_mul_f32 v82, v82, v44
    v_mul_f32 v83, v83, v44
    v_mfma_f32_16x16x32_bf16 v[184:187], a[204:207], v[176:179], v[184:187]
    ds_read_b64_tr_b16 a[188:189], v119 offset:20480
    ds_read_b64_tr_b16 a[190:191], v119 offset:22528
    v_mul_f32 v88, v88, v44
    s_waitcnt lgkmcnt(8)
    v_mfma_f32_16x16x32_bf16 v[136:139], a[208:211], v[192:195], v[136:139]
    ds_read_b64_tr_b16 a[192:193], v116 offset:24576
    ds_read_b64_tr_b16 a[194:195], v116 offset:26624
    v_mul_f32 v89, v89, v44
    v_mfma_f32_16x16x32_bf16 v[152:155], a[212:215], v[192:195], v[152:155]
    ds_read_b64_tr_b16 a[196:197], v117 offset:24576
    ds_read_b64_tr_b16 a[198:199], v117 offset:26624
    v_mul_f32 v90, v90, v44
    v_mul_f32 v91, v91, v44
    v_mfma_f32_16x16x32_bf16 v[168:171], a[216:219], v[192:195], v[168:171]
    ds_read_b64_tr_b16 a[200:201], v118 offset:24576
    ds_read_b64_tr_b16 a[202:203], v118 offset:26624
    v_cvt_pk_bf16_f32 v80, v80, v81
    v_mfma_f32_16x16x32_bf16 v[184:187], a[220:223], v[192:195], v[184:187]
    ds_read_b64_tr_b16 a[204:205], v119 offset:24576
    ds_read_b64_tr_b16 a[206:207], v119 offset:26624
    v_cvt_pk_bf16_f32 v81, v82, v83
    s_waitcnt lgkmcnt(8)
    v_mfma_f32_16x16x32_bf16 v[136:139], a[176:179], v[208:211], v[136:139]
    ds_read_b64_tr_b16 a[208:209], v116 offset:28672
    ds_read_b64_tr_b16 a[210:211], v116 offset:30720
    v_cvt_pk_bf16_f32 v82, v88, v89
    v_cvt_pk_bf16_f32 v83, v90, v91
    v_mfma_f32_16x16x32_bf16 v[152:155], a[180:183], v[208:211], v[152:155]
    ds_read_b64_tr_b16 a[212:213], v117 offset:28672
    ds_read_b64_tr_b16 a[214:215], v117 offset:30720
    s_mov_b32 s78, 35840
    v_mfma_f32_16x16x32_bf16 v[168:171], a[184:187], v[208:211], v[168:171]
    ds_read_b64_tr_b16 a[216:217], v118 offset:28672
    ds_read_b64_tr_b16 a[218:219], v118 offset:30720
    buffer_store_dwordx4 v[80:83], v42, s[52:55], s78 offen offset:0 sc1
    v_mfma_f32_16x16x32_bf16 v[184:187], a[188:191], v[208:211], v[184:187]
    ds_read_b64_tr_b16 a[220:221], v119 offset:28672
    ds_read_b64_tr_b16 a[222:223], v119 offset:30720
    s_waitcnt lgkmcnt(8)
    v_mfma_f32_16x16x32_bf16 v[136:139], a[192:195], v[224:227], v[136:139]
    s_waitcnt vmcnt(24)
    s_barrier
    ds_read_b64_tr_b16 a[176:177], v120 offset:0
    ds_read_b64_tr_b16 a[178:179], v120 offset:2048
    v_mfma_f32_16x16x32_bf16 v[152:155], a[196:199], v[224:227], v[152:155]
    ds_read_b64_tr_b16 a[180:181], v121 offset:0
    ds_read_b64_tr_b16 a[182:183], v121 offset:2048
    v_mfma_f32_16x16x32_bf16 v[168:171], a[200:203], v[224:227], v[168:171]
    ds_read_b64_tr_b16 a[184:185], v122 offset:0
    ds_read_b64_tr_b16 a[186:187], v122 offset:2048
    v_mfma_f32_16x16x32_bf16 v[184:187], a[204:207], v[224:227], v[184:187]
    ds_read_b64_tr_b16 a[188:189], v123 offset:0
    ds_read_b64_tr_b16 a[190:191], v123 offset:2048
    s_waitcnt lgkmcnt(8)
    v_mfma_f32_16x16x32_bf16 v[136:139], a[208:211], v[240:243], v[136:139]
    ds_read_b64_tr_b16 a[192:193], v120 offset:4096
    ds_read_b64_tr_b16 a[194:195], v120 offset:6144
    v_mfma_f32_16x16x32_bf16 v[152:155], a[212:215], v[240:243], v[152:155]
    ds_read_b64_tr_b16 a[196:197], v121 offset:4096
    ds_read_b64_tr_b16 a[198:199], v121 offset:6144
    v_mfma_f32_16x16x32_bf16 v[168:171], a[216:219], v[240:243], v[168:171]
    ds_read_b64_tr_b16 a[200:201], v122 offset:4096
    ds_read_b64_tr_b16 a[202:203], v122 offset:6144
    v_mfma_f32_16x16x32_bf16 v[184:187], a[220:223], v[240:243], v[184:187]
    ds_read_b64_tr_b16 a[204:205], v123 offset:4096
    ds_read_b64_tr_b16 a[206:207], v123 offset:6144
    s_waitcnt lgkmcnt(8)
    v_mfma_f32_16x16x32_bf16 v[64:67], a[176:179], v[128:131], 0
    ds_read_b64_tr_b16 a[208:209], v120 offset:8192
    ds_read_b64_tr_b16 a[210:211], v120 offset:10240
    v_mfma_f32_16x16x32_bf16 v[72:75], a[180:183], v[128:131], 0
    ds_read_b64_tr_b16 a[212:213], v121 offset:8192
    ds_read_b64_tr_b16 a[214:215], v121 offset:10240
    v_mfma_f32_16x16x32_bf16 v[80:83], a[184:187], v[128:131], 0
    ds_read_b64_tr_b16 a[216:217], v122 offset:8192
    ds_read_b64_tr_b16 a[218:219], v122 offset:10240
    v_mul_f32 v136, v136, v44
    v_mul_f32 v137, v137, v44
    v_mfma_f32_16x16x32_bf16 v[88:91], a[188:191], v[128:131], 0
    ds_read_b64_tr_b16 a[220:221], v123 offset:8192
    ds_read_b64_tr_b16 a[222:223], v123 offset:10240
    v_mul_f32 v138, v138, v44
    s_waitcnt lgkmcnt(8)
    v_mfma_f32_16x16x32_bf16 v[64:67], a[192:195], v[144:147], v[64:67]
    ds_read_b64_tr_b16 a[176:177], v120 offset:12288
    ds_read_b64_tr_b16 a[178:179], v120 offset:14336
    v_mul_f32 v139, v139, v44
    v_mfma_f32_16x16x32_bf16 v[72:75], a[196:199], v[144:147], v[72:75]
    ds_read_b64_tr_b16 a[180:181], v121 offset:12288
    ds_read_b64_tr_b16 a[182:183], v121 offset:14336
    v_mul_f32 v152, v152, v44
    v_mul_f32 v153, v153, v44
    v_mfma_f32_16x16x32_bf16 v[80:83], a[200:203], v[144:147], v[80:83]
    ds_read_b64_tr_b16 a[184:185], v122 offset:12288
    ds_read_b64_tr_b16 a[186:187], v122 offset:14336
    v_mul_f32 v154, v154, v44
    v_mfma_f32_16x16x32_bf16 v[88:91], a[204:207], v[144:147], v[88:91]
    ds_read_b64_tr_b16 a[188:189], v123 offset:12288
    ds_read_b64_tr_b16 a[190:191], v123 offset:14336
    v_mul_f32 v155, v155, v44
    s_waitcnt lgkmcnt(8)
    v_mfma_f32_16x16x32_bf16 v[64:67], a[208:211], v[160:163], v[64:67]
    ds_read_b64_tr_b16 a[192:193], v116 offset:49152
    ds_read_b64_tr_b16 a[194:195], v116 offset:51200
    v_cvt_pk_bf16_f32 v136, v136, v137
    v_cvt_pk_bf16_f32 v137, v138, v139
    v_mfma_f32_16x16x32_bf16 v[72:75], a[212:215], v[160:163], v[72:75]
    ds_read_b64_tr_b16 a[196:197], v117 offset:49152
    ds_read_b64_tr_b16 a[198:199], v117 offset:51200
    v_cvt_pk_bf16_f32 v138, v152, v153
    v_mfma_f32_16x16x32_bf16 v[80:83], a[216:219], v[160:163], v[80:83]
    ds_read_b64_tr_b16 a[200:201], v118 offset:49152
    ds_read_b64_tr_b16 a[202:203], v118 offset:51200
    v_cvt_pk_bf16_f32 v139, v154, v155
    v_mfma_f32_16x16x32_bf16 v[88:91], a[220:223], v[160:163], v[88:91]
    ds_read_b64_tr_b16 a[204:205], v119 offset:49152
    ds_read_b64_tr_b16 a[206:207], v119 offset:51200
    s_mov_b32 s78, 43008
    buffer_store_dwordx4 v[136:139], v42, s[52:55], s78 offen offset:0 sc1
    s_waitcnt lgkmcnt(8)
    v_mfma_f32_16x16x32_bf16 v[64:67], a[176:179], v[176:179], v[64:67]
    ds_read_b64_tr_b16 a[208:209], v116 offset:53248
    ds_read_b64_tr_b16 a[210:211], v116 offset:55296
    v_mul_f32 v168, v168, v44
    v_mfma_f32_16x16x32_bf16 v[72:75], a[180:183], v[176:179], v[72:75]
    ds_read_b64_tr_b16 a[212:213], v117 offset:53248
    ds_read_b64_tr_b16 a[214:215], v117 offset:55296
    v_mul_f32 v169, v169, v44
    v_mfma_f32_16x16x32_bf16 v[80:83], a[184:187], v[176:179], v[80:83]
    ds_read_b64_tr_b16 a[216:217], v118 offset:53248
    ds_read_b64_tr_b16 a[218:219], v118 offset:55296
    v_mul_f32 v170, v170, v44
    v_mul_f32 v171, v171, v44
    v_mfma_f32_16x16x32_bf16 v[88:91], a[188:191], v[176:179], v[88:91]
    ds_read_b64_tr_b16 a[220:221], v119 offset:53248
    ds_read_b64_tr_b16 a[222:223], v119 offset:55296
    v_mul_f32 v184, v184, v44
    s_waitcnt lgkmcnt(8)
    v_mfma_f32_16x16x32_bf16 v[64:67], a[192:195], v[192:195], v[64:67]
    ds_read_b64_tr_b16 a[176:177], v116 offset:57344
    ds_read_b64_tr_b16 a[178:179], v116 offset:59392
    v_mul_f32 v185, v185, v44
    v_mfma_f32_16x16x32_bf16 v[72:75], a[196:199], v[192:195], v[72:75]
    ds_read_b64_tr_b16 a[180:181], v117 offset:57344
    ds_read_b64_tr_b16 a[182:183], v117 offset:59392
    v_mul_f32 v186, v186, v44
    v_mul_f32 v187, v187, v44
    v_mfma_f32_16x16x32_bf16 v[80:83], a[200:203], v[192:195], v[80:83]
    ds_read_b64_tr_b16 a[184:185], v118 offset:57344
    ds_read_b64_tr_b16 a[186:187], v118 offset:59392
    v_cvt_pk_bf16_f32 v168, v168, v169
    v_mfma_f32_16x16x32_bf16 v[88:91], a[204:207], v[192:195], v[88:91]
    ds_read_b64_tr_b16 a[188:189], v119 offset:57344
    ds_read_b64_tr_b16 a[190:191], v119 offset:59392
    v_cvt_pk_bf16_f32 v169, v170, v171
    s_waitcnt lgkmcnt(8)
    v_mfma_f32_16x16x32_bf16 v[64:67], a[208:211], v[208:211], v[64:67]
    ds_read_b64_tr_b16 a[192:193], v116 offset:61440
    ds_read_b64_tr_b16 a[194:195], v116 offset:63488
    v_cvt_pk_bf16_f32 v170, v184, v185
    v_cvt_pk_bf16_f32 v171, v186, v187
    v_mfma_f32_16x16x32_bf16 v[72:75], a[212:215], v[208:211], v[72:75]
    ds_read_b64_tr_b16 a[196:197], v117 offset:61440
    ds_read_b64_tr_b16 a[198:199], v117 offset:63488
    s_mov_b32 s78, 50176
    v_mfma_f32_16x16x32_bf16 v[80:83], a[216:219], v[208:211], v[80:83]
    ds_read_b64_tr_b16 a[200:201], v118 offset:61440
    ds_read_b64_tr_b16 a[202:203], v118 offset:63488
    buffer_store_dwordx4 v[168:171], v42, s[52:55], s78 offen offset:0 sc1
    v_mfma_f32_16x16x32_bf16 v[88:91], a[220:223], v[208:211], v[88:91]
    ds_read_b64_tr_b16 a[204:205], v119 offset:61440
    ds_read_b64_tr_b16 a[206:207], v119 offset:63488
    s_waitcnt lgkmcnt(8)
    v_mfma_f32_16x16x32_bf16 v[64:67], a[176:179], v[224:227], v[64:67]
    s_barrier
    ds_read_b64_tr_b16 a[208:209], v112 offset:16384
    ds_read_b64_tr_b16 a[210:211], v112 offset:18432
    v_mfma_f32_16x16x32_bf16 v[72:75], a[180:183], v[224:227], v[72:75]
    ds_read_b64_tr_b16 a[212:213], v113 offset:16384
    ds_read_b64_tr_b16 a[214:215], v113 offset:18432
    v_mfma_f32_16x16x32_bf16 v[80:83], a[184:187], v[224:227], v[80:83]
    ds_read_b64_tr_b16 a[216:217], v114 offset:16384
    ds_read_b64_tr_b16 a[218:219], v114 offset:18432
    v_mfma_f32_16x16x32_bf16 v[88:91], a[188:191], v[224:227], v[88:91]
    ds_read_b64_tr_b16 a[220:221], v115 offset:16384
    ds_read_b64_tr_b16 a[222:223], v115 offset:18432
    s_waitcnt lgkmcnt(8)
    v_mfma_f32_16x16x32_bf16 v[64:67], a[192:195], v[240:243], v[64:67]
    ds_read_b64_tr_b16 a[176:177], v112 offset:20480
    ds_read_b64_tr_b16 a[178:179], v112 offset:22528
    v_mfma_f32_16x16x32_bf16 v[72:75], a[196:199], v[240:243], v[72:75]
    ds_read_b64_tr_b16 a[180:181], v113 offset:20480
    ds_read_b64_tr_b16 a[182:183], v113 offset:22528
    v_mfma_f32_16x16x32_bf16 v[80:83], a[200:203], v[240:243], v[80:83]
    ds_read_b64_tr_b16 a[184:185], v114 offset:20480
    ds_read_b64_tr_b16 a[186:187], v114 offset:22528
    v_mfma_f32_16x16x32_bf16 v[88:91], a[204:207], v[240:243], v[88:91]
    ds_read_b64_tr_b16 a[188:189], v115 offset:20480
    ds_read_b64_tr_b16 a[190:191], v115 offset:22528
    s_waitcnt lgkmcnt(8)
    v_mfma_f32_16x16x32_bf16 v[136:139], a[208:211], v[128:131], 0
    ds_read_b64_tr_b16 a[192:193], v112 offset:24576
    ds_read_b64_tr_b16 a[194:195], v112 offset:26624
    v_mfma_f32_16x16x32_bf16 v[152:155], a[212:215], v[128:131], 0
    ds_read_b64_tr_b16 a[196:197], v113 offset:24576
    ds_read_b64_tr_b16 a[198:199], v113 offset:26624
    v_mfma_f32_16x16x32_bf16 v[168:171], a[216:219], v[128:131], 0
    ds_read_b64_tr_b16 a[200:201], v114 offset:24576
    ds_read_b64_tr_b16 a[202:203], v114 offset:26624
    v_mul_f32 v64, v64, v44
    v_mul_f32 v65, v65, v44
    v_mfma_f32_16x16x32_bf16 v[184:187], a[220:223], v[128:131], 0
    ds_read_b64_tr_b16 a[204:205], v115 offset:24576
    ds_read_b64_tr_b16 a[206:207], v115 offset:26624
    v_mul_f32 v66, v66, v44
    s_waitcnt lgkmcnt(8)
    v_mfma_f32_16x16x32_bf16 v[136:139], a[176:179], v[144:147], v[136:139]
    ds_read_b64_tr_b16 a[208:209], v112 offset:28672
    ds_read_b64_tr_b16 a[210:211], v112 offset:30720
    v_mul_f32 v67, v67, v44
    v_mfma_f32_16x16x32_bf16 v[152:155], a[180:183], v[144:147], v[152:155]
    ds_read_b64_tr_b16 a[212:213], v113 offset:28672
    ds_read_b64_tr_b16 a[214:215], v113 offset:30720
    v_mul_f32 v72, v72, v44
    v_mul_f32 v73, v73, v44
    v_mfma_f32_16x16x32_bf16 v[168:171], a[184:187], v[144:147], v[168:171]
    ds_read_b64_tr_b16 a[216:217], v114 offset:28672
    ds_read_b64_tr_b16 a[218:219], v114 offset:30720
    v_mul_f32 v74, v74, v44
    v_mfma_f32_16x16x32_bf16 v[184:187], a[188:191], v[144:147], v[184:187]
    ds_read_b64_tr_b16 a[220:221], v115 offset:28672
    ds_read_b64_tr_b16 a[222:223], v115 offset:30720
    v_mul_f32 v75, v75, v44
    s_waitcnt lgkmcnt(8)
    v_mfma_f32_16x16x32_bf16 v[136:139], a[192:195], v[160:163], v[136:139]
    ds_read_b64_tr_b16 a[176:177], v112 offset:32768
    ds_read_b64_tr_b16 a[178:179], v112 offset:34816
    v_cvt_pk_bf16_f32 v64, v64, v65
    v_cvt_pk_bf16_f32 v65, v66, v67
    v_mfma_f32_16x16x32_bf16 v[152:155], a[196:199], v[160:163], v[152:155]
    ds_read_b64_tr_b16 a[180:181], v113 offset:32768
    ds_read_b64_tr_b16 a[182:183], v113 offset:34816
    v_cvt_pk_bf16_f32 v66, v72, v73
    v_mfma_f32_16x16x32_bf16 v[168:171], a[200:203], v[160:163], v[168:171]
    ds_read_b64_tr_b16 a[184:185], v114 offset:32768
    ds_read_b64_tr_b16 a[186:187], v114 offset:34816
    v_cvt_pk_bf16_f32 v67, v74, v75
    v_mfma_f32_16x16x32_bf16 v[184:187], a[204:207], v[160:163], v[184:187]
    ds_read_b64_tr_b16 a[188:189], v115 offset:32768
    ds_read_b64_tr_b16 a[190:191], v115 offset:34816
    s_mov_b32 s78, 57344
    buffer_store_dwordx4 v[64:67], v42, s[52:55], s78 offen offset:0 sc1
    s_waitcnt lgkmcnt(8)
    v_mfma_f32_16x16x32_bf16 v[136:139], a[208:211], v[176:179], v[136:139]
    ds_read_b64_tr_b16 a[192:193], v112 offset:36864
    ds_read_b64_tr_b16 a[194:195], v112 offset:38912
    v_mul_f32 v80, v80, v44
    v_mfma_f32_16x16x32_bf16 v[152:155], a[212:215], v[176:179], v[152:155]
    ds_read_b64_tr_b16 a[196:197], v113 offset:36864
    ds_read_b64_tr_b16 a[198:199], v113 offset:38912
    v_mul_f32 v81, v81, v44
    v_mfma_f32_16x16x32_bf16 v[168:171], a[216:219], v[176:179], v[168:171]
    ds_read_b64_tr_b16 a[200:201], v114 offset:36864
    ds_read_b64_tr_b16 a[202:203], v114 offset:38912
    v_mul_f32 v82, v82, v44
    v_mul_f32 v83, v83, v44
    v_mfma_f32_16x16x32_bf16 v[184:187], a[220:223], v[176:179], v[184:187]
    ds_read_b64_tr_b16 a[204:205], v115 offset:36864
    ds_read_b64_tr_b16 a[206:207], v115 offset:38912
    v_mul_f32 v88, v88, v44
    s_waitcnt lgkmcnt(8)
    v_mfma_f32_16x16x32_bf16 v[136:139], a[176:179], v[192:195], v[136:139]
    ds_read_b64_tr_b16 a[208:209], v112 offset:40960
    ds_read_b64_tr_b16 a[210:211], v112 offset:43008
    v_mul_f32 v89, v89, v44
    v_mfma_f32_16x16x32_bf16 v[152:155], a[180:183], v[192:195], v[152:155]
    ds_read_b64_tr_b16 a[212:213], v113 offset:40960
    ds_read_b64_tr_b16 a[214:215], v113 offset:43008
    v_mul_f32 v90, v90, v44
    v_mul_f32 v91, v91, v44
    v_mfma_f32_16x16x32_bf16 v[168:171], a[184:187], v[192:195], v[168:171]
    ds_read_b64_tr_b16 a[216:217], v114 offset:40960
    ds_read_b64_tr_b16 a[218:219], v114 offset:43008
    v_cvt_pk_bf16_f32 v80, v80, v81
    v_mfma_f32_16x16x32_bf16 v[184:187], a[188:191], v[192:195], v[184:187]
    ds_read_b64_tr_b16 a[220:221], v115 offset:40960
    ds_read_b64_tr_b16 a[222:223], v115 offset:43008
    v_cvt_pk_bf16_f32 v81, v82, v83
    s_waitcnt lgkmcnt(8)
    v_mfma_f32_16x16x32_bf16 v[136:139], a[192:195], v[208:211], v[136:139]
    ds_read_b64_tr_b16 a[176:177], v112 offset:45056
    ds_read_b64_tr_b16 a[178:179], v112 offset:47104
    v_cvt_pk_bf16_f32 v82, v88, v89
    v_cvt_pk_bf16_f32 v83, v90, v91
    v_mfma_f32_16x16x32_bf16 v[152:155], a[196:199], v[208:211], v[152:155]
    ds_read_b64_tr_b16 a[180:181], v113 offset:45056
    ds_read_b64_tr_b16 a[182:183], v113 offset:47104
    s_mov_b32 s78, 64512
    v_mfma_f32_16x16x32_bf16 v[168:171], a[200:203], v[208:211], v[168:171]
    ds_read_b64_tr_b16 a[184:185], v114 offset:45056
    ds_read_b64_tr_b16 a[186:187], v114 offset:47104
    buffer_store_dwordx4 v[80:83], v42, s[52:55], s78 offen offset:0 sc1
    v_mfma_f32_16x16x32_bf16 v[184:187], a[204:207], v[208:211], v[184:187]
    ds_read_b64_tr_b16 a[188:189], v115 offset:45056
    ds_read_b64_tr_b16 a[190:191], v115 offset:47104
    s_waitcnt lgkmcnt(8)
    v_mfma_f32_16x16x32_bf16 v[136:139], a[208:211], v[224:227], v[136:139]
    s_waitcnt vmcnt(6)
    s_barrier
    ds_read_b64_tr_b16 a[192:193], v112 offset:49152
    ds_read_b64_tr_b16 a[194:195], v112 offset:51200
    v_mfma_f32_16x16x32_bf16 v[152:155], a[212:215], v[224:227], v[152:155]
    ds_read_b64_tr_b16 a[196:197], v113 offset:49152
    ds_read_b64_tr_b16 a[198:199], v113 offset:51200
    v_mfma_f32_16x16x32_bf16 v[168:171], a[216:219], v[224:227], v[168:171]
    ds_read_b64_tr_b16 a[200:201], v114 offset:49152
    ds_read_b64_tr_b16 a[202:203], v114 offset:51200
    v_mfma_f32_16x16x32_bf16 v[184:187], a[220:223], v[224:227], v[184:187]
    ds_read_b64_tr_b16 a[204:205], v115 offset:49152
    ds_read_b64_tr_b16 a[206:207], v115 offset:51200
    s_waitcnt lgkmcnt(8)
    v_mfma_f32_16x16x32_bf16 v[136:139], a[176:179], v[240:243], v[136:139]
    ds_read_b64_tr_b16 a[208:209], v112 offset:53248
    ds_read_b64_tr_b16 a[210:211], v112 offset:55296
    v_mfma_f32_16x16x32_bf16 v[152:155], a[180:183], v[240:243], v[152:155]
    ds_read_b64_tr_b16 a[212:213], v113 offset:53248
    ds_read_b64_tr_b16 a[214:215], v113 offset:55296
    v_mfma_f32_16x16x32_bf16 v[168:171], a[184:187], v[240:243], v[168:171]
    ds_read_b64_tr_b16 a[216:217], v114 offset:53248
    ds_read_b64_tr_b16 a[218:219], v114 offset:55296
    v_mfma_f32_16x16x32_bf16 v[184:187], a[188:191], v[240:243], v[184:187]
    ds_read_b64_tr_b16 a[220:221], v115 offset:53248
    ds_read_b64_tr_b16 a[222:223], v115 offset:55296
    s_waitcnt lgkmcnt(8)
    v_mfma_f32_16x16x32_bf16 v[64:67], a[192:195], v[128:131], 0
    ds_read_b64_tr_b16 a[176:177], v112 offset:57344
    ds_read_b64_tr_b16 a[178:179], v112 offset:59392
    v_mfma_f32_16x16x32_bf16 v[72:75], a[196:199], v[128:131], 0
    ds_read_b64_tr_b16 a[180:181], v113 offset:57344
    ds_read_b64_tr_b16 a[182:183], v113 offset:59392
    v_mfma_f32_16x16x32_bf16 v[80:83], a[200:203], v[128:131], 0
    ds_read_b64_tr_b16 a[184:185], v114 offset:57344
    ds_read_b64_tr_b16 a[186:187], v114 offset:59392
    v_mul_f32 v136, v136, v44
    v_mul_f32 v137, v137, v44
    v_mul_f32 v138, v138, v44
    v_mfma_f32_16x16x32_bf16 v[88:91], a[204:207], v[128:131], 0
    ds_read_b64_tr_b16 a[188:189], v115 offset:57344
    ds_read_b64_tr_b16 a[190:191], v115 offset:59392
    v_mul_f32 v139, v139, v44
    v_mul_f32 v152, v152, v44
    s_waitcnt lgkmcnt(8)
    v_mfma_f32_16x16x32_bf16 v[64:67], a[208:211], v[144:147], v[64:67]
    ds_read_b64_tr_b16 a[192:193], v112 offset:61440
    ds_read_b64_tr_b16 a[194:195], v112 offset:63488
    v_mul_f32 v153, v153, v44
    v_mul_f32 v154, v154, v44
    v_mfma_f32_16x16x32_bf16 v[72:75], a[212:215], v[144:147], v[72:75]
    ds_read_b64_tr_b16 a[196:197], v113 offset:61440
    ds_read_b64_tr_b16 a[198:199], v113 offset:63488
    v_mul_f32 v155, v155, v44
    v_cvt_pk_bf16_f32 v136, v136, v137
    v_mfma_f32_16x16x32_bf16 v[80:83], a[216:219], v[144:147], v[80:83]
    ds_read_b64_tr_b16 a[200:201], v114 offset:61440
    ds_read_b64_tr_b16 a[202:203], v114 offset:63488
    v_cvt_pk_bf16_f32 v137, v138, v139
    v_cvt_pk_bf16_f32 v138, v152, v153
    v_mfma_f32_16x16x32_bf16 v[88:91], a[220:223], v[144:147], v[88:91]
    ds_read_b64_tr_b16 a[204:205], v115 offset:61440
    ds_read_b64_tr_b16 a[206:207], v115 offset:63488
    v_cvt_pk_bf16_f32 v139, v154, v155
    s_mov_b32 s78, 71680
    s_waitcnt lgkmcnt(8)
    v_mfma_f32_16x16x32_bf16 v[64:67], a[176:179], v[160:163], v[64:67]
    ds_read_b64_tr_b16 a[208:209], v120 offset:16384
    ds_read_b64_tr_b16 a[210:211], v120 offset:18432
    buffer_store_dwordx4 v[136:139], v42, s[52:55], s78 offen offset:0 sc1
    v_mul_f32 v168, v168, v44
    v_mfma_f32_16x16x32_bf16 v[72:75], a[180:183], v[160:163], v[72:75]
    ds_read_b64_tr_b16 a[212:213], v121 offset:16384
    ds_read_b64_tr_b16 a[214:215], v121 offset:18432
    v_mul_f32 v169, v169, v44
    v_mul_f32 v170, v170, v44
    v_mul_f32 v171, v171, v44
    v_mfma_f32_16x16x32_bf16 v[80:83], a[184:187], v[160:163], v[80:83]
    ds_read_b64_tr_b16 a[216:217], v122 offset:16384
    ds_read_b64_tr_b16 a[218:219], v122 offset:18432
    v_mul_f32 v184, v184, v44
    v_mul_f32 v185, v185, v44
    v_mfma_f32_16x16x32_bf16 v[88:91], a[188:191], v[160:163], v[88:91]
    ds_read_b64_tr_b16 a[220:221], v123 offset:16384
    ds_read_b64_tr_b16 a[222:223], v123 offset:18432
    v_mul_f32 v186, v186, v44
    v_mul_f32 v187, v187, v44
    s_waitcnt lgkmcnt(8)
    v_mfma_f32_16x16x32_bf16 v[64:67], a[192:195], v[176:179], v[64:67]
    ds_read_b64_tr_b16 a[176:177], v120 offset:20480
    ds_read_b64_tr_b16 a[178:179], v120 offset:22528
    v_cvt_pk_bf16_f32 v168, v168, v169
    v_cvt_pk_bf16_f32 v169, v170, v171
    v_mfma_f32_16x16x32_bf16 v[72:75], a[196:199], v[176:179], v[72:75]
    ds_read_b64_tr_b16 a[180:181], v121 offset:20480
    ds_read_b64_tr_b16 a[182:183], v121 offset:22528
    v_cvt_pk_bf16_f32 v170, v184, v185
    v_cvt_pk_bf16_f32 v171, v186, v187
    v_mfma_f32_16x16x32_bf16 v[80:83], a[200:203], v[176:179], v[80:83]
    ds_read_b64_tr_b16 a[184:185], v122 offset:20480
    ds_read_b64_tr_b16 a[186:187], v122 offset:22528
    s_mov_b32 s78, 78848
    buffer_store_dwordx4 v[168:171], v42, s[52:55], s78 offen offset:0 sc1
    v_mfma_f32_16x16x32_bf16 v[88:91], a[204:207], v[176:179], v[88:91]
    ds_read_b64_tr_b16 a[188:189], v123 offset:20480
    ds_read_b64_tr_b16 a[190:191], v123 offset:22528
    s_waitcnt lgkmcnt(8)
    v_mfma_f32_16x16x32_bf16 v[64:67], a[208:211], v[192:195], v[64:67]
    ds_read_b64_tr_b16 a[192:193], v120 offset:24576
    ds_read_b64_tr_b16 a[194:195], v120 offset:26624
    v_mfma_f32_16x16x32_bf16 v[72:75], a[212:215], v[192:195], v[72:75]
    ds_read_b64_tr_b16 a[196:197], v121 offset:24576
    ds_read_b64_tr_b16 a[198:199], v121 offset:26624
    v_mfma_f32_16x16x32_bf16 v[80:83], a[216:219], v[192:195], v[80:83]
    ds_read_b64_tr_b16 a[200:201], v122 offset:24576
    ds_read_b64_tr_b16 a[202:203], v122 offset:26624
    v_mfma_f32_16x16x32_bf16 v[88:91], a[220:223], v[192:195], v[88:91]
    ds_read_b64_tr_b16 a[204:205], v123 offset:24576
    ds_read_b64_tr_b16 a[206:207], v123 offset:26624
    s_waitcnt lgkmcnt(8)
    v_mfma_f32_16x16x32_bf16 v[64:67], a[176:179], v[208:211], v[64:67]
    ds_read_b64_tr_b16 a[208:209], v120 offset:28672
    ds_read_b64_tr_b16 a[210:211], v120 offset:30720
    v_mfma_f32_16x16x32_bf16 v[72:75], a[180:183], v[208:211], v[72:75]
    ds_read_b64_tr_b16 a[212:213], v121 offset:28672
    ds_read_b64_tr_b16 a[214:215], v121 offset:30720
    v_mfma_f32_16x16x32_bf16 v[80:83], a[184:187], v[208:211], v[80:83]
    ds_read_b64_tr_b16 a[216:217], v122 offset:28672
    ds_read_b64_tr_b16 a[218:219], v122 offset:30720
    v_mfma_f32_16x16x32_bf16 v[88:91], a[188:191], v[208:211], v[88:91]
    ds_read_b64_tr_b16 a[220:221], v123 offset:28672
    ds_read_b64_tr_b16 a[222:223], v123 offset:30720
    s_waitcnt lgkmcnt(8)
    v_mfma_f32_16x16x32_bf16 v[64:67], a[192:195], v[224:227], v[64:67]
    v_mfma_f32_16x16x32_bf16 v[72:75], a[196:199], v[224:227], v[72:75]
    v_mfma_f32_16x16x32_bf16 v[80:83], a[200:203], v[224:227], v[80:83]
    v_mfma_f32_16x16x32_bf16 v[88:91], a[204:207], v[224:227], v[88:91]
    s_waitcnt lgkmcnt(0)
    v_mfma_f32_16x16x32_bf16 v[64:67], a[208:211], v[240:243], v[64:67]
    v_mfma_f32_16x16x32_bf16 v[72:75], a[212:215], v[240:243], v[72:75]
    v_mfma_f32_16x16x32_bf16 v[80:83], a[216:219], v[240:243], v[80:83]
    v_mfma_f32_16x16x32_bf16 v[88:91], a[220:223], v[240:243], v[88:91]
    s_nop 7
    v_mul_f32 v64, v64, v44
    v_mul_f32 v65, v65, v44
    v_mul_f32 v66, v66, v44
    v_mul_f32 v67, v67, v44
    v_mul_f32 v72, v72, v44
    v_mul_f32 v73, v73, v44
    v_mul_f32 v74, v74, v44
    v_mul_f32 v75, v75, v44
    v_cvt_pk_bf16_f32 v64, v64, v65
    v_cvt_pk_bf16_f32 v65, v66, v67
    v_cvt_pk_bf16_f32 v66, v72, v73
    v_cvt_pk_bf16_f32 v67, v74, v75
    s_mov_b32 s78, 86016
    buffer_store_dwordx4 v[64:67], v42, s[52:55], s78 offen offset:0 sc1
    v_mul_f32 v80, v80, v44
    v_mul_f32 v81, v81, v44
    v_mul_f32 v82, v82, v44
    v_mul_f32 v83, v83, v44
    v_mul_f32 v88, v88, v44
    v_mul_f32 v89, v89, v44
    v_mul_f32 v90, v90, v44
    v_mul_f32 v91, v91, v44
    v_cvt_pk_bf16_f32 v80, v80, v81
    v_cvt_pk_bf16_f32 v81, v82, v83
    v_cvt_pk_bf16_f32 v82, v88, v89
    v_cvt_pk_bf16_f32 v83, v90, v91
    s_mov_b32 s78, 93184
    buffer_store_dwordx4 v[80:83], v42, s[52:55], s78 offen offset:0 sc1
    s_branch L_epi
L_fb_H:
    s_waitcnt vmcnt(0) lgkmcnt(0)
    s_nop 7
    v_mbcnt_lo_u32_b32 v3, -1, 0
    v_mbcnt_hi_u32_b32 v3, -1, v3
    v_and_b32 v1, 15, v3
    v_lshrrev_b32 v2, 4, v3
    v_and_b32 v0, 1, v2
    v_lshlrev_b32 v0, 1, v0
    v_lshrrev_b32 v2, 1, v2
    v_or_b32 v2, v2, v0
    v_lshlrev_b32 v2, 4, v2
    v_lshl_add_u32 v2, v1, 9, v2
    v_mov_b32 v46, 0xff800000
    s_mov_b32 s77, 0
L_fbl_H:
    buffer_load_dwordx4 a[176:179], v2, s[36:39], s77 offen offset:0
    buffer_load_dwordx4 a[180:183], v2, s[36:39], s77 offen offset:64
    buffer_load_dwordx4 a[184:187], v2, s[36:39], s77 offen offset:128
    buffer_load_dwordx4 a[188:191], v2, s[36:39], s77 offen offset:192
    buffer_load_dwordx4 a[192:195], v2, s[36:39], s77 offen offset:256
    buffer_load_dwordx4 a[196:199], v2, s[36:39], s77 offen offset:320
    buffer_load_dwordx4 a[200:203], v2, s[36:39], s77 offen offset:384
    buffer_load_dwordx4 a[204:207], v2, s[36:39], s77 offen offset:448
    s_waitcnt vmcnt(0)
    v_mfma_f32_16x16x32_bf16 v[64:67], a[176:179], a[112:115], 0
    v_mfma_f32_16x16x32_bf16 v[64:67], a[180:183], a[120:123], v[64:67]
    v_mfma_f32_16x16x32_bf16 v[64:67], a[184:187], a[128:131], v[64:67]
    v_mfma_f32_16x16x32_bf16 v[64:67], a[188:191], a[136:139], v[64:67]
    v_mfma_f32_16x16x32_bf16 v[64:67], a[192:195], a[144:147], v[64:67]
    v_mfma_f32_16x16x32_bf16 v[64:67], a[196:199], a[152:155], v[64:67]
    v_mfma_f32_16x16x32_bf16 v[64:67], a[200:203], a[160:163], v[64:67]
    v_mfma_f32_16x16x32_bf16 v[64:67], a[204:207], a[168:171], v[64:67]
    s_nop 7
    s_nop 7
    v_max3_f32 v46, v46, v64, v65
    v_max3_f32 v46, v46, v66, v67
    s_add_u32 s77, s77, 8192
    s_cmp_lt_u32 s77, 262144
    s_cbranch_scc1 L_fbl_H
    s_nop 1
    v_mov_b32 v1, v46
    s_nop 1
    v_permlane32_swap_b32 v46, v1
    s_nop 1
    v_max_f32 v46, v46, v1
    v_mov_b32 v1, v46
    s_nop 1
    v_permlane16_swap_b32 v46, v1
    s_nop 1
    v_max_f32 v46, v46, v1
    v_sub_f32 v48, 0, v46
    v_sub_f32 v49, 0, v46
    v_sub_f32 v50, 0, v46
    v_sub_f32 v51, 0, v46
    s_mov_b32 s76, 0
    s_mov_b32 s82, 0
    s_barrier
    s_branch L_restart_H
L_epi:
    s_waitcnt vmcnt(0)
    s_barrier
    v_mbcnt_lo_u32_b32 v3, -1, 0
    v_mbcnt_hi_u32_b32 v3, -1, v3
    s_lshl_b32 s83, s87, 4
    v_mov_b32 v4, s83
    s_cmp_lg_u32 s72, 0
    s_cbranch_scc1 L_noatom
    v_cmp_eq_u32 vcc, 0, v3
    s_and_saveexec_b64 s[88:89], vcc
    v_mov_b32 v5, 1
    buffer_atomic_add v5, v4, s[64:67], 0 offen sc1
    s_mov_b64 exec, s[88:89]
L_noatom:
    s_cmp_ge_u32 s79, 14
    s_cbranch_scc1 L_fin
    v_and_b32 v5, 15, v3
    v_lshrrev_b32 v6, 4, v3
    v_lshrrev_b32 v7, 2, v5
    v_and_b32 v16, 3, v5
    v_cmp_eq_u32 vcc, v6, v7
    v_cndmask_b32 v17, -1, v16, vcc
    v_mov_b32 v18, 0x3f80
    v_mov_b32 v19, 0x3f800000
    v_mov_b32 v20, 0
    v_cmp_eq_u32 vcc, 0, v17
    v_cndmask_b32 v8, v20, v18, vcc
    v_cmp_eq_u32 vcc, 1, v17
    v_cndmask_b32 v8, v8, v19, vcc
    v_cmp_eq_u32 vcc, 2, v17
    v_cndmask_b32 v9, v20, v18, vcc
    v_cmp_eq_u32 vcc, 3, v17
    v_cndmask_b32 v9, v9, v19, vcc
    v_mov_b32 v10, 0
    v_mov_b32 v11, 0
    v_mov_b32 v12, 0
    v_mov_b32 v13, 0
    v_mov_b32 v14, v8
    v_mov_b32 v15, v9
    v_mul_u32_u24 v21, 1792, v5
    v_lshl_add_u32 v21, v6, 3, v21
    s_mul_i32 s83, s72, 57344
    v_add_u32 v21, s83, v21
    s_mov_b32 s84, 0
L_poll:
    buffer_load_dword v5, v4, s[64:67], 0 offen sc1
    s_waitcnt vmcnt(0)
    v_readfirstlane_b32 s83, v5
    s_cmp_ge_u32 s83, 16
    s_cbranch_scc1 L_go2
    s_add_u32 s84, s84, 1
    s_cmp_lt_u32 s84, 20000
    s_sleep 1
    s_cbranch_scc1 L_poll
L_go2:
    s_mov_b32 s77, 0
    buffer_load_dwordx4 v[128:131], v42, s[56:59], s77 offen sc1
    s_mov_b32 s77, 100352
    buffer_load_dwordx4 v[132:135], v42, s[56:59], s77 offen sc1
    s_mov_b32 s77, 200704
    buffer_load_dwordx4 v[136:139], v42, s[56:59], s77 offen sc1
    s_mov_b32 s77, 301056
    buffer_load_dwordx4 v[140:143], v42, s[56:59], s77 offen sc1
    s_mov_b32 s77, 401408
    buffer_load_dwordx4 v[144:147], v42, s[56:59], s77 offen sc1
    s_mov_b32 s77, 501760
    buffer_load_dwordx4 v[148:151], v42, s[56:59], s77 offen sc1
    s_mov_b32 s77, 602112
    buffer_load_dwordx4 v[152:155], v42, s[56:59], s77 offen sc1
    s_mov_b32 s77, 702464
    buffer_load_dwordx4 v[156:159], v42, s[56:59], s77 offen sc1
    s_mov_b32 s77, 802816
    buffer_load_dwordx4 v[160:163], v42, s[56:59], s77 offen sc1
    s_mov_b32 s77, 903168
    buffer_load_dwordx4 v[164:167], v42, s[56:59], s77 offen sc1
    s_mov_b32 s77, 1003520
    buffer_load_dwordx4 v[168:171], v42, s[56:59], s77 offen sc1
    s_mov_b32 s77, 1103872
    buffer_load_dwordx4 v[172:175], v42, s[56:59], s77 offen sc1
    s_mov_b32 s77, 1204224
    buffer_load_dwordx4 v[176:179], v42, s[56:59], s77 offen sc1
    s_mov_b32 s77, 1304576
    buffer_load_dwordx4 v[180:183], v42, s[56:59], s77 offen sc1
    s_mov_b32 s77, 1404928
    buffer_load_dwordx4 v[184:187], v42, s[56:59], s77 offen sc1
    s_mov_b32 s77, 1505280
    buffer_load_dwordx4 v[188:191], v42, s[56:59], s77 offen sc1
    s_cmp_eq_u32 s72, 3
    s_cbranch_scc1 L_red1
    s_mov_b32 s77, 0
    buffer_load_dwordx4 v[192:195], v42, s[56:59], s77 offen offset:1024 sc1
    s_mov_b32 s77, 100352
    buffer_load_dwordx4 v[196:199], v42, s[56:59], s77 offen offset:1024 sc1
    s_mov_b32 s77, 200704
    buffer_load_dwordx4 v[200:203], v42, s[56:59], s77 offen offset:1024 sc1
    s_mov_b32 s77, 301056
    buffer_load_dwordx4 v[204:207], v42, s[56:59], s77 offen offset:1024 sc1
    s_mov_b32 s77, 401408
    buffer_load_dwordx4 v[208:211], v42, s[56:59], s77 offen offset:1024 sc1
    s_mov_b32 s77, 501760
    buffer_load_dwordx4 v[212:215], v42, s[56:59], s77 offen offset:1024 sc1
    s_mov_b32 s77, 602112
    buffer_load_dwordx4 v[216:219], v42, s[56:59], s77 offen offset:1024 sc1
    s_mov_b32 s77, 702464
    buffer_load_dwordx4 v[220:223], v42, s[56:59], s77 offen offset:1024 sc1
    s_mov_b32 s77, 802816
    buffer_load_dwordx4 v[224:227], v42, s[56:59], s77 offen offset:1024 sc1
    s_mov_b32 s77, 903168
    buffer_load_dwordx4 v[228:231], v42, s[56:59], s77 offen offset:1024 sc1
    s_mov_b32 s77, 1003520
    buffer_load_dwordx4 v[232:235], v42, s[56:59], s77 offen offset:1024 sc1
    s_mov_b32 s77, 1103872
    buffer_load_dwordx4 v[236:239], v42, s[56:59], s77 offen offset:1024 sc1
    s_mov_b32 s77, 1204224
    buffer_load_dwordx4 v[240:243], v42, s[56:59], s77 offen offset:1024 sc1
    s_mov_b32 s77, 1304576
    buffer_load_dwordx4 v[244:247], v42, s[56:59], s77 offen offset:1024 sc1
    s_mov_b32 s77, 1404928
    buffer_load_dwordx4 v[248:251], v42, s[56:59], s77 offen offset:1024 sc1
    s_mov_b32 s77, 1505280
    buffer_load_dwordx4 v[252:255], v42, s[56:59], s77 offen offset:1024 sc1
    s_waitcnt vmcnt(31)
    v_mfma_f32_16x16x32_bf16 v[64:67], v[8:11], v[128:131], 0
    v_mfma_f32_16x16x32_bf16 v[68:71], v[12:15], v[128:131], 0
    s_waitcnt vmcnt(30)
    v_mfma_f32_16x16x32_bf16 v[64:67], v[8:11], v[132:135], v[64:67]
    v_mfma_f32_16x16x32_bf16 v[68:71], v[12:15], v[132:135], v[68:71]
    s_waitcnt vmcnt(29)
    v_mfma_f32_16x16x32_bf16 v[64:67], v[8:11], v[136:139], v[64:67]
    v_mfma_f32_16x16x32_bf16 v[68:71], v[12:15], v[136:139], v[68:71]
    s_waitcnt vmcnt(28)
    v_mfma_f32_16x16x32_bf16 v[64:67], v[8:11], v[140:143], v[64:67]
    v_mfma_f32_16x16x32_bf16 v[68:71], v[12:15], v[140:143], v[68:71]
    s_waitcnt vmcnt(27)
    v_mfma_f32_16x16x32_bf16 v[64:67], v[8:11], v[144:147], v[64:67]
    v_mfma_f32_16x16x32_bf16 v[68:71], v[12:15], v[144:147], v[68:71]
    s_waitcnt vmcnt(26)
    v_mfma_f32_16x16x32_bf16 v[64:67], v[8:11], v[148:151], v[64:67]
    v_mfma_f32_16x16x32_bf16 v[68:71], v[12:15], v[148:151], v[68:71]
    s_waitcnt vmcnt(25)
    v_mfma_f32_16x16x32_bf16 v[64:67], v[8:11], v[152:155], v[64:67]
    v_mfma_f32_16x16x32_bf16 v[68:71], v[12:15], v[152:155], v[68:71]
    s_waitcnt vmcnt(24)
    v_mfma_f32_16x16x32_bf16 v[64:67], v[8:11], v[156:159], v[64:67]
    v_mfma_f32_16x16x32_bf16 v[68:71], v[12:15], v[156:159], v[68:71]
    s_waitcnt vmcnt(23)
    v_mfma_f32_16x16x32_bf16 v[64:67], v[8:11], v[160:163], v[64:67]
    v_mfma_f32_16x16x32_bf16 v[68:71], v[12:15], v[160:163], v[68:71]
    s_waitcnt vmcnt(22)
    v_mfma_f32_16x16x32_bf16 v[64:67], v[8:11], v[164:167], v[64:67]
    v_mfma_f32_16x16x32_bf16 v[68:71], v[12:15], v[164:167], v[68:71]
    s_waitcnt vmcnt(21)
    v_mfma_f32_16x16x32_bf16 v[64:67], v[8:11], v[168:171], v[64:67]
    v_mfma_f32_16x16x32_bf16 v[68:71], v[12:15], v[168:171], v[68:71]
    s_waitcnt vmcnt(20)
    v_mfma_f32_16x16x32_bf16 v[64:67], v[8:11], v[172:175], v[64:67]
    v_mfma_f32_16x16x32_bf16 v[68:71], v[12:15], v[172:175], v[68:71]
    s_waitcnt vmcnt(19)
    v_mfma_f32_16x16x32_bf16 v[64:67], v[8:11], v[176:179], v[64:67]
    v_mfma_f32_16x16x32_bf16 v[68:71], v[12:15], v[176:179], v[68:71]
    s_waitcnt vmcnt(18)
    v_mfma_f32_16x16x32_bf16 v[64:67], v[8:11], v[180:183], v[64:67]
    v_mfma_f32_16x16x32_bf16 v[68:71], v[12:15], v[180:183], v[68:71]
    s_waitcnt vmcnt(17)
    v_mfma_f32_16x16x32_bf16 v[64:67], v[8:11], v[184:187], v[64:67]
    v_mfma_f32_16x16x32_bf16 v[68:71], v[12:15], v[184:187], v[68:71]
    s_waitcnt vmcnt(16)
    v_mfma_f32_16x16x32_bf16 v[64:67], v[8:11], v[188:191], v[64:67]
    v_mfma_f32_16x16x32_bf16 v[68:71], v[12:15], v[188:191], v[68:71]
    s_waitcnt vmcnt(15)
    v_mfma_f32_16x16x32_bf16 v[72:75], v[8:11], v[192:195], 0
    v_mfma_f32_16x16x32_bf16 v[76:79], v[12:15], v[192:195], 0
    s_waitcnt vmcnt(14)
    v_mfma_f32_16x16x32_bf16 v[72:75], v[8:11], v[196:199], v[72:75]
    v_mfma_f32_16x16x32_bf16 v[76:79], v[12:15], v[196:199], v[76:79]
    s_waitcnt vmcnt(13)
    v_mfma_f32_16x16x32_bf16 v[72:75], v[8:11], v[200:203], v[72:75]
    v_mfma_f32_16x16x32_bf16 v[76:79], v[12:15], v[200:203], v[76:79]
    s_waitcnt vmcnt(12)
    v_mfma_f32_16x16x32_bf16 v[72:75], v[8:11], v[204:207], v[72:75]
    v_mfma_f32_16x16x32_bf16 v[76:79], v[12:15], v[204:207], v[76:79]
    s_waitcnt vmcnt(11)
    v_mfma_f32_16x16x32_bf16 v[72:75], v[8:11], v[208:211], v[72:75]
    v_mfma_f32_16x16x32_bf16 v[76:79], v[12:15], v[208:211], v[76:79]
    s_waitcnt vmcnt(10)
    v_mfma_f32_16x16x32_bf16 v[72:75], v[8:11], v[212:215], v[72:75]
    v_mfma_f32_16x16x32_bf16 v[76:79], v[12:15], v[212:215], v[76:79]
    s_waitcnt vmcnt(9)
    v_mfma_f32_16x16x32_bf16 v[72:75], v[8:11], v[216:219], v[72:75]
    v_mfma_f32_16x16x32_bf16 v[76:79], v[12:15], v[216:219], v[76:79]
    s_waitcnt vmcnt(8)
    v_mfma_f32_16x16x32_bf16 v[72:75], v[8:11], v[220:223], v[72:75]
    v_mfma_f32_16x16x32_bf16 v[76:79], v[12:15], v[220:223], v[76:79]
    s_waitcnt vmcnt(7)
    v_mfma_f32_16x16x32_bf16 v[72:75], v[8:11], v[224:227], v[72:75]
    v_mfma_f32_16x16x32_bf16 v[76:79], v[12:15], v[224:227], v[76:79]
    s_waitcnt vmcnt(6)
    v_mfma_f32_16x16x32_bf16 v[72:75], v[8:11], v[228:231], v[72:75]
    v_mfma_f32_16x16x32_bf16 v[76:79], v[12:15], v[228:231], v[76:79]
    s_waitcnt vmcnt(5)
    v_mfma_f32_16x16x32_bf16 v[72:75], v[8:11], v[232:235], v[72:75]
    v_mfma_f32_16x16x32_bf16 v[76:79], v[12:15], v[232:235], v[76:79]
    s_waitcnt vmcnt(4)
    v_mfma_f32_16x16x32_bf16 v[72:75], v[8:11], v[236:239], v[72:75]
    v_mfma_f32_16x16x32_bf16 v[76:79], v[12:15], v[236:239], v[76:79]
    s_waitcnt vmcnt(3)
    v_mfma_f32_16x16x32_bf16 v[72:75], v[8:11], v[240:243], v[72:75]
    v_mfma_f32_16x16x32_bf16 v[76:79], v[12:15], v[240:243], v[76:79]
    s_waitcnt vmcnt(2)
    v_mfma_f32_16x16x32_bf16 v[72:75], v[8:11], v[244:247], v[72:75]
    v_mfma_f32_16x16x32_bf16 v[76:79], v[12:15], v[244:247], v[76:79]
    s_waitcnt vmcnt(1)
    v_mfma_f32_16x16x32_bf16 v[72:75], v[8:11], v[248:251], v[72:75]
    v_mfma_f32_16x16x32_bf16 v[76:79], v[12:15], v[248:251], v[76:79]
    s_waitcnt vmcnt(0)
    v_mfma_f32_16x16x32_bf16 v[72:75], v[8:11], v[252:255], v[72:75]
    v_mfma_f32_16x16x32_bf16 v[76:79], v[12:15], v[252:255], v[76:79]
    s_mov_b32 s78, 28672
    s_nop 7
    s_nop 7
    v_cvt_pk_bf16_f32 v64, v64, v65
    v_cvt_pk_bf16_f32 v65, v66, v67
    v_cvt_pk_bf16_f32 v68, v68, v69
    v_cvt_pk_bf16_f32 v69, v70, v71
    buffer_store_dwordx2 v[64:65], v21, s[60:63], 0 offen offset:0
    buffer_store_dwordx2 v[68:69], v21, s[60:63], 0 offen offset:32
    s_nop 7
    s_nop 7
    v_cvt_pk_bf16_f32 v72, v72, v73
    v_cvt_pk_bf16_f32 v73, v74, v75
    v_cvt_pk_bf16_f32 v76, v76, v77
    v_cvt_pk_bf16_f32 v77, v78, v79
    buffer_store_dwordx2 v[72:73], v21, s[60:63], s78 offen offset:0
    buffer_store_dwordx2 v[76:77], v21, s[60:63], s78 offen offset:32
    s_branch L_fin
L_red1:
    s_waitcnt vmcnt(15)
    v_mfma_f32_16x16x32_bf16 v[64:67], v[8:11], v[128:131], 0
    v_mfma_f32_16x16x32_bf16 v[68:71], v[12:15], v[128:131], 0
    s_waitcnt vmcnt(14)
    v_mfma_f32_16x16x32_bf16 v[64:67], v[8:11], v[132:135], v[64:67]
    v_mfma_f32_16x16x32_bf16 v[68:71], v[12:15], v[132:135], v[68:71]
    s_waitcnt vmcnt(13)
    v_mfma_f32_16x16x32_bf16 v[64:67], v[8:11], v[136:139], v[64:67]
    v_mfma_f32_16x16x32_bf16 v[68:71], v[12:15], v[136:139], v[68:71]
    s_waitcnt vmcnt(12)
    v_mfma_f32_16x16x32_bf16 v[64:67], v[8:11], v[140:143], v[64:67]
    v_mfma_f32_16x16x32_bf16 v[68:71], v[12:15], v[140:143], v[68:71]
    s_waitcnt vmcnt(11)
    v_mfma_f32_16x16x32_bf16 v[64:67], v[8:11], v[144:147], v[64:67]
    v_mfma_f32_16x16x32_bf16 v[68:71], v[12:15], v[144:147], v[68:71]
    s_waitcnt vmcnt(10)
    v_mfma_f32_16x16x32_bf16 v[64:67], v[8:11], v[148:151], v[64:67]
    v_mfma_f32_16x16x32_bf16 v[68:71], v[12:15], v[148:151], v[68:71]
    s_waitcnt vmcnt(9)
    v_mfma_f32_16x16x32_bf16 v[64:67], v[8:11], v[152:155], v[64:67]
    v_mfma_f32_16x16x32_bf16 v[68:71], v[12:15], v[152:155], v[68:71]
    s_waitcnt vmcnt(8)
    v_mfma_f32_16x16x32_bf16 v[64:67], v[8:11], v[156:159], v[64:67]
    v_mfma_f32_16x16x32_bf16 v[68:71], v[12:15], v[156:159], v[68:71]
    s_waitcnt vmcnt(7)
    v_mfma_f32_16x16x32_bf16 v[64:67], v[8:11], v[160:163], v[64:67]
    v_mfma_f32_16x16x32_bf16 v[68:71], v[12:15], v[160:163], v[68:71]
    s_waitcnt vmcnt(6)
    v_mfma_f32_16x16x32_bf16 v[64:67], v[8:11], v[164:167], v[64:67]
    v_mfma_f32_16x16x32_bf16 v[68:71], v[12:15], v[164:167], v[68:71]
    s_waitcnt vmcnt(5)
    v_mfma_f32_16x16x32_bf16 v[64:67], v[8:11], v[168:171], v[64:67]
    v_mfma_f32_16x16x32_bf16 v[68:71], v[12:15], v[168:171], v[68:71]
    s_waitcnt vmcnt(4)
    v_mfma_f32_16x16x32_bf16 v[64:67], v[8:11], v[172:175], v[64:67]
    v_mfma_f32_16x16x32_bf16 v[68:71], v[12:15], v[172:175], v[68:71]
    s_waitcnt vmcnt(3)
    v_mfma_f32_16x16x32_bf16 v[64:67], v[8:11], v[176:179], v[64:67]
    v_mfma_f32_16x16x32_bf16 v[68:71], v[12:15], v[176:179], v[68:71]
    s_waitcnt vmcnt(2)
    v_mfma_f32_16x16x32_bf16 v[64:67], v[8:11], v[180:183], v[64:67]
    v_mfma_f32_16x16x32_bf16 v[68:71], v[12:15], v[180:183], v[68:71]
    s_waitcnt vmcnt(1)
    v_mfma_f32_16x16x32_bf16 v[64:67], v[8:11], v[184:187], v[64:67]
    v_mfma_f32_16x16x32_bf16 v[68:71], v[12:15], v[184:187], v[68:71]
    s_waitcnt vmcnt(0)
    v_mfma_f32_16x16x32_bf16 v[64:67], v[8:11], v[188:191], v[64:67]
    v_mfma_f32_16x16x32_bf16 v[68:71], v[12:15], v[188:191], v[68:71]
    s_nop 7
    s_nop 7
    v_cvt_pk_bf16_f32 v64, v64, v65
    v_cvt_pk_bf16_f32 v65, v66, v67
    v_cvt_pk_bf16_f32 v68, v68, v69
    v_cvt_pk_bf16_f32 v69, v70, v71
    buffer_store_dwordx2 v[64:65], v21, s[60:63], 0 offen offset:0
    buffer_store_dwordx2 v[68:69], v21, s[60:63], 0 offen offset:32
L_fin:
L_end:
    s_endpgm
L_codeend:
    s_endpgm
.section .rodata,"a"
.p2align 6
.amdhsa_kernel concat_heads__gqa_block_cached__mha_block_cached__near_ridge_kernel
  .amdhsa_next_free_vgpr 512
  .amdhsa_next_free_sgpr 102
  .amdhsa_accum_offset 256
  .amdhsa_group_segment_fixed_size 0
  .amdhsa_kernarg_size 104
  .amdhsa_user_sgpr_count 2
  .amdhsa_user_sgpr_kernarg_segment_ptr 1
  .amdhsa_system_sgpr_workgroup_id_x 1
.end_amdhsa_kernel
.p2align 6
```
